```python
import torch

def _softmax(x, axis=-1):
    return torch.softmax(x, dim=axis)

def _gelu(x):
    return torch.nn.functional.gelu(x, approximate='tanh')

def _silu(x):
    return torch.nn.functional.silu(x)

def _sigmoid(x):
    return torch.sigmoid(x)

def _layernorm(x, axis=-1, eps=1e-05):
    m = x.mean(dim=axis, keepdim=True)
    v = x.var(dim=axis, keepdim=True, unbiased=False)
    return (x - m) / torch.sqrt(v + eps)

def _scatter_add(tgt, idx, src, axis=0):
    return tgt.clone().index_add_(axis, idx, src)

def _segment_sum(src, seg, n):
    out = torch.zeros((n,) + src.shape[1:], dtype=src.dtype)
    return out.index_add_(0, seg, src)

def _pad(x, pw):
    flat = tuple((v for pair in reversed(pw) for v in pair))
    return torch.nn.functional.pad(x, flat)
kernel_name = 'interleave_layers__memory_aug_recurrent_mem_tr__glu_gated_reglu__prompt'

def setup_inputs():

    _w = lambda a: (lambda t: t.to(torch.bfloat16) if t.is_floating_point() else t)(torch.as_tensor(a))

    def _A_setup():
        B, S, Dm = (1, 2048, 512)
        H, Dh = (32, 128)
        M, seg = (8, 32)
        seg = min(seg, S)
        S = S // seg * seg
        return {'x': _w((lambda *s: torch.randn(*s, dtype=torch.bfloat16) * 0.05)(B, S, Dm)), 'mem0': _w((lambda *s: torch.randn(*s, dtype=torch.bfloat16) * 0.2)(B, M, Dm)), 'Wq': _w((lambda *s: torch.randn(*s, dtype=torch.bfloat16) * 1.6)(Dm, H, Dh) * Dm ** (-0.5)), 'Wk': _w((lambda *s: torch.randn(*s, dtype=torch.bfloat16) * 1.6)(Dm, H, Dh) * Dm ** (-0.5)), 'Wv': _w((lambda *s: torch.randn(*s, dtype=torch.bfloat16) * 0.2)(Dm, H, Dh) * Dm ** (-0.5)), 'Wo': _w((lambda *s: torch.randn(*s, dtype=torch.bfloat16) * 0.2)(H, Dh, Dm) * (H * Dh) ** (-0.5)), 'seg_len': seg}
    _A_in = _A_setup()

    def _B_setup():
        B, S, D, F = (1, 2048, 512, 1792)
        return {'x': _w((lambda *s: torch.randn(*s, dtype=torch.bfloat16) * 0.05)(B, S, D)), 'W_gate': _w((lambda *s: torch.randn(*s, dtype=torch.bfloat16) * 0.2)(D, F) * (2.0 / D) ** 0.5), 'W_up': _w((lambda *s: torch.randn(*s, dtype=torch.bfloat16) * 0.2)(D, F) * (2.0 / D) ** 0.5), 'W_down': _w((lambda *s: torch.randn(*s, dtype=torch.bfloat16) * 0.2)(F, D) * (1.0 / F) ** 0.5)}
    _B_in = _B_setup()
    return {'A_x': _A_in['x'], 'A_mem0': _A_in['mem0'], 'A_Wq': _A_in['Wq'], 'A_Wk': _A_in['Wk'], 'A_Wv': _A_in['Wv'], 'A_Wo': _A_in['Wo'], 'A_seg_len': _A_in['seg_len'], 'B_x': _B_in['x'], 'B_W_gate': _B_in['W_gate'], 'B_W_up': _B_in['W_up'], 'B_W_down': _B_in['W_down']}

def reference(A_x, A_mem0, A_Wq, A_Wk, A_Wv, A_Wo, A_seg_len, B_x, B_W_gate, B_W_up, B_W_down):

    def _A_ref(x, mem0, Wq, Wk, Wv, Wo, seg_len):
        B, S, Dm = x.shape
        H, Dh = (Wq.shape[1], Wq.shape[2])
        M = mem0.shape[1]
        scale = Dh ** (-0.5)
        n_seg = S // seg_len
        L = M + seg_len
        idx = torch.arange(L)
        mask = (idx[:, None] < M) | (idx[:, None] >= idx[None, :])
        mem = mem0
        outs = []
        for s in range(n_seg):
            xs = x[:, s * seg_len:(s + 1) * seg_len, :].clone()
            h = torch.concatenate([mem, xs], axis=1)
            q = torch.einsum('btd,dhe->bhte', h, Wq)
            k = torch.einsum('btd,dhe->bhte', h, Wk)
            v = torch.einsum('btd,dhe->bhte', h, Wv)
            scores = torch.einsum('bhqe,bhke->bhqk', q, k) * scale
            scores = torch.where(mask[None, None], scores, -1000000000.0)
            p = _softmax(scores, axis=-1)
            o = torch.einsum('bhqk,bhke->bhqe', p, v)
            o = torch.einsum('bhte,hed->btd', o, Wo)
            mem = o[:, :M, :].clone()
            outs.append(o[:, M:, :])
        return torch.concatenate(outs, axis=1)

    def _B_ref(x, W_gate, W_up, W_down):
        gate = torch.einsum('bsd,df->bsf', x, W_gate)
        up = torch.einsum('bsd,df->bsf', x, W_up)
        gate = gate * (lambda x, dt: x.to(dt))(gate > 0, gate.dtype)
        h = gate * up
        return torch.einsum('bsf,fd->bsd', h, W_down)
    x = A_x
    x = x + _A_ref(_layernorm(x, axis=-1), A_mem0, A_Wq, A_Wk, A_Wv, A_Wo, A_seg_len)
    x = x + _B_ref(_layernorm(x, axis=-1), B_W_gate, B_W_up, B_W_down)
    x = x + _A_ref(_layernorm(x, axis=-1), A_mem0, A_Wq, A_Wk, A_Wv, A_Wo, A_seg_len)
    x = x + _B_ref(_layernorm(x, axis=-1), B_W_gate, B_W_up, B_W_down)
    return x
```

```asm
; @launch grid=(256,1,1) block=(256,1,1) lds=163840
.amdgcn_target "amdgcn-amd-amdhsa--gfx950"
.text
.globl interleave_layers__memory_aug_recurrent_mem_tr__glu_gated_reglu__prompt_kernel
.p2align 8
.type interleave_layers__memory_aug_recurrent_mem_tr__glu_gated_reglu__prompt_kernel,@function
interleave_layers__memory_aug_recurrent_mem_tr__glu_gated_reglu__prompt_kernel:
  s_cmp_ge_u32 s2, 256
  s_cbranch_scc1 L_exit
  s_load_dwordx16 s[24:39], s[0:1], 0
  s_load_dwordx8 s[40:47], s[0:1], 64
  s_load_dwordx4 s[48:51], s[0:1], 96
  v_lshrrev_b32 v1, 6, v0
  s_nop 0
  v_readfirstlane_b32 s58, v1
  s_mov_b32 s72, 0
  s_waitcnt lgkmcnt(0)
  s_mov_b32 s4, s50
  s_and_b32 s5, s51, 0xffff
  s_mov_b32 s6, 0x10000000
  s_mov_b32 s7, 0x20000
  s_mov_b32 s8, s48
  s_and_b32 s9, s49, 0xffff
  s_mov_b32 s10, 0x100
  s_mov_b32 s11, 0x20000
  s_getreg_b32 s64, hwreg(HW_REG_XCC_ID)
  s_and_b32 s64, s64, 7
  s_lshr_b32 s65, s64, 1
  s_lshl_b32 s65, s65, 4
  s_and_b32 s61, s64, 1
  s_add_u32 s68, s65, s61
  s_lshl_b32 s65, s68, 2
  v_mov_b32 v1, 0
  v_mov_b32 v2, 1
  s_cmp_lg_u32 s58, 0
  s_cbranch_scc1 L_tk_1
  s_mov_b64 exec, 1
  buffer_atomic_add v2, v1, s[8:11], s65 offen sc0
  s_waitcnt vmcnt(0)
  ds_write_b32 v1, v2
  s_waitcnt lgkmcnt(0)
  s_mov_b64 exec, -1
L_tk_1:
  s_barrier
  ds_read_b32 v2, v1
  s_waitcnt lgkmcnt(0)
  v_readfirstlane_b32 s54, v2
  s_nop 3
  s_barrier
  v_and_b32 v3, 63, v0
  v_lshlrev_b32 v3, 2, v3
  s_cmp_ge_u32 s54, 32
  s_cbranch_scc1 L_ovf_2
  s_lshl_b32 s66, s64, 5
  s_add_u32 s66, s66, s54
L_pure_4:
  buffer_load_dword v4, v3, s[8:11], 0 offen sc1
  s_waitcnt vmcnt(0)
  v_readlane_b32 s61, v4, s68
  s_mov_b32 s86, 1
  s_nop 2
  s_cmp_ge_u32 s61, 32
  s_cbranch_scc1 L_slot_3
  s_mov_b32 s86, 0
  v_readlane_b32 s62, v4, 0
  v_readlane_b32 s61, v4, 1
  s_nop 1
  s_add_u32 s62, s62, s61
  v_readlane_b32 s61, v4, 16
  s_nop 1
  s_add_u32 s62, s62, s61
  v_readlane_b32 s61, v4, 17
  s_nop 1
  s_add_u32 s62, s62, s61
  v_readlane_b32 s61, v4, 32
  s_nop 1
  s_add_u32 s62, s62, s61
  v_readlane_b32 s61, v4, 33
  s_nop 1
  s_add_u32 s62, s62, s61
  v_readlane_b32 s61, v4, 48
  s_nop 1
  s_add_u32 s62, s62, s61
  v_readlane_b32 s61, v4, 49
  s_nop 1
  s_add_u32 s62, s62, s61
  s_cmp_ge_u32 s62, 256
  s_cbranch_scc1 L_slot_3
  s_add_u32 s72, s72, 1
  s_cmp_gt_u32 s72, 0x80000
  s_cbranch_scc1 L_exit
  s_branch L_pure_4
L_ovf_2:
  v_mov_b32 v1, 0
  v_mov_b32 v2, 1
  s_cmp_lg_u32 s58, 0
  s_cbranch_scc1 L_tk_5
  s_mov_b64 exec, 1
  buffer_atomic_add v2, v1, s[8:11], 12 offen sc0
  s_waitcnt vmcnt(0)
  ds_write_b32 v1, v2
  s_waitcnt lgkmcnt(0)
  s_mov_b64 exec, -1
L_tk_5:
  s_barrier
  ds_read_b32 v2, v1
  s_waitcnt lgkmcnt(0)
  v_readfirstlane_b32 s67, v2
  s_nop 3
  s_barrier
L_all_6:
  buffer_load_dword v4, v3, s[8:11], 0 offen sc1
  s_add_u32 s72, s72, 1
  s_cmp_gt_u32 s72, 0x80000
  s_cbranch_scc1 L_exit
  s_waitcnt vmcnt(0)
  v_readlane_b32 s62, v4, 0
  v_readlane_b32 s61, v4, 1
  s_nop 1
  s_add_u32 s62, s62, s61
  v_readlane_b32 s61, v4, 16
  s_nop 1
  s_add_u32 s62, s62, s61
  v_readlane_b32 s61, v4, 17
  s_nop 1
  s_add_u32 s62, s62, s61
  v_readlane_b32 s61, v4, 32
  s_nop 1
  s_add_u32 s62, s62, s61
  v_readlane_b32 s61, v4, 33
  s_nop 1
  s_add_u32 s62, s62, s61
  v_readlane_b32 s61, v4, 48
  s_nop 1
  s_add_u32 s62, s62, s61
  v_readlane_b32 s61, v4, 49
  s_nop 1
  s_add_u32 s62, s62, s61
  s_cmp_lt_u32 s62, 256
  s_cbranch_scc1 L_all_6
  s_mov_b32 s86, 0
  v_readlane_b32 s61, v4, 0
  s_nop 3
  s_min_u32 s61, s61, 32
  s_add_u32 s66, s61, s67
  s_cmp_ge_u32 s66, 32
  s_cbranch_scc1 L_fx_7
  s_add_u32 s66, s66, 0
  s_branch L_slot_3
L_fx_7:
  s_sub_u32 s67, s66, 32
  v_readlane_b32 s61, v4, 1
  s_nop 3
  s_min_u32 s61, s61, 32
  s_add_u32 s66, s61, s67
  s_cmp_ge_u32 s66, 32
  s_cbranch_scc1 L_fx_8
  s_add_u32 s66, s66, 32
  s_branch L_slot_3
L_fx_8:
  s_sub_u32 s67, s66, 32
  v_readlane_b32 s61, v4, 16
  s_nop 3
  s_min_u32 s61, s61, 32
  s_add_u32 s66, s61, s67
  s_cmp_ge_u32 s66, 32
  s_cbranch_scc1 L_fx_9
  s_add_u32 s66, s66, 64
  s_branch L_slot_3
L_fx_9:
  s_sub_u32 s67, s66, 32
  v_readlane_b32 s61, v4, 17
  s_nop 3
  s_min_u32 s61, s61, 32
  s_add_u32 s66, s61, s67
  s_cmp_ge_u32 s66, 32
  s_cbranch_scc1 L_fx_10
  s_add_u32 s66, s66, 96
  s_branch L_slot_3
L_fx_10:
  s_sub_u32 s67, s66, 32
  v_readlane_b32 s61, v4, 32
  s_nop 3
  s_min_u32 s61, s61, 32
  s_add_u32 s66, s61, s67
  s_cmp_ge_u32 s66, 32
  s_cbranch_scc1 L_fx_11
  s_add_u32 s66, s66, 128
  s_branch L_slot_3
L_fx_11:
  s_sub_u32 s67, s66, 32
  v_readlane_b32 s61, v4, 33
  s_nop 3
  s_min_u32 s61, s61, 32
  s_add_u32 s66, s61, s67
  s_cmp_ge_u32 s66, 32
  s_cbranch_scc1 L_fx_12
  s_add_u32 s66, s66, 160
  s_branch L_slot_3
L_fx_12:
  s_sub_u32 s67, s66, 32
  v_readlane_b32 s61, v4, 48
  s_nop 3
  s_min_u32 s61, s61, 32
  s_add_u32 s66, s61, s67
  s_cmp_ge_u32 s66, 32
  s_cbranch_scc1 L_fx_13
  s_add_u32 s66, s66, 192
  s_branch L_slot_3
L_fx_13:
  s_sub_u32 s67, s66, 32
  v_readlane_b32 s61, v4, 49
  s_nop 3
  s_min_u32 s61, s61, 32
  s_add_u32 s66, s61, s67
  s_cmp_ge_u32 s66, 32
  s_cbranch_scc1 L_fx_14
  s_add_u32 s66, s66, 224
  s_branch L_slot_3
L_fx_14:
  s_sub_u32 s67, s66, 32
  s_endpgm
L_slot_3:
  s_and_b32 s61, s66, 31
  s_lshr_b32 s62, s66, 5
  s_cmp_lg_u32 s62, 2
  s_cbranch_scc1 L_rmn_16
  s_mov_b32 s63, 104
  s_cmp_lt_u32 s61, 24
  s_cselect_b32 s63, 208, s63
  s_cmp_lt_u32 s61, 16
  s_cselect_b32 s63, 64, s63
  s_add_u32 s66, s61, s63
  s_branch L_rm_15
L_rmn_16:
  s_cmp_lg_u32 s62, 7
  s_cbranch_scc1 L_rmn_17
  s_mov_b32 s63, 112
  s_cmp_lt_u32 s61, 24
  s_cselect_b32 s63, 216, s63
  s_cmp_lt_u32 s61, 16
  s_cselect_b32 s63, 80, s63
  s_add_u32 s66, s61, s63
  s_branch L_rm_15
L_rmn_17:
  s_cmp_lg_u32 s62, 4
  s_cbranch_scc1 L_rmn_18
  s_mov_b32 s63, 120
  s_cmp_lt_u32 s61, 24
  s_cselect_b32 s63, 224, s63
  s_cmp_lt_u32 s61, 16
  s_cselect_b32 s63, 160, s63
  s_add_u32 s66, s61, s63
  s_branch L_rm_15
L_rmn_18:
  s_cmp_lg_u32 s62, 5
  s_cbranch_scc1 L_rmn_19
  s_mov_b32 s63, 128
  s_cmp_lt_u32 s61, 24
  s_cselect_b32 s63, 232, s63
  s_cmp_lt_u32 s61, 16
  s_cselect_b32 s63, 176, s63
  s_add_u32 s66, s61, s63
  s_branch L_rm_15
L_rmn_19:
L_rm_15:
  s_mov_b32 s97, s66
  s_cmp_lt_u32 s97, 32
  s_cbranch_scc1 L_dispatch
  s_mov_b32 s52, 0x1000000
  s_mov_b32 s53, 0x10000
  s_mov_b32 s75, 0x100000
  s_mov_b32 s55, 0
  s_mov_b32 s87, 0
  s_cmp_lt_u32 s97, 64
  s_cbranch_scc1 L_helper
  s_sub_u32 s66, s97, 64
  s_lshl_b32 s61, s66, 12
  v_lshlrev_b32 v1, 4, v0
  s_cmp_eq_u32 s66, 51
  s_cselect_b32 s62, 1, 0
  v_mov_b32 v4, s62
  v_mov_b32 v8, -1
  v_mov_b32 v5, s62
  v_mov_b32 v9, -1
  v_mov_b32 v6, s62
  v_mov_b32 v10, -1
  v_mov_b32 v7, s62
  v_mov_b32_e64 v11, -1
  buffer_store_dwordx4 v[4:7], v1, s[4:7], s61 offen sc1
  s_add_u32 s62, s61, 0x100000
  buffer_store_dwordx4 v[8:11], v1, s[4:7], s62 offen sc1
  s_add_u32 s62, s61, 0x1c0000
  buffer_store_dwordx4 v[8:11], v1, s[4:7], s62 offen sc1
  s_add_u32 s62, s61, 0x280000
  buffer_store_dwordx4 v[8:11], v1, s[4:7], s62 offen sc1
  s_and_b32 s62, s61, 0x7ffff
  s_add_u32 s62, s62, 0xd000000
  buffer_store_dwordx4 v[8:11], v1, s[4:7], s62 offen sc1
  s_add_u32 s62, s62, 0x800000
  buffer_store_dwordx4 v[8:11], v1, s[4:7], s62 offen sc1
  s_mov_b32 s52, 0x1000000
  s_mov_b32 s53, 0x10000
  s_mov_b32 s75, 0x100000
  s_lshr_b32 s55, s66, 2
  s_and_b32 s54, s66, 3
  s_mov_b32 s56, 48
  s_mov_b32 s57, 64
  v_mov_b32 v3, 0x0
  v_bfe_i32 v2, v0, 0, 1
  v_and_b32 v2, 0x10, v2
  v_add_u32 v3, v3, v2
  v_bfe_i32 v2, v0, 1, 1
  v_and_b32 v2, 0x20, v2
  v_add_u32 v3, v3, v2
  v_bfe_i32 v2, v0, 2, 1
  v_and_b32 v2, 0x40, v2
  v_add_u32 v3, v3, v2
  v_bfe_i32 v2, v0, 3, 1
  v_and_b32 v2, 0x100, v2
  v_add_u32 v3, v3, v2
  v_bfe_i32 v2, v0, 4, 1
  v_and_b32 v2, 0x200, v2
  v_add_u32 v3, v3, v2
  v_bfe_i32 v2, v0, 5, 1
  v_and_b32 v2, 0x400, v2
  v_add_u32 v3, v3, v2
  v_bfe_i32 v2, v0, 6, 1
  v_and_b32 v2, 0x1000, v2
  v_add_u32 v3, v3, v2
  v_bfe_i32 v2, v0, 7, 1
  v_and_b32 v2, 0x2000, v2
  v_add_u32 v3, v3, v2
  v_mov_b32 v4, 0x0
  v_bfe_i32 v2, v0, 0, 1
  v_and_b32 v2, 0x10, v2
  v_add_u32 v4, v4, v2
  v_bfe_i32 v2, v0, 1, 1
  v_and_b32 v2, 0x20, v2
  v_add_u32 v4, v4, v2
  v_bfe_i32 v2, v0, 2, 1
  v_and_b32 v2, 0x40, v2
  v_add_u32 v4, v4, v2
  v_bfe_i32 v2, v0, 3, 1
  v_and_b32 v2, 0x200, v2
  v_add_u32 v4, v4, v2
  v_bfe_i32 v2, v0, 4, 1
  v_and_b32 v2, 0x400, v2
  v_add_u32 v4, v4, v2
  v_bfe_i32 v2, v0, 5, 1
  v_and_b32 v2, 0x800, v2
  v_add_u32 v4, v4, v2
  v_bfe_i32 v2, v0, 6, 1
  v_and_b32 v2, 0x2000, v2
  v_add_u32 v4, v4, v2
  v_bfe_i32 v2, v0, 7, 1
  v_and_b32 v2, 0x4000, v2
  v_add_u32 v4, v4, v2
  v_add_u32 v5, 4096, v4
  v_mov_b32 v6, 0x0
  v_bfe_i32 v2, v0, 0, 1
  v_and_b32 v2, 0x400, v2
  v_add_u32 v6, v6, v2
  v_bfe_i32 v2, v0, 1, 1
  v_and_b32 v2, 0x800, v2
  v_add_u32 v6, v6, v2
  v_bfe_i32 v2, v0, 2, 1
  v_and_b32 v2, 0x1000, v2
  v_add_u32 v6, v6, v2
  v_bfe_i32 v2, v0, 3, 1
  v_and_b32 v2, 0x10, v2
  v_add_u32 v6, v6, v2
  v_bfe_i32 v2, v0, 4, 1
  v_and_b32 v2, 0x20, v2
  v_add_u32 v6, v6, v2
  v_bfe_i32 v2, v0, 5, 1
  v_and_b32 v2, 0x40, v2
  v_add_u32 v6, v6, v2
  v_bfe_i32 v2, v0, 6, 1
  v_and_b32 v2, 0x100, v2
  v_add_u32 v6, v6, v2
  v_bfe_i32 v2, v0, 7, 1
  v_and_b32 v2, 0x200, v2
  v_add_u32 v6, v6, v2
  v_mov_b32 v8, 0x0
  v_bfe_i32 v2, v0, 6, 1
  v_and_b32 v2, 0x10, v2
  v_add_u32 v8, v8, v2
  v_bfe_i32 v2, v0, 7, 1
  v_and_b32 v2, 0x20, v2
  v_add_u32 v8, v8, v2
  v_mov_b32 v9, 0x0
  v_bfe_i32 v2, v0, 0, 1
  v_and_b32 v2, 0x10, v2
  v_add_u32 v9, v9, v2
  v_bfe_i32 v2, v0, 1, 1
  v_and_b32 v2, 0x20, v2
  v_add_u32 v9, v9, v2
  v_bfe_i32 v2, v0, 2, 1
  v_and_b32 v2, 0x40, v2
  v_add_u32 v9, v9, v2
  v_bfe_i32 v2, v0, 6, 1
  v_and_b32 v2, 0x4, v2
  v_add_u32 v9, v9, v2
  v_bfe_i32 v2, v0, 7, 1
  v_and_b32 v2, 0x8, v2
  v_add_u32 v9, v9, v2
  v_mov_b32 v10, 0x0
  v_bfe_i32 v2, v0, 0, 1
  v_and_b32 v2, 0x10, v2
  v_add_u32 v10, v10, v2
  v_bfe_i32 v2, v0, 1, 1
  v_and_b32 v2, 0x20, v2
  v_add_u32 v10, v10, v2
  v_bfe_i32 v2, v0, 2, 1
  v_and_b32 v2, 0x40, v2
  v_add_u32 v10, v10, v2
  v_mov_b32_e64 v11, 1
  s_mov_b32 s12, s24
  s_and_b32 s13, s25, 0xffff
  s_mov_b32 s14, 0x200000
  s_mov_b32 s15, 0x20000
  s_mov_b32 s59, 0
  s_mov_b32 s88, 0
L_R_20:
  s_cmp_eq_u32 s59, 1
  s_cbranch_scc1 L_rh_21
  s_lshl_b32 s62, s55, 15
  s_lshl_b32 s61, s54, 13
  s_add_u32 s62, s62, s61
  buffer_load_dwordx4 v[40:43], v6, s[12:15], s62 offen
  buffer_load_dwordx4 v[44:47], v6, s[12:15], s62 offen offset:128
  s_waitcnt vmcnt(0)
  s_branch L_rj_22
L_rh_21:
  s_waitcnt vmcnt(2)
L_rj_22:
  s_mov_b32 s59, 0
  s_add_u32 s74, s55, s56
  s_lshl_b32 s76, s55, 15
  s_lshl_b32 s61, s54, 7
  s_add_u32 s76, s76, s61
  s_add_u32 s76, s76, s52
  s_lshl_b32 s77, s55, 15
  s_lshl_b32 s61, s54, 13
  s_add_u32 s77, s77, s61
  v_lshlrev_b32 v48, 16, v40
  v_and_b32 v49, 0xffff0000, v40
  v_lshlrev_b32 v50, 16, v41
  v_and_b32 v51, 0xffff0000, v41
  v_lshlrev_b32 v52, 16, v42
  v_and_b32 v53, 0xffff0000, v42
  v_lshlrev_b32 v54, 16, v43
  v_and_b32 v55, 0xffff0000, v43
  v_lshlrev_b32 v56, 16, v44
  v_and_b32 v57, 0xffff0000, v44
  v_lshlrev_b32 v58, 16, v45
  v_and_b32 v59, 0xffff0000, v45
  v_lshlrev_b32 v60, 16, v46
  v_and_b32 v61, 0xffff0000, v46
  v_lshlrev_b32 v62, 16, v47
  v_and_b32 v63, 0xffff0000, v47
  v_mov_b32 v32, v40
  v_mov_b32 v33, v41
  v_mov_b32 v34, v42
  v_mov_b32 v35, v43
  v_mov_b32 v36, v44
  v_mov_b32 v37, v45
  v_mov_b32 v38, v46
  v_mov_b32_e64 v39, v47
  s_add_u32 s62, s76, 0x5800000
  buffer_store_dwordx4 v[32:35], v4, s[4:7], s62 offen sc1
  buffer_store_dwordx4 v[36:39], v5, s[4:7], s62 offen sc1
  v_pk_add_f32 v[100:101], v[48:49], v[50:51]
  v_pk_add_f32 v[102:103], v[52:53], v[54:55]
  v_pk_add_f32 v[100:101], v[100:101], v[56:57]
  v_pk_add_f32 v[102:103], v[102:103], v[58:59]
  v_pk_add_f32 v[100:101], v[100:101], v[60:61]
  v_pk_add_f32 v[102:103], v[102:103], v[62:63]
  v_pk_add_f32 v[100:101], v[100:101], v[102:103]
  v_add_f32 v96, v100, v101
  s_nop 1
  v_add_f32_dpp v96, v96, v96 row_ror:8 row_mask:0xf bank_mask:0xf
  v_mov_b32 v100, v96
  s_nop 1
  v_permlane16_swap_b32 v96, v100
  s_nop 0
  v_add_f32 v96, v96, v100
  v_mov_b32 v100, v96
  s_nop 1
  v_permlane32_swap_b32 v96, v100
  s_nop 0
  v_add_f32 v96, v96, v100
  v_mul_f32 v96, 0x3c000000, v96
  v_sub_f32 v64, v48, v96
  v_sub_f32 v65, v49, v96
  v_sub_f32 v66, v50, v96
  v_sub_f32 v67, v51, v96
  v_sub_f32 v68, v52, v96
  v_sub_f32 v69, v53, v96
  v_sub_f32 v70, v54, v96
  v_sub_f32 v71, v55, v96
  v_sub_f32 v72, v56, v96
  v_sub_f32 v73, v57, v96
  v_sub_f32 v74, v58, v96
  v_sub_f32 v75, v59, v96
  v_sub_f32 v76, v60, v96
  v_sub_f32 v77, v61, v96
  v_sub_f32 v78, v62, v96
  v_sub_f32 v79, v63, v96
  v_pk_mul_f32 v[64:65], v[64:65], v[64:65]
  v_pk_mul_f32 v[66:67], v[66:67], v[66:67]
  v_pk_mul_f32 v[68:69], v[68:69], v[68:69]
  v_pk_mul_f32 v[70:71], v[70:71], v[70:71]
  v_pk_mul_f32 v[72:73], v[72:73], v[72:73]
  v_pk_mul_f32 v[74:75], v[74:75], v[74:75]
  v_pk_mul_f32 v[76:77], v[76:77], v[76:77]
  v_pk_mul_f32 v[78:79], v[78:79], v[78:79]
  v_pk_add_f32 v[100:101], v[64:65], v[66:67]
  v_pk_add_f32 v[102:103], v[68:69], v[70:71]
  v_pk_add_f32 v[100:101], v[100:101], v[72:73]
  v_pk_add_f32 v[102:103], v[102:103], v[74:75]
  v_pk_add_f32 v[100:101], v[100:101], v[76:77]
  v_pk_add_f32 v[102:103], v[102:103], v[78:79]
  v_pk_add_f32 v[100:101], v[100:101], v[102:103]
  v_add_f32 v97, v100, v101
  s_nop 1
  v_add_f32_dpp v97, v97, v97 row_ror:8 row_mask:0xf bank_mask:0xf
  v_mov_b32 v100, v97
  s_nop 1
  v_permlane16_swap_b32 v97, v100
  s_nop 0
  v_add_f32 v97, v97, v100
  v_mov_b32 v100, v97
  s_nop 1
  v_permlane32_swap_b32 v97, v100
  s_nop 0
  v_add_f32 v97, v97, v100
  s_mov_b64 exec, 0xff
  ds_write_b32 v9, v96
  ds_write_b32 v9, v97 offset:128
  s_mov_b64 exec, -1
  s_waitcnt lgkmcnt(0)
  s_barrier
  ds_read_b128 v[64:67], v10
  ds_read_b128 v[68:71], v10 offset:128
  v_xor_b32 v9, 256, v9
  v_xor_b32 v10, 256, v10
  s_waitcnt lgkmcnt(0)
  v_pk_add_f32 v[100:101], v[64:65], v[66:67]
  v_pk_add_f32 v[68:69], v[68:69], v[70:71]
  v_add_f32 v98, v100, v101
  v_add_f32 v96, v68, v69
  v_mul_f32 v98, 0x3e800000, v98
  v_mul_f32 v96, 0x3b000000, v96
  v_sub_f32 v64, v64, v98
  v_sub_f32 v65, v65, v98
  v_sub_f32 v66, v66, v98
  v_sub_f32 v67, v67, v98
  v_mul_f32 v68, v64, v64
  v_fmac_f32 v68, v65, v65
  v_fmac_f32 v68, v66, v66
  v_fmac_f32 v68, v67, v67
  v_fmac_f32 v96, 0x3e800000, v68
  v_cvt_pk_bf16_f32 v97, v98, v96
  v_lshlrev_b32_e64 v98, 16, v97
  v_and_b32 v96, 0xffff0000, v97
  v_add_f32 v96, 0x3727c5ac, v96
  v_cvt_pk_bf16_f32 v96, v96, v96
  v_lshlrev_b32 v96, 16, v96
  v_sqrt_f32 v96, v96
  s_nop 0
  v_cvt_pk_bf16_f32 v96, v96, v96
  v_lshlrev_b32 v96, 16, v96
  v_rcp_f32 v96, v96
  v_sub_f32 v64, v48, v98
  v_sub_f32 v65, v49, v98
  v_sub_f32 v66, v50, v98
  v_sub_f32 v67, v51, v98
  v_sub_f32 v68, v52, v98
  v_sub_f32 v69, v53, v98
  v_sub_f32 v70, v54, v98
  v_sub_f32 v71, v55, v98
  v_sub_f32 v72, v56, v98
  v_sub_f32 v73, v57, v98
  v_sub_f32 v74, v58, v98
  v_sub_f32 v75, v59, v98
  v_sub_f32 v76, v60, v98
  v_sub_f32 v77, v61, v98
  v_sub_f32 v78, v62, v98
  v_sub_f32_e64 v79, v63, v98
  v_cvt_pk_bf16_f32 v104, v64, v65
  v_cvt_pk_bf16_f32 v105, v66, v67
  v_cvt_pk_bf16_f32 v106, v68, v69
  v_cvt_pk_bf16_f32 v107, v70, v71
  v_cvt_pk_bf16_f32 v108, v72, v73
  v_cvt_pk_bf16_f32 v109, v74, v75
  v_cvt_pk_bf16_f32 v110, v76, v77
  v_cvt_pk_bf16_f32 v111, v78, v79
  v_lshlrev_b32 v64, 16, v104
  v_and_b32 v65, 0xffff0000, v104
  v_lshlrev_b32 v66, 16, v105
  v_and_b32 v67, 0xffff0000, v105
  v_lshlrev_b32 v68, 16, v106
  v_and_b32 v69, 0xffff0000, v106
  v_lshlrev_b32 v70, 16, v107
  v_and_b32 v71, 0xffff0000, v107
  v_lshlrev_b32 v72, 16, v108
  v_and_b32 v73, 0xffff0000, v108
  v_lshlrev_b32 v74, 16, v109
  v_and_b32 v75, 0xffff0000, v109
  v_lshlrev_b32 v76, 16, v110
  v_and_b32 v77, 0xffff0000, v110
  v_lshlrev_b32 v78, 16, v111
  v_and_b32 v79, 0xffff0000, v111
  v_pk_mul_f32 v[64:65], v[64:65], v[96:97] op_sel_hi:[1,0]
  v_pk_mul_f32 v[66:67], v[66:67], v[96:97] op_sel_hi:[1,0]
  v_pk_mul_f32 v[68:69], v[68:69], v[96:97] op_sel_hi:[1,0]
  v_pk_mul_f32 v[70:71], v[70:71], v[96:97] op_sel_hi:[1,0]
  v_pk_mul_f32 v[72:73], v[72:73], v[96:97] op_sel_hi:[1,0]
  v_pk_mul_f32 v[74:75], v[74:75], v[96:97] op_sel_hi:[1,0]
  v_pk_mul_f32 v[76:77], v[76:77], v[96:97] op_sel_hi:[1,0]
  v_pk_mul_f32 v[78:79], v[78:79], v[96:97] op_sel_hi:[1,0]
  v_cvt_pk_bf16_f32 v104, v64, v65
  v_cvt_pk_bf16_f32 v105, v66, v67
  v_cvt_pk_bf16_f32 v106, v68, v69
  v_cvt_pk_bf16_f32 v107, v70, v71
  v_cvt_pk_bf16_f32 v108, v72, v73
  v_cvt_pk_bf16_f32 v109, v74, v75
  v_cvt_pk_bf16_f32 v110, v76, v77
  v_cvt_pk_bf16_f32 v111, v78, v79
  s_add_u32 s62, s76, 0x5a00000
  buffer_store_dwordx4 v[104:107], v4, s[4:7], s62 offen sc1
  buffer_store_dwordx4 v[108:111], v5, s[4:7], s62 offen sc1
  s_lshl_b32 s61, s55, 6
  s_lshl_b32 s62, s54, 2
  s_add_u32 s61, s61, s62
  s_add_u32 s61, s61, s53
  s_mov_b32 s55, s74
  s_cmp_lt_u32 s55, s57
  s_cbranch_scc1 L_R_20
  s_waitcnt vmcnt(0)
  s_cmp_eq_u32 s88, 0
  s_cbranch_scc1 L_nofl_23
  s_mov_b64 exec, 1
  buffer_store_dword v11, v8, s[4:7], s88 offen sc1
  s_mov_b64 exec, -1
  s_mov_b32 s88, 0
L_nofl_23:
  s_barrier
  s_mov_b32 s8, s48
  s_and_b32 s9, s49, 0xffff
  s_mov_b32 s10, 0x100
  s_mov_b32 s11, 0x20000
  v_mov_b32 v1, 0
  v_mov_b32 v2, 1
  s_cmp_lg_u32 s58, 0
  s_cbranch_scc1 L_arr_24
  s_mov_b64 exec, 1
  s_and_b32 s61, s97, 3
  s_lshl_b32 s61, s61, 6
  buffer_atomic_add v2, v1, s[8:11], s61 offen offset:8
  s_mov_b64 exec, -1
L_arr_24:
  s_cmp_lt_u32 s97, 128
  s_cbranch_scc1 L_dispatch
  s_cmp_ge_u32 s97, 224
  s_cbranch_scc1 L_dispatch
  s_lshr_b32 s55, s97, 5
  s_sub_u32 s55, s55, 3
  s_cmp_eq_u32 s55, 1
  s_cselect_b32 s87, 5, s55
L_helper:
  s_and_b32 s54, s97, 31
  s_mov_b32 s56, 4
  s_mov_b32 s57, 32
  s_branch B_s1
L_dispatch:
  s_cmp_ge_u32 s97, 240
  s_cbranch_scc1 L_late_26
  s_cmp_lt_u32 s97, 32
  s_cbranch_scc1 L_go_25
  s_cmp_ge_u32 s97, 64
  s_cbranch_scc1 L_go_25
L_late_26:
  s_mov_b32 s8, s48
  s_and_b32 s9, s49, 0xffff
  s_mov_b32 s10, 0x100
  s_mov_b32 s11, 0x20000
  v_and_b32 v1, 3, v0
  v_lshlrev_b32 v1, 6, v1
L_gate_27:
  buffer_load_dword v4, v1, s[8:11], 0 offen offset:8 sc1
  s_waitcnt vmcnt(0)
  v_cmp_gt_u32 vcc, 48, v4
  s_cbranch_vccz L_gateok_28
  s_add_u32 s72, s72, 1
  s_cmp_gt_u32 s72, 0x80000
  s_cbranch_scc1 L_exit
  s_sleep 2
  s_branch L_gate_27
L_gateok_28:
  v_mov_b32 v1, 0
  s_mov_b32 s61, 0xd000000
L_lk_29:
  s_sleep 8
  buffer_load_dword v4, v1, s[4:7], s61 offen sc1
  s_add_u32 s72, s72, 1
  s_cmp_gt_u32 s72, 0x80000
  s_cbranch_scc1 L_exit
  s_waitcnt vmcnt(0)
  v_cmp_eq_u32 vcc, -1, v4
  s_cbranch_vccnz L_lk_29
L_go_25:
  s_mov_b32 s55, 0
  s_mov_b32 s56, 1
  s_mov_b32 s57, 64
  s_cmp_ge_u32 s97, 32
  s_cbranch_scc1 L_rt_30
  s_cmp_lt_u32 s97, 0
  s_cbranch_scc1 L_exit
  s_mov_b32 s52, 0x1000000
  s_mov_b32 s53, 0x10000
  s_mov_b32 s75, 0x100000
  s_sub_u32 s54, s97, 0
  s_cmp_eq_u32 s86, 1
  s_cbranch_scc1 B_chain_f
  s_branch B_chain
L_rt_30:
  s_cmp_ge_u32 s97, 64
  s_cbranch_scc1 L_rt_31
  s_cmp_lt_u32 s97, 32
  s_cbranch_scc1 L_exit
  s_mov_b32 s52, 0x7000000
  s_mov_b32 s53, 0x50000
  s_mov_b32 s75, 0x1c2000
  s_sub_u32 s54, s97, 32
  s_cmp_eq_u32 s86, 1
  s_cbranch_scc1 B_chain_f
  s_branch B_chain
L_rt_31:
  s_cmp_ge_u32 s97, 96
  s_cbranch_scc1 L_rt_32
  s_cmp_lt_u32 s97, 64
  s_cbranch_scc1 L_exit
  s_mov_b32 s52, 0x1000000
  s_mov_b32 s53, 0x10000
  s_mov_b32 s75, 0x100000
  s_sub_u32 s54, s97, 64
  s_cmp_eq_u32 s86, 1
  s_cbranch_scc1 B_s2_f
  s_branch B_s2
L_rt_32:
  s_cmp_ge_u32 s97, 100
  s_cbranch_scc1 L_rt_33
  s_cmp_lt_u32 s97, 96
  s_cbranch_scc1 L_exit
  s_mov_b32 s52, 0x1000000
  s_mov_b32 s53, 0x10000
  s_mov_b32 s75, 0x100000
  s_sub_u32 s54, s97, 96
  s_cmp_eq_u32 s86, 1
  s_cbranch_scc1 B_r3_f
  s_branch B_r3
L_rt_33:
  s_cmp_ge_u32 s97, 114
  s_cbranch_scc1 L_rt_34
  s_cmp_lt_u32 s97, 100
  s_cbranch_scc1 L_exit
  s_mov_b32 s52, 0x1000000
  s_mov_b32 s53, 0x10000
  s_mov_b32 s75, 0x100000
  s_sub_u32 s54, s97, 100
  s_cmp_eq_u32 s86, 1
  s_cbranch_scc1 B_s4_f
  s_branch B_s4
L_rt_34:
  s_cmp_ge_u32 s97, 122
  s_cbranch_scc1 L_rt_35
  s_cmp_lt_u32 s97, 114
  s_cbranch_scc1 L_exit
  s_mov_b32 s52, 0x1000000
  s_mov_b32 s53, 0x10000
  s_mov_b32 s75, 0x100000
  s_sub_u32 s54, s97, 114
  s_lshr_b32 s73, s54, 2
  s_and_b32 s54, s54, 3
  s_cmp_eq_u32 s86, 1
  s_cbranch_scc1 B_s5_f
  s_branch B_s5
L_rt_35:
  s_cmp_ge_u32 s97, 126
  s_cbranch_scc1 L_rt_36
  s_cmp_lt_u32 s97, 122
  s_cbranch_scc1 L_exit
  s_mov_b32 s52, 0x1000000
  s_mov_b32 s53, 0x10000
  s_mov_b32 s75, 0x100000
  s_sub_u32 s54, s97, 122
  s_branch B_r5
L_rt_36:
  s_cmp_ge_u32 s97, 160
  s_cbranch_scc1 L_rt_37
  s_cmp_lt_u32 s97, 128
  s_cbranch_scc1 L_exit
  s_mov_b32 s52, 0x7000000
  s_mov_b32 s53, 0x50000
  s_mov_b32 s75, 0x1c2000
  s_sub_u32 s54, s97, 128
  s_branch B_s1
L_rt_37:
  s_cmp_ge_u32 s97, 192
  s_cbranch_scc1 L_rt_38
  s_cmp_lt_u32 s97, 160
  s_cbranch_scc1 L_exit
  s_mov_b32 s52, 0x7000000
  s_mov_b32 s53, 0x50000
  s_mov_b32 s75, 0x1c2000
  s_sub_u32 s54, s97, 160
  s_cmp_eq_u32 s86, 1
  s_cbranch_scc1 B_s2_f
  s_branch B_s2
L_rt_38:
  s_cmp_ge_u32 s97, 196
  s_cbranch_scc1 L_rt_39
  s_cmp_lt_u32 s97, 192
  s_cbranch_scc1 L_exit
  s_mov_b32 s52, 0x7000000
  s_mov_b32 s53, 0x50000
  s_mov_b32 s75, 0x1c2000
  s_sub_u32 s54, s97, 192
  s_cmp_eq_u32 s86, 1
  s_cbranch_scc1 B_r3_f
  s_branch B_r3
L_rt_39:
  s_cmp_ge_u32 s97, 210
  s_cbranch_scc1 L_rt_40
  s_cmp_lt_u32 s97, 196
  s_cbranch_scc1 L_exit
  s_mov_b32 s52, 0x7000000
  s_mov_b32 s53, 0x50000
  s_mov_b32 s75, 0x1c2000
  s_sub_u32 s54, s97, 196
  s_cmp_eq_u32 s86, 1
  s_cbranch_scc1 B_s4_f
  s_branch B_s4
L_rt_40:
  s_cmp_ge_u32 s97, 218
  s_cbranch_scc1 L_rt_41
  s_cmp_lt_u32 s97, 210
  s_cbranch_scc1 L_exit
  s_mov_b32 s52, 0x7000000
  s_mov_b32 s53, 0x50000
  s_mov_b32 s75, 0x1c2000
  s_sub_u32 s54, s97, 210
  s_lshr_b32 s73, s54, 2
  s_and_b32 s54, s54, 3
  s_cmp_eq_u32 s86, 1
  s_cbranch_scc1 B_s5_f
  s_branch B_s5
L_rt_41:
  s_cmp_ge_u32 s97, 222
  s_cbranch_scc1 L_rt_42
  s_cmp_lt_u32 s97, 218
  s_cbranch_scc1 L_exit
  s_mov_b32 s52, 0x7000000
  s_mov_b32 s53, 0x50000
  s_mov_b32 s75, 0x1c2000
  s_sub_u32 s54, s97, 218
  s_branch B_r5f
L_rt_42:
  s_cmp_ge_u32 s97, 240
  s_cbranch_scc1 L_rt_43
  s_cmp_lt_u32 s97, 224
  s_cbranch_scc1 L_exit
  s_mov_b32 s52, 0x1000000
  s_mov_b32 s53, 0x10000
  s_mov_b32 s75, 0x100000
  s_sub_u32 s54, s97, 224
  s_lshr_b32 s73, s54, 2
  s_and_b32 s54, s54, 3
  s_branch B_s3
L_rt_43:
  s_cmp_ge_u32 s97, 256
  s_cbranch_scc1 L_rt_44
  s_cmp_lt_u32 s97, 240
  s_cbranch_scc1 L_exit
  s_mov_b32 s52, 0x7000000
  s_mov_b32 s53, 0x50000
  s_mov_b32 s75, 0x1c2000
  s_sub_u32 s54, s97, 240
  s_lshr_b32 s73, s54, 2
  s_and_b32 s54, s54, 3
  s_branch B_s3
L_rt_44:
  s_endpgm
B_ln0:
  v_mov_b32 v3, 0x0
  v_bfe_i32 v2, v0, 0, 1
  v_and_b32 v2, 0x10, v2
  v_add_u32 v3, v3, v2
  v_bfe_i32 v2, v0, 1, 1
  v_and_b32 v2, 0x20, v2
  v_add_u32 v3, v3, v2
  v_bfe_i32 v2, v0, 2, 1
  v_and_b32 v2, 0x40, v2
  v_add_u32 v3, v3, v2
  v_bfe_i32 v2, v0, 3, 1
  v_and_b32 v2, 0x100, v2
  v_add_u32 v3, v3, v2
  v_bfe_i32 v2, v0, 4, 1
  v_and_b32 v2, 0x200, v2
  v_add_u32 v3, v3, v2
  v_bfe_i32 v2, v0, 5, 1
  v_and_b32 v2, 0x400, v2
  v_add_u32 v3, v3, v2
  v_bfe_i32 v2, v0, 6, 1
  v_and_b32 v2, 0x1000, v2
  v_add_u32 v3, v3, v2
  v_bfe_i32 v2, v0, 7, 1
  v_and_b32 v2, 0x2000, v2
  v_add_u32 v3, v3, v2
  v_mov_b32 v4, 0x0
  v_bfe_i32 v2, v0, 0, 1
  v_and_b32 v2, 0x10, v2
  v_add_u32 v4, v4, v2
  v_bfe_i32 v2, v0, 1, 1
  v_and_b32 v2, 0x20, v2
  v_add_u32 v4, v4, v2
  v_bfe_i32 v2, v0, 2, 1
  v_and_b32 v2, 0x40, v2
  v_add_u32 v4, v4, v2
  v_bfe_i32 v2, v0, 3, 1
  v_and_b32 v2, 0x200, v2
  v_add_u32 v4, v4, v2
  v_bfe_i32 v2, v0, 4, 1
  v_and_b32 v2, 0x400, v2
  v_add_u32 v4, v4, v2
  v_bfe_i32 v2, v0, 5, 1
  v_and_b32 v2, 0x800, v2
  v_add_u32 v4, v4, v2
  v_bfe_i32 v2, v0, 6, 1
  v_and_b32 v2, 0x2000, v2
  v_add_u32 v4, v4, v2
  v_bfe_i32 v2, v0, 7, 1
  v_and_b32 v2, 0x4000, v2
  v_add_u32 v4, v4, v2
  v_add_u32 v5, 4096, v4
  v_mov_b32 v6, 0x0
  v_bfe_i32 v2, v0, 0, 1
  v_and_b32 v2, 0x400, v2
  v_add_u32 v6, v6, v2
  v_bfe_i32 v2, v0, 1, 1
  v_and_b32 v2, 0x800, v2
  v_add_u32 v6, v6, v2
  v_bfe_i32 v2, v0, 2, 1
  v_and_b32 v2, 0x1000, v2
  v_add_u32 v6, v6, v2
  v_bfe_i32 v2, v0, 3, 1
  v_and_b32 v2, 0x10, v2
  v_add_u32 v6, v6, v2
  v_bfe_i32 v2, v0, 4, 1
  v_and_b32 v2, 0x20, v2
  v_add_u32 v6, v6, v2
  v_bfe_i32 v2, v0, 5, 1
  v_and_b32 v2, 0x40, v2
  v_add_u32 v6, v6, v2
  v_bfe_i32 v2, v0, 6, 1
  v_and_b32 v2, 0x100, v2
  v_add_u32 v6, v6, v2
  v_bfe_i32 v2, v0, 7, 1
  v_and_b32 v2, 0x200, v2
  v_add_u32 v6, v6, v2
  v_mov_b32 v8, 0x0
  v_bfe_i32 v2, v0, 6, 1
  v_and_b32 v2, 0x10, v2
  v_add_u32 v8, v8, v2
  v_bfe_i32 v2, v0, 7, 1
  v_and_b32 v2, 0x20, v2
  v_add_u32 v8, v8, v2
  v_mov_b32 v9, 0x0
  v_bfe_i32 v2, v0, 0, 1
  v_and_b32 v2, 0x10, v2
  v_add_u32 v9, v9, v2
  v_bfe_i32 v2, v0, 1, 1
  v_and_b32 v2, 0x20, v2
  v_add_u32 v9, v9, v2
  v_bfe_i32 v2, v0, 2, 1
  v_and_b32 v2, 0x40, v2
  v_add_u32 v9, v9, v2
  v_bfe_i32 v2, v0, 6, 1
  v_and_b32 v2, 0x4, v2
  v_add_u32 v9, v9, v2
  v_bfe_i32 v2, v0, 7, 1
  v_and_b32 v2, 0x8, v2
  v_add_u32 v9, v9, v2
  v_mov_b32 v10, 0x0
  v_bfe_i32 v2, v0, 0, 1
  v_and_b32 v2, 0x10, v2
  v_add_u32 v10, v10, v2
  v_bfe_i32 v2, v0, 1, 1
  v_and_b32 v2, 0x20, v2
  v_add_u32 v10, v10, v2
  v_bfe_i32 v2, v0, 2, 1
  v_and_b32 v2, 0x40, v2
  v_add_u32 v10, v10, v2
  v_mov_b32_e64 v11, 1
  s_mov_b32 s12, s24
  s_and_b32 s13, s25, 0xffff
  s_mov_b32 s14, 0x200000
  s_mov_b32 s15, 0x20000
  s_mov_b32 s59, 0
  s_mov_b32 s88, 0
L_R_45:
  s_cmp_eq_u32 s59, 1
  s_cbranch_scc1 L_rh_46
  s_lshl_b32 s62, s55, 15
  s_lshl_b32 s61, s54, 13
  s_add_u32 s62, s62, s61
  buffer_load_dwordx4 v[40:43], v6, s[12:15], s62 offen
  buffer_load_dwordx4 v[44:47], v6, s[12:15], s62 offen offset:128
  s_waitcnt vmcnt(0)
  s_branch L_rj_47
L_rh_46:
  s_waitcnt vmcnt(2)
L_rj_47:
  s_mov_b32 s59, 0
  s_add_u32 s74, s55, s56
  s_lshl_b32 s76, s55, 15
  s_lshl_b32 s61, s54, 7
  s_add_u32 s76, s76, s61
  s_add_u32 s76, s76, s52
  s_lshl_b32 s77, s55, 15
  s_lshl_b32 s61, s54, 13
  s_add_u32 s77, s77, s61
  v_lshlrev_b32 v48, 16, v40
  v_and_b32 v49, 0xffff0000, v40
  v_lshlrev_b32 v50, 16, v41
  v_and_b32 v51, 0xffff0000, v41
  v_lshlrev_b32 v52, 16, v42
  v_and_b32 v53, 0xffff0000, v42
  v_lshlrev_b32 v54, 16, v43
  v_and_b32 v55, 0xffff0000, v43
  v_lshlrev_b32 v56, 16, v44
  v_and_b32 v57, 0xffff0000, v44
  v_lshlrev_b32 v58, 16, v45
  v_and_b32 v59, 0xffff0000, v45
  v_lshlrev_b32 v60, 16, v46
  v_and_b32 v61, 0xffff0000, v46
  v_lshlrev_b32 v62, 16, v47
  v_and_b32 v63, 0xffff0000, v47
  v_mov_b32 v32, v40
  v_mov_b32 v33, v41
  v_mov_b32 v34, v42
  v_mov_b32 v35, v43
  v_mov_b32 v36, v44
  v_mov_b32 v37, v45
  v_mov_b32 v38, v46
  v_mov_b32_e64 v39, v47
  s_add_u32 s62, s76, 0x5800000
  buffer_store_dwordx4 v[32:35], v4, s[4:7], s62 offen sc1
  buffer_store_dwordx4 v[36:39], v5, s[4:7], s62 offen sc1
  v_pk_add_f32 v[100:101], v[48:49], v[50:51]
  v_pk_add_f32 v[102:103], v[52:53], v[54:55]
  v_pk_add_f32 v[100:101], v[100:101], v[56:57]
  v_pk_add_f32 v[102:103], v[102:103], v[58:59]
  v_pk_add_f32 v[100:101], v[100:101], v[60:61]
  v_pk_add_f32 v[102:103], v[102:103], v[62:63]
  v_pk_add_f32 v[100:101], v[100:101], v[102:103]
  v_add_f32 v96, v100, v101
  s_nop 1
  v_add_f32_dpp v96, v96, v96 row_ror:8 row_mask:0xf bank_mask:0xf
  v_mov_b32 v100, v96
  s_nop 1
  v_permlane16_swap_b32 v96, v100
  s_nop 0
  v_add_f32 v96, v96, v100
  v_mov_b32 v100, v96
  s_nop 1
  v_permlane32_swap_b32 v96, v100
  s_nop 0
  v_add_f32 v96, v96, v100
  v_mul_f32 v96, 0x3c000000, v96
  v_sub_f32 v64, v48, v96
  v_sub_f32 v65, v49, v96
  v_sub_f32 v66, v50, v96
  v_sub_f32 v67, v51, v96
  v_sub_f32 v68, v52, v96
  v_sub_f32 v69, v53, v96
  v_sub_f32 v70, v54, v96
  v_sub_f32 v71, v55, v96
  v_sub_f32 v72, v56, v96
  v_sub_f32 v73, v57, v96
  v_sub_f32 v74, v58, v96
  v_sub_f32 v75, v59, v96
  v_sub_f32 v76, v60, v96
  v_sub_f32 v77, v61, v96
  v_sub_f32 v78, v62, v96
  v_sub_f32 v79, v63, v96
  v_pk_mul_f32 v[64:65], v[64:65], v[64:65]
  v_pk_mul_f32 v[66:67], v[66:67], v[66:67]
  v_pk_mul_f32 v[68:69], v[68:69], v[68:69]
  v_pk_mul_f32 v[70:71], v[70:71], v[70:71]
  v_pk_mul_f32 v[72:73], v[72:73], v[72:73]
  v_pk_mul_f32 v[74:75], v[74:75], v[74:75]
  v_pk_mul_f32 v[76:77], v[76:77], v[76:77]
  v_pk_mul_f32 v[78:79], v[78:79], v[78:79]
  v_pk_add_f32 v[100:101], v[64:65], v[66:67]
  v_pk_add_f32 v[102:103], v[68:69], v[70:71]
  v_pk_add_f32 v[100:101], v[100:101], v[72:73]
  v_pk_add_f32 v[102:103], v[102:103], v[74:75]
  v_pk_add_f32 v[100:101], v[100:101], v[76:77]
  v_pk_add_f32 v[102:103], v[102:103], v[78:79]
  v_pk_add_f32 v[100:101], v[100:101], v[102:103]
  v_add_f32 v97, v100, v101
  s_nop 1
  v_add_f32_dpp v97, v97, v97 row_ror:8 row_mask:0xf bank_mask:0xf
  v_mov_b32 v100, v97
  s_nop 1
  v_permlane16_swap_b32 v97, v100
  s_nop 0
  v_add_f32 v97, v97, v100
  v_mov_b32 v100, v97
  s_nop 1
  v_permlane32_swap_b32 v97, v100
  s_nop 0
  v_add_f32 v97, v97, v100
  s_mov_b64 exec, 0xff
  ds_write_b32 v9, v96
  ds_write_b32 v9, v97 offset:128
  s_mov_b64 exec, -1
  s_waitcnt lgkmcnt(0)
  s_barrier
  ds_read_b128 v[64:67], v10
  ds_read_b128 v[68:71], v10 offset:128
  v_xor_b32 v9, 256, v9
  v_xor_b32 v10, 256, v10
  s_waitcnt lgkmcnt(0)
  v_pk_add_f32 v[100:101], v[64:65], v[66:67]
  v_pk_add_f32 v[68:69], v[68:69], v[70:71]
  v_add_f32 v98, v100, v101
  v_add_f32 v96, v68, v69
  v_mul_f32 v98, 0x3e800000, v98
  v_mul_f32 v96, 0x3b000000, v96
  v_sub_f32 v64, v64, v98
  v_sub_f32 v65, v65, v98
  v_sub_f32 v66, v66, v98
  v_sub_f32 v67, v67, v98
  v_mul_f32 v68, v64, v64
  v_fmac_f32 v68, v65, v65
  v_fmac_f32 v68, v66, v66
  v_fmac_f32 v68, v67, v67
  v_fmac_f32 v96, 0x3e800000, v68
  v_cvt_pk_bf16_f32 v97, v98, v96
  v_lshlrev_b32_e64 v98, 16, v97
  v_and_b32 v96, 0xffff0000, v97
  v_add_f32 v96, 0x3727c5ac, v96
  v_cvt_pk_bf16_f32 v96, v96, v96
  v_lshlrev_b32 v96, 16, v96
  v_sqrt_f32 v96, v96
  s_nop 0
  v_cvt_pk_bf16_f32 v96, v96, v96
  v_lshlrev_b32 v96, 16, v96
  v_rcp_f32 v96, v96
  v_sub_f32 v64, v48, v98
  v_sub_f32 v65, v49, v98
  v_sub_f32 v66, v50, v98
  v_sub_f32 v67, v51, v98
  v_sub_f32 v68, v52, v98
  v_sub_f32 v69, v53, v98
  v_sub_f32 v70, v54, v98
  v_sub_f32 v71, v55, v98
  v_sub_f32 v72, v56, v98
  v_sub_f32 v73, v57, v98
  v_sub_f32 v74, v58, v98
  v_sub_f32 v75, v59, v98
  v_sub_f32 v76, v60, v98
  v_sub_f32 v77, v61, v98
  v_sub_f32 v78, v62, v98
  v_sub_f32_e64 v79, v63, v98
  v_cvt_pk_bf16_f32 v104, v64, v65
  v_cvt_pk_bf16_f32 v105, v66, v67
  v_cvt_pk_bf16_f32 v106, v68, v69
  v_cvt_pk_bf16_f32 v107, v70, v71
  v_cvt_pk_bf16_f32 v108, v72, v73
  v_cvt_pk_bf16_f32 v109, v74, v75
  v_cvt_pk_bf16_f32 v110, v76, v77
  v_cvt_pk_bf16_f32 v111, v78, v79
  v_lshlrev_b32 v64, 16, v104
  v_and_b32 v65, 0xffff0000, v104
  v_lshlrev_b32 v66, 16, v105
  v_and_b32 v67, 0xffff0000, v105
  v_lshlrev_b32 v68, 16, v106
  v_and_b32 v69, 0xffff0000, v106
  v_lshlrev_b32 v70, 16, v107
  v_and_b32 v71, 0xffff0000, v107
  v_lshlrev_b32 v72, 16, v108
  v_and_b32 v73, 0xffff0000, v108
  v_lshlrev_b32 v74, 16, v109
  v_and_b32 v75, 0xffff0000, v109
  v_lshlrev_b32 v76, 16, v110
  v_and_b32 v77, 0xffff0000, v110
  v_lshlrev_b32 v78, 16, v111
  v_and_b32 v79, 0xffff0000, v111
  v_pk_mul_f32 v[64:65], v[64:65], v[96:97] op_sel_hi:[1,0]
  v_pk_mul_f32 v[66:67], v[66:67], v[96:97] op_sel_hi:[1,0]
  v_pk_mul_f32 v[68:69], v[68:69], v[96:97] op_sel_hi:[1,0]
  v_pk_mul_f32 v[70:71], v[70:71], v[96:97] op_sel_hi:[1,0]
  v_pk_mul_f32 v[72:73], v[72:73], v[96:97] op_sel_hi:[1,0]
  v_pk_mul_f32 v[74:75], v[74:75], v[96:97] op_sel_hi:[1,0]
  v_pk_mul_f32 v[76:77], v[76:77], v[96:97] op_sel_hi:[1,0]
  v_pk_mul_f32 v[78:79], v[78:79], v[96:97] op_sel_hi:[1,0]
  v_cvt_pk_bf16_f32 v104, v64, v65
  v_cvt_pk_bf16_f32 v105, v66, v67
  v_cvt_pk_bf16_f32 v106, v68, v69
  v_cvt_pk_bf16_f32 v107, v70, v71
  v_cvt_pk_bf16_f32 v108, v72, v73
  v_cvt_pk_bf16_f32 v109, v74, v75
  v_cvt_pk_bf16_f32 v110, v76, v77
  v_cvt_pk_bf16_f32 v111, v78, v79
  s_add_u32 s62, s76, 0x5a00000
  buffer_store_dwordx4 v[104:107], v4, s[4:7], s62 offen sc1
  buffer_store_dwordx4 v[108:111], v5, s[4:7], s62 offen sc1
  s_lshl_b32 s61, s55, 6
  s_lshl_b32 s62, s54, 2
  s_add_u32 s61, s61, s62
  s_add_u32 s61, s61, s53
  s_add_u32 s88, s61, 0x23000
  s_mov_b32 s55, s74
  s_cmp_lt_u32 s55, s57
  s_cbranch_scc1 L_R_45
  s_waitcnt vmcnt(0)
  s_cmp_eq_u32 s88, 0
  s_cbranch_scc1 L_nofl_48
  s_mov_b64 exec, 1
  buffer_store_dword v11, v8, s[4:7], s88 offen sc1
  s_mov_b64 exec, -1
  s_mov_b32 s88, 0
L_nofl_48:
  s_endpgm
B_r3:
  v_mov_b32 v3, 0x0
  v_bfe_i32 v2, v0, 0, 1
  v_and_b32 v2, 0x10, v2
  v_add_u32 v3, v3, v2
  v_bfe_i32 v2, v0, 1, 1
  v_and_b32 v2, 0x20, v2
  v_add_u32 v3, v3, v2
  v_bfe_i32 v2, v0, 2, 1
  v_and_b32 v2, 0x40, v2
  v_add_u32 v3, v3, v2
  v_bfe_i32 v2, v0, 3, 1
  v_and_b32 v2, 0x8, v2
  v_add_u32 v3, v3, v2
  v_bfe_i32 v2, v0, 4, 1
  v_and_b32 v2, 0x100, v2
  v_add_u32 v3, v3, v2
  v_bfe_i32 v2, v0, 5, 1
  v_and_b32 v2, 0x200, v2
  v_add_u32 v3, v3, v2
  v_bfe_i32 v2, v0, 6, 1
  v_and_b32 v2, 0x800, v2
  v_add_u32 v3, v3, v2
  v_bfe_i32 v2, v0, 7, 1
  v_and_b32 v2, 0x1000, v2
  v_add_u32 v3, v3, v2
  v_mov_b32 v4, 0x0
  v_bfe_i32 v2, v0, 0, 1
  v_and_b32 v2, 0x10, v2
  v_add_u32 v4, v4, v2
  v_bfe_i32 v2, v0, 1, 1
  v_and_b32 v2, 0x20, v2
  v_add_u32 v4, v4, v2
  v_bfe_i32 v2, v0, 2, 1
  v_and_b32 v2, 0x40, v2
  v_add_u32 v4, v4, v2
  v_bfe_i32 v2, v0, 3, 1
  v_and_b32 v2, 0x200, v2
  v_add_u32 v4, v4, v2
  v_bfe_i32 v2, v0, 4, 1
  v_and_b32 v2, 0x400, v2
  v_add_u32 v4, v4, v2
  v_bfe_i32 v2, v0, 5, 1
  v_and_b32 v2, 0x800, v2
  v_add_u32 v4, v4, v2
  v_bfe_i32 v2, v0, 6, 1
  v_and_b32 v2, 0x2000, v2
  v_add_u32 v4, v4, v2
  v_bfe_i32 v2, v0, 7, 1
  v_and_b32 v2, 0x4000, v2
  v_add_u32 v4, v4, v2
  v_add_u32 v5, 4096, v4
  v_mov_b32 v6, 0x0
  v_bfe_i32 v2, v0, 0, 1
  v_and_b32 v2, 0x400, v2
  v_add_u32 v6, v6, v2
  v_bfe_i32 v2, v0, 1, 1
  v_and_b32 v2, 0x800, v2
  v_add_u32 v6, v6, v2
  v_bfe_i32 v2, v0, 2, 1
  v_and_b32 v2, 0x1000, v2
  v_add_u32 v6, v6, v2
  v_bfe_i32 v2, v0, 3, 1
  v_and_b32 v2, 0x10, v2
  v_add_u32 v6, v6, v2
  v_bfe_i32 v2, v0, 4, 1
  v_and_b32 v2, 0x20, v2
  v_add_u32 v6, v6, v2
  v_bfe_i32 v2, v0, 5, 1
  v_and_b32 v2, 0x40, v2
  v_add_u32 v6, v6, v2
  v_bfe_i32 v2, v0, 6, 1
  v_and_b32 v2, 0x100, v2
  v_add_u32 v6, v6, v2
  v_bfe_i32 v2, v0, 7, 1
  v_and_b32 v2, 0x200, v2
  v_add_u32 v6, v6, v2
  v_mov_b32 v7, 0x0
  v_bfe_i32 v2, v0, 0, 1
  v_and_b32 v2, 0x4, v2
  v_add_u32 v7, v7, v2
  v_bfe_i32 v2, v0, 1, 1
  v_and_b32 v2, 0x8, v2
  v_add_u32 v7, v7, v2
  v_bfe_i32 v2, v0, 2, 1
  v_and_b32 v2, 0x10, v2
  v_add_u32 v7, v7, v2
  v_bfe_i32 v2, v0, 3, 1
  v_and_b32 v2, 0x20, v2
  v_add_u32 v7, v7, v2
  v_bfe_i32 v2, v0, 6, 1
  v_and_b32 v2, 0x40, v2
  v_add_u32 v7, v7, v2
  v_bfe_i32 v2, v0, 7, 1
  v_and_b32 v2, 0x80, v2
  v_add_u32 v7, v7, v2
  v_mov_b32 v8, 0x0
  v_bfe_i32 v2, v0, 6, 1
  v_and_b32 v2, 0x10, v2
  v_add_u32 v8, v8, v2
  v_bfe_i32 v2, v0, 7, 1
  v_and_b32 v2, 0x20, v2
  v_add_u32 v8, v8, v2
  v_mov_b32 v13, 0x0
  v_bfe_i32 v2, v0, 0, 1
  v_and_b32 v2, 0x4, v2
  v_add_u32 v13, v13, v2
  v_bfe_i32 v2, v0, 1, 1
  v_and_b32 v2, 0x8, v2
  v_add_u32 v13, v13, v2
  v_bfe_i32 v2, v0, 2, 1
  v_and_b32 v2, 0x10, v2
  v_add_u32 v13, v13, v2
  v_bfe_i32 v2, v0, 3, 1
  v_and_b32 v2, 0x20, v2
  v_add_u32 v13, v13, v2
  v_mov_b32 v9, 0x0
  v_bfe_i32 v2, v0, 0, 1
  v_and_b32 v2, 0x10, v2
  v_add_u32 v9, v9, v2
  v_bfe_i32 v2, v0, 1, 1
  v_and_b32 v2, 0x20, v2
  v_add_u32 v9, v9, v2
  v_bfe_i32 v2, v0, 2, 1
  v_and_b32 v2, 0x40, v2
  v_add_u32 v9, v9, v2
  v_bfe_i32 v2, v0, 6, 1
  v_and_b32 v2, 0x4, v2
  v_add_u32 v9, v9, v2
  v_bfe_i32 v2, v0, 7, 1
  v_and_b32 v2, 0x8, v2
  v_add_u32 v9, v9, v2
  v_mov_b32 v10, 0x0
  v_bfe_i32 v2, v0, 0, 1
  v_and_b32 v2, 0x10, v2
  v_add_u32 v10, v10, v2
  v_bfe_i32 v2, v0, 1, 1
  v_and_b32 v2, 0x20, v2
  v_add_u32 v10, v10, v2
  v_bfe_i32 v2, v0, 2, 1
  v_and_b32 v2, 0x40, v2
  v_add_u32 v10, v10, v2
  v_mov_b32_e64 v11, 1
  s_mov_b32 s59, 0
  s_mov_b32 s88, 0
  s_mov_b32 s8, s48
  s_and_b32 s9, s49, 0xffff
  s_mov_b32 s10, 0x100
  s_mov_b32 s11, 0x20000
  v_and_b32 v2, 3, v0
  v_lshlrev_b32 v2, 6, v2
L_gate_49:
  buffer_load_dword v12, v2, s[8:11], 0 offen offset:8 sc1
  s_waitcnt vmcnt(0)
  v_cmp_gt_u32 vcc, 48, v12
  s_cbranch_vccz L_gateok_50
  s_add_u32 s72, s72, 1
  s_cmp_gt_u32 s72, 0x80000
  s_cbranch_scc1 L_exit
  s_sleep 2
  s_branch L_gate_49
L_gateok_50:
L_R_51:
  s_cmp_eq_u32 s59, 1
  s_cbranch_scc1 L_rh_52
L_rp_54:
  s_lshl_b32 s61, s55, 8
  s_add_u32 s61, s61, s53
  s_add_u32 s61, s61, 0x18000
  buffer_load_dword v12, v7, s[4:7], s61 offen sc1
  s_sub_u32 s63, s55, 8
  s_lshl_b32 s63, s63, 6
  s_add_u32 s63, s63, s53
  s_add_u32 s63, s63, 0x63000
  s_cmp_lt_u32 s55, 8
  s_cselect_b32 s63, 0x33000, s63
  buffer_load_dword v14, v13, s[4:7], s63 offen sc1
  s_waitcnt vmcnt(0)
  s_cmp_eq_u32 s88, 0
  s_cbranch_scc1 L_nofl_56
  s_mov_b64 exec, 1
  buffer_store_dword v11, v8, s[4:7], s88 offen sc1
  s_mov_b64 exec, -1
  s_mov_b32 s88, 0
L_nofl_56:
  v_min_u32 v12, v12, v14
  v_cmp_eq_u32 vcc, 0, v12
  s_cbranch_vccz L_rpo_55
  s_add_u32 s72, s72, 1
  s_cmp_gt_u32 s72, 0x80000
  s_cbranch_scc1 L_exit
  s_branch L_rp_54
L_rpo_55:
  s_lshl_b32 s61, s55, 18
  s_lshl_b32 s62, s54, 13
  s_add_u32 s61, s61, s62
  s_add_u32 s61, s61, s52
  s_add_u32 s61, s61, 0x3000000
  buffer_load_dwordx2 v[16:17], v3, s[4:7], s61 offen offset:0 sc1
  buffer_load_dwordx2 v[18:19], v3, s[4:7], s61 offen offset:128 sc1
  buffer_load_dwordx2 v[20:21], v3, s[4:7], s61 offen offset:1024 sc1
  buffer_load_dwordx2 v[22:23], v3, s[4:7], s61 offen offset:1152 sc1
  s_add_u32 s61, s61, 0x8000
  buffer_load_dwordx2 v[32:33], v3, s[4:7], s61 offen offset:0 sc1
  buffer_load_dwordx2 v[34:35], v3, s[4:7], s61 offen offset:128 sc1
  buffer_load_dwordx2 v[36:37], v3, s[4:7], s61 offen offset:1024 sc1
  buffer_load_dwordx2 v[38:39], v3, s[4:7], s61 offen offset:1152 sc1
  s_add_u32 s61, s61, 0x8000
  buffer_load_dwordx2 v[48:49], v3, s[4:7], s61 offen offset:0 sc1
  buffer_load_dwordx2 v[50:51], v3, s[4:7], s61 offen offset:128 sc1
  buffer_load_dwordx2 v[52:53], v3, s[4:7], s61 offen offset:1024 sc1
  buffer_load_dwordx2 v[54:55], v3, s[4:7], s61 offen offset:1152 sc1
  s_add_u32 s61, s61, 0x8000
  buffer_load_dwordx2 v[64:65], v3, s[4:7], s61 offen offset:0 sc1
  buffer_load_dwordx2 v[66:67], v3, s[4:7], s61 offen offset:128 sc1
  buffer_load_dwordx2 v[68:69], v3, s[4:7], s61 offen offset:1024 sc1
  buffer_load_dwordx2 v[70:71], v3, s[4:7], s61 offen offset:1152 sc1
  s_lshl_b32 s62, s55, 15
  s_lshl_b32 s61, s54, 7
  s_add_u32 s62, s62, s61
  s_add_u32 s62, s62, s52
  s_add_u32 s62, s62, 0x5800000
  buffer_load_dwordx4 v[88:91], v4, s[4:7], s62 offen sc1
  buffer_load_dwordx4 v[92:95], v5, s[4:7], s62 offen sc1
  s_waitcnt vmcnt(0)
  s_branch L_rj_53
L_rh_52:
  s_waitcnt vmcnt(2)
L_rj_53:
  s_mov_b32 s59, 0
  s_add_u32 s74, s55, s56
  s_min_u32 s62, s74, 63
  s_lshl_b32 s61, s62, 8
  s_add_u32 s61, s61, s53
  s_add_u32 s61, s61, 0x18000
  buffer_load_dword v12, v7, s[4:7], s61 offen sc1
  s_sub_u32 s63, s62, 8
  s_lshl_b32 s63, s63, 6
  s_add_u32 s63, s63, s53
  s_add_u32 s63, s63, 0x63000
  s_cmp_lt_u32 s62, 8
  s_cselect_b32 s63, 0x33000, s63
  buffer_load_dword v14, v13, s[4:7], s63 offen sc1
  s_and_b32 s76, s55, 7
  s_lshl_b32 s76, s76, 15
  s_lshl_b32 s61, s54, 7
  s_add_u32 s76, s76, s61
  s_add_u32 s76, s76, s52
  s_lshl_b32 s77, s55, 15
  s_lshl_b32 s61, s54, 13
  s_add_u32 s77, s77, s61
  v_lshlrev_b32 v96, 16, v88
  v_and_b32 v97, 0xffff0000, v88
  v_lshlrev_b32 v98, 16, v89
  v_and_b32 v99, 0xffff0000, v89
  v_lshlrev_b32 v100, 16, v90
  v_and_b32 v101, 0xffff0000, v90
  v_lshlrev_b32 v102, 16, v91
  v_and_b32 v103, 0xffff0000, v91
  v_lshlrev_b32 v104, 16, v92
  v_and_b32 v105, 0xffff0000, v92
  v_lshlrev_b32 v106, 16, v93
  v_and_b32 v107, 0xffff0000, v93
  v_lshlrev_b32 v108, 16, v94
  v_and_b32 v109, 0xffff0000, v94
  v_lshlrev_b32 v110, 16, v95
  v_and_b32 v111, 0xffff0000, v95
  v_lshlrev_b32 v112, 16, v16
  v_and_b32 v113, 0xffff0000, v16
  v_lshlrev_b32 v114, 16, v17
  v_and_b32 v115, 0xffff0000, v17
  v_lshlrev_b32 v116, 16, v18
  v_and_b32 v117, 0xffff0000, v18
  v_lshlrev_b32 v118, 16, v19
  v_and_b32 v119, 0xffff0000, v19
  v_lshlrev_b32 v120, 16, v20
  v_and_b32 v121, 0xffff0000, v20
  v_lshlrev_b32 v122, 16, v21
  v_and_b32 v123, 0xffff0000, v21
  v_lshlrev_b32 v124, 16, v22
  v_and_b32 v125, 0xffff0000, v22
  v_lshlrev_b32 v126, 16, v23
  v_and_b32 v127, 0xffff0000, v23
  v_lshlrev_b32 v128, 16, v32
  v_and_b32 v129, 0xffff0000, v32
  v_lshlrev_b32 v130, 16, v33
  v_and_b32 v131, 0xffff0000, v33
  v_lshlrev_b32 v132, 16, v34
  v_and_b32 v133, 0xffff0000, v34
  v_lshlrev_b32 v134, 16, v35
  v_and_b32 v135, 0xffff0000, v35
  v_lshlrev_b32 v136, 16, v36
  v_and_b32 v137, 0xffff0000, v36
  v_lshlrev_b32 v138, 16, v37
  v_and_b32 v139, 0xffff0000, v37
  v_lshlrev_b32 v140, 16, v38
  v_and_b32 v141, 0xffff0000, v38
  v_lshlrev_b32_e64 v142, 16, v39
  v_and_b32 v143, 0xffff0000, v39
  v_pk_add_f32 v[112:113], v[112:113], v[128:129]
  v_pk_add_f32 v[114:115], v[114:115], v[130:131]
  v_pk_add_f32 v[116:117], v[116:117], v[132:133]
  v_pk_add_f32 v[118:119], v[118:119], v[134:135]
  v_pk_add_f32 v[120:121], v[120:121], v[136:137]
  v_pk_add_f32 v[122:123], v[122:123], v[138:139]
  v_pk_add_f32 v[124:125], v[124:125], v[140:141]
  v_pk_add_f32 v[126:127], v[126:127], v[142:143]
  v_lshlrev_b32 v128, 16, v48
  v_and_b32 v129, 0xffff0000, v48
  v_lshlrev_b32 v130, 16, v49
  v_and_b32 v131, 0xffff0000, v49
  v_lshlrev_b32 v132, 16, v50
  v_and_b32 v133, 0xffff0000, v50
  v_lshlrev_b32 v134, 16, v51
  v_and_b32 v135, 0xffff0000, v51
  v_lshlrev_b32 v136, 16, v52
  v_and_b32 v137, 0xffff0000, v52
  v_lshlrev_b32 v138, 16, v53
  v_and_b32 v139, 0xffff0000, v53
  v_lshlrev_b32 v140, 16, v54
  v_and_b32 v141, 0xffff0000, v54
  v_lshlrev_b32 v142, 16, v55
  v_and_b32 v143, 0xffff0000, v55
  v_pk_add_f32 v[112:113], v[112:113], v[128:129]
  v_pk_add_f32 v[114:115], v[114:115], v[130:131]
  v_pk_add_f32 v[116:117], v[116:117], v[132:133]
  v_pk_add_f32 v[118:119], v[118:119], v[134:135]
  v_pk_add_f32 v[120:121], v[120:121], v[136:137]
  v_pk_add_f32 v[122:123], v[122:123], v[138:139]
  v_pk_add_f32 v[124:125], v[124:125], v[140:141]
  v_pk_add_f32 v[126:127], v[126:127], v[142:143]
  v_lshlrev_b32 v128, 16, v64
  v_and_b32 v129, 0xffff0000, v64
  v_lshlrev_b32 v130, 16, v65
  v_and_b32 v131, 0xffff0000, v65
  v_lshlrev_b32 v132, 16, v66
  v_and_b32 v133, 0xffff0000, v66
  v_lshlrev_b32 v134, 16, v67
  v_and_b32 v135, 0xffff0000, v67
  v_lshlrev_b32 v136, 16, v68
  v_and_b32 v137, 0xffff0000, v68
  v_lshlrev_b32 v138, 16, v69
  v_and_b32 v139, 0xffff0000, v69
  v_lshlrev_b32 v140, 16, v70
  v_and_b32 v141, 0xffff0000, v70
  v_lshlrev_b32 v142, 16, v71
  v_and_b32 v143, 0xffff0000, v71
  v_pk_add_f32 v[112:113], v[112:113], v[128:129]
  v_pk_add_f32 v[114:115], v[114:115], v[130:131]
  v_pk_add_f32 v[116:117], v[116:117], v[132:133]
  v_pk_add_f32 v[118:119], v[118:119], v[134:135]
  v_pk_add_f32 v[120:121], v[120:121], v[136:137]
  v_pk_add_f32 v[122:123], v[122:123], v[138:139]
  v_pk_add_f32 v[124:125], v[124:125], v[140:141]
  v_pk_add_f32 v[126:127], v[126:127], v[142:143]
  v_cvt_pk_bf16_f32 v152, v112, v113
  v_cvt_pk_bf16_f32 v153, v114, v115
  v_cvt_pk_bf16_f32 v154, v116, v117
  v_cvt_pk_bf16_f32 v155, v118, v119
  v_cvt_pk_bf16_f32 v156, v120, v121
  v_cvt_pk_bf16_f32 v157, v122, v123
  v_cvt_pk_bf16_f32 v158, v124, v125
  v_cvt_pk_bf16_f32 v159, v126, v127
  v_lshlrev_b32 v112, 16, v152
  v_and_b32 v113, 0xffff0000, v152
  v_lshlrev_b32 v114, 16, v153
  v_and_b32 v115, 0xffff0000, v153
  v_lshlrev_b32 v116, 16, v154
  v_and_b32 v117, 0xffff0000, v154
  v_lshlrev_b32 v118, 16, v155
  v_and_b32 v119, 0xffff0000, v155
  v_lshlrev_b32 v120, 16, v156
  v_and_b32 v121, 0xffff0000, v156
  v_lshlrev_b32 v122, 16, v157
  v_and_b32 v123, 0xffff0000, v157
  v_lshlrev_b32 v124, 16, v158
  v_and_b32 v125, 0xffff0000, v158
  v_lshlrev_b32 v126, 16, v159
  v_and_b32 v127, 0xffff0000, v159
  v_pk_add_f32 v[96:97], v[96:97], v[112:113]
  v_pk_add_f32 v[98:99], v[98:99], v[114:115]
  v_pk_add_f32 v[100:101], v[100:101], v[116:117]
  v_pk_add_f32 v[102:103], v[102:103], v[118:119]
  v_pk_add_f32 v[104:105], v[104:105], v[120:121]
  v_pk_add_f32 v[106:107], v[106:107], v[122:123]
  v_pk_add_f32 v[108:109], v[108:109], v[124:125]
  v_pk_add_f32 v[110:111], v[110:111], v[126:127]
  v_cvt_pk_bf16_f32 v80, v96, v97
  v_cvt_pk_bf16_f32 v81, v98, v99
  v_cvt_pk_bf16_f32 v82, v100, v101
  v_cvt_pk_bf16_f32 v83, v102, v103
  v_cvt_pk_bf16_f32 v84, v104, v105
  v_cvt_pk_bf16_f32 v85, v106, v107
  v_cvt_pk_bf16_f32 v86, v108, v109
  v_cvt_pk_bf16_f32 v87, v110, v111
  s_add_u32 s62, s76, 0x5c00000
  buffer_store_dwordx4 v[80:83], v4, s[4:7], s62 offen sc1
  buffer_store_dwordx4 v[84:87], v5, s[4:7], s62 offen sc1
  v_lshlrev_b32 v96, 16, v80
  v_and_b32 v97, 0xffff0000, v80
  v_lshlrev_b32 v98, 16, v81
  v_and_b32 v99, 0xffff0000, v81
  v_lshlrev_b32 v100, 16, v82
  v_and_b32 v101, 0xffff0000, v82
  v_lshlrev_b32 v102, 16, v83
  v_and_b32 v103, 0xffff0000, v83
  v_lshlrev_b32 v104, 16, v84
  v_and_b32 v105, 0xffff0000, v84
  v_lshlrev_b32 v106, 16, v85
  v_and_b32 v107, 0xffff0000, v85
  v_lshlrev_b32 v108, 16, v86
  v_and_b32 v109, 0xffff0000, v86
  v_lshlrev_b32 v110, 16, v87
  v_and_b32 v111, 0xffff0000, v87
  v_pk_add_f32 v[148:149], v[96:97], v[98:99]
  v_pk_add_f32 v[150:151], v[100:101], v[102:103]
  v_pk_add_f32 v[148:149], v[148:149], v[104:105]
  v_pk_add_f32 v[150:151], v[150:151], v[106:107]
  v_pk_add_f32 v[148:149], v[148:149], v[108:109]
  v_pk_add_f32 v[150:151], v[150:151], v[110:111]
  v_pk_add_f32 v[148:149], v[148:149], v[150:151]
  v_add_f32 v144, v148, v149
  s_nop 1
  v_add_f32_dpp v144, v144, v144 row_ror:8 row_mask:0xf bank_mask:0xf
  v_mov_b32 v148, v144
  s_nop 1
  v_permlane16_swap_b32 v144, v148
  s_nop 0
  v_add_f32 v144, v144, v148
  v_mov_b32 v148, v144
  s_nop 1
  v_permlane32_swap_b32 v144, v148
  s_nop 0
  v_add_f32 v144, v144, v148
  v_mul_f32 v144, 0x3c000000, v144
  v_sub_f32 v112, v96, v144
  v_sub_f32 v113, v97, v144
  v_sub_f32 v114, v98, v144
  v_sub_f32 v115, v99, v144
  v_sub_f32 v116, v100, v144
  v_sub_f32 v117, v101, v144
  v_sub_f32 v118, v102, v144
  v_sub_f32 v119, v103, v144
  v_sub_f32 v120, v104, v144
  v_sub_f32 v121, v105, v144
  v_sub_f32 v122, v106, v144
  v_sub_f32 v123, v107, v144
  v_sub_f32 v124, v108, v144
  v_sub_f32 v125, v109, v144
  v_sub_f32 v126, v110, v144
  v_sub_f32 v127, v111, v144
  v_pk_mul_f32 v[112:113], v[112:113], v[112:113]
  v_pk_mul_f32 v[114:115], v[114:115], v[114:115]
  v_pk_mul_f32 v[116:117], v[116:117], v[116:117]
  v_pk_mul_f32 v[118:119], v[118:119], v[118:119]
  v_pk_mul_f32 v[120:121], v[120:121], v[120:121]
  v_pk_mul_f32 v[122:123], v[122:123], v[122:123]
  v_pk_mul_f32 v[124:125], v[124:125], v[124:125]
  v_pk_mul_f32 v[126:127], v[126:127], v[126:127]
  v_pk_add_f32 v[148:149], v[112:113], v[114:115]
  v_pk_add_f32 v[150:151], v[116:117], v[118:119]
  v_pk_add_f32 v[148:149], v[148:149], v[120:121]
  v_pk_add_f32 v[150:151], v[150:151], v[122:123]
  v_pk_add_f32 v[148:149], v[148:149], v[124:125]
  v_pk_add_f32 v[150:151], v[150:151], v[126:127]
  v_pk_add_f32 v[148:149], v[148:149], v[150:151]
  v_add_f32 v145, v148, v149
  s_nop 1
  v_add_f32_dpp v145, v145, v145 row_ror:8 row_mask:0xf bank_mask:0xf
  v_mov_b32 v148, v145
  s_nop 1
  v_permlane16_swap_b32 v145, v148
  s_nop 0
  v_add_f32 v145, v145, v148
  v_mov_b32 v148, v145
  s_nop 1
  v_permlane32_swap_b32 v145, v148
  s_nop 0
  v_add_f32 v145, v145, v148
  s_mov_b64 exec, 0xff
  ds_write_b32 v9, v144
  ds_write_b32 v9, v145 offset:128
  s_mov_b64 exec, -1
  s_waitcnt lgkmcnt(0)
  s_barrier
  ds_read_b128 v[112:115], v10
  ds_read_b128 v[116:119], v10 offset:128
  s_waitcnt vmcnt(2)
  s_cmp_eq_u32 s88, 0
  s_cbranch_scc1 L_nofl_58
  s_mov_b64 exec, 1
  buffer_store_dword v11, v8, s[4:7], s88 offen sc1
  s_mov_b64 exec, -1
  s_mov_b32 s88, 0
L_nofl_58:
  s_cmp_ge_u32 s74, s57
  s_cbranch_scc1 L_rnp_57
  v_min_u32 v12, v12, v14
  v_cmp_eq_u32 vcc, 0, v12
  s_cbranch_vccnz L_rnp_57
  s_lshl_b32 s61, s74, 18
  s_lshl_b32 s62, s54, 13
  s_add_u32 s61, s61, s62
  s_add_u32 s61, s61, s52
  s_add_u32 s61, s61, 0x3000000
  buffer_load_dwordx2 v[16:17], v3, s[4:7], s61 offen offset:0 sc1
  buffer_load_dwordx2 v[18:19], v3, s[4:7], s61 offen offset:128 sc1
  buffer_load_dwordx2 v[20:21], v3, s[4:7], s61 offen offset:1024 sc1
  buffer_load_dwordx2 v[22:23], v3, s[4:7], s61 offen offset:1152 sc1
  s_add_u32 s61, s61, 0x8000
  buffer_load_dwordx2 v[32:33], v3, s[4:7], s61 offen offset:0 sc1
  buffer_load_dwordx2 v[34:35], v3, s[4:7], s61 offen offset:128 sc1
  buffer_load_dwordx2 v[36:37], v3, s[4:7], s61 offen offset:1024 sc1
  buffer_load_dwordx2 v[38:39], v3, s[4:7], s61 offen offset:1152 sc1
  s_add_u32 s61, s61, 0x8000
  buffer_load_dwordx2 v[48:49], v3, s[4:7], s61 offen offset:0 sc1
  buffer_load_dwordx2 v[50:51], v3, s[4:7], s61 offen offset:128 sc1
  buffer_load_dwordx2 v[52:53], v3, s[4:7], s61 offen offset:1024 sc1
  buffer_load_dwordx2 v[54:55], v3, s[4:7], s61 offen offset:1152 sc1
  s_add_u32 s61, s61, 0x8000
  buffer_load_dwordx2 v[64:65], v3, s[4:7], s61 offen offset:0 sc1
  buffer_load_dwordx2 v[66:67], v3, s[4:7], s61 offen offset:128 sc1
  buffer_load_dwordx2 v[68:69], v3, s[4:7], s61 offen offset:1024 sc1
  buffer_load_dwordx2 v[70:71], v3, s[4:7], s61 offen offset:1152 sc1
  s_lshl_b32 s62, s74, 15
  s_lshl_b32 s61, s54, 7
  s_add_u32 s62, s62, s61
  s_add_u32 s62, s62, s52
  s_add_u32 s62, s62, 0x5800000
  buffer_load_dwordx4 v[88:91], v4, s[4:7], s62 offen sc1
  buffer_load_dwordx4 v[92:95], v5, s[4:7], s62 offen sc1
  s_mov_b32 s59, 1
L_rnp_57:
  v_xor_b32 v9, 256, v9
  v_xor_b32 v10, 256, v10
  s_waitcnt lgkmcnt(0)
  v_pk_add_f32 v[148:149], v[112:113], v[114:115]
  v_pk_add_f32 v[116:117], v[116:117], v[118:119]
  v_add_f32 v146, v148, v149
  v_add_f32 v144, v116, v117
  v_mul_f32 v146, 0x3e800000, v146
  v_mul_f32 v144, 0x3b000000, v144
  v_sub_f32 v112, v112, v146
  v_sub_f32 v113, v113, v146
  v_sub_f32 v114, v114, v146
  v_sub_f32 v115, v115, v146
  v_mul_f32 v116, v112, v112
  v_fmac_f32 v116, v113, v113
  v_fmac_f32 v116, v114, v114
  v_fmac_f32 v116, v115, v115
  v_fmac_f32 v144, 0x3e800000, v116
  v_cvt_pk_bf16_f32 v145, v146, v144
  v_lshlrev_b32_e64 v146, 16, v145
  v_and_b32 v144, 0xffff0000, v145
  v_add_f32 v144, 0x3727c5ac, v144
  v_cvt_pk_bf16_f32 v144, v144, v144
  v_lshlrev_b32 v144, 16, v144
  v_sqrt_f32 v144, v144
  s_nop 0
  v_cvt_pk_bf16_f32 v144, v144, v144
  v_lshlrev_b32 v144, 16, v144
  v_rcp_f32 v144, v144
  v_sub_f32 v112, v96, v146
  v_sub_f32 v113, v97, v146
  v_sub_f32 v114, v98, v146
  v_sub_f32 v115, v99, v146
  v_sub_f32 v116, v100, v146
  v_sub_f32 v117, v101, v146
  v_sub_f32 v118, v102, v146
  v_sub_f32 v119, v103, v146
  v_sub_f32 v120, v104, v146
  v_sub_f32 v121, v105, v146
  v_sub_f32 v122, v106, v146
  v_sub_f32 v123, v107, v146
  v_sub_f32 v124, v108, v146
  v_sub_f32 v125, v109, v146
  v_sub_f32 v126, v110, v146
  v_sub_f32_e64 v127, v111, v146
  v_cvt_pk_bf16_f32 v152, v112, v113
  v_cvt_pk_bf16_f32 v153, v114, v115
  v_cvt_pk_bf16_f32 v154, v116, v117
  v_cvt_pk_bf16_f32 v155, v118, v119
  v_cvt_pk_bf16_f32 v156, v120, v121
  v_cvt_pk_bf16_f32 v157, v122, v123
  v_cvt_pk_bf16_f32 v158, v124, v125
  v_cvt_pk_bf16_f32 v159, v126, v127
  v_lshlrev_b32 v112, 16, v152
  v_and_b32 v113, 0xffff0000, v152
  v_lshlrev_b32 v114, 16, v153
  v_and_b32 v115, 0xffff0000, v153
  v_lshlrev_b32 v116, 16, v154
  v_and_b32 v117, 0xffff0000, v154
  v_lshlrev_b32 v118, 16, v155
  v_and_b32 v119, 0xffff0000, v155
  v_lshlrev_b32 v120, 16, v156
  v_and_b32 v121, 0xffff0000, v156
  v_lshlrev_b32 v122, 16, v157
  v_and_b32 v123, 0xffff0000, v157
  v_lshlrev_b32 v124, 16, v158
  v_and_b32 v125, 0xffff0000, v158
  v_lshlrev_b32 v126, 16, v159
  v_and_b32 v127, 0xffff0000, v159
  v_pk_mul_f32 v[112:113], v[112:113], v[144:145] op_sel_hi:[1,0]
  v_pk_mul_f32 v[114:115], v[114:115], v[144:145] op_sel_hi:[1,0]
  v_pk_mul_f32 v[116:117], v[116:117], v[144:145] op_sel_hi:[1,0]
  v_pk_mul_f32 v[118:119], v[118:119], v[144:145] op_sel_hi:[1,0]
  v_pk_mul_f32 v[120:121], v[120:121], v[144:145] op_sel_hi:[1,0]
  v_pk_mul_f32 v[122:123], v[122:123], v[144:145] op_sel_hi:[1,0]
  v_pk_mul_f32 v[124:125], v[124:125], v[144:145] op_sel_hi:[1,0]
  v_pk_mul_f32 v[126:127], v[126:127], v[144:145] op_sel_hi:[1,0]
  v_cvt_pk_bf16_f32 v152, v112, v113
  v_cvt_pk_bf16_f32 v153, v114, v115
  v_cvt_pk_bf16_f32 v154, v116, v117
  v_cvt_pk_bf16_f32 v155, v118, v119
  v_cvt_pk_bf16_f32 v156, v120, v121
  v_cvt_pk_bf16_f32 v157, v122, v123
  v_cvt_pk_bf16_f32 v158, v124, v125
  v_cvt_pk_bf16_f32 v159, v126, v127
  s_add_u32 s62, s76, 0x5e00000
  buffer_store_dwordx4 v[152:155], v4, s[4:7], s62 offen sc1
  buffer_store_dwordx4 v[156:159], v5, s[4:7], s62 offen sc1
  s_lshl_b32 s61, s55, 6
  s_lshl_b32 s62, s54, 2
  s_add_u32 s61, s61, s62
  s_add_u32 s61, s61, s53
  s_add_u32 s88, s61, 0x1c000
  s_mov_b32 s55, s74
  s_cmp_lt_u32 s55, s57
  s_cbranch_scc1 L_R_51
  s_waitcnt vmcnt(0)
  s_cmp_eq_u32 s88, 0
  s_cbranch_scc1 L_nofl_59
  s_mov_b64 exec, 1
  buffer_store_dword v11, v8, s[4:7], s88 offen sc1
  s_mov_b64 exec, -1
  s_mov_b32 s88, 0
L_nofl_59:
  s_endpgm
B_r3_f:
  v_mov_b32 v3, 0x0
  v_bfe_i32 v2, v0, 0, 1
  v_and_b32 v2, 0x10, v2
  v_add_u32 v3, v3, v2
  v_bfe_i32 v2, v0, 1, 1
  v_and_b32 v2, 0x20, v2
  v_add_u32 v3, v3, v2
  v_bfe_i32 v2, v0, 2, 1
  v_and_b32 v2, 0x40, v2
  v_add_u32 v3, v3, v2
  v_bfe_i32 v2, v0, 3, 1
  v_and_b32 v2, 0x8, v2
  v_add_u32 v3, v3, v2
  v_bfe_i32 v2, v0, 4, 1
  v_and_b32 v2, 0x100, v2
  v_add_u32 v3, v3, v2
  v_bfe_i32 v2, v0, 5, 1
  v_and_b32 v2, 0x200, v2
  v_add_u32 v3, v3, v2
  v_bfe_i32 v2, v0, 6, 1
  v_and_b32 v2, 0x800, v2
  v_add_u32 v3, v3, v2
  v_bfe_i32 v2, v0, 7, 1
  v_and_b32 v2, 0x1000, v2
  v_add_u32 v3, v3, v2
  v_mov_b32 v4, 0x0
  v_bfe_i32 v2, v0, 0, 1
  v_and_b32 v2, 0x10, v2
  v_add_u32 v4, v4, v2
  v_bfe_i32 v2, v0, 1, 1
  v_and_b32 v2, 0x20, v2
  v_add_u32 v4, v4, v2
  v_bfe_i32 v2, v0, 2, 1
  v_and_b32 v2, 0x40, v2
  v_add_u32 v4, v4, v2
  v_bfe_i32 v2, v0, 3, 1
  v_and_b32 v2, 0x200, v2
  v_add_u32 v4, v4, v2
  v_bfe_i32 v2, v0, 4, 1
  v_and_b32 v2, 0x400, v2
  v_add_u32 v4, v4, v2
  v_bfe_i32 v2, v0, 5, 1
  v_and_b32 v2, 0x800, v2
  v_add_u32 v4, v4, v2
  v_bfe_i32 v2, v0, 6, 1
  v_and_b32 v2, 0x2000, v2
  v_add_u32 v4, v4, v2
  v_bfe_i32 v2, v0, 7, 1
  v_and_b32 v2, 0x4000, v2
  v_add_u32 v4, v4, v2
  v_add_u32 v5, 4096, v4
  v_mov_b32 v6, 0x0
  v_bfe_i32 v2, v0, 0, 1
  v_and_b32 v2, 0x400, v2
  v_add_u32 v6, v6, v2
  v_bfe_i32 v2, v0, 1, 1
  v_and_b32 v2, 0x800, v2
  v_add_u32 v6, v6, v2
  v_bfe_i32 v2, v0, 2, 1
  v_and_b32 v2, 0x1000, v2
  v_add_u32 v6, v6, v2
  v_bfe_i32 v2, v0, 3, 1
  v_and_b32 v2, 0x10, v2
  v_add_u32 v6, v6, v2
  v_bfe_i32 v2, v0, 4, 1
  v_and_b32 v2, 0x20, v2
  v_add_u32 v6, v6, v2
  v_bfe_i32 v2, v0, 5, 1
  v_and_b32 v2, 0x40, v2
  v_add_u32 v6, v6, v2
  v_bfe_i32 v2, v0, 6, 1
  v_and_b32 v2, 0x100, v2
  v_add_u32 v6, v6, v2
  v_bfe_i32 v2, v0, 7, 1
  v_and_b32 v2, 0x200, v2
  v_add_u32 v6, v6, v2
  v_mov_b32 v7, 0x0
  v_bfe_i32 v2, v0, 0, 1
  v_and_b32 v2, 0x4, v2
  v_add_u32 v7, v7, v2
  v_bfe_i32 v2, v0, 1, 1
  v_and_b32 v2, 0x8, v2
  v_add_u32 v7, v7, v2
  v_bfe_i32 v2, v0, 2, 1
  v_and_b32 v2, 0x10, v2
  v_add_u32 v7, v7, v2
  v_bfe_i32 v2, v0, 3, 1
  v_and_b32 v2, 0x20, v2
  v_add_u32 v7, v7, v2
  v_bfe_i32 v2, v0, 6, 1
  v_and_b32 v2, 0x40, v2
  v_add_u32 v7, v7, v2
  v_bfe_i32 v2, v0, 7, 1
  v_and_b32 v2, 0x80, v2
  v_add_u32 v7, v7, v2
  v_mov_b32 v8, 0x0
  v_bfe_i32 v2, v0, 6, 1
  v_and_b32 v2, 0x10, v2
  v_add_u32 v8, v8, v2
  v_bfe_i32 v2, v0, 7, 1
  v_and_b32 v2, 0x20, v2
  v_add_u32 v8, v8, v2
  v_mov_b32 v13, 0x0
  v_bfe_i32 v2, v0, 0, 1
  v_and_b32 v2, 0x4, v2
  v_add_u32 v13, v13, v2
  v_bfe_i32 v2, v0, 1, 1
  v_and_b32 v2, 0x8, v2
  v_add_u32 v13, v13, v2
  v_bfe_i32 v2, v0, 2, 1
  v_and_b32 v2, 0x10, v2
  v_add_u32 v13, v13, v2
  v_bfe_i32 v2, v0, 3, 1
  v_and_b32 v2, 0x20, v2
  v_add_u32 v13, v13, v2
  v_mov_b32 v9, 0x0
  v_bfe_i32 v2, v0, 0, 1
  v_and_b32 v2, 0x10, v2
  v_add_u32 v9, v9, v2
  v_bfe_i32 v2, v0, 1, 1
  v_and_b32 v2, 0x20, v2
  v_add_u32 v9, v9, v2
  v_bfe_i32 v2, v0, 2, 1
  v_and_b32 v2, 0x40, v2
  v_add_u32 v9, v9, v2
  v_bfe_i32 v2, v0, 6, 1
  v_and_b32 v2, 0x4, v2
  v_add_u32 v9, v9, v2
  v_bfe_i32 v2, v0, 7, 1
  v_and_b32 v2, 0x8, v2
  v_add_u32 v9, v9, v2
  v_mov_b32 v10, 0x0
  v_bfe_i32 v2, v0, 0, 1
  v_and_b32 v2, 0x10, v2
  v_add_u32 v10, v10, v2
  v_bfe_i32 v2, v0, 1, 1
  v_and_b32 v2, 0x20, v2
  v_add_u32 v10, v10, v2
  v_bfe_i32 v2, v0, 2, 1
  v_and_b32 v2, 0x40, v2
  v_add_u32 v10, v10, v2
  v_mov_b32 v11, 1
  s_mov_b32 s59, 0
  s_mov_b32 s88, 0
  s_lshl_b32 s61, s54, 7
  s_add_u32 s61, s61, s52
  s_add_u32 s62, s61, 0x5e00000
  s_add_u32 s61, s61, 0x5c00000
  buffer_load_dwordx4 v[96:99], v4, s[4:7], s61 offen sc1
  buffer_load_dwordx4 v[96:99], v5, s[4:7], s61 offen sc1
  s_add_u32 s61, s61, 0x8000
  buffer_load_dwordx4 v[96:99], v4, s[4:7], s62 offen sc1
  buffer_load_dwordx4 v[96:99], v5, s[4:7], s62 offen sc1
  s_add_u32 s62, s62, 0x8000
  buffer_load_dwordx4 v[96:99], v4, s[4:7], s61 offen sc1
  buffer_load_dwordx4 v[96:99], v5, s[4:7], s61 offen sc1
  s_add_u32 s61, s61, 0x8000
  buffer_load_dwordx4 v[96:99], v4, s[4:7], s62 offen sc1
  buffer_load_dwordx4 v[96:99], v5, s[4:7], s62 offen sc1
  s_add_u32 s62, s62, 0x8000
  buffer_load_dwordx4 v[96:99], v4, s[4:7], s61 offen sc1
  buffer_load_dwordx4 v[96:99], v5, s[4:7], s61 offen sc1
  s_add_u32 s61, s61, 0x8000
  buffer_load_dwordx4 v[96:99], v4, s[4:7], s62 offen sc1
  buffer_load_dwordx4 v[96:99], v5, s[4:7], s62 offen sc1
  s_add_u32 s62, s62, 0x8000
  buffer_load_dwordx4 v[96:99], v4, s[4:7], s61 offen sc1
  buffer_load_dwordx4 v[96:99], v5, s[4:7], s61 offen sc1
  s_add_u32 s61, s61, 0x8000
  buffer_load_dwordx4 v[96:99], v4, s[4:7], s62 offen sc1
  buffer_load_dwordx4 v[96:99], v5, s[4:7], s62 offen sc1
  s_add_u32 s62, s62, 0x8000
  buffer_load_dwordx4 v[96:99], v4, s[4:7], s61 offen sc1
  buffer_load_dwordx4 v[96:99], v5, s[4:7], s61 offen sc1
  s_add_u32 s61, s61, 0x8000
  buffer_load_dwordx4 v[96:99], v4, s[4:7], s62 offen sc1
  buffer_load_dwordx4 v[96:99], v5, s[4:7], s62 offen sc1
  s_add_u32 s62, s62, 0x8000
  buffer_load_dwordx4 v[96:99], v4, s[4:7], s61 offen sc1
  buffer_load_dwordx4 v[96:99], v5, s[4:7], s61 offen sc1
  s_add_u32 s61, s61, 0x8000
  buffer_load_dwordx4 v[96:99], v4, s[4:7], s62 offen sc1
  buffer_load_dwordx4 v[96:99], v5, s[4:7], s62 offen sc1
  s_add_u32 s62, s62, 0x8000
  buffer_load_dwordx4 v[96:99], v4, s[4:7], s61 offen sc1
  buffer_load_dwordx4 v[96:99], v5, s[4:7], s61 offen sc1
  s_add_u32 s61, s61, 0x8000
  buffer_load_dwordx4 v[96:99], v4, s[4:7], s62 offen sc1
  buffer_load_dwordx4 v[96:99], v5, s[4:7], s62 offen sc1
  s_add_u32 s62, s62, 0x8000
  buffer_load_dwordx4 v[96:99], v4, s[4:7], s61 offen sc1
  buffer_load_dwordx4 v[96:99], v5, s[4:7], s61 offen sc1
  s_add_u32 s61, s61, 0x8000
  buffer_load_dwordx4 v[96:99], v4, s[4:7], s62 offen sc1
  buffer_load_dwordx4 v[96:99], v5, s[4:7], s62 offen sc1
  s_add_u32 s62, s62, 0x8000
  s_mov_b32 s8, s48
  s_and_b32 s9, s49, 0xffff
  s_mov_b32 s10, 0x100
  s_mov_b32 s11, 0x20000
  v_and_b32 v2, 3, v0
  v_lshlrev_b32 v2, 6, v2
L_gate_60:
  buffer_load_dword v12, v2, s[8:11], 0 offen offset:8 sc1
  s_waitcnt vmcnt(0)
  v_cmp_gt_u32 vcc, 48, v12
  s_cbranch_vccz L_gateok_61
  s_add_u32 s72, s72, 1
  s_cmp_gt_u32 s72, 0x80000
  s_cbranch_scc1 L_exit
  s_sleep 2
  s_branch L_gate_60
L_gateok_61:
L_R_62:
  s_cmp_eq_u32 s59, 1
  s_cbranch_scc1 L_rh_63
L_rp_65:
  s_lshl_b32 s61, s55, 8
  s_add_u32 s61, s61, s53
  s_add_u32 s61, s61, 0x18000
  buffer_load_dword v12, v7, s[4:7], s61 offen sc1
  s_sub_u32 s63, s55, 8
  s_lshl_b32 s63, s63, 6
  s_add_u32 s63, s63, s53
  s_add_u32 s63, s63, 0x63000
  s_cmp_lt_u32 s55, 8
  s_cselect_b32 s63, 0x33000, s63
  buffer_load_dword v14, v13, s[4:7], s63 offen sc1
  s_waitcnt vmcnt(0)
  s_cmp_eq_u32 s88, 0
  s_cbranch_scc1 L_nofl_67
  s_mov_b64 exec, 1
  buffer_store_dword v11, v8, s[4:7], s88 offen
  s_mov_b64 exec, -1
  s_mov_b32 s88, 0
L_nofl_67:
  v_min_u32 v12, v12, v14
  v_cmp_eq_u32 vcc, 0, v12
  s_cbranch_vccz L_rpo_66
  s_add_u32 s72, s72, 1
  s_cmp_gt_u32 s72, 0x80000
  s_cbranch_scc1 L_exit
  s_branch L_rp_65
L_rpo_66:
  s_lshl_b32 s61, s55, 18
  s_lshl_b32 s62, s54, 13
  s_add_u32 s61, s61, s62
  s_add_u32 s61, s61, s52
  s_add_u32 s61, s61, 0x3000000
  buffer_load_dwordx2 v[16:17], v3, s[4:7], s61 offen offset:0 sc1
  buffer_load_dwordx2 v[18:19], v3, s[4:7], s61 offen offset:128 sc1
  buffer_load_dwordx2 v[20:21], v3, s[4:7], s61 offen offset:1024 sc1
  buffer_load_dwordx2 v[22:23], v3, s[4:7], s61 offen offset:1152 sc1
  s_add_u32 s61, s61, 0x8000
  buffer_load_dwordx2 v[32:33], v3, s[4:7], s61 offen offset:0 sc1
  buffer_load_dwordx2 v[34:35], v3, s[4:7], s61 offen offset:128 sc1
  buffer_load_dwordx2 v[36:37], v3, s[4:7], s61 offen offset:1024 sc1
  buffer_load_dwordx2 v[38:39], v3, s[4:7], s61 offen offset:1152 sc1
  s_add_u32 s61, s61, 0x8000
  buffer_load_dwordx2 v[48:49], v3, s[4:7], s61 offen offset:0 sc1
  buffer_load_dwordx2 v[50:51], v3, s[4:7], s61 offen offset:128 sc1
  buffer_load_dwordx2 v[52:53], v3, s[4:7], s61 offen offset:1024 sc1
  buffer_load_dwordx2 v[54:55], v3, s[4:7], s61 offen offset:1152 sc1
  s_add_u32 s61, s61, 0x8000
  buffer_load_dwordx2 v[64:65], v3, s[4:7], s61 offen offset:0 sc1
  buffer_load_dwordx2 v[66:67], v3, s[4:7], s61 offen offset:128 sc1
  buffer_load_dwordx2 v[68:69], v3, s[4:7], s61 offen offset:1024 sc1
  buffer_load_dwordx2 v[70:71], v3, s[4:7], s61 offen offset:1152 sc1
  s_lshl_b32 s62, s55, 15
  s_lshl_b32 s61, s54, 7
  s_add_u32 s62, s62, s61
  s_add_u32 s62, s62, s52
  s_add_u32 s62, s62, 0x5800000
  buffer_load_dwordx4 v[88:91], v4, s[4:7], s62 offen sc1
  buffer_load_dwordx4 v[92:95], v5, s[4:7], s62 offen sc1
  s_waitcnt vmcnt(0)
  s_branch L_rj_64
L_rh_63:
  s_waitcnt vmcnt(2)
L_rj_64:
  s_mov_b32 s59, 0
  s_add_u32 s74, s55, s56
  s_min_u32 s62, s74, 63
  s_lshl_b32 s61, s62, 8
  s_add_u32 s61, s61, s53
  s_add_u32 s61, s61, 0x18000
  buffer_load_dword v12, v7, s[4:7], s61 offen sc1
  s_sub_u32 s63, s62, 8
  s_lshl_b32 s63, s63, 6
  s_add_u32 s63, s63, s53
  s_add_u32 s63, s63, 0x63000
  s_cmp_lt_u32 s62, 8
  s_cselect_b32 s63, 0x33000, s63
  buffer_load_dword v14, v13, s[4:7], s63 offen sc1
  s_and_b32 s76, s55, 7
  s_lshl_b32 s76, s76, 15
  s_lshl_b32 s61, s54, 7
  s_add_u32 s76, s76, s61
  s_add_u32 s76, s76, s52
  s_lshl_b32 s77, s55, 15
  s_lshl_b32 s61, s54, 13
  s_add_u32 s77, s77, s61
  v_lshlrev_b32 v96, 16, v88
  v_and_b32 v97, 0xffff0000, v88
  v_lshlrev_b32 v98, 16, v89
  v_and_b32 v99, 0xffff0000, v89
  v_lshlrev_b32 v100, 16, v90
  v_and_b32 v101, 0xffff0000, v90
  v_lshlrev_b32 v102, 16, v91
  v_and_b32 v103, 0xffff0000, v91
  v_lshlrev_b32 v104, 16, v92
  v_and_b32 v105, 0xffff0000, v92
  v_lshlrev_b32 v106, 16, v93
  v_and_b32 v107, 0xffff0000, v93
  v_lshlrev_b32 v108, 16, v94
  v_and_b32 v109, 0xffff0000, v94
  v_lshlrev_b32 v110, 16, v95
  v_and_b32 v111, 0xffff0000, v95
  v_lshlrev_b32 v112, 16, v16
  v_and_b32 v113, 0xffff0000, v16
  v_lshlrev_b32 v114, 16, v17
  v_and_b32 v115, 0xffff0000, v17
  v_lshlrev_b32 v116, 16, v18
  v_and_b32 v117, 0xffff0000, v18
  v_lshlrev_b32 v118, 16, v19
  v_and_b32 v119, 0xffff0000, v19
  v_lshlrev_b32 v120, 16, v20
  v_and_b32 v121, 0xffff0000, v20
  v_lshlrev_b32 v122, 16, v21
  v_and_b32 v123, 0xffff0000, v21
  v_lshlrev_b32 v124, 16, v22
  v_and_b32 v125, 0xffff0000, v22
  v_lshlrev_b32 v126, 16, v23
  v_and_b32 v127, 0xffff0000, v23
  v_lshlrev_b32 v128, 16, v32
  v_and_b32 v129, 0xffff0000, v32
  v_lshlrev_b32 v130, 16, v33
  v_and_b32 v131, 0xffff0000, v33
  v_lshlrev_b32 v132, 16, v34
  v_and_b32 v133, 0xffff0000, v34
  v_lshlrev_b32 v134, 16, v35
  v_and_b32 v135, 0xffff0000, v35
  v_lshlrev_b32 v136, 16, v36
  v_and_b32 v137, 0xffff0000, v36
  v_lshlrev_b32 v138, 16, v37
  v_and_b32 v139, 0xffff0000, v37
  v_lshlrev_b32 v140, 16, v38
  v_and_b32 v141, 0xffff0000, v38
  v_lshlrev_b32 v142, 16, v39
  v_and_b32 v143, 0xffff0000, v39
  v_pk_add_f32 v[112:113], v[112:113], v[128:129]
  v_pk_add_f32 v[114:115], v[114:115], v[130:131]
  v_pk_add_f32 v[116:117], v[116:117], v[132:133]
  v_pk_add_f32 v[118:119], v[118:119], v[134:135]
  v_pk_add_f32 v[120:121], v[120:121], v[136:137]
  v_pk_add_f32 v[122:123], v[122:123], v[138:139]
  v_pk_add_f32 v[124:125], v[124:125], v[140:141]
  v_pk_add_f32 v[126:127], v[126:127], v[142:143]
  v_lshlrev_b32 v128, 16, v48
  v_and_b32 v129, 0xffff0000, v48
  v_lshlrev_b32 v130, 16, v49
  v_and_b32 v131, 0xffff0000, v49
  v_lshlrev_b32 v132, 16, v50
  v_and_b32 v133, 0xffff0000, v50
  v_lshlrev_b32 v134, 16, v51
  v_and_b32 v135, 0xffff0000, v51
  v_lshlrev_b32 v136, 16, v52
  v_and_b32 v137, 0xffff0000, v52
  v_lshlrev_b32 v138, 16, v53
  v_and_b32 v139, 0xffff0000, v53
  v_lshlrev_b32 v140, 16, v54
  v_and_b32 v141, 0xffff0000, v54
  v_lshlrev_b32 v142, 16, v55
  v_and_b32 v143, 0xffff0000, v55
  v_pk_add_f32 v[112:113], v[112:113], v[128:129]
  v_pk_add_f32 v[114:115], v[114:115], v[130:131]
  v_pk_add_f32 v[116:117], v[116:117], v[132:133]
  v_pk_add_f32 v[118:119], v[118:119], v[134:135]
  v_pk_add_f32 v[120:121], v[120:121], v[136:137]
  v_pk_add_f32 v[122:123], v[122:123], v[138:139]
  v_pk_add_f32 v[124:125], v[124:125], v[140:141]
  v_pk_add_f32 v[126:127], v[126:127], v[142:143]
  v_lshlrev_b32 v128, 16, v64
  v_and_b32 v129, 0xffff0000, v64
  v_lshlrev_b32 v130, 16, v65
  v_and_b32 v131, 0xffff0000, v65
  v_lshlrev_b32 v132, 16, v66
  v_and_b32 v133, 0xffff0000, v66
  v_lshlrev_b32 v134, 16, v67
  v_and_b32 v135, 0xffff0000, v67
  v_lshlrev_b32 v136, 16, v68
  v_and_b32 v137, 0xffff0000, v68
  v_lshlrev_b32 v138, 16, v69
  v_and_b32 v139, 0xffff0000, v69
  v_lshlrev_b32 v140, 16, v70
  v_and_b32 v141, 0xffff0000, v70
  v_lshlrev_b32 v142, 16, v71
  v_and_b32 v143, 0xffff0000, v71
  v_pk_add_f32 v[112:113], v[112:113], v[128:129]
  v_pk_add_f32 v[114:115], v[114:115], v[130:131]
  v_pk_add_f32 v[116:117], v[116:117], v[132:133]
  v_pk_add_f32 v[118:119], v[118:119], v[134:135]
  v_pk_add_f32 v[120:121], v[120:121], v[136:137]
  v_pk_add_f32 v[122:123], v[122:123], v[138:139]
  v_pk_add_f32 v[124:125], v[124:125], v[140:141]
  v_pk_add_f32 v[126:127], v[126:127], v[142:143]
  v_cvt_pk_bf16_f32 v152, v112, v113
  v_cvt_pk_bf16_f32 v153, v114, v115
  v_cvt_pk_bf16_f32 v154, v116, v117
  v_cvt_pk_bf16_f32 v155, v118, v119
  v_cvt_pk_bf16_f32 v156, v120, v121
  v_cvt_pk_bf16_f32 v157, v122, v123
  v_cvt_pk_bf16_f32 v158, v124, v125
  v_cvt_pk_bf16_f32 v159, v126, v127
  v_lshlrev_b32 v112, 16, v152
  v_and_b32 v113, 0xffff0000, v152
  v_lshlrev_b32 v114, 16, v153
  v_and_b32 v115, 0xffff0000, v153
  v_lshlrev_b32 v116, 16, v154
  v_and_b32 v117, 0xffff0000, v154
  v_lshlrev_b32 v118, 16, v155
  v_and_b32 v119, 0xffff0000, v155
  v_lshlrev_b32 v120, 16, v156
  v_and_b32 v121, 0xffff0000, v156
  v_lshlrev_b32 v122, 16, v157
  v_and_b32 v123, 0xffff0000, v157
  v_lshlrev_b32 v124, 16, v158
  v_and_b32 v125, 0xffff0000, v158
  v_lshlrev_b32 v126, 16, v159
  v_and_b32 v127, 0xffff0000, v159
  v_pk_add_f32 v[96:97], v[96:97], v[112:113]
  v_pk_add_f32 v[98:99], v[98:99], v[114:115]
  v_pk_add_f32 v[100:101], v[100:101], v[116:117]
  v_pk_add_f32 v[102:103], v[102:103], v[118:119]
  v_pk_add_f32 v[104:105], v[104:105], v[120:121]
  v_pk_add_f32 v[106:107], v[106:107], v[122:123]
  v_pk_add_f32 v[108:109], v[108:109], v[124:125]
  v_pk_add_f32 v[110:111], v[110:111], v[126:127]
  v_cvt_pk_bf16_f32 v80, v96, v97
  v_cvt_pk_bf16_f32 v81, v98, v99
  v_cvt_pk_bf16_f32 v82, v100, v101
  v_cvt_pk_bf16_f32 v83, v102, v103
  v_cvt_pk_bf16_f32 v84, v104, v105
  v_cvt_pk_bf16_f32 v85, v106, v107
  v_cvt_pk_bf16_f32 v86, v108, v109
  v_cvt_pk_bf16_f32 v87, v110, v111
  s_add_u32 s62, s76, 0x5c00000
  buffer_store_dwordx4 v[80:83], v4, s[4:7], s62 offen
  buffer_store_dwordx4 v[84:87], v5, s[4:7], s62 offen
  v_lshlrev_b32 v96, 16, v80
  v_and_b32 v97, 0xffff0000, v80
  v_lshlrev_b32 v98, 16, v81
  v_and_b32 v99, 0xffff0000, v81
  v_lshlrev_b32 v100, 16, v82
  v_and_b32 v101, 0xffff0000, v82
  v_lshlrev_b32 v102, 16, v83
  v_and_b32 v103, 0xffff0000, v83
  v_lshlrev_b32 v104, 16, v84
  v_and_b32 v105, 0xffff0000, v84
  v_lshlrev_b32 v106, 16, v85
  v_and_b32 v107, 0xffff0000, v85
  v_lshlrev_b32 v108, 16, v86
  v_and_b32 v109, 0xffff0000, v86
  v_lshlrev_b32 v110, 16, v87
  v_and_b32 v111, 0xffff0000, v87
  v_pk_add_f32 v[148:149], v[96:97], v[98:99]
  v_pk_add_f32 v[150:151], v[100:101], v[102:103]
  v_pk_add_f32 v[148:149], v[148:149], v[104:105]
  v_pk_add_f32 v[150:151], v[150:151], v[106:107]
  v_pk_add_f32 v[148:149], v[148:149], v[108:109]
  v_pk_add_f32 v[150:151], v[150:151], v[110:111]
  v_pk_add_f32 v[148:149], v[148:149], v[150:151]
  v_add_f32 v144, v148, v149
  s_nop 1
  v_add_f32_dpp v144, v144, v144 row_ror:8 row_mask:0xf bank_mask:0xf
  v_mov_b32 v148, v144
  s_nop 1
  v_permlane16_swap_b32 v144, v148
  s_nop 0
  v_add_f32 v144, v144, v148
  v_mov_b32 v148, v144
  s_nop 1
  v_permlane32_swap_b32 v144, v148
  s_nop 0
  v_add_f32 v144, v144, v148
  v_mul_f32 v144, 0x3c000000, v144
  v_sub_f32 v112, v96, v144
  v_sub_f32 v113, v97, v144
  v_sub_f32 v114, v98, v144
  v_sub_f32 v115, v99, v144
  v_sub_f32 v116, v100, v144
  v_sub_f32 v117, v101, v144
  v_sub_f32 v118, v102, v144
  v_sub_f32 v119, v103, v144
  v_sub_f32 v120, v104, v144
  v_sub_f32 v121, v105, v144
  v_sub_f32 v122, v106, v144
  v_sub_f32 v123, v107, v144
  v_sub_f32 v124, v108, v144
  v_sub_f32 v125, v109, v144
  v_sub_f32 v126, v110, v144
  v_sub_f32 v127, v111, v144
  v_pk_mul_f32 v[112:113], v[112:113], v[112:113]
  v_pk_mul_f32 v[114:115], v[114:115], v[114:115]
  v_pk_mul_f32 v[116:117], v[116:117], v[116:117]
  v_pk_mul_f32 v[118:119], v[118:119], v[118:119]
  v_pk_mul_f32 v[120:121], v[120:121], v[120:121]
  v_pk_mul_f32 v[122:123], v[122:123], v[122:123]
  v_pk_mul_f32 v[124:125], v[124:125], v[124:125]
  v_pk_mul_f32 v[126:127], v[126:127], v[126:127]
  v_pk_add_f32 v[148:149], v[112:113], v[114:115]
  v_pk_add_f32 v[150:151], v[116:117], v[118:119]
  v_pk_add_f32 v[148:149], v[148:149], v[120:121]
  v_pk_add_f32 v[150:151], v[150:151], v[122:123]
  v_pk_add_f32 v[148:149], v[148:149], v[124:125]
  v_pk_add_f32 v[150:151], v[150:151], v[126:127]
  v_pk_add_f32 v[148:149], v[148:149], v[150:151]
  v_add_f32 v145, v148, v149
  s_nop 1
  v_add_f32_dpp v145, v145, v145 row_ror:8 row_mask:0xf bank_mask:0xf
  v_mov_b32 v148, v145
  s_nop 1
  v_permlane16_swap_b32 v145, v148
  s_nop 0
  v_add_f32 v145, v145, v148
  v_mov_b32 v148, v145
  s_nop 1
  v_permlane32_swap_b32 v145, v148
  s_nop 0
  v_add_f32 v145, v145, v148
  s_mov_b64 exec, 0xff
  ds_write_b32 v9, v144
  ds_write_b32 v9, v145 offset:128
  s_mov_b64 exec, -1
  s_waitcnt lgkmcnt(0)
  s_barrier
  ds_read_b128 v[112:115], v10
  ds_read_b128 v[116:119], v10 offset:128
  s_waitcnt vmcnt(2)
  s_cmp_eq_u32 s88, 0
  s_cbranch_scc1 L_nofl_69
  s_mov_b64 exec, 1
  buffer_store_dword v11, v8, s[4:7], s88 offen
  s_mov_b64 exec, -1
  s_mov_b32 s88, 0
L_nofl_69:
  s_cmp_ge_u32 s74, s57
  s_cbranch_scc1 L_rnp_68
  v_min_u32 v12, v12, v14
  v_cmp_eq_u32 vcc, 0, v12
  s_cbranch_vccnz L_rnp_68
  s_lshl_b32 s61, s74, 18
  s_lshl_b32 s62, s54, 13
  s_add_u32 s61, s61, s62
  s_add_u32 s61, s61, s52
  s_add_u32 s61, s61, 0x3000000
  buffer_load_dwordx2 v[16:17], v3, s[4:7], s61 offen offset:0 sc1
  buffer_load_dwordx2 v[18:19], v3, s[4:7], s61 offen offset:128 sc1
  buffer_load_dwordx2 v[20:21], v3, s[4:7], s61 offen offset:1024 sc1
  buffer_load_dwordx2 v[22:23], v3, s[4:7], s61 offen offset:1152 sc1
  s_add_u32 s61, s61, 0x8000
  buffer_load_dwordx2 v[32:33], v3, s[4:7], s61 offen offset:0 sc1
  buffer_load_dwordx2 v[34:35], v3, s[4:7], s61 offen offset:128 sc1
  buffer_load_dwordx2 v[36:37], v3, s[4:7], s61 offen offset:1024 sc1
  buffer_load_dwordx2 v[38:39], v3, s[4:7], s61 offen offset:1152 sc1
  s_add_u32 s61, s61, 0x8000
  buffer_load_dwordx2 v[48:49], v3, s[4:7], s61 offen offset:0 sc1
  buffer_load_dwordx2 v[50:51], v3, s[4:7], s61 offen offset:128 sc1
  buffer_load_dwordx2 v[52:53], v3, s[4:7], s61 offen offset:1024 sc1
  buffer_load_dwordx2 v[54:55], v3, s[4:7], s61 offen offset:1152 sc1
  s_add_u32 s61, s61, 0x8000
  buffer_load_dwordx2 v[64:65], v3, s[4:7], s61 offen offset:0 sc1
  buffer_load_dwordx2 v[66:67], v3, s[4:7], s61 offen offset:128 sc1
  buffer_load_dwordx2 v[68:69], v3, s[4:7], s61 offen offset:1024 sc1
  buffer_load_dwordx2 v[70:71], v3, s[4:7], s61 offen offset:1152 sc1
  s_lshl_b32 s62, s74, 15
  s_lshl_b32 s61, s54, 7
  s_add_u32 s62, s62, s61
  s_add_u32 s62, s62, s52
  s_add_u32 s62, s62, 0x5800000
  buffer_load_dwordx4 v[88:91], v4, s[4:7], s62 offen sc1
  buffer_load_dwordx4 v[92:95], v5, s[4:7], s62 offen sc1
  s_mov_b32 s59, 1
L_rnp_68:
  v_xor_b32 v9, 256, v9
  v_xor_b32 v10, 256, v10
  s_waitcnt lgkmcnt(0)
  v_pk_add_f32 v[148:149], v[112:113], v[114:115]
  v_pk_add_f32 v[116:117], v[116:117], v[118:119]
  v_add_f32 v146, v148, v149
  v_add_f32 v144, v116, v117
  v_mul_f32 v146, 0x3e800000, v146
  v_mul_f32 v144, 0x3b000000, v144
  v_sub_f32 v112, v112, v146
  v_sub_f32 v113, v113, v146
  v_sub_f32 v114, v114, v146
  v_sub_f32 v115, v115, v146
  v_mul_f32 v116, v112, v112
  v_fmac_f32 v116, v113, v113
  v_fmac_f32 v116, v114, v114
  v_fmac_f32 v116, v115, v115
  v_fmac_f32 v144, 0x3e800000, v116
  v_cvt_pk_bf16_f32 v145, v146, v144
  v_lshlrev_b32_e64 v146, 16, v145
  v_and_b32 v144, 0xffff0000, v145
  v_add_f32 v144, 0x3727c5ac, v144
  v_cvt_pk_bf16_f32 v144, v144, v144
  v_lshlrev_b32 v144, 16, v144
  v_sqrt_f32 v144, v144
  s_nop 0
  v_cvt_pk_bf16_f32 v144, v144, v144
  v_lshlrev_b32 v144, 16, v144
  v_rcp_f32 v144, v144
  v_sub_f32 v112, v96, v146
  v_sub_f32 v113, v97, v146
  v_sub_f32 v114, v98, v146
  v_sub_f32 v115, v99, v146
  v_sub_f32 v116, v100, v146
  v_sub_f32 v117, v101, v146
  v_sub_f32 v118, v102, v146
  v_sub_f32 v119, v103, v146
  v_sub_f32 v120, v104, v146
  v_sub_f32 v121, v105, v146
  v_sub_f32 v122, v106, v146
  v_sub_f32 v123, v107, v146
  v_sub_f32 v124, v108, v146
  v_sub_f32 v125, v109, v146
  v_sub_f32 v126, v110, v146
  v_sub_f32_e64 v127, v111, v146
  v_cvt_pk_bf16_f32 v152, v112, v113
  v_cvt_pk_bf16_f32 v153, v114, v115
  v_cvt_pk_bf16_f32 v154, v116, v117
  v_cvt_pk_bf16_f32 v155, v118, v119
  v_cvt_pk_bf16_f32 v156, v120, v121
  v_cvt_pk_bf16_f32 v157, v122, v123
  v_cvt_pk_bf16_f32 v158, v124, v125
  v_cvt_pk_bf16_f32 v159, v126, v127
  v_lshlrev_b32 v112, 16, v152
  v_and_b32 v113, 0xffff0000, v152
  v_lshlrev_b32 v114, 16, v153
  v_and_b32 v115, 0xffff0000, v153
  v_lshlrev_b32 v116, 16, v154
  v_and_b32 v117, 0xffff0000, v154
  v_lshlrev_b32 v118, 16, v155
  v_and_b32 v119, 0xffff0000, v155
  v_lshlrev_b32 v120, 16, v156
  v_and_b32 v121, 0xffff0000, v156
  v_lshlrev_b32 v122, 16, v157
  v_and_b32 v123, 0xffff0000, v157
  v_lshlrev_b32 v124, 16, v158
  v_and_b32 v125, 0xffff0000, v158
  v_lshlrev_b32 v126, 16, v159
  v_and_b32 v127, 0xffff0000, v159
  v_pk_mul_f32 v[112:113], v[112:113], v[144:145] op_sel_hi:[1,0]
  v_pk_mul_f32 v[114:115], v[114:115], v[144:145] op_sel_hi:[1,0]
  v_pk_mul_f32 v[116:117], v[116:117], v[144:145] op_sel_hi:[1,0]
  v_pk_mul_f32 v[118:119], v[118:119], v[144:145] op_sel_hi:[1,0]
  v_pk_mul_f32 v[120:121], v[120:121], v[144:145] op_sel_hi:[1,0]
  v_pk_mul_f32 v[122:123], v[122:123], v[144:145] op_sel_hi:[1,0]
  v_pk_mul_f32 v[124:125], v[124:125], v[144:145] op_sel_hi:[1,0]
  v_pk_mul_f32 v[126:127], v[126:127], v[144:145] op_sel_hi:[1,0]
  v_cvt_pk_bf16_f32 v152, v112, v113
  v_cvt_pk_bf16_f32 v153, v114, v115
  v_cvt_pk_bf16_f32 v154, v116, v117
  v_cvt_pk_bf16_f32 v155, v118, v119
  v_cvt_pk_bf16_f32 v156, v120, v121
  v_cvt_pk_bf16_f32 v157, v122, v123
  v_cvt_pk_bf16_f32 v158, v124, v125
  v_cvt_pk_bf16_f32 v159, v126, v127
  s_add_u32 s62, s76, 0x5e00000
  buffer_store_dwordx4 v[152:155], v4, s[4:7], s62 offen
  buffer_store_dwordx4 v[156:159], v5, s[4:7], s62 offen
  s_lshl_b32 s61, s55, 6
  s_lshl_b32 s62, s54, 2
  s_add_u32 s61, s61, s62
  s_add_u32 s61, s61, s53
  s_add_u32 s88, s61, 0x1c000
  s_mov_b32 s55, s74
  s_cmp_lt_u32 s55, s57
  s_cbranch_scc1 L_R_62
  s_waitcnt vmcnt(0)
  s_cmp_eq_u32 s88, 0
  s_cbranch_scc1 L_nofl_70
  s_mov_b64 exec, 1
  buffer_store_dword v11, v8, s[4:7], s88 offen
  s_mov_b64 exec, -1
  s_mov_b32 s88, 0
L_nofl_70:
  s_endpgm
B_r5:
  v_mov_b32 v3, 0x0
  v_bfe_i32 v2, v0, 0, 1
  v_and_b32 v2, 0x10, v2
  v_add_u32 v3, v3, v2
  v_bfe_i32 v2, v0, 1, 1
  v_and_b32 v2, 0x20, v2
  v_add_u32 v3, v3, v2
  v_bfe_i32 v2, v0, 2, 1
  v_and_b32 v2, 0x40, v2
  v_add_u32 v3, v3, v2
  v_bfe_i32 v2, v0, 3, 1
  v_and_b32 v2, 0x8, v2
  v_add_u32 v3, v3, v2
  v_bfe_i32 v2, v0, 4, 1
  v_and_b32 v2, 0x100, v2
  v_add_u32 v3, v3, v2
  v_bfe_i32 v2, v0, 5, 1
  v_and_b32 v2, 0x200, v2
  v_add_u32 v3, v3, v2
  v_bfe_i32 v2, v0, 6, 1
  v_and_b32 v2, 0x800, v2
  v_add_u32 v3, v3, v2
  v_bfe_i32 v2, v0, 7, 1
  v_and_b32 v2, 0x1000, v2
  v_add_u32 v3, v3, v2
  v_mov_b32 v4, 0x0
  v_bfe_i32 v2, v0, 0, 1
  v_and_b32 v2, 0x10, v2
  v_add_u32 v4, v4, v2
  v_bfe_i32 v2, v0, 1, 1
  v_and_b32 v2, 0x20, v2
  v_add_u32 v4, v4, v2
  v_bfe_i32 v2, v0, 2, 1
  v_and_b32 v2, 0x40, v2
  v_add_u32 v4, v4, v2
  v_bfe_i32 v2, v0, 3, 1
  v_and_b32 v2, 0x200, v2
  v_add_u32 v4, v4, v2
  v_bfe_i32 v2, v0, 4, 1
  v_and_b32 v2, 0x400, v2
  v_add_u32 v4, v4, v2
  v_bfe_i32 v2, v0, 5, 1
  v_and_b32 v2, 0x800, v2
  v_add_u32 v4, v4, v2
  v_bfe_i32 v2, v0, 6, 1
  v_and_b32 v2, 0x2000, v2
  v_add_u32 v4, v4, v2
  v_bfe_i32 v2, v0, 7, 1
  v_and_b32 v2, 0x4000, v2
  v_add_u32 v4, v4, v2
  v_add_u32 v5, 4096, v4
  v_mov_b32 v6, 0x0
  v_bfe_i32 v2, v0, 0, 1
  v_and_b32 v2, 0x400, v2
  v_add_u32 v6, v6, v2
  v_bfe_i32 v2, v0, 1, 1
  v_and_b32 v2, 0x800, v2
  v_add_u32 v6, v6, v2
  v_bfe_i32 v2, v0, 2, 1
  v_and_b32 v2, 0x1000, v2
  v_add_u32 v6, v6, v2
  v_bfe_i32 v2, v0, 3, 1
  v_and_b32 v2, 0x10, v2
  v_add_u32 v6, v6, v2
  v_bfe_i32 v2, v0, 4, 1
  v_and_b32 v2, 0x20, v2
  v_add_u32 v6, v6, v2
  v_bfe_i32 v2, v0, 5, 1
  v_and_b32 v2, 0x40, v2
  v_add_u32 v6, v6, v2
  v_bfe_i32 v2, v0, 6, 1
  v_and_b32 v2, 0x100, v2
  v_add_u32 v6, v6, v2
  v_bfe_i32 v2, v0, 7, 1
  v_and_b32 v2, 0x200, v2
  v_add_u32 v6, v6, v2
  v_mov_b32 v7, 0x0
  v_bfe_i32 v2, v0, 0, 1
  v_and_b32 v2, 0x4, v2
  v_add_u32 v7, v7, v2
  v_bfe_i32 v2, v0, 1, 1
  v_and_b32 v2, 0x8, v2
  v_add_u32 v7, v7, v2
  v_bfe_i32 v2, v0, 2, 1
  v_and_b32 v2, 0x10, v2
  v_add_u32 v7, v7, v2
  v_bfe_i32 v2, v0, 6, 1
  v_and_b32 v2, 0x20, v2
  v_add_u32 v7, v7, v2
  v_bfe_i32 v2, v0, 7, 1
  v_and_b32 v2, 0x40, v2
  v_add_u32 v7, v7, v2
  v_mov_b32 v8, 0x0
  v_bfe_i32 v2, v0, 6, 1
  v_and_b32 v2, 0x10, v2
  v_add_u32 v8, v8, v2
  v_bfe_i32 v2, v0, 7, 1
  v_and_b32 v2, 0x20, v2
  v_add_u32 v8, v8, v2
  v_mov_b32 v9, 0x0
  v_bfe_i32 v2, v0, 0, 1
  v_and_b32 v2, 0x10, v2
  v_add_u32 v9, v9, v2
  v_bfe_i32 v2, v0, 1, 1
  v_and_b32 v2, 0x20, v2
  v_add_u32 v9, v9, v2
  v_bfe_i32 v2, v0, 2, 1
  v_and_b32 v2, 0x40, v2
  v_add_u32 v9, v9, v2
  v_bfe_i32 v2, v0, 6, 1
  v_and_b32 v2, 0x4, v2
  v_add_u32 v9, v9, v2
  v_bfe_i32 v2, v0, 7, 1
  v_and_b32 v2, 0x8, v2
  v_add_u32 v9, v9, v2
  v_mov_b32 v10, 0x0
  v_bfe_i32 v2, v0, 0, 1
  v_and_b32 v2, 0x10, v2
  v_add_u32 v10, v10, v2
  v_bfe_i32 v2, v0, 1, 1
  v_and_b32 v2, 0x20, v2
  v_add_u32 v10, v10, v2
  v_bfe_i32 v2, v0, 2, 1
  v_and_b32 v2, 0x40, v2
  v_add_u32 v10, v10, v2
  v_mov_b32_e64 v11, 1
  s_mov_b32 s59, 0
  s_mov_b32 s88, 0
  s_mov_b32 s8, s48
  s_and_b32 s9, s49, 0xffff
  s_mov_b32 s10, 0x100
  s_mov_b32 s11, 0x20000
  v_and_b32 v2, 3, v0
  v_lshlrev_b32 v2, 6, v2
L_gate_71:
  buffer_load_dword v12, v2, s[8:11], 0 offen offset:8 sc1
  s_waitcnt vmcnt(0)
  v_cmp_gt_u32 vcc, 48, v12
  s_cbranch_vccz L_gateok_72
  s_add_u32 s72, s72, 1
  s_cmp_gt_u32 s72, 0x80000
  s_cbranch_scc1 L_exit
  s_sleep 2
  s_branch L_gate_71
L_gateok_72:
L_R_73:
  s_cmp_eq_u32 s59, 1
  s_cbranch_scc1 L_rh_74
L_rp_76:
  s_lshl_b32 s61, s55, 7
  s_add_u32 s61, s61, s53
  s_add_u32 s61, s61, 0x21000
  buffer_load_dword v12, v7, s[4:7], s61 offen sc1
  s_waitcnt vmcnt(0)
  s_cmp_eq_u32 s88, 0
  s_cbranch_scc1 L_nofl_78
  s_mov_b64 exec, 1
  buffer_store_dword v11, v8, s[4:7], s88 offen sc1
  s_mov_b64 exec, -1
  s_mov_b32 s88, 0
L_nofl_78:
  v_cmp_eq_u32 vcc, 0, v12
  s_cbranch_vccz L_rpo_77
  s_add_u32 s72, s72, 1
  s_cmp_gt_u32 s72, 0x80000
  s_cbranch_scc1 L_exit
  s_branch L_rp_76
L_rpo_77:
  s_and_b32 s61, s55, 7
  s_lshl_b32 s61, s61, 17
  s_lshl_b32 s62, s54, 13
  s_add_u32 s61, s61, s62
  s_add_u32 s61, s61, s52
  s_add_u32 s61, s61, 0x4000000
  buffer_load_dwordx2 v[16:17], v3, s[4:7], s61 offen offset:0 sc1
  buffer_load_dwordx2 v[18:19], v3, s[4:7], s61 offen offset:128 sc1
  buffer_load_dwordx2 v[20:21], v3, s[4:7], s61 offen offset:1024 sc1
  buffer_load_dwordx2 v[22:23], v3, s[4:7], s61 offen offset:1152 sc1
  s_add_u32 s61, s61, 0x8000
  buffer_load_dwordx2 v[32:33], v3, s[4:7], s61 offen offset:0 sc1
  buffer_load_dwordx2 v[34:35], v3, s[4:7], s61 offen offset:128 sc1
  buffer_load_dwordx2 v[36:37], v3, s[4:7], s61 offen offset:1024 sc1
  buffer_load_dwordx2 v[38:39], v3, s[4:7], s61 offen offset:1152 sc1
  s_and_b32 s62, s55, 7
  s_lshl_b32 s62, s62, 15
  s_lshl_b32 s61, s54, 7
  s_add_u32 s62, s62, s61
  s_add_u32 s62, s62, s52
  s_add_u32 s62, s62, 0x5c00000
  buffer_load_dwordx4 v[56:59], v4, s[4:7], s62 offen sc1
  buffer_load_dwordx4 v[60:63], v5, s[4:7], s62 offen sc1
  s_waitcnt vmcnt(0)
  s_branch L_rj_75
L_rh_74:
  s_waitcnt vmcnt(2)
L_rj_75:
  s_mov_b32 s59, 0
  s_add_u32 s74, s55, s56
  s_min_u32 s62, s74, 63
  s_lshl_b32 s61, s62, 7
  s_add_u32 s61, s61, s53
  s_add_u32 s61, s61, 0x21000
  buffer_load_dword v12, v7, s[4:7], s61 offen sc1
  s_lshl_b32 s76, s55, 15
  s_lshl_b32 s61, s54, 7
  s_add_u32 s76, s76, s61
  s_add_u32 s76, s76, s52
  s_lshl_b32 s77, s55, 15
  s_lshl_b32 s61, s54, 13
  s_add_u32 s77, s77, s61
  v_lshlrev_b32 v64, 16, v56
  v_and_b32 v65, 0xffff0000, v56
  v_lshlrev_b32 v66, 16, v57
  v_and_b32 v67, 0xffff0000, v57
  v_lshlrev_b32 v68, 16, v58
  v_and_b32 v69, 0xffff0000, v58
  v_lshlrev_b32 v70, 16, v59
  v_and_b32 v71, 0xffff0000, v59
  v_lshlrev_b32 v72, 16, v60
  v_and_b32 v73, 0xffff0000, v60
  v_lshlrev_b32 v74, 16, v61
  v_and_b32 v75, 0xffff0000, v61
  v_lshlrev_b32 v76, 16, v62
  v_and_b32 v77, 0xffff0000, v62
  v_lshlrev_b32 v78, 16, v63
  v_and_b32 v79, 0xffff0000, v63
  v_lshlrev_b32 v80, 16, v16
  v_and_b32 v81, 0xffff0000, v16
  v_lshlrev_b32 v82, 16, v17
  v_and_b32 v83, 0xffff0000, v17
  v_lshlrev_b32 v84, 16, v18
  v_and_b32 v85, 0xffff0000, v18
  v_lshlrev_b32 v86, 16, v19
  v_and_b32 v87, 0xffff0000, v19
  v_lshlrev_b32 v88, 16, v20
  v_and_b32 v89, 0xffff0000, v20
  v_lshlrev_b32 v90, 16, v21
  v_and_b32 v91, 0xffff0000, v21
  v_lshlrev_b32 v92, 16, v22
  v_and_b32 v93, 0xffff0000, v22
  v_lshlrev_b32 v94, 16, v23
  v_and_b32 v95, 0xffff0000, v23
  v_lshlrev_b32 v96, 16, v32
  v_and_b32 v97, 0xffff0000, v32
  v_lshlrev_b32 v98, 16, v33
  v_and_b32 v99, 0xffff0000, v33
  v_lshlrev_b32 v100, 16, v34
  v_and_b32 v101, 0xffff0000, v34
  v_lshlrev_b32 v102, 16, v35
  v_and_b32 v103, 0xffff0000, v35
  v_lshlrev_b32 v104, 16, v36
  v_and_b32 v105, 0xffff0000, v36
  v_lshlrev_b32 v106, 16, v37
  v_and_b32 v107, 0xffff0000, v37
  v_lshlrev_b32 v108, 16, v38
  v_and_b32 v109, 0xffff0000, v38
  v_lshlrev_b32_e64 v110, 16, v39
  v_and_b32 v111, 0xffff0000, v39
  v_pk_add_f32 v[80:81], v[80:81], v[96:97]
  v_pk_add_f32 v[82:83], v[82:83], v[98:99]
  v_pk_add_f32 v[84:85], v[84:85], v[100:101]
  v_pk_add_f32 v[86:87], v[86:87], v[102:103]
  v_pk_add_f32 v[88:89], v[88:89], v[104:105]
  v_pk_add_f32 v[90:91], v[90:91], v[106:107]
  v_pk_add_f32 v[92:93], v[92:93], v[108:109]
  v_pk_add_f32 v[94:95], v[94:95], v[110:111]
  v_cvt_pk_bf16_f32 v120, v80, v81
  v_cvt_pk_bf16_f32 v121, v82, v83
  v_cvt_pk_bf16_f32 v122, v84, v85
  v_cvt_pk_bf16_f32 v123, v86, v87
  v_cvt_pk_bf16_f32 v124, v88, v89
  v_cvt_pk_bf16_f32 v125, v90, v91
  v_cvt_pk_bf16_f32 v126, v92, v93
  v_cvt_pk_bf16_f32 v127, v94, v95
  v_lshlrev_b32 v80, 16, v120
  v_and_b32 v81, 0xffff0000, v120
  v_lshlrev_b32 v82, 16, v121
  v_and_b32 v83, 0xffff0000, v121
  v_lshlrev_b32 v84, 16, v122
  v_and_b32 v85, 0xffff0000, v122
  v_lshlrev_b32 v86, 16, v123
  v_and_b32 v87, 0xffff0000, v123
  v_lshlrev_b32 v88, 16, v124
  v_and_b32 v89, 0xffff0000, v124
  v_lshlrev_b32 v90, 16, v125
  v_and_b32 v91, 0xffff0000, v125
  v_lshlrev_b32 v92, 16, v126
  v_and_b32 v93, 0xffff0000, v126
  v_lshlrev_b32 v94, 16, v127
  v_and_b32 v95, 0xffff0000, v127
  v_pk_add_f32 v[64:65], v[64:65], v[80:81]
  v_pk_add_f32 v[66:67], v[66:67], v[82:83]
  v_pk_add_f32 v[68:69], v[68:69], v[84:85]
  v_pk_add_f32 v[70:71], v[70:71], v[86:87]
  v_pk_add_f32 v[72:73], v[72:73], v[88:89]
  v_pk_add_f32 v[74:75], v[74:75], v[90:91]
  v_pk_add_f32 v[76:77], v[76:77], v[92:93]
  v_pk_add_f32 v[78:79], v[78:79], v[94:95]
  v_cvt_pk_bf16_f32 v48, v64, v65
  v_cvt_pk_bf16_f32 v49, v66, v67
  v_cvt_pk_bf16_f32 v50, v68, v69
  v_cvt_pk_bf16_f32 v51, v70, v71
  v_cvt_pk_bf16_f32 v52, v72, v73
  v_cvt_pk_bf16_f32 v53, v74, v75
  v_cvt_pk_bf16_f32 v54, v76, v77
  v_cvt_pk_bf16_f32 v55, v78, v79
  s_add_u32 s62, s76, 0xb800000
  buffer_store_dwordx4 v[48:51], v4, s[4:7], s62 offen sc1
  buffer_store_dwordx4 v[52:55], v5, s[4:7], s62 offen sc1
  v_lshlrev_b32 v64, 16, v48
  v_and_b32 v65, 0xffff0000, v48
  v_lshlrev_b32 v66, 16, v49
  v_and_b32 v67, 0xffff0000, v49
  v_lshlrev_b32 v68, 16, v50
  v_and_b32 v69, 0xffff0000, v50
  v_lshlrev_b32 v70, 16, v51
  v_and_b32 v71, 0xffff0000, v51
  v_lshlrev_b32 v72, 16, v52
  v_and_b32 v73, 0xffff0000, v52
  v_lshlrev_b32 v74, 16, v53
  v_and_b32 v75, 0xffff0000, v53
  v_lshlrev_b32 v76, 16, v54
  v_and_b32 v77, 0xffff0000, v54
  v_lshlrev_b32 v78, 16, v55
  v_and_b32 v79, 0xffff0000, v55
  v_pk_add_f32 v[116:117], v[64:65], v[66:67]
  v_pk_add_f32 v[118:119], v[68:69], v[70:71]
  v_pk_add_f32 v[116:117], v[116:117], v[72:73]
  v_pk_add_f32 v[118:119], v[118:119], v[74:75]
  v_pk_add_f32 v[116:117], v[116:117], v[76:77]
  v_pk_add_f32 v[118:119], v[118:119], v[78:79]
  v_pk_add_f32 v[116:117], v[116:117], v[118:119]
  v_add_f32 v112, v116, v117
  s_nop 1
  v_add_f32_dpp v112, v112, v112 row_ror:8 row_mask:0xf bank_mask:0xf
  v_mov_b32 v116, v112
  s_nop 1
  v_permlane16_swap_b32 v112, v116
  s_nop 0
  v_add_f32 v112, v112, v116
  v_mov_b32 v116, v112
  s_nop 1
  v_permlane32_swap_b32 v112, v116
  s_nop 0
  v_add_f32 v112, v112, v116
  v_mul_f32 v112, 0x3c000000, v112
  v_sub_f32 v80, v64, v112
  v_sub_f32 v81, v65, v112
  v_sub_f32 v82, v66, v112
  v_sub_f32 v83, v67, v112
  v_sub_f32 v84, v68, v112
  v_sub_f32 v85, v69, v112
  v_sub_f32 v86, v70, v112
  v_sub_f32 v87, v71, v112
  v_sub_f32 v88, v72, v112
  v_sub_f32 v89, v73, v112
  v_sub_f32 v90, v74, v112
  v_sub_f32 v91, v75, v112
  v_sub_f32 v92, v76, v112
  v_sub_f32 v93, v77, v112
  v_sub_f32 v94, v78, v112
  v_sub_f32 v95, v79, v112
  v_pk_mul_f32 v[80:81], v[80:81], v[80:81]
  v_pk_mul_f32 v[82:83], v[82:83], v[82:83]
  v_pk_mul_f32 v[84:85], v[84:85], v[84:85]
  v_pk_mul_f32 v[86:87], v[86:87], v[86:87]
  v_pk_mul_f32 v[88:89], v[88:89], v[88:89]
  v_pk_mul_f32 v[90:91], v[90:91], v[90:91]
  v_pk_mul_f32 v[92:93], v[92:93], v[92:93]
  v_pk_mul_f32 v[94:95], v[94:95], v[94:95]
  v_pk_add_f32 v[116:117], v[80:81], v[82:83]
  v_pk_add_f32 v[118:119], v[84:85], v[86:87]
  v_pk_add_f32 v[116:117], v[116:117], v[88:89]
  v_pk_add_f32 v[118:119], v[118:119], v[90:91]
  v_pk_add_f32 v[116:117], v[116:117], v[92:93]
  v_pk_add_f32 v[118:119], v[118:119], v[94:95]
  v_pk_add_f32 v[116:117], v[116:117], v[118:119]
  v_add_f32 v113, v116, v117
  s_nop 1
  v_add_f32_dpp v113, v113, v113 row_ror:8 row_mask:0xf bank_mask:0xf
  v_mov_b32 v116, v113
  s_nop 1
  v_permlane16_swap_b32 v113, v116
  s_nop 0
  v_add_f32 v113, v113, v116
  v_mov_b32 v116, v113
  s_nop 1
  v_permlane32_swap_b32 v113, v116
  s_nop 0
  v_add_f32 v113, v113, v116
  s_mov_b64 exec, 0xff
  ds_write_b32 v9, v112
  ds_write_b32 v9, v113 offset:128
  s_mov_b64 exec, -1
  s_waitcnt lgkmcnt(0)
  s_barrier
  ds_read_b128 v[80:83], v10
  ds_read_b128 v[84:87], v10 offset:128
  s_waitcnt vmcnt(2)
  s_cmp_eq_u32 s88, 0
  s_cbranch_scc1 L_nofl_80
  s_mov_b64 exec, 1
  buffer_store_dword v11, v8, s[4:7], s88 offen sc1
  s_mov_b64 exec, -1
  s_mov_b32 s88, 0
L_nofl_80:
  s_cmp_ge_u32 s74, s57
  s_cbranch_scc1 L_rnp_79
  v_cmp_eq_u32 vcc, 0, v12
  s_cbranch_vccnz L_rnp_79
  s_and_b32 s61, s74, 7
  s_lshl_b32 s61, s61, 17
  s_lshl_b32 s62, s54, 13
  s_add_u32 s61, s61, s62
  s_add_u32 s61, s61, s52
  s_add_u32 s61, s61, 0x4000000
  buffer_load_dwordx2 v[16:17], v3, s[4:7], s61 offen offset:0 sc1
  buffer_load_dwordx2 v[18:19], v3, s[4:7], s61 offen offset:128 sc1
  buffer_load_dwordx2 v[20:21], v3, s[4:7], s61 offen offset:1024 sc1
  buffer_load_dwordx2 v[22:23], v3, s[4:7], s61 offen offset:1152 sc1
  s_add_u32 s61, s61, 0x8000
  buffer_load_dwordx2 v[32:33], v3, s[4:7], s61 offen offset:0 sc1
  buffer_load_dwordx2 v[34:35], v3, s[4:7], s61 offen offset:128 sc1
  buffer_load_dwordx2 v[36:37], v3, s[4:7], s61 offen offset:1024 sc1
  buffer_load_dwordx2 v[38:39], v3, s[4:7], s61 offen offset:1152 sc1
  s_and_b32 s62, s74, 7
  s_lshl_b32 s62, s62, 15
  s_lshl_b32 s61, s54, 7
  s_add_u32 s62, s62, s61
  s_add_u32 s62, s62, s52
  s_add_u32 s62, s62, 0x5c00000
  buffer_load_dwordx4 v[56:59], v4, s[4:7], s62 offen sc1
  buffer_load_dwordx4 v[60:63], v5, s[4:7], s62 offen sc1
  s_mov_b32 s59, 1
L_rnp_79:
  v_xor_b32 v9, 256, v9
  v_xor_b32 v10, 256, v10
  s_waitcnt lgkmcnt(0)
  v_pk_add_f32 v[116:117], v[80:81], v[82:83]
  v_pk_add_f32 v[84:85], v[84:85], v[86:87]
  v_add_f32 v114, v116, v117
  v_add_f32 v112, v84, v85
  v_mul_f32 v114, 0x3e800000, v114
  v_mul_f32 v112, 0x3b000000, v112
  v_sub_f32 v80, v80, v114
  v_sub_f32 v81, v81, v114
  v_sub_f32 v82, v82, v114
  v_sub_f32 v83, v83, v114
  v_mul_f32 v84, v80, v80
  v_fmac_f32 v84, v81, v81
  v_fmac_f32 v84, v82, v82
  v_fmac_f32 v84, v83, v83
  v_fmac_f32 v112, 0x3e800000, v84
  v_cvt_pk_bf16_f32 v113, v114, v112
  v_lshlrev_b32 v114, 16, v113
  v_and_b32 v112, 0xffff0000, v113
  v_add_f32 v112, 0x3727c5ac, v112
  v_cvt_pk_bf16_f32 v112, v112, v112
  v_lshlrev_b32 v112, 16, v112
  v_sqrt_f32 v112, v112
  s_nop 0
  v_cvt_pk_bf16_f32 v112, v112, v112
  v_lshlrev_b32 v112, 16, v112
  v_rcp_f32 v112, v112
  v_sub_f32 v80, v64, v114
  v_sub_f32 v81, v65, v114
  v_sub_f32 v82, v66, v114
  v_sub_f32 v83, v67, v114
  v_sub_f32 v84, v68, v114
  v_sub_f32 v85, v69, v114
  v_sub_f32 v86, v70, v114
  v_sub_f32 v87, v71, v114
  v_sub_f32 v88, v72, v114
  v_sub_f32 v89, v73, v114
  v_sub_f32 v90, v74, v114
  v_sub_f32 v91, v75, v114
  v_sub_f32 v92, v76, v114
  v_sub_f32 v93, v77, v114
  v_sub_f32 v94, v78, v114
  v_sub_f32_e64 v95, v79, v114
  v_cvt_pk_bf16_f32 v120, v80, v81
  v_cvt_pk_bf16_f32 v121, v82, v83
  v_cvt_pk_bf16_f32 v122, v84, v85
  v_cvt_pk_bf16_f32 v123, v86, v87
  v_cvt_pk_bf16_f32 v124, v88, v89
  v_cvt_pk_bf16_f32 v125, v90, v91
  v_cvt_pk_bf16_f32 v126, v92, v93
  v_cvt_pk_bf16_f32 v127, v94, v95
  v_lshlrev_b32 v80, 16, v120
  v_and_b32 v81, 0xffff0000, v120
  v_lshlrev_b32 v82, 16, v121
  v_and_b32 v83, 0xffff0000, v121
  v_lshlrev_b32 v84, 16, v122
  v_and_b32 v85, 0xffff0000, v122
  v_lshlrev_b32 v86, 16, v123
  v_and_b32 v87, 0xffff0000, v123
  v_lshlrev_b32 v88, 16, v124
  v_and_b32 v89, 0xffff0000, v124
  v_lshlrev_b32 v90, 16, v125
  v_and_b32 v91, 0xffff0000, v125
  v_lshlrev_b32 v92, 16, v126
  v_and_b32 v93, 0xffff0000, v126
  v_lshlrev_b32 v94, 16, v127
  v_and_b32 v95, 0xffff0000, v127
  v_pk_mul_f32 v[80:81], v[80:81], v[112:113] op_sel_hi:[1,0]
  v_pk_mul_f32 v[82:83], v[82:83], v[112:113] op_sel_hi:[1,0]
  v_pk_mul_f32 v[84:85], v[84:85], v[112:113] op_sel_hi:[1,0]
  v_pk_mul_f32 v[86:87], v[86:87], v[112:113] op_sel_hi:[1,0]
  v_pk_mul_f32 v[88:89], v[88:89], v[112:113] op_sel_hi:[1,0]
  v_pk_mul_f32 v[90:91], v[90:91], v[112:113] op_sel_hi:[1,0]
  v_pk_mul_f32 v[92:93], v[92:93], v[112:113] op_sel_hi:[1,0]
  v_pk_mul_f32 v[94:95], v[94:95], v[112:113] op_sel_hi:[1,0]
  v_cvt_pk_bf16_f32 v120, v80, v81
  v_cvt_pk_bf16_f32 v121, v82, v83
  v_cvt_pk_bf16_f32 v122, v84, v85
  v_cvt_pk_bf16_f32 v123, v86, v87
  v_cvt_pk_bf16_f32 v124, v88, v89
  v_cvt_pk_bf16_f32 v125, v90, v91
  v_cvt_pk_bf16_f32 v126, v92, v93
  v_cvt_pk_bf16_f32 v127, v94, v95
  s_add_u32 s62, s76, 0xba00000
  buffer_store_dwordx4 v[120:123], v4, s[4:7], s62 offen sc1
  buffer_store_dwordx4 v[124:127], v5, s[4:7], s62 offen sc1
  s_lshl_b32 s61, s55, 6
  s_lshl_b32 s62, s54, 2
  s_add_u32 s61, s61, s62
  s_add_u32 s61, s61, s53
  s_add_u32 s88, s61, 0x63000
  s_mov_b32 s55, s74
  s_cmp_lt_u32 s55, s57
  s_cbranch_scc1 L_R_73
  s_waitcnt vmcnt(0)
  s_cmp_eq_u32 s88, 0
  s_cbranch_scc1 L_nofl_81
  s_mov_b64 exec, 1
  buffer_store_dword v11, v8, s[4:7], s88 offen sc1
  s_mov_b64 exec, -1
  s_mov_b32 s88, 0
L_nofl_81:
  s_endpgm
B_r5f:
  v_mov_b32 v3, 0x0
  v_bfe_i32 v2, v0, 0, 1
  v_and_b32 v2, 0x10, v2
  v_add_u32 v3, v3, v2
  v_bfe_i32 v2, v0, 1, 1
  v_and_b32 v2, 0x20, v2
  v_add_u32 v3, v3, v2
  v_bfe_i32 v2, v0, 2, 1
  v_and_b32 v2, 0x40, v2
  v_add_u32 v3, v3, v2
  v_bfe_i32 v2, v0, 3, 1
  v_and_b32 v2, 0x8, v2
  v_add_u32 v3, v3, v2
  v_bfe_i32 v2, v0, 4, 1
  v_and_b32 v2, 0x100, v2
  v_add_u32 v3, v3, v2
  v_bfe_i32 v2, v0, 5, 1
  v_and_b32 v2, 0x200, v2
  v_add_u32 v3, v3, v2
  v_bfe_i32 v2, v0, 6, 1
  v_and_b32 v2, 0x800, v2
  v_add_u32 v3, v3, v2
  v_bfe_i32 v2, v0, 7, 1
  v_and_b32 v2, 0x1000, v2
  v_add_u32 v3, v3, v2
  v_mov_b32 v4, 0x0
  v_bfe_i32 v2, v0, 0, 1
  v_and_b32 v2, 0x10, v2
  v_add_u32 v4, v4, v2
  v_bfe_i32 v2, v0, 1, 1
  v_and_b32 v2, 0x20, v2
  v_add_u32 v4, v4, v2
  v_bfe_i32 v2, v0, 2, 1
  v_and_b32 v2, 0x40, v2
  v_add_u32 v4, v4, v2
  v_bfe_i32 v2, v0, 3, 1
  v_and_b32 v2, 0x200, v2
  v_add_u32 v4, v4, v2
  v_bfe_i32 v2, v0, 4, 1
  v_and_b32 v2, 0x400, v2
  v_add_u32 v4, v4, v2
  v_bfe_i32 v2, v0, 5, 1
  v_and_b32 v2, 0x800, v2
  v_add_u32 v4, v4, v2
  v_bfe_i32 v2, v0, 6, 1
  v_and_b32 v2, 0x2000, v2
  v_add_u32 v4, v4, v2
  v_bfe_i32 v2, v0, 7, 1
  v_and_b32 v2, 0x4000, v2
  v_add_u32 v4, v4, v2
  v_add_u32 v5, 4096, v4
  v_mov_b32 v6, 0x0
  v_bfe_i32 v2, v0, 0, 1
  v_and_b32 v2, 0x400, v2
  v_add_u32 v6, v6, v2
  v_bfe_i32 v2, v0, 1, 1
  v_and_b32 v2, 0x800, v2
  v_add_u32 v6, v6, v2
  v_bfe_i32 v2, v0, 2, 1
  v_and_b32 v2, 0x1000, v2
  v_add_u32 v6, v6, v2
  v_bfe_i32 v2, v0, 3, 1
  v_and_b32 v2, 0x10, v2
  v_add_u32 v6, v6, v2
  v_bfe_i32 v2, v0, 4, 1
  v_and_b32 v2, 0x20, v2
  v_add_u32 v6, v6, v2
  v_bfe_i32 v2, v0, 5, 1
  v_and_b32 v2, 0x40, v2
  v_add_u32 v6, v6, v2
  v_bfe_i32 v2, v0, 6, 1
  v_and_b32 v2, 0x100, v2
  v_add_u32 v6, v6, v2
  v_bfe_i32 v2, v0, 7, 1
  v_and_b32 v2, 0x200, v2
  v_add_u32 v6, v6, v2
  v_mov_b32 v7, 0x0
  v_bfe_i32 v2, v0, 0, 1
  v_and_b32 v2, 0x4, v2
  v_add_u32 v7, v7, v2
  v_bfe_i32 v2, v0, 1, 1
  v_and_b32 v2, 0x8, v2
  v_add_u32 v7, v7, v2
  v_bfe_i32 v2, v0, 2, 1
  v_and_b32 v2, 0x10, v2
  v_add_u32 v7, v7, v2
  v_bfe_i32 v2, v0, 6, 1
  v_and_b32 v2, 0x20, v2
  v_add_u32 v7, v7, v2
  v_bfe_i32 v2, v0, 7, 1
  v_and_b32 v2, 0x40, v2
  v_add_u32 v7, v7, v2
  v_mov_b32 v8, 0x0
  v_bfe_i32 v2, v0, 6, 1
  v_and_b32 v2, 0x10, v2
  v_add_u32 v8, v8, v2
  v_bfe_i32 v2, v0, 7, 1
  v_and_b32 v2, 0x20, v2
  v_add_u32 v8, v8, v2
  v_mov_b32 v9, 0x0
  v_bfe_i32 v2, v0, 0, 1
  v_and_b32 v2, 0x10, v2
  v_add_u32 v9, v9, v2
  v_bfe_i32 v2, v0, 1, 1
  v_and_b32 v2, 0x20, v2
  v_add_u32 v9, v9, v2
  v_bfe_i32 v2, v0, 2, 1
  v_and_b32 v2, 0x40, v2
  v_add_u32 v9, v9, v2
  v_bfe_i32 v2, v0, 6, 1
  v_and_b32 v2, 0x4, v2
  v_add_u32 v9, v9, v2
  v_bfe_i32 v2, v0, 7, 1
  v_and_b32 v2, 0x8, v2
  v_add_u32 v9, v9, v2
  v_mov_b32 v10, 0x0
  v_bfe_i32 v2, v0, 0, 1
  v_and_b32 v2, 0x10, v2
  v_add_u32 v10, v10, v2
  v_bfe_i32 v2, v0, 1, 1
  v_and_b32 v2, 0x20, v2
  v_add_u32 v10, v10, v2
  v_bfe_i32 v2, v0, 2, 1
  v_and_b32 v2, 0x40, v2
  v_add_u32 v10, v10, v2
  v_mov_b32_e64 v11, 1
  s_mov_b32 s16, s46
  s_and_b32 s17, s47, 0xffff
  s_mov_b32 s18, 0x200000
  s_mov_b32 s19, 0x20000
  s_mov_b32 s59, 0
  s_mov_b32 s88, 0
  s_mov_b32 s8, s48
  s_and_b32 s9, s49, 0xffff
  s_mov_b32 s10, 0x100
  s_mov_b32 s11, 0x20000
  v_and_b32 v2, 3, v0
  v_lshlrev_b32 v2, 6, v2
L_gate_82:
  buffer_load_dword v12, v2, s[8:11], 0 offen offset:8 sc1
  s_waitcnt vmcnt(0)
  v_cmp_gt_u32 vcc, 48, v12
  s_cbranch_vccz L_gateok_83
  s_add_u32 s72, s72, 1
  s_cmp_gt_u32 s72, 0x80000
  s_cbranch_scc1 L_exit
  s_sleep 2
  s_branch L_gate_82
L_gateok_83:
L_R_84:
  s_cmp_eq_u32 s59, 1
  s_cbranch_scc1 L_rh_85
L_rp_87:
  s_lshl_b32 s61, s55, 7
  s_add_u32 s61, s61, s53
  s_add_u32 s61, s61, 0x21000
  buffer_load_dword v12, v7, s[4:7], s61 offen sc1
  s_waitcnt vmcnt(0)
  s_cmp_eq_u32 s88, 0
  s_cbranch_scc1 L_nofl_89
  s_mov_b64 exec, 1
  buffer_store_dword v11, v8, s[4:7], s88 offen sc1
  s_mov_b64 exec, -1
  s_mov_b32 s88, 0
L_nofl_89:
  v_cmp_eq_u32 vcc, 0, v12
  s_cbranch_vccz L_rpo_88
  s_add_u32 s72, s72, 1
  s_cmp_gt_u32 s72, 0x80000
  s_cbranch_scc1 L_exit
  s_branch L_rp_87
L_rpo_88:
  s_and_b32 s61, s55, 7
  s_lshl_b32 s61, s61, 17
  s_lshl_b32 s62, s54, 13
  s_add_u32 s61, s61, s62
  s_add_u32 s61, s61, s52
  s_add_u32 s61, s61, 0x4000000
  buffer_load_dwordx2 v[16:17], v3, s[4:7], s61 offen offset:0 sc1
  buffer_load_dwordx2 v[18:19], v3, s[4:7], s61 offen offset:128 sc1
  buffer_load_dwordx2 v[20:21], v3, s[4:7], s61 offen offset:1024 sc1
  buffer_load_dwordx2 v[22:23], v3, s[4:7], s61 offen offset:1152 sc1
  s_add_u32 s61, s61, 0x8000
  buffer_load_dwordx2 v[32:33], v3, s[4:7], s61 offen offset:0 sc1
  buffer_load_dwordx2 v[34:35], v3, s[4:7], s61 offen offset:128 sc1
  buffer_load_dwordx2 v[36:37], v3, s[4:7], s61 offen offset:1024 sc1
  buffer_load_dwordx2 v[38:39], v3, s[4:7], s61 offen offset:1152 sc1
  s_and_b32 s62, s55, 7
  s_lshl_b32 s62, s62, 15
  s_lshl_b32 s61, s54, 7
  s_add_u32 s62, s62, s61
  s_add_u32 s62, s62, s52
  s_add_u32 s62, s62, 0x5c00000
  buffer_load_dwordx4 v[56:59], v4, s[4:7], s62 offen sc1
  buffer_load_dwordx4 v[60:63], v5, s[4:7], s62 offen sc1
  s_waitcnt vmcnt(0)
  s_branch L_rj_86
L_rh_85:
  s_waitcnt vmcnt(0)
L_rj_86:
  s_mov_b32 s59, 0
  s_add_u32 s74, s55, s56
  s_min_u32 s62, s74, 63
  s_lshl_b32 s61, s62, 7
  s_add_u32 s61, s61, s53
  s_add_u32 s61, s61, 0x21000
  buffer_load_dword v12, v7, s[4:7], s61 offen sc1
  s_lshl_b32 s76, s55, 15
  s_lshl_b32 s61, s54, 7
  s_add_u32 s76, s76, s61
  s_add_u32 s76, s76, s52
  s_lshl_b32 s77, s55, 15
  s_lshl_b32 s61, s54, 13
  s_add_u32 s77, s77, s61
  v_lshlrev_b32 v64, 16, v56
  v_and_b32 v65, 0xffff0000, v56
  v_lshlrev_b32 v66, 16, v57
  v_and_b32 v67, 0xffff0000, v57
  v_lshlrev_b32 v68, 16, v58
  v_and_b32 v69, 0xffff0000, v58
  v_lshlrev_b32 v70, 16, v59
  v_and_b32 v71, 0xffff0000, v59
  v_lshlrev_b32 v72, 16, v60
  v_and_b32 v73, 0xffff0000, v60
  v_lshlrev_b32 v74, 16, v61
  v_and_b32 v75, 0xffff0000, v61
  v_lshlrev_b32 v76, 16, v62
  v_and_b32 v77, 0xffff0000, v62
  v_lshlrev_b32 v78, 16, v63
  v_and_b32 v79, 0xffff0000, v63
  v_lshlrev_b32 v80, 16, v16
  v_and_b32 v81, 0xffff0000, v16
  v_lshlrev_b32 v82, 16, v17
  v_and_b32 v83, 0xffff0000, v17
  v_lshlrev_b32 v84, 16, v18
  v_and_b32 v85, 0xffff0000, v18
  v_lshlrev_b32 v86, 16, v19
  v_and_b32 v87, 0xffff0000, v19
  v_lshlrev_b32 v88, 16, v20
  v_and_b32 v89, 0xffff0000, v20
  v_lshlrev_b32 v90, 16, v21
  v_and_b32 v91, 0xffff0000, v21
  v_lshlrev_b32 v92, 16, v22
  v_and_b32 v93, 0xffff0000, v22
  v_lshlrev_b32 v94, 16, v23
  v_and_b32 v95, 0xffff0000, v23
  v_lshlrev_b32 v96, 16, v32
  v_and_b32 v97, 0xffff0000, v32
  v_lshlrev_b32 v98, 16, v33
  v_and_b32 v99, 0xffff0000, v33
  v_lshlrev_b32 v100, 16, v34
  v_and_b32 v101, 0xffff0000, v34
  v_lshlrev_b32 v102, 16, v35
  v_and_b32 v103, 0xffff0000, v35
  v_lshlrev_b32 v104, 16, v36
  v_and_b32 v105, 0xffff0000, v36
  v_lshlrev_b32 v106, 16, v37
  v_and_b32 v107, 0xffff0000, v37
  v_lshlrev_b32 v108, 16, v38
  v_and_b32 v109, 0xffff0000, v38
  v_lshlrev_b32 v110, 16, v39
  v_and_b32 v111, 0xffff0000, v39
  v_pk_add_f32 v[80:81], v[80:81], v[96:97]
  v_pk_add_f32 v[82:83], v[82:83], v[98:99]
  v_pk_add_f32 v[84:85], v[84:85], v[100:101]
  v_pk_add_f32 v[86:87], v[86:87], v[102:103]
  v_pk_add_f32 v[88:89], v[88:89], v[104:105]
  v_pk_add_f32 v[90:91], v[90:91], v[106:107]
  v_pk_add_f32 v[92:93], v[92:93], v[108:109]
  v_pk_add_f32 v[94:95], v[94:95], v[110:111]
  v_cvt_pk_bf16_f32 v120, v80, v81
  v_cvt_pk_bf16_f32 v121, v82, v83
  v_cvt_pk_bf16_f32 v122, v84, v85
  v_cvt_pk_bf16_f32 v123, v86, v87
  v_cvt_pk_bf16_f32 v124, v88, v89
  v_cvt_pk_bf16_f32 v125, v90, v91
  v_cvt_pk_bf16_f32 v126, v92, v93
  v_cvt_pk_bf16_f32 v127, v94, v95
  v_lshlrev_b32 v80, 16, v120
  v_and_b32 v81, 0xffff0000, v120
  v_lshlrev_b32 v82, 16, v121
  v_and_b32 v83, 0xffff0000, v121
  v_lshlrev_b32 v84, 16, v122
  v_and_b32 v85, 0xffff0000, v122
  v_lshlrev_b32 v86, 16, v123
  v_and_b32 v87, 0xffff0000, v123
  v_lshlrev_b32 v88, 16, v124
  v_and_b32 v89, 0xffff0000, v124
  v_lshlrev_b32 v90, 16, v125
  v_and_b32 v91, 0xffff0000, v125
  v_lshlrev_b32 v92, 16, v126
  v_and_b32 v93, 0xffff0000, v126
  v_lshlrev_b32 v94, 16, v127
  v_and_b32 v95, 0xffff0000, v127
  v_pk_add_f32 v[64:65], v[64:65], v[80:81]
  v_pk_add_f32 v[66:67], v[66:67], v[82:83]
  v_pk_add_f32 v[68:69], v[68:69], v[84:85]
  v_pk_add_f32 v[70:71], v[70:71], v[86:87]
  v_pk_add_f32 v[72:73], v[72:73], v[88:89]
  v_pk_add_f32 v[74:75], v[74:75], v[90:91]
  v_pk_add_f32 v[76:77], v[76:77], v[92:93]
  v_pk_add_f32 v[78:79], v[78:79], v[94:95]
  v_cvt_pk_bf16_f32 v48, v64, v65
  v_cvt_pk_bf16_f32 v49, v66, v67
  v_cvt_pk_bf16_f32 v50, v68, v69
  v_cvt_pk_bf16_f32 v51, v70, v71
  v_cvt_pk_bf16_f32 v52, v72, v73
  v_cvt_pk_bf16_f32 v53, v74, v75
  v_cvt_pk_bf16_f32 v54, v76, v77
  v_cvt_pk_bf16_f32 v55, v78, v79
  buffer_store_dwordx4 v[48:51], v6, s[16:19], s77 offen
  buffer_store_dwordx4 v[52:55], v6, s[16:19], s77 offen offset:128
  s_waitcnt vmcnt(2)
  s_cmp_eq_u32 s88, 0
  s_cbranch_scc1 L_nofl_91
  s_mov_b64 exec, 1
  buffer_store_dword v11, v8, s[4:7], s88 offen sc1
  s_mov_b64 exec, -1
  s_mov_b32 s88, 0
L_nofl_91:
  s_cmp_ge_u32 s74, s57
  s_cbranch_scc1 L_rnp_90
  v_cmp_eq_u32 vcc, 0, v12
  s_cbranch_vccnz L_rnp_90
  s_and_b32 s61, s74, 7
  s_lshl_b32 s61, s61, 17
  s_lshl_b32 s62, s54, 13
  s_add_u32 s61, s61, s62
  s_add_u32 s61, s61, s52
  s_add_u32 s61, s61, 0x4000000
  buffer_load_dwordx2 v[16:17], v3, s[4:7], s61 offen offset:0 sc1
  buffer_load_dwordx2 v[18:19], v3, s[4:7], s61 offen offset:128 sc1
  buffer_load_dwordx2 v[20:21], v3, s[4:7], s61 offen offset:1024 sc1
  buffer_load_dwordx2 v[22:23], v3, s[4:7], s61 offen offset:1152 sc1
  s_add_u32 s61, s61, 0x8000
  buffer_load_dwordx2 v[32:33], v3, s[4:7], s61 offen offset:0 sc1
  buffer_load_dwordx2 v[34:35], v3, s[4:7], s61 offen offset:128 sc1
  buffer_load_dwordx2 v[36:37], v3, s[4:7], s61 offen offset:1024 sc1
  buffer_load_dwordx2 v[38:39], v3, s[4:7], s61 offen offset:1152 sc1
  s_and_b32 s62, s74, 7
  s_lshl_b32 s62, s62, 15
  s_lshl_b32 s61, s54, 7
  s_add_u32 s62, s62, s61
  s_add_u32 s62, s62, s52
  s_add_u32 s62, s62, 0x5c00000
  buffer_load_dwordx4 v[56:59], v4, s[4:7], s62 offen sc1
  buffer_load_dwordx4 v[60:63], v5, s[4:7], s62 offen sc1
  s_mov_b32 s59, 1
L_rnp_90:
  s_lshl_b32 s61, s55, 6
  s_lshl_b32 s62, s54, 2
  s_add_u32 s61, s61, s62
  s_add_u32 s61, s61, s53
  s_add_u32 s88, s61, 0x63000
  s_mov_b32 s55, s74
  s_cmp_lt_u32 s55, s57
  s_cbranch_scc1 L_R_84
  s_waitcnt vmcnt(0)
  s_cmp_eq_u32 s88, 0
  s_cbranch_scc1 L_nofl_92
  s_mov_b64 exec, 1
  buffer_store_dword v11, v8, s[4:7], s88 offen sc1
  s_mov_b64 exec, -1
  s_mov_b32 s88, 0
L_nofl_92:
  s_endpgm
B_s1:
  v_mov_b32 v6, 0x0
  v_bfe_i32 v2, v0, 0, 1
  v_and_b32 v2, 0x10, v2
  v_add_u32 v6, v6, v2
  v_bfe_i32 v2, v0, 1, 1
  v_and_b32 v2, 0x20, v2
  v_add_u32 v6, v6, v2
  v_bfe_i32 v2, v0, 2, 1
  v_and_b32 v2, 0x40, v2
  v_add_u32 v6, v6, v2
  v_bfe_i32 v2, v0, 3, 1
  v_and_b32 v2, 0x80, v2
  v_add_u32 v6, v6, v2
  v_bfe_i32 v2, v0, 4, 1
  v_and_b32 v2, 0x100, v2
  v_add_u32 v6, v6, v2
  v_bfe_i32 v2, v0, 5, 1
  v_and_b32 v2, 0x200, v2
  v_add_u32 v6, v6, v2
  v_bfe_i32 v2, v0, 6, 1
  v_and_b32 v2, 0x1000, v2
  v_add_u32 v6, v6, v2
  v_bfe_i32 v2, v0, 7, 1
  v_and_b32 v2, 0x2000, v2
  v_add_u32 v6, v6, v2
  v_mov_b32 v7, 0x0
  v_bfe_i32 v2, v0, 0, 1
  v_and_b32 v2, 0x10, v2
  v_add_u32 v7, v7, v2
  v_bfe_i32 v2, v0, 1, 1
  v_and_b32 v2, 0x20, v2
  v_add_u32 v7, v7, v2
  v_bfe_i32 v2, v0, 2, 1
  v_and_b32 v2, 0x40, v2
  v_add_u32 v7, v7, v2
  v_bfe_i32 v2, v0, 3, 1
  v_and_b32 v2, 0x80, v2
  v_add_u32 v7, v7, v2
  v_bfe_i32 v2, v0, 4, 1
  v_and_b32 v2, 0x100, v2
  v_add_u32 v7, v7, v2
  v_bfe_i32 v2, v0, 5, 1
  v_and_b32 v2, 0x200, v2
  v_add_u32 v7, v7, v2
  v_mov_b32 v8, 0x0
  v_bfe_i32 v2, v0, 0, 1
  v_and_b32 v2, 0x4, v2
  v_add_u32 v8, v8, v2
  v_bfe_i32 v2, v0, 1, 1
  v_and_b32 v2, 0x8, v2
  v_add_u32 v8, v8, v2
  v_bfe_i32 v2, v0, 2, 1
  v_and_b32 v2, 0x10, v2
  v_add_u32 v8, v8, v2
  v_bfe_i32 v2, v0, 3, 1
  v_and_b32 v2, 0x20, v2
  v_add_u32 v8, v8, v2
  v_mov_b32 v9, 0x0
  v_bfe_i32 v2, v0, 6, 1
  v_and_b32 v2, 0x4, v2
  v_add_u32 v9, v9, v2
  v_bfe_i32 v2, v0, 7, 1
  v_and_b32 v2, 0x8, v2
  v_add_u32 v9, v9, v2
  v_mov_b32 v10, 1
  v_mov_b32 v12, 0x0
  v_bfe_i32 v2, v0, 0, 1
  v_and_b32 v2, 0x10, v2
  v_add_u32 v12, v12, v2
  v_bfe_i32 v2, v0, 1, 1
  v_and_b32 v2, 0x20, v2
  v_add_u32 v12, v12, v2
  v_bfe_i32 v2, v0, 2, 1
  v_and_b32 v2, 0x40, v2
  v_add_u32 v12, v12, v2
  v_bfe_i32 v2, v0, 3, 1
  v_and_b32 v2, 0x80, v2
  v_add_u32 v12, v12, v2
  v_bfe_i32 v2, v0, 4, 1
  v_and_b32 v2, 0x100, v2
  v_add_u32 v12, v12, v2
  v_bfe_i32 v2, v0, 5, 1
  v_and_b32 v2, 0x200, v2
  v_add_u32 v12, v12, v2
  v_bfe_i32 v2, v0, 6, 1
  v_and_b32 v2, 0x800, v2
  v_add_u32 v12, v12, v2
  v_bfe_i32 v2, v0, 7, 1
  v_and_b32 v2, 0x1000, v2
  v_add_u32_e64 v12, v12, v2
  s_mov_b32 s8, s30
  s_and_b32 s9, s31, 0xffff
  s_mov_b32 s10, 0x400000
  s_mov_b32 s11, 0x20000
  s_mov_b32 s12, s32
  s_and_b32 s13, s33, 0xffff
  s_mov_b32 s14, 0x400000
  s_mov_b32 s15, 0x20000
  v_mov_b32 v3, 0x0
  v_bfe_i32 v2, v0, 0, 1
  v_and_b32 v2, 0x10, v2
  v_xor_b32 v3, v3, v2
  v_bfe_i32 v2, v0, 1, 1
  v_and_b32 v2, 0x20, v2
  v_xor_b32 v3, v3, v2
  v_bfe_i32 v2, v0, 2, 1
  v_and_b32 v2, 0x40, v2
  v_xor_b32 v3, v3, v2
  v_bfe_i32 v2, v0, 3, 1
  v_and_b32 v2, 0x80, v2
  v_xor_b32 v3, v3, v2
  v_bfe_i32 v2, v0, 4, 1
  v_and_b32 v2, 0x40, v2
  v_xor_b32 v3, v3, v2
  v_bfe_i32 v2, v0, 5, 1
  v_and_b32 v2, 0x80, v2
  v_xor_b32 v3, v3, v2
  v_mov_b32 v5, 0x0
  v_bfe_i32 v2, v0, 4, 1
  v_and_b32 v2, 0x2000, v2
  v_add_u32 v5, v5, v2
  v_bfe_i32 v2, v0, 5, 1
  v_and_b32 v2, 0x4000, v2
  v_add_u32 v5, v5, v2
  v_add_u32 v3, v3, v5
  v_mov_b32 v4, 0x0
  v_bfe_i32 v2, v0, 0, 1
  v_and_b32 v2, 0x8, v2
  v_xor_b32 v4, v4, v2
  v_bfe_i32 v2, v0, 1, 1
  v_and_b32 v2, 0x10, v2
  v_xor_b32 v4, v4, v2
  v_bfe_i32 v2, v0, 2, 1
  v_and_b32 v2, 0x140, v2
  v_xor_b32 v4, v4, v2
  v_bfe_i32 v2, v0, 3, 1
  v_and_b32 v2, 0x280, v2
  v_xor_b32 v4, v4, v2
  v_bfe_i32 v2, v0, 4, 1
  v_and_b32 v2, 0x20, v2
  v_xor_b32 v4, v4, v2
  v_bfe_i32 v2, v0, 5, 1
  v_and_b32 v2, 0x800, v2
  v_xor_b32 v4, v4, v2
  v_bfe_i32 v2, v0, 6, 1
  v_and_b32 v2, 0x40, v2
  v_xor_b32 v4, v4, v2
  v_bfe_i32 v2, v0, 7, 1
  v_and_b32 v2, 0x80, v2
  v_xor_b32 v4, v4, v2
  v_add_u32 v5, 0x10000, v4
  s_lshl_b32 s76, s54, 8
  s_barrier
  s_mul_i32 s61, s58, 1048576
  s_add_u32 s61, s61, s76
  s_add_u32 s61, s61, 0
  s_mul_i32 s62, s58, 32768
  s_mov_b32 s63, 0
L_wdma_93:
  s_mov_b32 m0, s62
  s_add_u32 s62, s62, 1024
  buffer_load_dwordx4 v3, s[8:11], s61 offen lds
  s_add_u32 s61, s61, 32768
  s_add_u32 s63, s63, 1
  s_cmp_lt_u32 s63, 32
  s_cbranch_scc1 L_wdma_93
  s_waitcnt vmcnt(0)
  s_barrier
  ds_read_b64_tr_b16 a[0:1], v4 offset:0
  ds_read_b64_tr_b16 a[2:3], v4 offset:1024
  ds_read_b64_tr_b16 a[4:5], v4 offset:4096
  ds_read_b64_tr_b16 a[6:7], v4 offset:5120
  ds_read_b64_tr_b16 a[8:9], v4 offset:8192
  ds_read_b64_tr_b16 a[10:11], v4 offset:9216
  ds_read_b64_tr_b16 a[12:13], v4 offset:12288
  ds_read_b64_tr_b16 a[14:15], v4 offset:13312
  s_waitcnt lgkmcnt(0)
  ds_read_b64_tr_b16 a[16:17], v4 offset:16384
  ds_read_b64_tr_b16 a[18:19], v4 offset:17408
  ds_read_b64_tr_b16 a[20:21], v4 offset:20480
  ds_read_b64_tr_b16 a[22:23], v4 offset:21504
  ds_read_b64_tr_b16 a[24:25], v4 offset:24576
  ds_read_b64_tr_b16 a[26:27], v4 offset:25600
  ds_read_b64_tr_b16 a[28:29], v4 offset:28672
  ds_read_b64_tr_b16 a[30:31], v4 offset:29696
  s_waitcnt lgkmcnt(0)
  ds_read_b64_tr_b16 a[32:33], v4 offset:32768
  ds_read_b64_tr_b16 a[34:35], v4 offset:33792
  ds_read_b64_tr_b16 a[36:37], v4 offset:36864
  ds_read_b64_tr_b16 a[38:39], v4 offset:37888
  ds_read_b64_tr_b16 a[40:41], v4 offset:40960
  ds_read_b64_tr_b16 a[42:43], v4 offset:41984
  ds_read_b64_tr_b16 a[44:45], v4 offset:45056
  ds_read_b64_tr_b16 a[46:47], v4 offset:46080
  s_waitcnt lgkmcnt(0)
  ds_read_b64_tr_b16 a[48:49], v4 offset:49152
  ds_read_b64_tr_b16 a[50:51], v4 offset:50176
  ds_read_b64_tr_b16 a[52:53], v4 offset:53248
  ds_read_b64_tr_b16 a[54:55], v4 offset:54272
  ds_read_b64_tr_b16 a[56:57], v4 offset:57344
  ds_read_b64_tr_b16 a[58:59], v4 offset:58368
  ds_read_b64_tr_b16 a[60:61], v4 offset:61440
  ds_read_b64_tr_b16 a[62:63], v4 offset:62464
  s_waitcnt lgkmcnt(0)
  ds_read_b64_tr_b16 a[64:65], v5 offset:0
  ds_read_b64_tr_b16 a[66:67], v5 offset:1024
  ds_read_b64_tr_b16 a[68:69], v5 offset:4096
  ds_read_b64_tr_b16 a[70:71], v5 offset:5120
  ds_read_b64_tr_b16 a[72:73], v5 offset:8192
  ds_read_b64_tr_b16 a[74:75], v5 offset:9216
  ds_read_b64_tr_b16 a[76:77], v5 offset:12288
  ds_read_b64_tr_b16 a[78:79], v5 offset:13312
  s_waitcnt lgkmcnt(0)
  ds_read_b64_tr_b16 a[80:81], v5 offset:16384
  ds_read_b64_tr_b16 a[82:83], v5 offset:17408
  ds_read_b64_tr_b16 a[84:85], v5 offset:20480
  ds_read_b64_tr_b16 a[86:87], v5 offset:21504
  ds_read_b64_tr_b16 a[88:89], v5 offset:24576
  ds_read_b64_tr_b16 a[90:91], v5 offset:25600
  ds_read_b64_tr_b16 a[92:93], v5 offset:28672
  ds_read_b64_tr_b16 a[94:95], v5 offset:29696
  s_waitcnt lgkmcnt(0)
  ds_read_b64_tr_b16 a[96:97], v5 offset:32768
  ds_read_b64_tr_b16 a[98:99], v5 offset:33792
  ds_read_b64_tr_b16 a[100:101], v5 offset:36864
  ds_read_b64_tr_b16 a[102:103], v5 offset:37888
  ds_read_b64_tr_b16 a[104:105], v5 offset:40960
  ds_read_b64_tr_b16 a[106:107], v5 offset:41984
  ds_read_b64_tr_b16 a[108:109], v5 offset:45056
  ds_read_b64_tr_b16 a[110:111], v5 offset:46080
  s_waitcnt lgkmcnt(0)
  ds_read_b64_tr_b16 a[112:113], v5 offset:49152
  ds_read_b64_tr_b16 a[114:115], v5 offset:50176
  ds_read_b64_tr_b16 a[116:117], v5 offset:53248
  ds_read_b64_tr_b16 a[118:119], v5 offset:54272
  ds_read_b64_tr_b16 a[120:121], v5 offset:57344
  ds_read_b64_tr_b16 a[122:123], v5 offset:58368
  ds_read_b64_tr_b16 a[124:125], v5 offset:61440
  ds_read_b64_tr_b16 a[126:127], v5 offset:62464
  s_waitcnt lgkmcnt(0)
  s_waitcnt lgkmcnt(0)
  s_barrier
  s_mul_i32 s61, s58, 1048576
  s_add_u32 s61, s61, s76
  s_add_u32 s61, s61, 0
  s_mul_i32 s62, s58, 32768
  s_mov_b32 s63, 0
L_wdma_94:
  s_mov_b32 m0, s62
  s_add_u32 s62, s62, 1024
  buffer_load_dwordx4 v3, s[12:15], s61 offen lds
  s_add_u32 s61, s61, 32768
  s_add_u32 s63, s63, 1
  s_cmp_lt_u32 s63, 32
  s_cbranch_scc1 L_wdma_94
  s_waitcnt vmcnt(0)
  s_barrier
  ds_read_b64_tr_b16 a[128:129], v4 offset:0
  ds_read_b64_tr_b16 a[130:131], v4 offset:1024
  ds_read_b64_tr_b16 a[132:133], v4 offset:4096
  ds_read_b64_tr_b16 a[134:135], v4 offset:5120
  ds_read_b64_tr_b16 a[136:137], v4 offset:8192
  ds_read_b64_tr_b16 a[138:139], v4 offset:9216
  ds_read_b64_tr_b16 a[140:141], v4 offset:12288
  ds_read_b64_tr_b16 a[142:143], v4 offset:13312
  s_waitcnt lgkmcnt(0)
  ds_read_b64_tr_b16 a[144:145], v4 offset:16384
  ds_read_b64_tr_b16 a[146:147], v4 offset:17408
  ds_read_b64_tr_b16 a[148:149], v4 offset:20480
  ds_read_b64_tr_b16 a[150:151], v4 offset:21504
  ds_read_b64_tr_b16 a[152:153], v4 offset:24576
  ds_read_b64_tr_b16 a[154:155], v4 offset:25600
  ds_read_b64_tr_b16 a[156:157], v4 offset:28672
  ds_read_b64_tr_b16 a[158:159], v4 offset:29696
  s_waitcnt lgkmcnt(0)
  ds_read_b64_tr_b16 a[160:161], v4 offset:32768
  ds_read_b64_tr_b16 a[162:163], v4 offset:33792
  ds_read_b64_tr_b16 a[164:165], v4 offset:36864
  ds_read_b64_tr_b16 a[166:167], v4 offset:37888
  ds_read_b64_tr_b16 a[168:169], v4 offset:40960
  ds_read_b64_tr_b16 a[170:171], v4 offset:41984
  ds_read_b64_tr_b16 a[172:173], v4 offset:45056
  ds_read_b64_tr_b16 a[174:175], v4 offset:46080
  s_waitcnt lgkmcnt(0)
  ds_read_b64_tr_b16 a[176:177], v4 offset:49152
  ds_read_b64_tr_b16 a[178:179], v4 offset:50176
  ds_read_b64_tr_b16 a[180:181], v4 offset:53248
  ds_read_b64_tr_b16 a[182:183], v4 offset:54272
  ds_read_b64_tr_b16 a[184:185], v4 offset:57344
  ds_read_b64_tr_b16 a[186:187], v4 offset:58368
  ds_read_b64_tr_b16 a[188:189], v4 offset:61440
  ds_read_b64_tr_b16 a[190:191], v4 offset:62464
  s_waitcnt lgkmcnt(0)
  ds_read_b64_tr_b16 a[192:193], v5 offset:0
  ds_read_b64_tr_b16 a[194:195], v5 offset:1024
  ds_read_b64_tr_b16 a[196:197], v5 offset:4096
  ds_read_b64_tr_b16 a[198:199], v5 offset:5120
  ds_read_b64_tr_b16 a[200:201], v5 offset:8192
  ds_read_b64_tr_b16 a[202:203], v5 offset:9216
  ds_read_b64_tr_b16 a[204:205], v5 offset:12288
  ds_read_b64_tr_b16 a[206:207], v5 offset:13312
  s_waitcnt lgkmcnt(0)
  ds_read_b64_tr_b16 a[208:209], v5 offset:16384
  ds_read_b64_tr_b16 a[210:211], v5 offset:17408
  ds_read_b64_tr_b16 a[212:213], v5 offset:20480
  ds_read_b64_tr_b16 a[214:215], v5 offset:21504
  ds_read_b64_tr_b16 a[216:217], v5 offset:24576
  ds_read_b64_tr_b16 a[218:219], v5 offset:25600
  ds_read_b64_tr_b16 a[220:221], v5 offset:28672
  ds_read_b64_tr_b16 a[222:223], v5 offset:29696
  s_waitcnt lgkmcnt(0)
  ds_read_b64_tr_b16 a[224:225], v5 offset:32768
  ds_read_b64_tr_b16 a[226:227], v5 offset:33792
  ds_read_b64_tr_b16 a[228:229], v5 offset:36864
  ds_read_b64_tr_b16 a[230:231], v5 offset:37888
  ds_read_b64_tr_b16 a[232:233], v5 offset:40960
  ds_read_b64_tr_b16 a[234:235], v5 offset:41984
  ds_read_b64_tr_b16 a[236:237], v5 offset:45056
  ds_read_b64_tr_b16 a[238:239], v5 offset:46080
  s_waitcnt lgkmcnt(0)
  ds_read_b64_tr_b16 a[240:241], v5 offset:49152
  ds_read_b64_tr_b16 a[242:243], v5 offset:50176
  ds_read_b64_tr_b16 a[244:245], v5 offset:53248
  ds_read_b64_tr_b16 a[246:247], v5 offset:54272
  ds_read_b64_tr_b16 a[248:249], v5 offset:57344
  ds_read_b64_tr_b16 a[250:251], v5 offset:58368
  ds_read_b64_tr_b16 a[252:253], v5 offset:61440
  ds_read_b64_tr_b16 a[254:255], v5 offset:62464
  s_waitcnt lgkmcnt(0)
  s_waitcnt lgkmcnt(0)
  s_barrier
  s_mov_b32 s20, s50
  s_and_b32 s21, s51, 0xffff
  s_mov_b32 s22, 0x0
  s_mov_b32 s23, 0x20000
  s_mov_b32 s8, s48
  s_and_b32 s9, s49, 0xffff
  s_mov_b32 s10, 0x100
  s_mov_b32 s11, 0x20000
  v_and_b32 v2, 3, v0
  v_lshlrev_b32 v2, 6, v2
L_gate_95:
  buffer_load_dword v11, v2, s[8:11], 0 offen offset:8 sc1
  s_waitcnt vmcnt(0)
  v_cmp_gt_u32 vcc, 48, v11
  s_cbranch_vccz L_gateok_96
  s_add_u32 s72, s72, 1
  s_cmp_gt_u32 s72, 0x80000
  s_cbranch_scc1 L_exit
  s_sleep 2
  s_branch L_gate_95
L_gateok_96:
  s_mov_b32 s59, 0
  s_mov_b32 s88, 0
  s_mov_b32 s60, 0
  v_mov_b32 v113, 0
  v_add_u32 v112, 0x8000, v7
  s_mov_b32 s60, 0
L_s1h0_97:
  s_cmp_eq_u32 s60, 1
  s_cbranch_scc1 L_hp_101
  s_lshl_b32 s63, s55, 6
  s_add_u32 s63, s63, 0x23000
  s_add_u32 s63, s63, s53
  s_lshl_b32 s61, s55, 15
  s_add_u32 s61, s61, 0x5a00000
  s_add_u32 s61, s61, s52
  s_lshl_b32 s62, s58, 12
  s_add_u32 m0, s62, 0x0
L_poll_103:
  buffer_load_dword v11, v8, s[4:7], s63 offen sc1
  s_waitcnt vmcnt(0)
  s_cmp_eq_u32 s88, 0
  s_cbranch_scc1 L_nofl_105
  s_mov_b64 exec, 1
  buffer_store_dword v10, v9, s[4:7], s88 offen sc1
  s_mov_b64 exec, -1
  s_mov_b32 s88, 0
L_nofl_105:
  v_cmp_eq_u32 vcc, 0, v11
  s_cbranch_vccz L_pollok_104
  s_add_u32 s72, s72, 1
  s_cmp_gt_u32 s72, 0x80000
  s_cbranch_scc1 L_exit
  s_branch L_poll_103
L_pollok_104:
  buffer_load_dwordx4 v6, s[4:7], s61 offen offset:0 sc1 lds
  buffer_load_dwordx4 v6, s[4:7], s61 offen offset:1024 sc1 lds
  buffer_load_dwordx4 v6, s[4:7], s61 offen offset:2048 sc1 lds
  buffer_load_dwordx4 v6, s[4:7], s61 offen offset:3072 sc1 lds
  s_add_u32 m0, m0, 0x4000
  s_add_u32 s61, s61, 0x4000
  buffer_load_dwordx4 v6, s[4:7], s61 offen offset:0 sc1 lds
  buffer_load_dwordx4 v6, s[4:7], s61 offen offset:1024 sc1 lds
  buffer_load_dwordx4 v6, s[4:7], s61 offen offset:2048 sc1 lds
  buffer_load_dwordx4 v6, s[4:7], s61 offen offset:3072 sc1 lds
  s_waitcnt vmcnt(4)
  s_branch L_hj_102
L_hp_101:
  s_waitcnt vmcnt(4)
L_hj_102:
  s_barrier
  ds_read_b128 v[16:19], v7 offset:0
  ds_read_b128 v[20:23], v7 offset:1024
  ds_read_b128 v[24:27], v7 offset:2048
L_s1b0_99:
  s_add_u32 s74, s55, s56
  s_min_u32 s64, s74, 63
  s_lshl_b32 s96, s64, 6
  s_add_u32 s96, s96, 0x23000
  s_add_u32 s96, s96, s53
  s_mov_b32 s59, 0
  s_mov_b32 s80, 0
  ds_read_b128 v[28:31], v7 offset:3072
  s_waitcnt lgkmcnt(3)
  v_mfma_f32_32x32x16_bf16 v[32:47], a[0:3], v[16:19], 0
  buffer_load_dword v11, v8, s[4:7], s96 offen sc1
  v_mfma_f32_32x32x16_bf16 v[48:63], v[16:19], a[128:131], 0
  ds_read_b128 v[16:19], v7 offset:4096
  s_waitcnt lgkmcnt(3)
  v_mfma_f32_32x32x16_bf16 v[32:47], a[4:7], v[20:23], v[32:47]
  v_mfma_f32_32x32x16_bf16 v[48:63], v[20:23], a[132:135], v[48:63]
  s_cmp_lg_u32 s60, 2
  s_cbranch_scc1 L_ep_106
  v_cvt_pk_bf16_f32 v64, v80, v81
  v_cvt_pk_bf16_f32 v65, v82, v83
  v_cvt_pk_bf16_f32 v66, v84, v85
  v_cvt_pk_bf16_f32 v67, v86, v87
  buffer_store_dwordx4 v[64:67], v12, s[4:7], s76 offen offset:0 sc1
L_ep_106:
  ds_read_b128 v[20:23], v7 offset:5120
  s_waitcnt lgkmcnt(3)
  v_mfma_f32_32x32x16_bf16 v[32:47], a[8:11], v[24:27], v[32:47]
  s_cmp_lg_u32 s60, 2
  s_cbranch_scc1 L_ep_107
  v_cvt_pk_bf16_f32 v68, v88, v89
  v_cvt_pk_bf16_f32 v69, v90, v91
  v_cvt_pk_bf16_f32 v70, v92, v93
  v_cvt_pk_bf16_f32 v71, v94, v95
  buffer_store_dwordx4 v[68:71], v12, s[4:7], s76 offen offset:1024 sc1
L_ep_107:
  v_mfma_f32_32x32x16_bf16 v[48:63], v[24:27], a[136:139], v[48:63]
  s_cmp_lg_u32 s60, 2
  s_cbranch_scc1 L_ep_108
  v_cvt_pk_bf16_f32 v72, v96, v97
  v_cvt_pk_bf16_f32 v73, v98, v99
  v_cvt_pk_bf16_f32 v74, v100, v101
  v_cvt_pk_bf16_f32 v75, v102, v103
  buffer_store_dwordx4 v[72:75], v12, s[4:7], s77 offen offset:0 sc1
L_ep_108:
  ds_read_b128 v[24:27], v7 offset:6144
  s_waitcnt lgkmcnt(3)
  v_mfma_f32_32x32x16_bf16 v[32:47], a[12:15], v[28:31], v[32:47]
  s_cmp_lg_u32 s60, 2
  s_cbranch_scc1 L_ep_109
  v_cvt_pk_bf16_f32 v76, v104, v105
  v_cvt_pk_bf16_f32 v77, v106, v107
  v_cvt_pk_bf16_f32 v78, v108, v109
  v_cvt_pk_bf16_f32 v79, v110, v111
  buffer_store_dwordx4 v[76:79], v12, s[4:7], s77 offen offset:1024 sc1
  s_mov_b32 s88, s78
L_ep_109:
  v_mfma_f32_32x32x16_bf16 v[48:63], v[28:31], a[140:143], v[48:63]
  ds_read_b128 v[28:31], v7 offset:7168
  s_waitcnt lgkmcnt(3)
  v_mfma_f32_32x32x16_bf16 v[32:47], a[16:19], v[16:19], v[32:47]
  v_mfma_f32_32x32x16_bf16 v[48:63], v[16:19], a[144:147], v[48:63]
  ds_read_b128 v[16:19], v7 offset:8192
  s_waitcnt lgkmcnt(3)
  v_mfma_f32_32x32x16_bf16 v[32:47], a[20:23], v[20:23], v[32:47]
  v_mfma_f32_32x32x16_bf16 v[48:63], v[20:23], a[148:151], v[48:63]
  ds_read_b128 v[20:23], v7 offset:9216
  s_waitcnt lgkmcnt(3)
  v_mfma_f32_32x32x16_bf16 v[32:47], a[24:27], v[24:27], v[32:47]
  v_mfma_f32_32x32x16_bf16 v[48:63], v[24:27], a[152:155], v[48:63]
  ds_read_b128 v[24:27], v7 offset:10240
  s_waitcnt lgkmcnt(3)
  v_mfma_f32_32x32x16_bf16 v[32:47], a[28:31], v[28:31], v[32:47]
  v_mfma_f32_32x32x16_bf16 v[48:63], v[28:31], a[156:159], v[48:63]
  ds_read_b128 v[28:31], v7 offset:11264
  s_waitcnt lgkmcnt(3)
  v_mfma_f32_32x32x16_bf16 v[32:47], a[32:35], v[16:19], v[32:47]
  v_mfma_f32_32x32x16_bf16 v[48:63], v[16:19], a[160:163], v[48:63]
  ds_read_b128 v[16:19], v7 offset:12288
  s_waitcnt lgkmcnt(3)
  v_mfma_f32_32x32x16_bf16 v[32:47], a[36:39], v[20:23], v[32:47]
  v_mfma_f32_32x32x16_bf16 v[48:63], v[20:23], a[164:167], v[48:63]
  ds_read_b128 v[20:23], v7 offset:13312
  s_waitcnt lgkmcnt(3)
  v_mfma_f32_32x32x16_bf16 v[32:47], a[40:43], v[24:27], v[32:47]
  v_mfma_f32_32x32x16_bf16 v[48:63], v[24:27], a[168:171], v[48:63]
  s_cmp_lg_u32 s60, 1
  s_cbranch_scc1 L_hfa_110
  s_waitcnt vmcnt(1)
  s_mov_b64 exec, 1
  buffer_store_dword v10, v9, s[4:7], s88 offen sc1
  s_mov_b64 exec, -1
  s_mov_b32 s88, 0
L_hfa_110:
  ds_read_b128 v[24:27], v7 offset:14336
  s_waitcnt lgkmcnt(3)
  v_mfma_f32_32x32x16_bf16 v[32:47], a[44:47], v[28:31], v[32:47]
  v_mfma_f32_32x32x16_bf16 v[48:63], v[28:31], a[172:175], v[48:63]
  s_cmp_lg_u32 s60, 2
  s_cbranch_scc1 L_hfb_111
  s_cmp_eq_u32 s59, 1
  s_cbranch_scc1 L_hfc_112
  s_waitcnt vmcnt(0)
L_hfc_112:
  s_waitcnt vmcnt(8)
  s_mov_b64 exec, 1
  buffer_store_dword v10, v9, s[4:7], s88 offen sc1
  s_mov_b64 exec, -1
  s_mov_b32 s88, 0
L_hfb_111:
  ds_read_b128 v[28:31], v7 offset:15360
  s_waitcnt lgkmcnt(3)
  v_mfma_f32_32x32x16_bf16 v[32:47], a[48:51], v[16:19], v[32:47]
  v_mfma_f32_32x32x16_bf16 v[48:63], v[16:19], a[176:179], v[48:63]
  s_cmp_eq_u32 s60, 2
  s_cbranch_scc1 L_h1b_114
  s_cmp_eq_u32 s60, 1
  s_cbranch_scc1 L_h1a_113
  s_waitcnt vmcnt(0)
L_h1a_113:
  s_waitcnt vmcnt(1)
L_h1b_114:
  s_waitcnt vmcnt(4)
  v_cmp_eq_u32 vcc, 0, v11
  s_cmp_lt_u32 s74, s57
  s_cselect_b64 s[70:71], vcc, -1
  s_cmp_eq_u64 s[70:71], 0
  s_cselect_b32 s89, s58, 7
L_h1c_115:
  s_barrier
  ds_read_b128 v[16:19], v7 offset:16384
  s_waitcnt lgkmcnt(3)
  v_mfma_f32_32x32x16_bf16 v[32:47], a[52:55], v[20:23], v[32:47]
  v_mfma_f32_32x32x16_bf16 v[48:63], v[20:23], a[180:183], v[48:63]
  s_cmp_eq_u32 s89, 0
  s_cbranch_scc1 L_hwo_116
L_hwb_117:
  ds_read_b128 v[20:23], v7 offset:17408
  s_waitcnt lgkmcnt(3)
  v_mfma_f32_32x32x16_bf16 v[32:47], a[56:59], v[24:27], v[32:47]
  v_mfma_f32_32x32x16_bf16 v[48:63], v[24:27], a[184:187], v[48:63]
  ds_read_b128 v[24:27], v7 offset:18432
  s_waitcnt lgkmcnt(3)
  v_mfma_f32_32x32x16_bf16 v[32:47], a[60:63], v[28:31], v[32:47]
  v_mfma_f32_32x32x16_bf16 v[48:63], v[28:31], a[188:191], v[48:63]
  s_cmp_eq_u32 s89, 1
  s_cbranch_scc1 L_hwo_118
L_hwb_119:
  ds_read_b128 v[28:31], v7 offset:19456
  s_waitcnt lgkmcnt(3)
  v_mfma_f32_32x32x16_bf16 v[32:47], a[64:67], v[16:19], v[32:47]
  v_mfma_f32_32x32x16_bf16 v[48:63], v[16:19], a[192:195], v[48:63]
  ds_read_b128 v[16:19], v7 offset:20480
  s_waitcnt lgkmcnt(3)
  v_mfma_f32_32x32x16_bf16 v[32:47], a[68:71], v[20:23], v[32:47]
  v_mfma_f32_32x32x16_bf16 v[48:63], v[20:23], a[196:199], v[48:63]
  s_cmp_eq_u32 s89, 2
  s_cbranch_scc1 L_hwo_120
L_hwb_121:
  ds_read_b128 v[20:23], v7 offset:21504
  s_waitcnt lgkmcnt(3)
  v_mfma_f32_32x32x16_bf16 v[32:47], a[72:75], v[24:27], v[32:47]
  v_mfma_f32_32x32x16_bf16 v[48:63], v[24:27], a[200:203], v[48:63]
  ds_read_b128 v[24:27], v7 offset:22528
  s_waitcnt lgkmcnt(3)
  v_mfma_f32_32x32x16_bf16 v[32:47], a[76:79], v[28:31], v[32:47]
  v_mfma_f32_32x32x16_bf16 v[48:63], v[28:31], a[204:207], v[48:63]
  s_cmp_eq_u32 s89, 3
  s_cbranch_scc1 L_hwo_122
L_hwb_123:
  s_cmp_lg_u32 s89, 7
  s_cbranch_scc1 L_hre_124
  buffer_load_dword v11, v8, s[4:7], s96 offen sc1
L_hre_124:
  ds_read_b128 v[28:31], v7 offset:23552
  s_waitcnt lgkmcnt(3)
  v_mfma_f32_32x32x16_bf16 v[32:47], a[80:83], v[16:19], v[32:47]
  v_mfma_f32_32x32x16_bf16 v[48:63], v[16:19], a[208:211], v[48:63]
  ds_read_b128 v[16:19], v7 offset:24576
  s_waitcnt lgkmcnt(3)
  v_mfma_f32_32x32x16_bf16 v[32:47], a[84:87], v[20:23], v[32:47]
  v_mfma_f32_32x32x16_bf16 v[48:63], v[20:23], a[212:215], v[48:63]
  ds_read_b128 v[20:23], v7 offset:25600
  s_waitcnt lgkmcnt(3)
  v_mfma_f32_32x32x16_bf16 v[32:47], a[88:91], v[24:27], v[32:47]
  v_mfma_f32_32x32x16_bf16 v[48:63], v[24:27], a[216:219], v[48:63]
  ds_read_b128 v[24:27], v7 offset:26624
  s_waitcnt lgkmcnt(3)
  v_mfma_f32_32x32x16_bf16 v[32:47], a[92:95], v[28:31], v[32:47]
  v_mfma_f32_32x32x16_bf16 v[48:63], v[28:31], a[220:223], v[48:63]
  ds_read_b128 v[28:31], v7 offset:27648
  s_waitcnt lgkmcnt(3)
  v_mfma_f32_32x32x16_bf16 v[32:47], a[96:99], v[16:19], v[32:47]
  v_mfma_f32_32x32x16_bf16 v[48:63], v[16:19], a[224:227], v[48:63]
  ds_read_b128 v[16:19], v7 offset:28672
  s_waitcnt lgkmcnt(3)
  v_mfma_f32_32x32x16_bf16 v[32:47], a[100:103], v[20:23], v[32:47]
  v_mfma_f32_32x32x16_bf16 v[48:63], v[20:23], a[228:231], v[48:63]
  ds_read_b128 v[20:23], v7 offset:29696
  s_waitcnt lgkmcnt(3)
  v_mfma_f32_32x32x16_bf16 v[32:47], a[104:107], v[24:27], v[32:47]
  v_mfma_f32_32x32x16_bf16 v[48:63], v[24:27], a[232:235], v[48:63]
  ds_read_b128 v[24:27], v7 offset:30720
  s_waitcnt lgkmcnt(3)
  v_mfma_f32_32x32x16_bf16 v[32:47], a[108:111], v[28:31], v[32:47]
  v_mfma_f32_32x32x16_bf16 v[48:63], v[28:31], a[236:239], v[48:63]
  ds_read_b128 v[28:31], v7 offset:31744
  s_waitcnt lgkmcnt(3)
  v_mfma_f32_32x32x16_bf16 v[32:47], a[112:115], v[16:19], v[32:47]
  s_lshl_b32 s76, s55, 18
  s_lshl_b32 s77, s54, 13
  s_add_u32 s76, s76, s77
  s_add_u32 s76, s76, s52
  v_mfma_f32_32x32x16_bf16 v[48:63], v[16:19], a[240:243], v[48:63]
  s_waitcnt lgkmcnt(2)
  v_mfma_f32_32x32x16_bf16 v[32:47], a[116:119], v[20:23], v[32:47]
  s_add_u32 s77, s76, 0x1000000
  s_lshl_b32 s78, s55, 9
  s_lshl_b32 s79, s54, 4
  s_add_u32 s78, s78, s79
  v_mfma_f32_32x32x16_bf16 v[48:63], v[20:23], a[244:247], v[48:63]
  s_waitcnt lgkmcnt(1)
  v_mfma_f32_32x32x16_bf16 v[32:47], a[120:123], v[24:27], v[32:47]
  s_add_u32 s78, s78, s53
  v_mfma_f32_32x32x16_bf16 v[48:63], v[24:27], a[248:251], v[48:63]
  s_waitcnt lgkmcnt(0)
  v_mfma_f32_32x32x16_bf16 v[32:47], a[124:127], v[28:31], v[32:47]
  v_mfma_f32_32x32x16_bf16 v[48:63], v[28:31], a[252:255], v[48:63]
  s_cmp_lg_u32 s59, 1
  s_cbranch_scc1 L_late_125
  s_cmp_eq_u32 s80, 1
  s_cbranch_scc1 L_st1_126
  s_waitcnt vmcnt(0)
L_st1_126:
  s_waitcnt vmcnt(1)
  s_barrier
  ds_read_b128 v[16:19], v112 offset:0
  ds_read_b128 v[20:23], v112 offset:1024
  ds_read_b128 v[24:27], v112 offset:2048
  s_mov_b32 s60, 2
  s_mov_b32 s55, s74
  s_branch L_s1b1_100
L_late_125:
  s_mov_b32 s60, 0
  s_waitcnt vmcnt(0)
  s_cmp_ge_u32 s74, s57
  s_cbranch_scc1 L_nl_127
  v_cmp_eq_u32 vcc, 0, v11
  s_cbranch_vccnz L_nl_127
  s_mov_b32 s64, 0x8000
  s_lshl_b32 s61, s74, 15
  s_add_u32 s61, s61, 0x5a00000
  s_add_u32 s61, s61, s52
  s_lshl_b32 s62, s58, 12
  s_add_u32 m0, s62, s64
  s_nop 0
  buffer_load_dwordx4 v6, s[4:7], s61 offen offset:0 sc1 lds
  buffer_load_dwordx4 v6, s[4:7], s61 offen offset:1024 sc1 lds
  buffer_load_dwordx4 v6, s[4:7], s61 offen offset:2048 sc1 lds
  buffer_load_dwordx4 v6, s[4:7], s61 offen offset:3072 sc1 lds
  s_add_u32 m0, m0, 0x4000
  s_add_u32 s61, s61, 0x4000
  buffer_load_dwordx4 v6, s[4:7], s61 offen offset:0 sc1 lds
  buffer_load_dwordx4 v6, s[4:7], s61 offen offset:1024 sc1 lds
  buffer_load_dwordx4 v6, s[4:7], s61 offen offset:2048 sc1 lds
  buffer_load_dwordx4 v6, s[4:7], s61 offen offset:3072 sc1 lds
  s_mov_b32 s60, 1
L_nl_127:
  s_nop 7
  v_cvt_pk_bf16_f32 v64, v32, v33
  v_cvt_pk_bf16_f32 v65, v34, v35
  v_cvt_pk_bf16_f32 v66, v36, v37
  v_cvt_pk_bf16_f32 v67, v38, v39
  buffer_store_dwordx4 v[64:67], v12, s[4:7], s76 offen offset:0 sc1
  v_cvt_pk_bf16_f32 v68, v40, v41
  v_cvt_pk_bf16_f32 v69, v42, v43
  v_cvt_pk_bf16_f32 v70, v44, v45
  v_cvt_pk_bf16_f32 v71, v46, v47
  buffer_store_dwordx4 v[68:71], v12, s[4:7], s76 offen offset:1024 sc1
  v_cvt_pk_bf16_f32 v72, v48, v49
  v_cvt_pk_bf16_f32 v73, v50, v51
  v_cvt_pk_bf16_f32 v74, v52, v53
  v_cvt_pk_bf16_f32 v75, v54, v55
  buffer_store_dwordx4 v[72:75], v12, s[4:7], s77 offen offset:0 sc1
  v_cvt_pk_bf16_f32 v76, v56, v57
  v_cvt_pk_bf16_f32 v77, v58, v59
  v_cvt_pk_bf16_f32 v78, v60, v61
  v_cvt_pk_bf16_f32 v79, v62, v63
  buffer_store_dwordx4 v[76:79], v12, s[4:7], s77 offen offset:1024 sc1
  s_mov_b32 s88, s78
  s_mov_b32 s55, s74
  s_cmp_lt_u32 s55, s57
  s_cbranch_scc1 L_s1h1_98
  s_waitcnt vmcnt(0)
  s_cmp_eq_u32 s88, 0
  s_cbranch_scc1 L_nofl_128
  s_mov_b64 exec, 1
  buffer_store_dword v10, v9, s[4:7], s88 offen sc1
  s_mov_b64 exec, -1
  s_mov_b32 s88, 0
L_nofl_128:
  s_and_b32 s61, s87, 3
  s_cmp_lg_u32 s61, 0
  s_cbranch_scc1 L_s1n_129
  s_cmp_eq_u32 s87, 4
  s_cbranch_scc1 L_s1a_130
  s_cmp_eq_u32 s87, 8
  s_cbranch_scc1 L_exit
  s_cmp_eq_u32 s87, 0
  s_cbranch_scc1 L_dispatch
  s_add_u32 s54, s54, 16
  s_mov_b32 s55, 64
  s_mov_b32 s87, 0
  s_branch B_s1
L_s1a_130:
  s_mov_b32 s52, 0x7000000
  s_mov_b32 s53, 0x50000
  s_mov_b32 s75, 0x1c2000
  s_mov_b32 s55, 0
  s_mov_b32 s56, 1
  s_mov_b32 s57, 64
  s_mov_b32 s87, 8
  s_branch L_s1h1_98
L_s1n_129:
  s_sub_u32 s87, s87, 1
  s_sub_u32 s55, s55, 1
  s_sub_u32 s56, s56, 1
  s_cmp_eq_u32 s56, 3
  s_cselect_b32 s57, 38, 52
  s_cmp_eq_u32 s56, 1
  s_cselect_b32 s57, 64, s57
  s_branch L_s1h1_98
L_s1h1_98:
  s_cmp_eq_u32 s60, 1
  s_cbranch_scc1 L_hp_131
  s_lshl_b32 s63, s55, 6
  s_add_u32 s63, s63, 0x23000
  s_add_u32 s63, s63, s53
  s_lshl_b32 s61, s55, 15
  s_add_u32 s61, s61, 0x5a00000
  s_add_u32 s61, s61, s52
  s_lshl_b32 s62, s58, 12
  s_add_u32 m0, s62, 0x8000
L_poll_133:
  buffer_load_dword v11, v8, s[4:7], s63 offen sc1
  s_waitcnt vmcnt(0)
  s_cmp_eq_u32 s88, 0
  s_cbranch_scc1 L_nofl_135
  s_mov_b64 exec, 1
  buffer_store_dword v10, v9, s[4:7], s88 offen sc1
  s_mov_b64 exec, -1
  s_mov_b32 s88, 0
L_nofl_135:
  v_cmp_eq_u32 vcc, 0, v11
  s_cbranch_vccz L_pollok_134
  s_add_u32 s72, s72, 1
  s_cmp_gt_u32 s72, 0x80000
  s_cbranch_scc1 L_exit
  s_branch L_poll_133
L_pollok_134:
  buffer_load_dwordx4 v6, s[4:7], s61 offen offset:0 sc1 lds
  buffer_load_dwordx4 v6, s[4:7], s61 offen offset:1024 sc1 lds
  buffer_load_dwordx4 v6, s[4:7], s61 offen offset:2048 sc1 lds
  buffer_load_dwordx4 v6, s[4:7], s61 offen offset:3072 sc1 lds
  s_add_u32 m0, m0, 0x4000
  s_add_u32 s61, s61, 0x4000
  buffer_load_dwordx4 v6, s[4:7], s61 offen offset:0 sc1 lds
  buffer_load_dwordx4 v6, s[4:7], s61 offen offset:1024 sc1 lds
  buffer_load_dwordx4 v6, s[4:7], s61 offen offset:2048 sc1 lds
  buffer_load_dwordx4 v6, s[4:7], s61 offen offset:3072 sc1 lds
  s_waitcnt vmcnt(4)
  s_branch L_hj_132
L_hp_131:
  s_waitcnt vmcnt(4)
L_hj_132:
  s_barrier
  ds_read_b128 v[16:19], v112 offset:0
  ds_read_b128 v[20:23], v112 offset:1024
  ds_read_b128 v[24:27], v112 offset:2048
L_s1b1_100:
  s_add_u32 s74, s55, s56
  s_min_u32 s64, s74, 63
  s_lshl_b32 s96, s64, 6
  s_add_u32 s96, s96, 0x23000
  s_add_u32 s96, s96, s53
  s_mov_b32 s59, 0
  s_mov_b32 s80, 0
  ds_read_b128 v[28:31], v112 offset:3072
  s_waitcnt lgkmcnt(3)
  v_mfma_f32_32x32x16_bf16 v[80:95], a[0:3], v[16:19], 0
  buffer_load_dword v11, v8, s[4:7], s96 offen sc1
  v_mfma_f32_32x32x16_bf16 v[96:111], v[16:19], a[128:131], 0
  ds_read_b128 v[16:19], v112 offset:4096
  s_waitcnt lgkmcnt(3)
  v_mfma_f32_32x32x16_bf16 v[80:95], a[4:7], v[20:23], v[80:95]
  v_mfma_f32_32x32x16_bf16 v[96:111], v[20:23], a[132:135], v[96:111]
  s_cmp_lg_u32 s60, 2
  s_cbranch_scc1 L_ep_136
  v_cvt_pk_bf16_f32 v64, v32, v33
  v_cvt_pk_bf16_f32 v65, v34, v35
  v_cvt_pk_bf16_f32 v66, v36, v37
  v_cvt_pk_bf16_f32 v67, v38, v39
  buffer_store_dwordx4 v[64:67], v12, s[4:7], s76 offen offset:0 sc1
L_ep_136:
  ds_read_b128 v[20:23], v112 offset:5120
  s_waitcnt lgkmcnt(3)
  v_mfma_f32_32x32x16_bf16 v[80:95], a[8:11], v[24:27], v[80:95]
  s_cmp_lg_u32 s60, 2
  s_cbranch_scc1 L_ep_137
  v_cvt_pk_bf16_f32 v68, v40, v41
  v_cvt_pk_bf16_f32 v69, v42, v43
  v_cvt_pk_bf16_f32 v70, v44, v45
  v_cvt_pk_bf16_f32 v71, v46, v47
  buffer_store_dwordx4 v[68:71], v12, s[4:7], s76 offen offset:1024 sc1
L_ep_137:
  v_mfma_f32_32x32x16_bf16 v[96:111], v[24:27], a[136:139], v[96:111]
  s_cmp_lg_u32 s60, 2
  s_cbranch_scc1 L_ep_138
  v_cvt_pk_bf16_f32 v72, v48, v49
  v_cvt_pk_bf16_f32 v73, v50, v51
  v_cvt_pk_bf16_f32 v74, v52, v53
  v_cvt_pk_bf16_f32 v75, v54, v55
  buffer_store_dwordx4 v[72:75], v12, s[4:7], s77 offen offset:0 sc1
L_ep_138:
  ds_read_b128 v[24:27], v112 offset:6144
  s_waitcnt lgkmcnt(3)
  v_mfma_f32_32x32x16_bf16 v[80:95], a[12:15], v[28:31], v[80:95]
  s_cmp_lg_u32 s60, 2
  s_cbranch_scc1 L_ep_139
  v_cvt_pk_bf16_f32 v76, v56, v57
  v_cvt_pk_bf16_f32 v77, v58, v59
  v_cvt_pk_bf16_f32 v78, v60, v61
  v_cvt_pk_bf16_f32 v79, v62, v63
  buffer_store_dwordx4 v[76:79], v12, s[4:7], s77 offen offset:1024 sc1
  s_mov_b32 s88, s78
L_ep_139:
  v_mfma_f32_32x32x16_bf16 v[96:111], v[28:31], a[140:143], v[96:111]
  ds_read_b128 v[28:31], v112 offset:7168
  s_waitcnt lgkmcnt(3)
  v_mfma_f32_32x32x16_bf16 v[80:95], a[16:19], v[16:19], v[80:95]
  v_mfma_f32_32x32x16_bf16 v[96:111], v[16:19], a[144:147], v[96:111]
  ds_read_b128 v[16:19], v112 offset:8192
  s_waitcnt lgkmcnt(3)
  v_mfma_f32_32x32x16_bf16 v[80:95], a[20:23], v[20:23], v[80:95]
  v_mfma_f32_32x32x16_bf16 v[96:111], v[20:23], a[148:151], v[96:111]
  ds_read_b128 v[20:23], v112 offset:9216
  s_waitcnt lgkmcnt(3)
  v_mfma_f32_32x32x16_bf16 v[80:95], a[24:27], v[24:27], v[80:95]
  v_mfma_f32_32x32x16_bf16 v[96:111], v[24:27], a[152:155], v[96:111]
  ds_read_b128 v[24:27], v112 offset:10240
  s_waitcnt lgkmcnt(3)
  v_mfma_f32_32x32x16_bf16 v[80:95], a[28:31], v[28:31], v[80:95]
  v_mfma_f32_32x32x16_bf16 v[96:111], v[28:31], a[156:159], v[96:111]
  ds_read_b128 v[28:31], v112 offset:11264
  s_waitcnt lgkmcnt(3)
  v_mfma_f32_32x32x16_bf16 v[80:95], a[32:35], v[16:19], v[80:95]
  v_mfma_f32_32x32x16_bf16 v[96:111], v[16:19], a[160:163], v[96:111]
  ds_read_b128 v[16:19], v112 offset:12288
  s_waitcnt lgkmcnt(3)
  v_mfma_f32_32x32x16_bf16 v[80:95], a[36:39], v[20:23], v[80:95]
  v_mfma_f32_32x32x16_bf16 v[96:111], v[20:23], a[164:167], v[96:111]
  ds_read_b128 v[20:23], v112 offset:13312
  s_waitcnt lgkmcnt(3)
  v_mfma_f32_32x32x16_bf16 v[80:95], a[40:43], v[24:27], v[80:95]
  v_mfma_f32_32x32x16_bf16 v[96:111], v[24:27], a[168:171], v[96:111]
  s_cmp_lg_u32 s60, 1
  s_cbranch_scc1 L_hfa_140
  s_waitcnt vmcnt(1)
  s_mov_b64 exec, 1
  buffer_store_dword v10, v9, s[4:7], s88 offen sc1
  s_mov_b64 exec, -1
  s_mov_b32 s88, 0
L_hfa_140:
  ds_read_b128 v[24:27], v112 offset:14336
  s_waitcnt lgkmcnt(3)
  v_mfma_f32_32x32x16_bf16 v[80:95], a[44:47], v[28:31], v[80:95]
  v_mfma_f32_32x32x16_bf16 v[96:111], v[28:31], a[172:175], v[96:111]
  s_cmp_lg_u32 s60, 2
  s_cbranch_scc1 L_hfb_141
  s_cmp_eq_u32 s59, 1
  s_cbranch_scc1 L_hfc_142
  s_waitcnt vmcnt(0)
L_hfc_142:
  s_waitcnt vmcnt(8)
  s_mov_b64 exec, 1
  buffer_store_dword v10, v9, s[4:7], s88 offen sc1
  s_mov_b64 exec, -1
  s_mov_b32 s88, 0
L_hfb_141:
  ds_read_b128 v[28:31], v112 offset:15360
  s_waitcnt lgkmcnt(3)
  v_mfma_f32_32x32x16_bf16 v[80:95], a[48:51], v[16:19], v[80:95]
  v_mfma_f32_32x32x16_bf16 v[96:111], v[16:19], a[176:179], v[96:111]
  s_cmp_eq_u32 s60, 2
  s_cbranch_scc1 L_h1b_144
  s_cmp_eq_u32 s60, 1
  s_cbranch_scc1 L_h1a_143
  s_waitcnt vmcnt(0)
L_h1a_143:
  s_waitcnt vmcnt(1)
L_h1b_144:
  s_waitcnt vmcnt(4)
  v_cmp_eq_u32 vcc, 0, v11
  s_cmp_lt_u32 s74, s57
  s_cselect_b64 s[70:71], vcc, -1
  s_cmp_eq_u64 s[70:71], 0
  s_cselect_b32 s89, s58, 7
L_h1c_145:
  s_barrier
  ds_read_b128 v[16:19], v112 offset:16384
  s_waitcnt lgkmcnt(3)
  v_mfma_f32_32x32x16_bf16 v[80:95], a[52:55], v[20:23], v[80:95]
  v_mfma_f32_32x32x16_bf16 v[96:111], v[20:23], a[180:183], v[96:111]
  s_cmp_eq_u32 s89, 0
  s_cbranch_scc1 L_hwo_146
L_hwb_147:
  ds_read_b128 v[20:23], v112 offset:17408
  s_waitcnt lgkmcnt(3)
  v_mfma_f32_32x32x16_bf16 v[80:95], a[56:59], v[24:27], v[80:95]
  v_mfma_f32_32x32x16_bf16 v[96:111], v[24:27], a[184:187], v[96:111]
  ds_read_b128 v[24:27], v112 offset:18432
  s_waitcnt lgkmcnt(3)
  v_mfma_f32_32x32x16_bf16 v[80:95], a[60:63], v[28:31], v[80:95]
  v_mfma_f32_32x32x16_bf16 v[96:111], v[28:31], a[188:191], v[96:111]
  s_cmp_eq_u32 s89, 1
  s_cbranch_scc1 L_hwo_148
L_hwb_149:
  ds_read_b128 v[28:31], v112 offset:19456
  s_waitcnt lgkmcnt(3)
  v_mfma_f32_32x32x16_bf16 v[80:95], a[64:67], v[16:19], v[80:95]
  v_mfma_f32_32x32x16_bf16 v[96:111], v[16:19], a[192:195], v[96:111]
  ds_read_b128 v[16:19], v112 offset:20480
  s_waitcnt lgkmcnt(3)
  v_mfma_f32_32x32x16_bf16 v[80:95], a[68:71], v[20:23], v[80:95]
  v_mfma_f32_32x32x16_bf16 v[96:111], v[20:23], a[196:199], v[96:111]
  s_cmp_eq_u32 s89, 2
  s_cbranch_scc1 L_hwo_150
L_hwb_151:
  ds_read_b128 v[20:23], v112 offset:21504
  s_waitcnt lgkmcnt(3)
  v_mfma_f32_32x32x16_bf16 v[80:95], a[72:75], v[24:27], v[80:95]
  v_mfma_f32_32x32x16_bf16 v[96:111], v[24:27], a[200:203], v[96:111]
  ds_read_b128 v[24:27], v112 offset:22528
  s_waitcnt lgkmcnt(3)
  v_mfma_f32_32x32x16_bf16 v[80:95], a[76:79], v[28:31], v[80:95]
  v_mfma_f32_32x32x16_bf16 v[96:111], v[28:31], a[204:207], v[96:111]
  s_cmp_eq_u32 s89, 3
  s_cbranch_scc1 L_hwo_152
L_hwb_153:
  s_cmp_lg_u32 s89, 7
  s_cbranch_scc1 L_hre_154
  buffer_load_dword v11, v8, s[4:7], s96 offen sc1
L_hre_154:
  ds_read_b128 v[28:31], v112 offset:23552
  s_waitcnt lgkmcnt(3)
  v_mfma_f32_32x32x16_bf16 v[80:95], a[80:83], v[16:19], v[80:95]
  v_mfma_f32_32x32x16_bf16 v[96:111], v[16:19], a[208:211], v[96:111]
  ds_read_b128 v[16:19], v112 offset:24576
  s_waitcnt lgkmcnt(3)
  v_mfma_f32_32x32x16_bf16 v[80:95], a[84:87], v[20:23], v[80:95]
  v_mfma_f32_32x32x16_bf16 v[96:111], v[20:23], a[212:215], v[96:111]
  ds_read_b128 v[20:23], v112 offset:25600
  s_waitcnt lgkmcnt(3)
  v_mfma_f32_32x32x16_bf16 v[80:95], a[88:91], v[24:27], v[80:95]
  v_mfma_f32_32x32x16_bf16 v[96:111], v[24:27], a[216:219], v[96:111]
  ds_read_b128 v[24:27], v112 offset:26624
  s_waitcnt lgkmcnt(3)
  v_mfma_f32_32x32x16_bf16 v[80:95], a[92:95], v[28:31], v[80:95]
  v_mfma_f32_32x32x16_bf16 v[96:111], v[28:31], a[220:223], v[96:111]
  ds_read_b128 v[28:31], v112 offset:27648
  s_waitcnt lgkmcnt(3)
  v_mfma_f32_32x32x16_bf16 v[80:95], a[96:99], v[16:19], v[80:95]
  v_mfma_f32_32x32x16_bf16 v[96:111], v[16:19], a[224:227], v[96:111]
  ds_read_b128 v[16:19], v112 offset:28672
  s_waitcnt lgkmcnt(3)
  v_mfma_f32_32x32x16_bf16 v[80:95], a[100:103], v[20:23], v[80:95]
  v_mfma_f32_32x32x16_bf16 v[96:111], v[20:23], a[228:231], v[96:111]
  ds_read_b128 v[20:23], v112 offset:29696
  s_waitcnt lgkmcnt(3)
  v_mfma_f32_32x32x16_bf16 v[80:95], a[104:107], v[24:27], v[80:95]
  v_mfma_f32_32x32x16_bf16 v[96:111], v[24:27], a[232:235], v[96:111]
  ds_read_b128 v[24:27], v112 offset:30720
  s_waitcnt lgkmcnt(3)
  v_mfma_f32_32x32x16_bf16 v[80:95], a[108:111], v[28:31], v[80:95]
  v_mfma_f32_32x32x16_bf16 v[96:111], v[28:31], a[236:239], v[96:111]
  ds_read_b128 v[28:31], v112 offset:31744
  s_waitcnt lgkmcnt(3)
  v_mfma_f32_32x32x16_bf16 v[80:95], a[112:115], v[16:19], v[80:95]
  s_lshl_b32 s76, s55, 18
  s_lshl_b32 s77, s54, 13
  s_add_u32 s76, s76, s77
  s_add_u32 s76, s76, s52
  v_mfma_f32_32x32x16_bf16 v[96:111], v[16:19], a[240:243], v[96:111]
  s_waitcnt lgkmcnt(2)
  v_mfma_f32_32x32x16_bf16 v[80:95], a[116:119], v[20:23], v[80:95]
  s_add_u32 s77, s76, 0x1000000
  s_lshl_b32 s78, s55, 9
  s_lshl_b32 s79, s54, 4
  s_add_u32 s78, s78, s79
  v_mfma_f32_32x32x16_bf16 v[96:111], v[20:23], a[244:247], v[96:111]
  s_waitcnt lgkmcnt(1)
  v_mfma_f32_32x32x16_bf16 v[80:95], a[120:123], v[24:27], v[80:95]
  s_add_u32 s78, s78, s53
  v_mfma_f32_32x32x16_bf16 v[96:111], v[24:27], a[248:251], v[96:111]
  s_waitcnt lgkmcnt(0)
  v_mfma_f32_32x32x16_bf16 v[80:95], a[124:127], v[28:31], v[80:95]
  v_mfma_f32_32x32x16_bf16 v[96:111], v[28:31], a[252:255], v[96:111]
  s_cmp_lg_u32 s59, 1
  s_cbranch_scc1 L_late_155
  s_cmp_eq_u32 s80, 1
  s_cbranch_scc1 L_st1_156
  s_waitcnt vmcnt(0)
L_st1_156:
  s_waitcnt vmcnt(1)
  s_barrier
  ds_read_b128 v[16:19], v7 offset:0
  ds_read_b128 v[20:23], v7 offset:1024
  ds_read_b128 v[24:27], v7 offset:2048
  s_mov_b32 s60, 2
  s_mov_b32 s55, s74
  s_branch L_s1b0_99
L_late_155:
  s_mov_b32 s60, 0
  s_waitcnt vmcnt(0)
  s_cmp_ge_u32 s74, s57
  s_cbranch_scc1 L_nl_157
  v_cmp_eq_u32 vcc, 0, v11
  s_cbranch_vccnz L_nl_157
  s_mov_b32 s64, 0x0
  s_lshl_b32 s61, s74, 15
  s_add_u32 s61, s61, 0x5a00000
  s_add_u32 s61, s61, s52
  s_lshl_b32 s62, s58, 12
  s_add_u32 m0, s62, s64
  s_nop 0
  buffer_load_dwordx4 v6, s[4:7], s61 offen offset:0 sc1 lds
  buffer_load_dwordx4 v6, s[4:7], s61 offen offset:1024 sc1 lds
  buffer_load_dwordx4 v6, s[4:7], s61 offen offset:2048 sc1 lds
  buffer_load_dwordx4 v6, s[4:7], s61 offen offset:3072 sc1 lds
  s_add_u32 m0, m0, 0x4000
  s_add_u32 s61, s61, 0x4000
  buffer_load_dwordx4 v6, s[4:7], s61 offen offset:0 sc1 lds
  buffer_load_dwordx4 v6, s[4:7], s61 offen offset:1024 sc1 lds
  buffer_load_dwordx4 v6, s[4:7], s61 offen offset:2048 sc1 lds
  buffer_load_dwordx4 v6, s[4:7], s61 offen offset:3072 sc1 lds
  s_mov_b32 s60, 1
L_nl_157:
  s_nop 7
  v_cvt_pk_bf16_f32 v64, v80, v81
  v_cvt_pk_bf16_f32 v65, v82, v83
  v_cvt_pk_bf16_f32 v66, v84, v85
  v_cvt_pk_bf16_f32 v67, v86, v87
  buffer_store_dwordx4 v[64:67], v12, s[4:7], s76 offen offset:0 sc1
  v_cvt_pk_bf16_f32 v68, v88, v89
  v_cvt_pk_bf16_f32 v69, v90, v91
  v_cvt_pk_bf16_f32 v70, v92, v93
  v_cvt_pk_bf16_f32 v71, v94, v95
  buffer_store_dwordx4 v[68:71], v12, s[4:7], s76 offen offset:1024 sc1
  v_cvt_pk_bf16_f32 v72, v96, v97
  v_cvt_pk_bf16_f32 v73, v98, v99
  v_cvt_pk_bf16_f32 v74, v100, v101
  v_cvt_pk_bf16_f32 v75, v102, v103
  buffer_store_dwordx4 v[72:75], v12, s[4:7], s77 offen offset:0 sc1
  v_cvt_pk_bf16_f32 v76, v104, v105
  v_cvt_pk_bf16_f32 v77, v106, v107
  v_cvt_pk_bf16_f32 v78, v108, v109
  v_cvt_pk_bf16_f32 v79, v110, v111
  buffer_store_dwordx4 v[76:79], v12, s[4:7], s77 offen offset:1024 sc1
  s_mov_b32 s88, s78
  s_mov_b32 s55, s74
  s_cmp_lt_u32 s55, s57
  s_cbranch_scc1 L_s1h0_97
  s_waitcnt vmcnt(0)
  s_cmp_eq_u32 s88, 0
  s_cbranch_scc1 L_nofl_158
  s_mov_b64 exec, 1
  buffer_store_dword v10, v9, s[4:7], s88 offen sc1
  s_mov_b64 exec, -1
  s_mov_b32 s88, 0
L_nofl_158:
  s_and_b32 s61, s87, 3
  s_cmp_lg_u32 s61, 0
  s_cbranch_scc1 L_s1n_159
  s_cmp_eq_u32 s87, 4
  s_cbranch_scc1 L_s1a_160
  s_cmp_eq_u32 s87, 8
  s_cbranch_scc1 L_exit
  s_cmp_eq_u32 s87, 0
  s_cbranch_scc1 L_dispatch
  s_add_u32 s54, s54, 16
  s_mov_b32 s55, 64
  s_mov_b32 s87, 0
  s_branch B_s1
L_s1a_160:
  s_mov_b32 s52, 0x7000000
  s_mov_b32 s53, 0x50000
  s_mov_b32 s75, 0x1c2000
  s_mov_b32 s55, 0
  s_mov_b32 s56, 1
  s_mov_b32 s57, 64
  s_mov_b32 s87, 8
  s_branch L_s1h0_97
L_s1n_159:
  s_sub_u32 s87, s87, 1
  s_sub_u32 s55, s55, 1
  s_sub_u32 s56, s56, 1
  s_cmp_eq_u32 s56, 3
  s_cselect_b32 s57, 38, 52
  s_cmp_eq_u32 s56, 1
  s_cselect_b32 s57, 64, s57
  s_branch L_s1h0_97
L_hwo_116:
  s_mov_b32 s64, 0x8000
  s_lshl_b32 s61, s74, 15
  s_add_u32 s61, s61, 0x5a00000
  s_add_u32 s61, s61, s52
  s_lshl_b32 s62, s58, 12
  s_add_u32 m0, s62, s64
  s_nop 0
  buffer_load_dwordx4 v6, s[4:7], s61 offen offset:0 sc1 lds
  buffer_load_dwordx4 v6, s[4:7], s61 offen offset:1024 sc1 lds
  buffer_load_dwordx4 v6, s[4:7], s61 offen offset:2048 sc1 lds
  buffer_load_dwordx4 v6, s[4:7], s61 offen offset:3072 sc1 lds
  s_add_u32 m0, m0, 0x4000
  s_add_u32 s61, s61, 0x4000
  buffer_load_dwordx4 v6, s[4:7], s61 offen offset:0 sc1 lds
  buffer_load_dwordx4 v6, s[4:7], s61 offen offset:1024 sc1 lds
  buffer_load_dwordx4 v6, s[4:7], s61 offen offset:2048 sc1 lds
  buffer_load_dwordx4 v6, s[4:7], s61 offen offset:3072 sc1 lds
  s_mov_b32 s59, 1
  s_branch L_hwb_117
L_hwo_118:
  s_mov_b32 s64, 0x8000
  s_lshl_b32 s61, s74, 15
  s_add_u32 s61, s61, 0x5a00000
  s_add_u32 s61, s61, s52
  s_lshl_b32 s62, s58, 12
  s_add_u32 m0, s62, s64
  s_nop 0
  buffer_load_dwordx4 v6, s[4:7], s61 offen offset:0 sc1 lds
  buffer_load_dwordx4 v6, s[4:7], s61 offen offset:1024 sc1 lds
  buffer_load_dwordx4 v6, s[4:7], s61 offen offset:2048 sc1 lds
  buffer_load_dwordx4 v6, s[4:7], s61 offen offset:3072 sc1 lds
  s_add_u32 m0, m0, 0x4000
  s_add_u32 s61, s61, 0x4000
  buffer_load_dwordx4 v6, s[4:7], s61 offen offset:0 sc1 lds
  buffer_load_dwordx4 v6, s[4:7], s61 offen offset:1024 sc1 lds
  buffer_load_dwordx4 v6, s[4:7], s61 offen offset:2048 sc1 lds
  buffer_load_dwordx4 v6, s[4:7], s61 offen offset:3072 sc1 lds
  s_mov_b32 s59, 1
  s_branch L_hwb_119
L_hwo_120:
  s_mov_b32 s64, 0x8000
  s_lshl_b32 s61, s74, 15
  s_add_u32 s61, s61, 0x5a00000
  s_add_u32 s61, s61, s52
  s_lshl_b32 s62, s58, 12
  s_add_u32 m0, s62, s64
  s_nop 0
  buffer_load_dwordx4 v6, s[4:7], s61 offen offset:0 sc1 lds
  buffer_load_dwordx4 v6, s[4:7], s61 offen offset:1024 sc1 lds
  buffer_load_dwordx4 v6, s[4:7], s61 offen offset:2048 sc1 lds
  buffer_load_dwordx4 v6, s[4:7], s61 offen offset:3072 sc1 lds
  s_add_u32 m0, m0, 0x4000
  s_add_u32 s61, s61, 0x4000
  buffer_load_dwordx4 v6, s[4:7], s61 offen offset:0 sc1 lds
  buffer_load_dwordx4 v6, s[4:7], s61 offen offset:1024 sc1 lds
  buffer_load_dwordx4 v6, s[4:7], s61 offen offset:2048 sc1 lds
  buffer_load_dwordx4 v6, s[4:7], s61 offen offset:3072 sc1 lds
  s_mov_b32 s59, 1
  s_branch L_hwb_121
L_hwo_122:
  s_mov_b32 s64, 0x8000
  s_lshl_b32 s61, s74, 15
  s_add_u32 s61, s61, 0x5a00000
  s_add_u32 s61, s61, s52
  s_lshl_b32 s62, s58, 12
  s_add_u32 m0, s62, s64
  s_nop 0
  buffer_load_dwordx4 v6, s[4:7], s61 offen offset:0 sc1 lds
  buffer_load_dwordx4 v6, s[4:7], s61 offen offset:1024 sc1 lds
  buffer_load_dwordx4 v6, s[4:7], s61 offen offset:2048 sc1 lds
  buffer_load_dwordx4 v6, s[4:7], s61 offen offset:3072 sc1 lds
  s_add_u32 m0, m0, 0x4000
  s_add_u32 s61, s61, 0x4000
  buffer_load_dwordx4 v6, s[4:7], s61 offen offset:0 sc1 lds
  buffer_load_dwordx4 v6, s[4:7], s61 offen offset:1024 sc1 lds
  buffer_load_dwordx4 v6, s[4:7], s61 offen offset:2048 sc1 lds
  buffer_load_dwordx4 v6, s[4:7], s61 offen offset:3072 sc1 lds
  s_mov_b32 s59, 1
  s_branch L_hwb_123
L_hwo_146:
  s_mov_b32 s64, 0x0
  s_lshl_b32 s61, s74, 15
  s_add_u32 s61, s61, 0x5a00000
  s_add_u32 s61, s61, s52
  s_lshl_b32 s62, s58, 12
  s_add_u32 m0, s62, s64
  s_nop 0
  buffer_load_dwordx4 v6, s[4:7], s61 offen offset:0 sc1 lds
  buffer_load_dwordx4 v6, s[4:7], s61 offen offset:1024 sc1 lds
  buffer_load_dwordx4 v6, s[4:7], s61 offen offset:2048 sc1 lds
  buffer_load_dwordx4 v6, s[4:7], s61 offen offset:3072 sc1 lds
  s_add_u32 m0, m0, 0x4000
  s_add_u32 s61, s61, 0x4000
  buffer_load_dwordx4 v6, s[4:7], s61 offen offset:0 sc1 lds
  buffer_load_dwordx4 v6, s[4:7], s61 offen offset:1024 sc1 lds
  buffer_load_dwordx4 v6, s[4:7], s61 offen offset:2048 sc1 lds
  buffer_load_dwordx4 v6, s[4:7], s61 offen offset:3072 sc1 lds
  s_mov_b32 s59, 1
  s_branch L_hwb_147
L_hwo_148:
  s_mov_b32 s64, 0x0
  s_lshl_b32 s61, s74, 15
  s_add_u32 s61, s61, 0x5a00000
  s_add_u32 s61, s61, s52
  s_lshl_b32 s62, s58, 12
  s_add_u32 m0, s62, s64
  s_nop 0
  buffer_load_dwordx4 v6, s[4:7], s61 offen offset:0 sc1 lds
  buffer_load_dwordx4 v6, s[4:7], s61 offen offset:1024 sc1 lds
  buffer_load_dwordx4 v6, s[4:7], s61 offen offset:2048 sc1 lds
  buffer_load_dwordx4 v6, s[4:7], s61 offen offset:3072 sc1 lds
  s_add_u32 m0, m0, 0x4000
  s_add_u32 s61, s61, 0x4000
  buffer_load_dwordx4 v6, s[4:7], s61 offen offset:0 sc1 lds
  buffer_load_dwordx4 v6, s[4:7], s61 offen offset:1024 sc1 lds
  buffer_load_dwordx4 v6, s[4:7], s61 offen offset:2048 sc1 lds
  buffer_load_dwordx4 v6, s[4:7], s61 offen offset:3072 sc1 lds
  s_mov_b32 s59, 1
  s_branch L_hwb_149
L_hwo_150:
  s_mov_b32 s64, 0x0
  s_lshl_b32 s61, s74, 15
  s_add_u32 s61, s61, 0x5a00000
  s_add_u32 s61, s61, s52
  s_lshl_b32 s62, s58, 12
  s_add_u32 m0, s62, s64
  s_nop 0
  buffer_load_dwordx4 v6, s[4:7], s61 offen offset:0 sc1 lds
  buffer_load_dwordx4 v6, s[4:7], s61 offen offset:1024 sc1 lds
  buffer_load_dwordx4 v6, s[4:7], s61 offen offset:2048 sc1 lds
  buffer_load_dwordx4 v6, s[4:7], s61 offen offset:3072 sc1 lds
  s_add_u32 m0, m0, 0x4000
  s_add_u32 s61, s61, 0x4000
  buffer_load_dwordx4 v6, s[4:7], s61 offen offset:0 sc1 lds
  buffer_load_dwordx4 v6, s[4:7], s61 offen offset:1024 sc1 lds
  buffer_load_dwordx4 v6, s[4:7], s61 offen offset:2048 sc1 lds
  buffer_load_dwordx4 v6, s[4:7], s61 offen offset:3072 sc1 lds
  s_mov_b32 s59, 1
  s_branch L_hwb_151
L_hwo_152:
  s_mov_b32 s64, 0x0
  s_lshl_b32 s61, s74, 15
  s_add_u32 s61, s61, 0x5a00000
  s_add_u32 s61, s61, s52
  s_lshl_b32 s62, s58, 12
  s_add_u32 m0, s62, s64
  s_nop 0
  buffer_load_dwordx4 v6, s[4:7], s61 offen offset:0 sc1 lds
  buffer_load_dwordx4 v6, s[4:7], s61 offen offset:1024 sc1 lds
  buffer_load_dwordx4 v6, s[4:7], s61 offen offset:2048 sc1 lds
  buffer_load_dwordx4 v6, s[4:7], s61 offen offset:3072 sc1 lds
  s_add_u32 m0, m0, 0x4000
  s_add_u32 s61, s61, 0x4000
  buffer_load_dwordx4 v6, s[4:7], s61 offen offset:0 sc1 lds
  buffer_load_dwordx4 v6, s[4:7], s61 offen offset:1024 sc1 lds
  buffer_load_dwordx4 v6, s[4:7], s61 offen offset:2048 sc1 lds
  buffer_load_dwordx4 v6, s[4:7], s61 offen offset:3072 sc1 lds
  s_mov_b32 s59, 1
  s_branch L_hwb_153
  s_endpgm
B_s3:
  v_mov_b32 v6, 0x0
  v_bfe_i32 v2, v0, 0, 1
  v_and_b32 v2, 0x10, v2
  v_add_u32 v6, v6, v2
  v_bfe_i32 v2, v0, 1, 1
  v_and_b32 v2, 0x20, v2
  v_add_u32 v6, v6, v2
  v_bfe_i32 v2, v0, 2, 1
  v_and_b32 v2, 0x40, v2
  v_add_u32 v6, v6, v2
  v_bfe_i32 v2, v0, 3, 1
  v_and_b32 v2, 0x80, v2
  v_add_u32 v6, v6, v2
  v_bfe_i32 v2, v0, 4, 1
  v_and_b32 v2, 0x100, v2
  v_add_u32 v6, v6, v2
  v_bfe_i32 v2, v0, 5, 1
  v_and_b32 v2, 0x200, v2
  v_add_u32 v6, v6, v2
  v_bfe_i32 v2, v0, 6, 1
  v_and_b32 v2, 0x1000, v2
  v_add_u32 v6, v6, v2
  v_bfe_i32 v2, v0, 7, 1
  v_and_b32 v2, 0x2000, v2
  v_add_u32 v6, v6, v2
  v_mov_b32 v7, 0x0
  v_bfe_i32 v2, v0, 0, 1
  v_and_b32 v2, 0x10, v2
  v_add_u32 v7, v7, v2
  v_bfe_i32 v2, v0, 1, 1
  v_and_b32 v2, 0x20, v2
  v_add_u32 v7, v7, v2
  v_bfe_i32 v2, v0, 2, 1
  v_and_b32 v2, 0x40, v2
  v_add_u32 v7, v7, v2
  v_bfe_i32 v2, v0, 3, 1
  v_and_b32 v2, 0x80, v2
  v_add_u32 v7, v7, v2
  v_bfe_i32 v2, v0, 4, 1
  v_and_b32 v2, 0x100, v2
  v_add_u32 v7, v7, v2
  v_bfe_i32 v2, v0, 5, 1
  v_and_b32 v2, 0x200, v2
  v_add_u32 v7, v7, v2
  v_mov_b32 v8, 0x0
  v_bfe_i32 v2, v0, 0, 1
  v_and_b32 v2, 0x4, v2
  v_add_u32 v8, v8, v2
  v_bfe_i32 v2, v0, 1, 1
  v_and_b32 v2, 0x8, v2
  v_add_u32 v8, v8, v2
  v_bfe_i32 v2, v0, 2, 1
  v_and_b32 v2, 0x10, v2
  v_add_u32 v8, v8, v2
  v_bfe_i32 v2, v0, 3, 1
  v_and_b32 v2, 0x20, v2
  v_add_u32 v8, v8, v2
  v_bfe_i32 v2, v0, 4, 1
  v_and_b32 v2, 0x40, v2
  v_add_u32 v8, v8, v2
  v_mov_b32 v9, 0x0
  v_bfe_i32 v2, v0, 6, 1
  v_and_b32 v2, 0x4, v2
  v_add_u32 v9, v9, v2
  v_bfe_i32 v2, v0, 7, 1
  v_and_b32 v2, 0x8, v2
  v_add_u32 v9, v9, v2
  v_mov_b32 v10, 1
  v_mov_b32 v12, 0x0
  v_bfe_i32 v2, v0, 0, 1
  v_and_b32 v2, 0x10, v2
  v_add_u32 v12, v12, v2
  v_bfe_i32 v2, v0, 1, 1
  v_and_b32 v2, 0x20, v2
  v_add_u32 v12, v12, v2
  v_bfe_i32 v2, v0, 2, 1
  v_and_b32 v2, 0x40, v2
  v_add_u32 v12, v12, v2
  v_bfe_i32 v2, v0, 3, 1
  v_and_b32 v2, 0x2000, v2
  v_add_u32 v12, v12, v2
  v_bfe_i32 v2, v0, 4, 1
  v_and_b32 v2, 0x4000, v2
  v_add_u32 v12, v12, v2
  v_bfe_i32 v2, v0, 5, 1
  v_and_b32 v2, 0x80, v2
  v_add_u32 v12, v12, v2
  v_bfe_i32 v2, v0, 6, 1
  v_and_b32 v2, 0x200, v2
  v_add_u32 v12, v12, v2
  v_bfe_i32 v2, v0, 7, 1
  v_and_b32 v2, 0x400, v2
  v_add_u32_e64 v12, v12, v2
  s_mov_b32 s8, s34
  s_and_b32 s9, s35, 0xffff
  s_mov_b32 s10, 0x400000
  s_mov_b32 s11, 0x20000
  v_mov_b32 v3, 0x0
  v_bfe_i32 v2, v0, 0, 1
  v_and_b32 v2, 0x10, v2
  v_xor_b32 v3, v3, v2
  v_bfe_i32 v2, v0, 1, 1
  v_and_b32 v2, 0x20, v2
  v_xor_b32 v3, v3, v2
  v_bfe_i32 v2, v0, 2, 1
  v_and_b32 v2, 0x40, v2
  v_xor_b32 v3, v3, v2
  v_bfe_i32 v2, v0, 3, 1
  v_and_b32 v2, 0x80, v2
  v_xor_b32 v3, v3, v2
  v_bfe_i32 v2, v0, 4, 1
  v_and_b32 v2, 0x40, v2
  v_xor_b32 v3, v3, v2
  v_bfe_i32 v2, v0, 5, 1
  v_and_b32 v2, 0x80, v2
  v_xor_b32 v3, v3, v2
  v_mov_b32 v5, 0x0
  v_bfe_i32 v2, v0, 4, 1
  v_and_b32 v2, 0x400, v2
  v_add_u32 v5, v5, v2
  v_bfe_i32 v2, v0, 5, 1
  v_and_b32 v2, 0x800, v2
  v_add_u32 v5, v5, v2
  v_add_u32 v3, v3, v5
  v_mov_b32 v4, 0x0
  v_bfe_i32 v2, v0, 0, 1
  v_and_b32 v2, 0x8, v2
  v_xor_b32 v4, v4, v2
  v_bfe_i32 v2, v0, 1, 1
  v_and_b32 v2, 0x10, v2
  v_xor_b32 v4, v4, v2
  v_bfe_i32 v2, v0, 2, 1
  v_and_b32 v2, 0x140, v2
  v_xor_b32 v4, v4, v2
  v_bfe_i32 v2, v0, 3, 1
  v_and_b32 v2, 0x280, v2
  v_xor_b32 v4, v4, v2
  v_bfe_i32 v2, v0, 4, 1
  v_and_b32 v2, 0x20, v2
  v_xor_b32 v4, v4, v2
  v_bfe_i32 v2, v0, 5, 1
  v_and_b32 v2, 0x400, v2
  v_xor_b32 v4, v4, v2
  v_bfe_i32 v2, v0, 6, 1
  v_and_b32 v2, 0x40, v2
  v_xor_b32 v4, v4, v2
  v_bfe_i32 v2, v0, 7, 1
  v_and_b32 v2, 0x80, v2
  v_xor_b32 v4, v4, v2
  v_add_u32 v5, 0x10000, v4
  s_lshl_b32 s76, s54, 8
  s_lshl_b32 s77, s73, 20
  s_add_u32 s76, s76, s77
  s_barrier
  s_mul_i32 s61, s58, 131072
  s_add_u32 s61, s61, s76
  s_add_u32 s61, s61, 0
  s_mul_i32 s62, s58, 32768
  s_mov_b32 s63, 0
L_wdma_161:
  s_mov_b32 m0, s62
  s_add_u32 s62, s62, 1024
  buffer_load_dwordx4 v3, s[8:11], s61 offen lds
  s_add_u32 s61, s61, 4096
  s_add_u32 s63, s63, 1
  s_cmp_lt_u32 s63, 32
  s_cbranch_scc1 L_wdma_161
  s_waitcnt vmcnt(0)
  s_barrier
  ds_read_b64_tr_b16 a[0:1], v4 offset:0
  ds_read_b64_tr_b16 a[2:3], v4 offset:2048
  ds_read_b64_tr_b16 a[4:5], v4 offset:4096
  ds_read_b64_tr_b16 a[6:7], v4 offset:6144
  ds_read_b64_tr_b16 a[8:9], v4 offset:8192
  ds_read_b64_tr_b16 a[10:11], v4 offset:10240
  ds_read_b64_tr_b16 a[12:13], v4 offset:12288
  ds_read_b64_tr_b16 a[14:15], v4 offset:14336
  s_waitcnt lgkmcnt(0)
  ds_read_b64_tr_b16 a[16:17], v4 offset:16384
  ds_read_b64_tr_b16 a[18:19], v4 offset:18432
  ds_read_b64_tr_b16 a[20:21], v4 offset:20480
  ds_read_b64_tr_b16 a[22:23], v4 offset:22528
  ds_read_b64_tr_b16 a[24:25], v4 offset:24576
  ds_read_b64_tr_b16 a[26:27], v4 offset:26624
  ds_read_b64_tr_b16 a[28:29], v4 offset:28672
  ds_read_b64_tr_b16 a[30:31], v4 offset:30720
  s_waitcnt lgkmcnt(0)
  ds_read_b64_tr_b16 a[32:33], v4 offset:32768
  ds_read_b64_tr_b16 a[34:35], v4 offset:34816
  ds_read_b64_tr_b16 a[36:37], v4 offset:36864
  ds_read_b64_tr_b16 a[38:39], v4 offset:38912
  ds_read_b64_tr_b16 a[40:41], v4 offset:40960
  ds_read_b64_tr_b16 a[42:43], v4 offset:43008
  ds_read_b64_tr_b16 a[44:45], v4 offset:45056
  ds_read_b64_tr_b16 a[46:47], v4 offset:47104
  s_waitcnt lgkmcnt(0)
  ds_read_b64_tr_b16 a[48:49], v4 offset:49152
  ds_read_b64_tr_b16 a[50:51], v4 offset:51200
  ds_read_b64_tr_b16 a[52:53], v4 offset:53248
  ds_read_b64_tr_b16 a[54:55], v4 offset:55296
  ds_read_b64_tr_b16 a[56:57], v4 offset:57344
  ds_read_b64_tr_b16 a[58:59], v4 offset:59392
  ds_read_b64_tr_b16 a[60:61], v4 offset:61440
  ds_read_b64_tr_b16 a[62:63], v4 offset:63488
  s_waitcnt lgkmcnt(0)
  ds_read_b64_tr_b16 a[64:65], v5 offset:0
  ds_read_b64_tr_b16 a[66:67], v5 offset:2048
  ds_read_b64_tr_b16 a[68:69], v5 offset:4096
  ds_read_b64_tr_b16 a[70:71], v5 offset:6144
  ds_read_b64_tr_b16 a[72:73], v5 offset:8192
  ds_read_b64_tr_b16 a[74:75], v5 offset:10240
  ds_read_b64_tr_b16 a[76:77], v5 offset:12288
  ds_read_b64_tr_b16 a[78:79], v5 offset:14336
  s_waitcnt lgkmcnt(0)
  ds_read_b64_tr_b16 a[80:81], v5 offset:16384
  ds_read_b64_tr_b16 a[82:83], v5 offset:18432
  ds_read_b64_tr_b16 a[84:85], v5 offset:20480
  ds_read_b64_tr_b16 a[86:87], v5 offset:22528
  ds_read_b64_tr_b16 a[88:89], v5 offset:24576
  ds_read_b64_tr_b16 a[90:91], v5 offset:26624
  ds_read_b64_tr_b16 a[92:93], v5 offset:28672
  ds_read_b64_tr_b16 a[94:95], v5 offset:30720
  s_waitcnt lgkmcnt(0)
  ds_read_b64_tr_b16 a[96:97], v5 offset:32768
  ds_read_b64_tr_b16 a[98:99], v5 offset:34816
  ds_read_b64_tr_b16 a[100:101], v5 offset:36864
  ds_read_b64_tr_b16 a[102:103], v5 offset:38912
  ds_read_b64_tr_b16 a[104:105], v5 offset:40960
  ds_read_b64_tr_b16 a[106:107], v5 offset:43008
  ds_read_b64_tr_b16 a[108:109], v5 offset:45056
  ds_read_b64_tr_b16 a[110:111], v5 offset:47104
  s_waitcnt lgkmcnt(0)
  ds_read_b64_tr_b16 a[112:113], v5 offset:49152
  ds_read_b64_tr_b16 a[114:115], v5 offset:51200
  ds_read_b64_tr_b16 a[116:117], v5 offset:53248
  ds_read_b64_tr_b16 a[118:119], v5 offset:55296
  ds_read_b64_tr_b16 a[120:121], v5 offset:57344
  ds_read_b64_tr_b16 a[122:123], v5 offset:59392
  ds_read_b64_tr_b16 a[124:125], v5 offset:61440
  ds_read_b64_tr_b16 a[126:127], v5 offset:63488
  s_waitcnt lgkmcnt(0)
  s_waitcnt lgkmcnt(0)
  s_barrier
  s_mul_i32 s61, s58, 131072
  s_add_u32 s61, s61, s76
  s_add_u32 s61, s61, 524288
  s_mul_i32 s62, s58, 32768
  s_mov_b32 s63, 0
L_wdma_162:
  s_mov_b32 m0, s62
  s_add_u32 s62, s62, 1024
  buffer_load_dwordx4 v3, s[8:11], s61 offen lds
  s_add_u32 s61, s61, 4096
  s_add_u32 s63, s63, 1
  s_cmp_lt_u32 s63, 32
  s_cbranch_scc1 L_wdma_162
  s_waitcnt vmcnt(0)
  s_barrier
  ds_read_b64_tr_b16 a[128:129], v4 offset:0
  ds_read_b64_tr_b16 a[130:131], v4 offset:2048
  ds_read_b64_tr_b16 a[132:133], v4 offset:4096
  ds_read_b64_tr_b16 a[134:135], v4 offset:6144
  ds_read_b64_tr_b16 a[136:137], v4 offset:8192
  ds_read_b64_tr_b16 a[138:139], v4 offset:10240
  ds_read_b64_tr_b16 a[140:141], v4 offset:12288
  ds_read_b64_tr_b16 a[142:143], v4 offset:14336
  s_waitcnt lgkmcnt(0)
  ds_read_b64_tr_b16 a[144:145], v4 offset:16384
  ds_read_b64_tr_b16 a[146:147], v4 offset:18432
  ds_read_b64_tr_b16 a[148:149], v4 offset:20480
  ds_read_b64_tr_b16 a[150:151], v4 offset:22528
  ds_read_b64_tr_b16 a[152:153], v4 offset:24576
  ds_read_b64_tr_b16 a[154:155], v4 offset:26624
  ds_read_b64_tr_b16 a[156:157], v4 offset:28672
  ds_read_b64_tr_b16 a[158:159], v4 offset:30720
  s_waitcnt lgkmcnt(0)
  ds_read_b64_tr_b16 a[160:161], v4 offset:32768
  ds_read_b64_tr_b16 a[162:163], v4 offset:34816
  ds_read_b64_tr_b16 a[164:165], v4 offset:36864
  ds_read_b64_tr_b16 a[166:167], v4 offset:38912
  ds_read_b64_tr_b16 a[168:169], v4 offset:40960
  ds_read_b64_tr_b16 a[170:171], v4 offset:43008
  ds_read_b64_tr_b16 a[172:173], v4 offset:45056
  ds_read_b64_tr_b16 a[174:175], v4 offset:47104
  s_waitcnt lgkmcnt(0)
  ds_read_b64_tr_b16 a[176:177], v4 offset:49152
  ds_read_b64_tr_b16 a[178:179], v4 offset:51200
  ds_read_b64_tr_b16 a[180:181], v4 offset:53248
  ds_read_b64_tr_b16 a[182:183], v4 offset:55296
  ds_read_b64_tr_b16 a[184:185], v4 offset:57344
  ds_read_b64_tr_b16 a[186:187], v4 offset:59392
  ds_read_b64_tr_b16 a[188:189], v4 offset:61440
  ds_read_b64_tr_b16 a[190:191], v4 offset:63488
  s_waitcnt lgkmcnt(0)
  ds_read_b64_tr_b16 a[192:193], v5 offset:0
  ds_read_b64_tr_b16 a[194:195], v5 offset:2048
  ds_read_b64_tr_b16 a[196:197], v5 offset:4096
  ds_read_b64_tr_b16 a[198:199], v5 offset:6144
  ds_read_b64_tr_b16 a[200:201], v5 offset:8192
  ds_read_b64_tr_b16 a[202:203], v5 offset:10240
  ds_read_b64_tr_b16 a[204:205], v5 offset:12288
  ds_read_b64_tr_b16 a[206:207], v5 offset:14336
  s_waitcnt lgkmcnt(0)
  ds_read_b64_tr_b16 a[208:209], v5 offset:16384
  ds_read_b64_tr_b16 a[210:211], v5 offset:18432
  ds_read_b64_tr_b16 a[212:213], v5 offset:20480
  ds_read_b64_tr_b16 a[214:215], v5 offset:22528
  ds_read_b64_tr_b16 a[216:217], v5 offset:24576
  ds_read_b64_tr_b16 a[218:219], v5 offset:26624
  ds_read_b64_tr_b16 a[220:221], v5 offset:28672
  ds_read_b64_tr_b16 a[222:223], v5 offset:30720
  s_waitcnt lgkmcnt(0)
  ds_read_b64_tr_b16 a[224:225], v5 offset:32768
  ds_read_b64_tr_b16 a[226:227], v5 offset:34816
  ds_read_b64_tr_b16 a[228:229], v5 offset:36864
  ds_read_b64_tr_b16 a[230:231], v5 offset:38912
  ds_read_b64_tr_b16 a[232:233], v5 offset:40960
  ds_read_b64_tr_b16 a[234:235], v5 offset:43008
  ds_read_b64_tr_b16 a[236:237], v5 offset:45056
  ds_read_b64_tr_b16 a[238:239], v5 offset:47104
  s_waitcnt lgkmcnt(0)
  ds_read_b64_tr_b16 a[240:241], v5 offset:49152
  ds_read_b64_tr_b16 a[242:243], v5 offset:51200
  ds_read_b64_tr_b16 a[244:245], v5 offset:53248
  ds_read_b64_tr_b16 a[246:247], v5 offset:55296
  ds_read_b64_tr_b16 a[248:249], v5 offset:57344
  ds_read_b64_tr_b16 a[250:251], v5 offset:59392
  ds_read_b64_tr_b16 a[252:253], v5 offset:61440
  ds_read_b64_tr_b16 a[254:255], v5 offset:63488
  s_waitcnt lgkmcnt(0)
  s_waitcnt lgkmcnt(0)
  s_barrier
  s_mov_b32 s20, s50
  s_and_b32 s21, s51, 0xffff
  s_mov_b32 s22, 0x0
  s_mov_b32 s23, 0x20000
  s_mov_b32 s8, s48
  s_and_b32 s9, s49, 0xffff
  s_mov_b32 s10, 0x100
  s_mov_b32 s11, 0x20000
  v_and_b32 v2, 3, v0
  v_lshlrev_b32 v2, 6, v2
L_gate_163:
  buffer_load_dword v11, v2, s[8:11], 0 offen offset:8 sc1
  s_waitcnt vmcnt(0)
  v_cmp_gt_u32 vcc, 48, v11
  s_cbranch_vccz L_gateok_164
  s_add_u32 s72, s72, 1
  s_cmp_gt_u32 s72, 0x80000
  s_cbranch_scc1 L_exit
  s_sleep 2
  s_branch L_gate_163
L_gateok_164:
  s_mov_b32 s59, 0
  s_mov_b32 s88, 0
  s_mov_b32 s60, 0
  v_mov_b32 v113, 0
  v_add_u32 v112, 0x10000, v7
  s_mov_b32 s60, 0
L_s3h0_165:
  s_cmp_eq_u32 s60, 1
  s_cbranch_scc1 L_hp_169
  s_lshl_b32 s63, s55, 9
  s_lshl_b32 s68, s73, 7
  s_add_u32 s63, s63, s68
  s_add_u32 s63, s63, 0x10000
  s_add_u32 s63, s63, s53
  s_and_b32 s61, s55, 7
  s_lshl_b32 s61, s61, 18
  s_lshl_b32 s68, s73, 16
  s_add_u32 s61, s61, s68
  s_add_u32 s61, s61, 0x2000000
  s_add_u32 s61, s61, s52
  s_lshl_b32 s62, s58, 12
  s_add_u32 m0, s62, 0x0
L_poll_171:
  buffer_load_dword v11, v8, s[4:7], s63 offen sc1
  s_waitcnt vmcnt(0)
  s_cmp_eq_u32 s88, 0
  s_cbranch_scc1 L_nofl_173
  s_mov_b64 exec, 1
  buffer_store_dword v10, v9, s[4:7], s88 offen sc1
  s_mov_b64 exec, -1
  s_mov_b32 s88, 0
L_nofl_173:
  v_cmp_eq_u32 vcc, 0, v11
  s_cbranch_vccz L_pollok_172
  s_add_u32 s72, s72, 1
  s_cmp_gt_u32 s72, 0x80000
  s_cbranch_scc1 L_exit
  s_branch L_poll_171
L_pollok_172:
  buffer_load_dwordx4 v6, s[4:7], s61 offen offset:0 sc1 lds
  buffer_load_dwordx4 v6, s[4:7], s61 offen offset:1024 sc1 lds
  buffer_load_dwordx4 v6, s[4:7], s61 offen offset:2048 sc1 lds
  buffer_load_dwordx4 v6, s[4:7], s61 offen offset:3072 sc1 lds
  s_add_u32 m0, m0, 0x4000
  s_add_u32 s61, s61, 0x4000
  buffer_load_dwordx4 v6, s[4:7], s61 offen offset:0 sc1 lds
  buffer_load_dwordx4 v6, s[4:7], s61 offen offset:1024 sc1 lds
  buffer_load_dwordx4 v6, s[4:7], s61 offen offset:2048 sc1 lds
  buffer_load_dwordx4 v6, s[4:7], s61 offen offset:3072 sc1 lds
  s_add_u32 m0, m0, 0x4000
  s_add_u32 s61, s61, 0x4000
  buffer_load_dwordx4 v6, s[4:7], s61 offen offset:0 sc1 lds
  buffer_load_dwordx4 v6, s[4:7], s61 offen offset:1024 sc1 lds
  buffer_load_dwordx4 v6, s[4:7], s61 offen offset:2048 sc1 lds
  buffer_load_dwordx4 v6, s[4:7], s61 offen offset:3072 sc1 lds
  s_add_u32 m0, m0, 0x4000
  s_add_u32 s61, s61, 0x4000
  buffer_load_dwordx4 v6, s[4:7], s61 offen offset:0 sc1 lds
  buffer_load_dwordx4 v6, s[4:7], s61 offen offset:1024 sc1 lds
  buffer_load_dwordx4 v6, s[4:7], s61 offen offset:2048 sc1 lds
  buffer_load_dwordx4 v6, s[4:7], s61 offen offset:3072 sc1 lds
  s_waitcnt vmcnt(12)
  s_branch L_hj_170
L_hp_169:
  s_waitcnt vmcnt(2)
L_hj_170:
  s_barrier
  ds_read_b128 v[16:19], v7 offset:0
  ds_read_b128 v[20:23], v7 offset:1024
  ds_read_b128 v[24:27], v7 offset:2048
L_s3b0_167:
  s_add_u32 s74, s55, s56
  s_min_u32 s64, s74, 63
  s_lshl_b32 s96, s64, 9
  s_lshl_b32 s68, s73, 7
  s_add_u32 s96, s96, s68
  s_add_u32 s96, s96, 0x10000
  s_add_u32 s96, s96, s53
  s_mov_b32 s59, 0
  s_mov_b32 s80, 0
  ds_read_b128 v[28:31], v7 offset:3072
  s_waitcnt lgkmcnt(3)
  v_mfma_f32_32x32x16_bf16 v[32:47], a[0:3], v[16:19], 0
  buffer_load_dword v11, v8, s[4:7], s96 offen sc1
  ds_read_b128 v[16:19], v7 offset:4096
  s_waitcnt lgkmcnt(3)
  v_mfma_f32_32x32x16_bf16 v[32:47], a[4:7], v[20:23], v[32:47]
  ds_read_b128 v[20:23], v7 offset:5120
  s_waitcnt lgkmcnt(3)
  v_mfma_f32_32x32x16_bf16 v[32:47], a[8:11], v[24:27], v[32:47]
  ds_read_b128 v[24:27], v7 offset:6144
  s_waitcnt lgkmcnt(3)
  v_mfma_f32_32x32x16_bf16 v[32:47], a[12:15], v[28:31], v[32:47]
  ds_read_b128 v[28:31], v7 offset:7168
  s_waitcnt lgkmcnt(3)
  v_mfma_f32_32x32x16_bf16 v[32:47], a[16:19], v[16:19], v[32:47]
  ds_read_b128 v[16:19], v7 offset:8192
  s_waitcnt lgkmcnt(3)
  v_mfma_f32_32x32x16_bf16 v[32:47], a[20:23], v[20:23], v[32:47]
  ds_read_b128 v[20:23], v7 offset:9216
  s_waitcnt lgkmcnt(3)
  v_mfma_f32_32x32x16_bf16 v[32:47], a[24:27], v[24:27], v[32:47]
  ds_read_b128 v[24:27], v7 offset:10240
  s_waitcnt lgkmcnt(3)
  v_mfma_f32_32x32x16_bf16 v[32:47], a[28:31], v[28:31], v[32:47]
  ds_read_b128 v[28:31], v7 offset:11264
  s_waitcnt lgkmcnt(3)
  v_mfma_f32_32x32x16_bf16 v[32:47], a[32:35], v[16:19], v[32:47]
  ds_read_b128 v[16:19], v7 offset:12288
  s_waitcnt lgkmcnt(3)
  v_mfma_f32_32x32x16_bf16 v[32:47], a[36:39], v[20:23], v[32:47]
  ds_read_b128 v[20:23], v7 offset:13312
  s_waitcnt lgkmcnt(3)
  v_mfma_f32_32x32x16_bf16 v[32:47], a[40:43], v[24:27], v[32:47]
  ds_read_b128 v[24:27], v7 offset:14336
  s_waitcnt lgkmcnt(3)
  v_mfma_f32_32x32x16_bf16 v[32:47], a[44:47], v[28:31], v[32:47]
  ds_read_b128 v[28:31], v7 offset:15360
  s_waitcnt lgkmcnt(3)
  v_mfma_f32_32x32x16_bf16 v[32:47], a[48:51], v[16:19], v[32:47]
  s_cmp_lg_u32 s60, 0
  s_cbranch_scc1 L_hm_174
  s_waitcnt vmcnt(9)
L_hm_174:
  s_barrier
  ds_read_b128 v[16:19], v7 offset:16384
  s_waitcnt lgkmcnt(3)
  v_mfma_f32_32x32x16_bf16 v[32:47], a[52:55], v[20:23], v[32:47]
  ds_read_b128 v[20:23], v7 offset:17408
  s_waitcnt lgkmcnt(3)
  v_mfma_f32_32x32x16_bf16 v[32:47], a[56:59], v[24:27], v[32:47]
  ds_read_b128 v[24:27], v7 offset:18432
  s_waitcnt lgkmcnt(3)
  v_mfma_f32_32x32x16_bf16 v[32:47], a[60:63], v[28:31], v[32:47]
  ds_read_b128 v[28:31], v7 offset:19456
  s_waitcnt lgkmcnt(3)
  v_mfma_f32_32x32x16_bf16 v[32:47], a[64:67], v[16:19], v[32:47]
  ds_read_b128 v[16:19], v7 offset:20480
  s_waitcnt lgkmcnt(3)
  v_mfma_f32_32x32x16_bf16 v[32:47], a[68:71], v[20:23], v[32:47]
  ds_read_b128 v[20:23], v7 offset:21504
  s_waitcnt lgkmcnt(3)
  v_mfma_f32_32x32x16_bf16 v[32:47], a[72:75], v[24:27], v[32:47]
  ds_read_b128 v[24:27], v7 offset:22528
  s_waitcnt lgkmcnt(3)
  v_mfma_f32_32x32x16_bf16 v[32:47], a[76:79], v[28:31], v[32:47]
  ds_read_b128 v[28:31], v7 offset:23552
  s_waitcnt lgkmcnt(3)
  v_mfma_f32_32x32x16_bf16 v[32:47], a[80:83], v[16:19], v[32:47]
  ds_read_b128 v[16:19], v7 offset:24576
  s_waitcnt lgkmcnt(3)
  v_mfma_f32_32x32x16_bf16 v[32:47], a[84:87], v[20:23], v[32:47]
  s_cmp_lg_u32 s60, 1
  s_cbranch_scc1 L_hfa_175
  s_waitcnt vmcnt(1)
  s_mov_b64 exec, 1
  buffer_store_dword v10, v9, s[4:7], s88 offen sc1
  s_mov_b64 exec, -1
  s_mov_b32 s88, 0
L_hfa_175:
  ds_read_b128 v[20:23], v7 offset:25600
  s_waitcnt lgkmcnt(3)
  v_mfma_f32_32x32x16_bf16 v[32:47], a[88:91], v[24:27], v[32:47]
  ds_read_b128 v[24:27], v7 offset:26624
  s_waitcnt lgkmcnt(3)
  v_mfma_f32_32x32x16_bf16 v[32:47], a[92:95], v[28:31], v[32:47]
  ds_read_b128 v[28:31], v7 offset:27648
  s_waitcnt lgkmcnt(3)
  v_mfma_f32_32x32x16_bf16 v[32:47], a[96:99], v[16:19], v[32:47]
  ds_read_b128 v[16:19], v7 offset:28672
  s_waitcnt lgkmcnt(3)
  v_mfma_f32_32x32x16_bf16 v[32:47], a[100:103], v[20:23], v[32:47]
  ds_read_b128 v[20:23], v7 offset:29696
  s_waitcnt lgkmcnt(3)
  v_mfma_f32_32x32x16_bf16 v[32:47], a[104:107], v[24:27], v[32:47]
  ds_read_b128 v[24:27], v7 offset:30720
  s_waitcnt lgkmcnt(3)
  v_mfma_f32_32x32x16_bf16 v[32:47], a[108:111], v[28:31], v[32:47]
  ds_read_b128 v[28:31], v7 offset:31744
  s_waitcnt lgkmcnt(3)
  v_mfma_f32_32x32x16_bf16 v[32:47], a[112:115], v[16:19], v[32:47]
  s_cmp_eq_u32 s60, 2
  s_cbranch_scc1 L_h1b_177
  s_cmp_eq_u32 s60, 1
  s_cbranch_scc1 L_h1a_176
  s_waitcnt vmcnt(0)
L_h1a_176:
  s_waitcnt vmcnt(1)
L_h1b_177:
  s_waitcnt vmcnt(2)
  v_cmp_eq_u32 vcc, 0, v11
  s_cmp_lt_u32 s74, s57
  s_cselect_b64 s[70:71], vcc, -1
  s_cmp_eq_u64 s[70:71], 0
  s_cselect_b32 s89, s58, 7
L_h1c_178:
  s_barrier
  ds_read_b128 v[16:19], v7 offset:32768
  s_waitcnt lgkmcnt(3)
  v_mfma_f32_32x32x16_bf16 v[32:47], a[116:119], v[20:23], v[32:47]
  s_cmp_eq_u32 s89, 0
  s_cbranch_scc1 L_hwo_179
L_hwb_180:
  ds_read_b128 v[20:23], v7 offset:33792
  s_waitcnt lgkmcnt(3)
  v_mfma_f32_32x32x16_bf16 v[32:47], a[120:123], v[24:27], v[32:47]
  ds_read_b128 v[24:27], v7 offset:34816
  s_waitcnt lgkmcnt(3)
  v_mfma_f32_32x32x16_bf16 v[32:47], a[124:127], v[28:31], v[32:47]
  ds_read_b128 v[28:31], v7 offset:35840
  s_waitcnt lgkmcnt(3)
  v_mfma_f32_32x32x16_bf16 v[32:47], a[128:131], v[16:19], v[32:47]
  ds_read_b128 v[16:19], v7 offset:36864
  s_waitcnt lgkmcnt(3)
  v_mfma_f32_32x32x16_bf16 v[32:47], a[132:135], v[20:23], v[32:47]
  ds_read_b128 v[20:23], v7 offset:37888
  s_waitcnt lgkmcnt(3)
  v_mfma_f32_32x32x16_bf16 v[32:47], a[136:139], v[24:27], v[32:47]
  s_cmp_eq_u32 s89, 1
  s_cbranch_scc1 L_hwo_181
L_hwb_182:
  ds_read_b128 v[24:27], v7 offset:38912
  s_waitcnt lgkmcnt(3)
  v_mfma_f32_32x32x16_bf16 v[32:47], a[140:143], v[28:31], v[32:47]
  ds_read_b128 v[28:31], v7 offset:39936
  s_waitcnt lgkmcnt(3)
  v_mfma_f32_32x32x16_bf16 v[32:47], a[144:147], v[16:19], v[32:47]
  ds_read_b128 v[16:19], v7 offset:40960
  s_waitcnt lgkmcnt(3)
  v_mfma_f32_32x32x16_bf16 v[32:47], a[148:151], v[20:23], v[32:47]
  ds_read_b128 v[20:23], v7 offset:41984
  s_waitcnt lgkmcnt(3)
  v_mfma_f32_32x32x16_bf16 v[32:47], a[152:155], v[24:27], v[32:47]
  ds_read_b128 v[24:27], v7 offset:43008
  s_waitcnt lgkmcnt(3)
  v_mfma_f32_32x32x16_bf16 v[32:47], a[156:159], v[28:31], v[32:47]
  s_cmp_eq_u32 s89, 2
  s_cbranch_scc1 L_hwo_183
L_hwb_184:
  s_cmp_lg_u32 s89, 7
  s_cbranch_scc1 L_hre_185
  buffer_load_dword v11, v8, s[4:7], s96 offen sc1
L_hre_185:
  ds_read_b128 v[28:31], v7 offset:44032
  s_waitcnt lgkmcnt(3)
  v_mfma_f32_32x32x16_bf16 v[32:47], a[160:163], v[16:19], v[32:47]
  ds_read_b128 v[16:19], v7 offset:45056
  s_waitcnt lgkmcnt(3)
  v_mfma_f32_32x32x16_bf16 v[32:47], a[164:167], v[20:23], v[32:47]
  ds_read_b128 v[20:23], v7 offset:46080
  s_waitcnt lgkmcnt(3)
  v_mfma_f32_32x32x16_bf16 v[32:47], a[168:171], v[24:27], v[32:47]
  ds_read_b128 v[24:27], v7 offset:47104
  s_waitcnt lgkmcnt(3)
  v_mfma_f32_32x32x16_bf16 v[32:47], a[172:175], v[28:31], v[32:47]
  ds_read_b128 v[28:31], v7 offset:48128
  s_waitcnt lgkmcnt(3)
  v_mfma_f32_32x32x16_bf16 v[32:47], a[176:179], v[16:19], v[32:47]
  s_cmp_eq_u32 s89, 3
  s_cbranch_scc1 L_hwo_186
L_hwb_187:
  ds_read_b128 v[16:19], v7 offset:49152
  s_waitcnt lgkmcnt(3)
  v_mfma_f32_32x32x16_bf16 v[32:47], a[180:183], v[20:23], v[32:47]
  ds_read_b128 v[20:23], v7 offset:50176
  s_waitcnt lgkmcnt(3)
  v_mfma_f32_32x32x16_bf16 v[32:47], a[184:187], v[24:27], v[32:47]
  ds_read_b128 v[24:27], v7 offset:51200
  s_waitcnt lgkmcnt(3)
  v_mfma_f32_32x32x16_bf16 v[32:47], a[188:191], v[28:31], v[32:47]
  ds_read_b128 v[28:31], v7 offset:52224
  s_waitcnt lgkmcnt(3)
  v_mfma_f32_32x32x16_bf16 v[32:47], a[192:195], v[16:19], v[32:47]
  ds_read_b128 v[16:19], v7 offset:53248
  s_waitcnt lgkmcnt(3)
  v_mfma_f32_32x32x16_bf16 v[32:47], a[196:199], v[20:23], v[32:47]
  ds_read_b128 v[20:23], v7 offset:54272
  s_waitcnt lgkmcnt(3)
  v_mfma_f32_32x32x16_bf16 v[32:47], a[200:203], v[24:27], v[32:47]
  ds_read_b128 v[24:27], v7 offset:55296
  s_waitcnt lgkmcnt(3)
  v_mfma_f32_32x32x16_bf16 v[32:47], a[204:207], v[28:31], v[32:47]
  ds_read_b128 v[28:31], v7 offset:56320
  s_waitcnt lgkmcnt(3)
  v_mfma_f32_32x32x16_bf16 v[32:47], a[208:211], v[16:19], v[32:47]
  ds_read_b128 v[16:19], v7 offset:57344
  s_waitcnt lgkmcnt(3)
  v_mfma_f32_32x32x16_bf16 v[32:47], a[212:215], v[20:23], v[32:47]
  ds_read_b128 v[20:23], v7 offset:58368
  s_waitcnt lgkmcnt(3)
  v_mfma_f32_32x32x16_bf16 v[32:47], a[216:219], v[24:27], v[32:47]
  ds_read_b128 v[24:27], v7 offset:59392
  s_waitcnt lgkmcnt(3)
  v_mfma_f32_32x32x16_bf16 v[32:47], a[220:223], v[28:31], v[32:47]
  ds_read_b128 v[28:31], v7 offset:60416
  s_waitcnt lgkmcnt(3)
  v_mfma_f32_32x32x16_bf16 v[32:47], a[224:227], v[16:19], v[32:47]
  s_lshl_b32 s76, s55, 18
  s_lshl_b32 s77, s73, 15
  ds_read_b128 v[16:19], v7 offset:61440
  s_waitcnt lgkmcnt(3)
  v_mfma_f32_32x32x16_bf16 v[32:47], a[228:231], v[20:23], v[32:47]
  s_add_u32 s76, s76, s77
  s_lshl_b32 s77, s54, 11
  ds_read_b128 v[20:23], v7 offset:62464
  s_waitcnt lgkmcnt(3)
  v_mfma_f32_32x32x16_bf16 v[32:47], a[232:235], v[24:27], v[32:47]
  s_add_u32 s76, s76, s77
  s_add_u32 s76, s76, s52
  ds_read_b128 v[24:27], v7 offset:63488
  s_waitcnt lgkmcnt(3)
  v_mfma_f32_32x32x16_bf16 v[32:47], a[236:239], v[28:31], v[32:47]
  s_add_u32 s76, s76, 0x3000000
  s_lshl_b32 s78, s55, 8
  ds_read_b128 v[28:31], v7 offset:64512
  s_waitcnt lgkmcnt(3)
  v_mfma_f32_32x32x16_bf16 v[32:47], a[240:243], v[16:19], v[32:47]
  s_lshl_b32 s79, s54, 6
  s_add_u32 s78, s78, s79
  s_waitcnt lgkmcnt(2)
  v_mfma_f32_32x32x16_bf16 v[32:47], a[244:247], v[20:23], v[32:47]
  s_lshl_b32 s79, s73, 4
  s_add_u32 s78, s78, s79
  s_waitcnt lgkmcnt(1)
  v_mfma_f32_32x32x16_bf16 v[32:47], a[248:251], v[24:27], v[32:47]
  s_add_u32 s78, s78, 0x18000
  s_add_u32 s78, s78, s53
  s_waitcnt lgkmcnt(0)
  v_mfma_f32_32x32x16_bf16 v[32:47], a[252:255], v[28:31], v[32:47]
  s_cmp_lg_u32 s59, 1
  s_cbranch_scc1 L_late_188
  s_mov_b32 s60, 1
  s_branch L_nl_190
  s_cmp_eq_u32 s80, 1
  s_cbranch_scc1 L_st1_189
  s_waitcnt vmcnt(0)
L_st1_189:
  s_waitcnt vmcnt(1)
  s_barrier
  ds_read_b128 v[16:19], v112 offset:0
  ds_read_b128 v[20:23], v112 offset:1024
  ds_read_b128 v[24:27], v112 offset:2048
  s_mov_b32 s60, 2
  s_mov_b32 s55, s74
  s_branch L_s3b1_168
L_late_188:
  s_mov_b32 s60, 0
  s_waitcnt vmcnt(0)
  s_cmp_ge_u32 s74, s57
  s_cbranch_scc1 L_nl_190
  v_cmp_eq_u32 vcc, 0, v11
  s_cbranch_vccnz L_nl_190
  s_mov_b32 s64, 0x10000
  s_and_b32 s61, s74, 7
  s_lshl_b32 s61, s61, 18
  s_lshl_b32 s68, s73, 16
  s_add_u32 s61, s61, s68
  s_add_u32 s61, s61, 0x2000000
  s_add_u32 s61, s61, s52
  s_lshl_b32 s62, s58, 12
  s_add_u32 m0, s62, s64
  s_nop 0
  buffer_load_dwordx4 v6, s[4:7], s61 offen offset:0 sc1 lds
  buffer_load_dwordx4 v6, s[4:7], s61 offen offset:1024 sc1 lds
  buffer_load_dwordx4 v6, s[4:7], s61 offen offset:2048 sc1 lds
  buffer_load_dwordx4 v6, s[4:7], s61 offen offset:3072 sc1 lds
  s_add_u32 m0, m0, 0x4000
  s_add_u32 s61, s61, 0x4000
  buffer_load_dwordx4 v6, s[4:7], s61 offen offset:0 sc1 lds
  buffer_load_dwordx4 v6, s[4:7], s61 offen offset:1024 sc1 lds
  buffer_load_dwordx4 v6, s[4:7], s61 offen offset:2048 sc1 lds
  buffer_load_dwordx4 v6, s[4:7], s61 offen offset:3072 sc1 lds
  s_add_u32 m0, m0, 0x4000
  s_add_u32 s61, s61, 0x4000
  buffer_load_dwordx4 v6, s[4:7], s61 offen offset:0 sc1 lds
  buffer_load_dwordx4 v6, s[4:7], s61 offen offset:1024 sc1 lds
  buffer_load_dwordx4 v6, s[4:7], s61 offen offset:2048 sc1 lds
  buffer_load_dwordx4 v6, s[4:7], s61 offen offset:3072 sc1 lds
  s_add_u32 m0, m0, 0x4000
  s_add_u32 s61, s61, 0x4000
  buffer_load_dwordx4 v6, s[4:7], s61 offen offset:0 sc1 lds
  buffer_load_dwordx4 v6, s[4:7], s61 offen offset:1024 sc1 lds
  buffer_load_dwordx4 v6, s[4:7], s61 offen offset:2048 sc1 lds
  buffer_load_dwordx4 v6, s[4:7], s61 offen offset:3072 sc1 lds
  s_mov_b32 s60, 1
L_nl_190:
  s_nop 7
  v_cvt_pk_bf16_f32 v64, v32, v33
  v_cvt_pk_bf16_f32 v65, v34, v35
  v_cvt_pk_bf16_f32 v66, v36, v37
  v_cvt_pk_bf16_f32 v67, v38, v39
  buffer_store_dwordx4 v[64:67], v12, s[4:7], s76 offen offset:0 sc1
  v_cvt_pk_bf16_f32 v68, v40, v41
  v_cvt_pk_bf16_f32 v69, v42, v43
  v_cvt_pk_bf16_f32 v70, v44, v45
  v_cvt_pk_bf16_f32 v71, v46, v47
  buffer_store_dwordx4 v[68:71], v12, s[4:7], s76 offen offset:256 sc1
  s_mov_b32 s88, s78
  s_mov_b32 s55, s74
  s_cmp_lt_u32 s55, s57
  s_cbranch_scc1 L_s3h1_166
  s_waitcnt vmcnt(0)
  s_cmp_eq_u32 s88, 0
  s_cbranch_scc1 L_nofl_191
  s_mov_b64 exec, 1
  buffer_store_dword v10, v9, s[4:7], s88 offen sc1
  s_mov_b64 exec, -1
  s_mov_b32 s88, 0
L_nofl_191:
  s_endpgm
L_s3h1_166:
  s_cmp_eq_u32 s60, 1
  s_cbranch_scc1 L_hp_192
  s_lshl_b32 s63, s55, 9
  s_lshl_b32 s68, s73, 7
  s_add_u32 s63, s63, s68
  s_add_u32 s63, s63, 0x10000
  s_add_u32 s63, s63, s53
  s_and_b32 s61, s55, 7
  s_lshl_b32 s61, s61, 18
  s_lshl_b32 s68, s73, 16
  s_add_u32 s61, s61, s68
  s_add_u32 s61, s61, 0x2000000
  s_add_u32 s61, s61, s52
  s_lshl_b32 s62, s58, 12
  s_add_u32 m0, s62, 0x10000
L_poll_194:
  buffer_load_dword v11, v8, s[4:7], s63 offen sc1
  s_waitcnt vmcnt(0)
  s_cmp_eq_u32 s88, 0
  s_cbranch_scc1 L_nofl_196
  s_mov_b64 exec, 1
  buffer_store_dword v10, v9, s[4:7], s88 offen sc1
  s_mov_b64 exec, -1
  s_mov_b32 s88, 0
L_nofl_196:
  v_cmp_eq_u32 vcc, 0, v11
  s_cbranch_vccz L_pollok_195
  s_add_u32 s72, s72, 1
  s_cmp_gt_u32 s72, 0x80000
  s_cbranch_scc1 L_exit
  s_branch L_poll_194
L_pollok_195:
  buffer_load_dwordx4 v6, s[4:7], s61 offen offset:0 sc1 lds
  buffer_load_dwordx4 v6, s[4:7], s61 offen offset:1024 sc1 lds
  buffer_load_dwordx4 v6, s[4:7], s61 offen offset:2048 sc1 lds
  buffer_load_dwordx4 v6, s[4:7], s61 offen offset:3072 sc1 lds
  s_add_u32 m0, m0, 0x4000
  s_add_u32 s61, s61, 0x4000
  buffer_load_dwordx4 v6, s[4:7], s61 offen offset:0 sc1 lds
  buffer_load_dwordx4 v6, s[4:7], s61 offen offset:1024 sc1 lds
  buffer_load_dwordx4 v6, s[4:7], s61 offen offset:2048 sc1 lds
  buffer_load_dwordx4 v6, s[4:7], s61 offen offset:3072 sc1 lds
  s_add_u32 m0, m0, 0x4000
  s_add_u32 s61, s61, 0x4000
  buffer_load_dwordx4 v6, s[4:7], s61 offen offset:0 sc1 lds
  buffer_load_dwordx4 v6, s[4:7], s61 offen offset:1024 sc1 lds
  buffer_load_dwordx4 v6, s[4:7], s61 offen offset:2048 sc1 lds
  buffer_load_dwordx4 v6, s[4:7], s61 offen offset:3072 sc1 lds
  s_add_u32 m0, m0, 0x4000
  s_add_u32 s61, s61, 0x4000
  buffer_load_dwordx4 v6, s[4:7], s61 offen offset:0 sc1 lds
  buffer_load_dwordx4 v6, s[4:7], s61 offen offset:1024 sc1 lds
  buffer_load_dwordx4 v6, s[4:7], s61 offen offset:2048 sc1 lds
  buffer_load_dwordx4 v6, s[4:7], s61 offen offset:3072 sc1 lds
  s_waitcnt vmcnt(12)
  s_branch L_hj_193
L_hp_192:
  s_waitcnt vmcnt(2)
L_hj_193:
  s_barrier
  ds_read_b128 v[16:19], v112 offset:0
  ds_read_b128 v[20:23], v112 offset:1024
  ds_read_b128 v[24:27], v112 offset:2048
L_s3b1_168:
  s_add_u32 s74, s55, s56
  s_min_u32 s64, s74, 63
  s_lshl_b32 s96, s64, 9
  s_lshl_b32 s68, s73, 7
  s_add_u32 s96, s96, s68
  s_add_u32 s96, s96, 0x10000
  s_add_u32 s96, s96, s53
  s_mov_b32 s59, 0
  s_mov_b32 s80, 0
  ds_read_b128 v[28:31], v112 offset:3072
  s_waitcnt lgkmcnt(3)
  v_mfma_f32_32x32x16_bf16 v[80:95], a[0:3], v[16:19], 0
  buffer_load_dword v11, v8, s[4:7], s96 offen sc1
  ds_read_b128 v[16:19], v112 offset:4096
  s_waitcnt lgkmcnt(3)
  v_mfma_f32_32x32x16_bf16 v[80:95], a[4:7], v[20:23], v[80:95]
  ds_read_b128 v[20:23], v112 offset:5120
  s_waitcnt lgkmcnt(3)
  v_mfma_f32_32x32x16_bf16 v[80:95], a[8:11], v[24:27], v[80:95]
  ds_read_b128 v[24:27], v112 offset:6144
  s_waitcnt lgkmcnt(3)
  v_mfma_f32_32x32x16_bf16 v[80:95], a[12:15], v[28:31], v[80:95]
  ds_read_b128 v[28:31], v112 offset:7168
  s_waitcnt lgkmcnt(3)
  v_mfma_f32_32x32x16_bf16 v[80:95], a[16:19], v[16:19], v[80:95]
  ds_read_b128 v[16:19], v112 offset:8192
  s_waitcnt lgkmcnt(3)
  v_mfma_f32_32x32x16_bf16 v[80:95], a[20:23], v[20:23], v[80:95]
  ds_read_b128 v[20:23], v112 offset:9216
  s_waitcnt lgkmcnt(3)
  v_mfma_f32_32x32x16_bf16 v[80:95], a[24:27], v[24:27], v[80:95]
  ds_read_b128 v[24:27], v112 offset:10240
  s_waitcnt lgkmcnt(3)
  v_mfma_f32_32x32x16_bf16 v[80:95], a[28:31], v[28:31], v[80:95]
  ds_read_b128 v[28:31], v112 offset:11264
  s_waitcnt lgkmcnt(3)
  v_mfma_f32_32x32x16_bf16 v[80:95], a[32:35], v[16:19], v[80:95]
  ds_read_b128 v[16:19], v112 offset:12288
  s_waitcnt lgkmcnt(3)
  v_mfma_f32_32x32x16_bf16 v[80:95], a[36:39], v[20:23], v[80:95]
  ds_read_b128 v[20:23], v112 offset:13312
  s_waitcnt lgkmcnt(3)
  v_mfma_f32_32x32x16_bf16 v[80:95], a[40:43], v[24:27], v[80:95]
  ds_read_b128 v[24:27], v112 offset:14336
  s_waitcnt lgkmcnt(3)
  v_mfma_f32_32x32x16_bf16 v[80:95], a[44:47], v[28:31], v[80:95]
  ds_read_b128 v[28:31], v112 offset:15360
  s_waitcnt lgkmcnt(3)
  v_mfma_f32_32x32x16_bf16 v[80:95], a[48:51], v[16:19], v[80:95]
  s_cmp_lg_u32 s60, 0
  s_cbranch_scc1 L_hm_197
  s_waitcnt vmcnt(9)
L_hm_197:
  s_barrier
  ds_read_b128 v[16:19], v112 offset:16384
  s_waitcnt lgkmcnt(3)
  v_mfma_f32_32x32x16_bf16 v[80:95], a[52:55], v[20:23], v[80:95]
  ds_read_b128 v[20:23], v112 offset:17408
  s_waitcnt lgkmcnt(3)
  v_mfma_f32_32x32x16_bf16 v[80:95], a[56:59], v[24:27], v[80:95]
  ds_read_b128 v[24:27], v112 offset:18432
  s_waitcnt lgkmcnt(3)
  v_mfma_f32_32x32x16_bf16 v[80:95], a[60:63], v[28:31], v[80:95]
  ds_read_b128 v[28:31], v112 offset:19456
  s_waitcnt lgkmcnt(3)
  v_mfma_f32_32x32x16_bf16 v[80:95], a[64:67], v[16:19], v[80:95]
  ds_read_b128 v[16:19], v112 offset:20480
  s_waitcnt lgkmcnt(3)
  v_mfma_f32_32x32x16_bf16 v[80:95], a[68:71], v[20:23], v[80:95]
  ds_read_b128 v[20:23], v112 offset:21504
  s_waitcnt lgkmcnt(3)
  v_mfma_f32_32x32x16_bf16 v[80:95], a[72:75], v[24:27], v[80:95]
  ds_read_b128 v[24:27], v112 offset:22528
  s_waitcnt lgkmcnt(3)
  v_mfma_f32_32x32x16_bf16 v[80:95], a[76:79], v[28:31], v[80:95]
  ds_read_b128 v[28:31], v112 offset:23552
  s_waitcnt lgkmcnt(3)
  v_mfma_f32_32x32x16_bf16 v[80:95], a[80:83], v[16:19], v[80:95]
  ds_read_b128 v[16:19], v112 offset:24576
  s_waitcnt lgkmcnt(3)
  v_mfma_f32_32x32x16_bf16 v[80:95], a[84:87], v[20:23], v[80:95]
  s_cmp_lg_u32 s60, 1
  s_cbranch_scc1 L_hfa_198
  s_waitcnt vmcnt(1)
  s_mov_b64 exec, 1
  buffer_store_dword v10, v9, s[4:7], s88 offen sc1
  s_mov_b64 exec, -1
  s_mov_b32 s88, 0
L_hfa_198:
  ds_read_b128 v[20:23], v112 offset:25600
  s_waitcnt lgkmcnt(3)
  v_mfma_f32_32x32x16_bf16 v[80:95], a[88:91], v[24:27], v[80:95]
  ds_read_b128 v[24:27], v112 offset:26624
  s_waitcnt lgkmcnt(3)
  v_mfma_f32_32x32x16_bf16 v[80:95], a[92:95], v[28:31], v[80:95]
  ds_read_b128 v[28:31], v112 offset:27648
  s_waitcnt lgkmcnt(3)
  v_mfma_f32_32x32x16_bf16 v[80:95], a[96:99], v[16:19], v[80:95]
  ds_read_b128 v[16:19], v112 offset:28672
  s_waitcnt lgkmcnt(3)
  v_mfma_f32_32x32x16_bf16 v[80:95], a[100:103], v[20:23], v[80:95]
  ds_read_b128 v[20:23], v112 offset:29696
  s_waitcnt lgkmcnt(3)
  v_mfma_f32_32x32x16_bf16 v[80:95], a[104:107], v[24:27], v[80:95]
  ds_read_b128 v[24:27], v112 offset:30720
  s_waitcnt lgkmcnt(3)
  v_mfma_f32_32x32x16_bf16 v[80:95], a[108:111], v[28:31], v[80:95]
  ds_read_b128 v[28:31], v112 offset:31744
  s_waitcnt lgkmcnt(3)
  v_mfma_f32_32x32x16_bf16 v[80:95], a[112:115], v[16:19], v[80:95]
  s_cmp_eq_u32 s60, 2
  s_cbranch_scc1 L_h1b_200
  s_cmp_eq_u32 s60, 1
  s_cbranch_scc1 L_h1a_199
  s_waitcnt vmcnt(0)
L_h1a_199:
  s_waitcnt vmcnt(1)
L_h1b_200:
  s_waitcnt vmcnt(2)
  v_cmp_eq_u32 vcc, 0, v11
  s_cmp_lt_u32 s74, s57
  s_cselect_b64 s[70:71], vcc, -1
  s_cmp_eq_u64 s[70:71], 0
  s_cselect_b32 s89, s58, 7
L_h1c_201:
  s_barrier
  ds_read_b128 v[16:19], v112 offset:32768
  s_waitcnt lgkmcnt(3)
  v_mfma_f32_32x32x16_bf16 v[80:95], a[116:119], v[20:23], v[80:95]
  s_cmp_eq_u32 s89, 0
  s_cbranch_scc1 L_hwo_202
L_hwb_203:
  ds_read_b128 v[20:23], v112 offset:33792
  s_waitcnt lgkmcnt(3)
  v_mfma_f32_32x32x16_bf16 v[80:95], a[120:123], v[24:27], v[80:95]
  ds_read_b128 v[24:27], v112 offset:34816
  s_waitcnt lgkmcnt(3)
  v_mfma_f32_32x32x16_bf16 v[80:95], a[124:127], v[28:31], v[80:95]
  ds_read_b128 v[28:31], v112 offset:35840
  s_waitcnt lgkmcnt(3)
  v_mfma_f32_32x32x16_bf16 v[80:95], a[128:131], v[16:19], v[80:95]
  ds_read_b128 v[16:19], v112 offset:36864
  s_waitcnt lgkmcnt(3)
  v_mfma_f32_32x32x16_bf16 v[80:95], a[132:135], v[20:23], v[80:95]
  ds_read_b128 v[20:23], v112 offset:37888
  s_waitcnt lgkmcnt(3)
  v_mfma_f32_32x32x16_bf16 v[80:95], a[136:139], v[24:27], v[80:95]
  s_cmp_eq_u32 s89, 1
  s_cbranch_scc1 L_hwo_204
L_hwb_205:
  ds_read_b128 v[24:27], v112 offset:38912
  s_waitcnt lgkmcnt(3)
  v_mfma_f32_32x32x16_bf16 v[80:95], a[140:143], v[28:31], v[80:95]
  ds_read_b128 v[28:31], v112 offset:39936
  s_waitcnt lgkmcnt(3)
  v_mfma_f32_32x32x16_bf16 v[80:95], a[144:147], v[16:19], v[80:95]
  ds_read_b128 v[16:19], v112 offset:40960
  s_waitcnt lgkmcnt(3)
  v_mfma_f32_32x32x16_bf16 v[80:95], a[148:151], v[20:23], v[80:95]
  ds_read_b128 v[20:23], v112 offset:41984
  s_waitcnt lgkmcnt(3)
  v_mfma_f32_32x32x16_bf16 v[80:95], a[152:155], v[24:27], v[80:95]
  ds_read_b128 v[24:27], v112 offset:43008
  s_waitcnt lgkmcnt(3)
  v_mfma_f32_32x32x16_bf16 v[80:95], a[156:159], v[28:31], v[80:95]
  s_cmp_eq_u32 s89, 2
  s_cbranch_scc1 L_hwo_206
L_hwb_207:
  s_cmp_lg_u32 s89, 7
  s_cbranch_scc1 L_hre_208
  buffer_load_dword v11, v8, s[4:7], s96 offen sc1
L_hre_208:
  ds_read_b128 v[28:31], v112 offset:44032
  s_waitcnt lgkmcnt(3)
  v_mfma_f32_32x32x16_bf16 v[80:95], a[160:163], v[16:19], v[80:95]
  ds_read_b128 v[16:19], v112 offset:45056
  s_waitcnt lgkmcnt(3)
  v_mfma_f32_32x32x16_bf16 v[80:95], a[164:167], v[20:23], v[80:95]
  ds_read_b128 v[20:23], v112 offset:46080
  s_waitcnt lgkmcnt(3)
  v_mfma_f32_32x32x16_bf16 v[80:95], a[168:171], v[24:27], v[80:95]
  ds_read_b128 v[24:27], v112 offset:47104
  s_waitcnt lgkmcnt(3)
  v_mfma_f32_32x32x16_bf16 v[80:95], a[172:175], v[28:31], v[80:95]
  ds_read_b128 v[28:31], v112 offset:48128
  s_waitcnt lgkmcnt(3)
  v_mfma_f32_32x32x16_bf16 v[80:95], a[176:179], v[16:19], v[80:95]
  s_cmp_eq_u32 s89, 3
  s_cbranch_scc1 L_hwo_209
L_hwb_210:
  ds_read_b128 v[16:19], v112 offset:49152
  s_waitcnt lgkmcnt(3)
  v_mfma_f32_32x32x16_bf16 v[80:95], a[180:183], v[20:23], v[80:95]
  ds_read_b128 v[20:23], v112 offset:50176
  s_waitcnt lgkmcnt(3)
  v_mfma_f32_32x32x16_bf16 v[80:95], a[184:187], v[24:27], v[80:95]
  ds_read_b128 v[24:27], v112 offset:51200
  s_waitcnt lgkmcnt(3)
  v_mfma_f32_32x32x16_bf16 v[80:95], a[188:191], v[28:31], v[80:95]
  ds_read_b128 v[28:31], v112 offset:52224
  s_waitcnt lgkmcnt(3)
  v_mfma_f32_32x32x16_bf16 v[80:95], a[192:195], v[16:19], v[80:95]
  ds_read_b128 v[16:19], v112 offset:53248
  s_waitcnt lgkmcnt(3)
  v_mfma_f32_32x32x16_bf16 v[80:95], a[196:199], v[20:23], v[80:95]
  ds_read_b128 v[20:23], v112 offset:54272
  s_waitcnt lgkmcnt(3)
  v_mfma_f32_32x32x16_bf16 v[80:95], a[200:203], v[24:27], v[80:95]
  ds_read_b128 v[24:27], v112 offset:55296
  s_waitcnt lgkmcnt(3)
  v_mfma_f32_32x32x16_bf16 v[80:95], a[204:207], v[28:31], v[80:95]
  ds_read_b128 v[28:31], v112 offset:56320
  s_waitcnt lgkmcnt(3)
  v_mfma_f32_32x32x16_bf16 v[80:95], a[208:211], v[16:19], v[80:95]
  ds_read_b128 v[16:19], v112 offset:57344
  s_waitcnt lgkmcnt(3)
  v_mfma_f32_32x32x16_bf16 v[80:95], a[212:215], v[20:23], v[80:95]
  ds_read_b128 v[20:23], v112 offset:58368
  s_waitcnt lgkmcnt(3)
  v_mfma_f32_32x32x16_bf16 v[80:95], a[216:219], v[24:27], v[80:95]
  ds_read_b128 v[24:27], v112 offset:59392
  s_waitcnt lgkmcnt(3)
  v_mfma_f32_32x32x16_bf16 v[80:95], a[220:223], v[28:31], v[80:95]
  ds_read_b128 v[28:31], v112 offset:60416
  s_waitcnt lgkmcnt(3)
  v_mfma_f32_32x32x16_bf16 v[80:95], a[224:227], v[16:19], v[80:95]
  s_lshl_b32 s76, s55, 18
  s_lshl_b32 s77, s73, 15
  ds_read_b128 v[16:19], v112 offset:61440
  s_waitcnt lgkmcnt(3)
  v_mfma_f32_32x32x16_bf16 v[80:95], a[228:231], v[20:23], v[80:95]
  s_add_u32 s76, s76, s77
  s_lshl_b32 s77, s54, 11
  ds_read_b128 v[20:23], v112 offset:62464
  s_waitcnt lgkmcnt(3)
  v_mfma_f32_32x32x16_bf16 v[80:95], a[232:235], v[24:27], v[80:95]
  s_add_u32 s76, s76, s77
  s_add_u32 s76, s76, s52
  ds_read_b128 v[24:27], v112 offset:63488
  s_waitcnt lgkmcnt(3)
  v_mfma_f32_32x32x16_bf16 v[80:95], a[236:239], v[28:31], v[80:95]
  s_add_u32 s76, s76, 0x3000000
  s_lshl_b32 s78, s55, 8
  ds_read_b128 v[28:31], v112 offset:64512
  s_waitcnt lgkmcnt(3)
  v_mfma_f32_32x32x16_bf16 v[80:95], a[240:243], v[16:19], v[80:95]
  s_lshl_b32 s79, s54, 6
  s_add_u32 s78, s78, s79
  s_waitcnt lgkmcnt(2)
  v_mfma_f32_32x32x16_bf16 v[80:95], a[244:247], v[20:23], v[80:95]
  s_lshl_b32 s79, s73, 4
  s_add_u32 s78, s78, s79
  s_waitcnt lgkmcnt(1)
  v_mfma_f32_32x32x16_bf16 v[80:95], a[248:251], v[24:27], v[80:95]
  s_add_u32 s78, s78, 0x18000
  s_add_u32 s78, s78, s53
  s_waitcnt lgkmcnt(0)
  v_mfma_f32_32x32x16_bf16 v[80:95], a[252:255], v[28:31], v[80:95]
  s_cmp_lg_u32 s59, 1
  s_cbranch_scc1 L_late_211
  s_mov_b32 s60, 1
  s_branch L_nl_213
  s_cmp_eq_u32 s80, 1
  s_cbranch_scc1 L_st1_212
  s_waitcnt vmcnt(0)
L_st1_212:
  s_waitcnt vmcnt(1)
  s_barrier
  ds_read_b128 v[16:19], v7 offset:0
  ds_read_b128 v[20:23], v7 offset:1024
  ds_read_b128 v[24:27], v7 offset:2048
  s_mov_b32 s60, 2
  s_mov_b32 s55, s74
  s_branch L_s3b0_167
L_late_211:
  s_mov_b32 s60, 0
  s_waitcnt vmcnt(0)
  s_cmp_ge_u32 s74, s57
  s_cbranch_scc1 L_nl_213
  v_cmp_eq_u32 vcc, 0, v11
  s_cbranch_vccnz L_nl_213
  s_mov_b32 s64, 0x0
  s_and_b32 s61, s74, 7
  s_lshl_b32 s61, s61, 18
  s_lshl_b32 s68, s73, 16
  s_add_u32 s61, s61, s68
  s_add_u32 s61, s61, 0x2000000
  s_add_u32 s61, s61, s52
  s_lshl_b32 s62, s58, 12
  s_add_u32 m0, s62, s64
  s_nop 0
  buffer_load_dwordx4 v6, s[4:7], s61 offen offset:0 sc1 lds
  buffer_load_dwordx4 v6, s[4:7], s61 offen offset:1024 sc1 lds
  buffer_load_dwordx4 v6, s[4:7], s61 offen offset:2048 sc1 lds
  buffer_load_dwordx4 v6, s[4:7], s61 offen offset:3072 sc1 lds
  s_add_u32 m0, m0, 0x4000
  s_add_u32 s61, s61, 0x4000
  buffer_load_dwordx4 v6, s[4:7], s61 offen offset:0 sc1 lds
  buffer_load_dwordx4 v6, s[4:7], s61 offen offset:1024 sc1 lds
  buffer_load_dwordx4 v6, s[4:7], s61 offen offset:2048 sc1 lds
  buffer_load_dwordx4 v6, s[4:7], s61 offen offset:3072 sc1 lds
  s_add_u32 m0, m0, 0x4000
  s_add_u32 s61, s61, 0x4000
  buffer_load_dwordx4 v6, s[4:7], s61 offen offset:0 sc1 lds
  buffer_load_dwordx4 v6, s[4:7], s61 offen offset:1024 sc1 lds
  buffer_load_dwordx4 v6, s[4:7], s61 offen offset:2048 sc1 lds
  buffer_load_dwordx4 v6, s[4:7], s61 offen offset:3072 sc1 lds
  s_add_u32 m0, m0, 0x4000
  s_add_u32 s61, s61, 0x4000
  buffer_load_dwordx4 v6, s[4:7], s61 offen offset:0 sc1 lds
  buffer_load_dwordx4 v6, s[4:7], s61 offen offset:1024 sc1 lds
  buffer_load_dwordx4 v6, s[4:7], s61 offen offset:2048 sc1 lds
  buffer_load_dwordx4 v6, s[4:7], s61 offen offset:3072 sc1 lds
  s_mov_b32 s60, 1
L_nl_213:
  s_nop 7
  v_cvt_pk_bf16_f32 v64, v80, v81
  v_cvt_pk_bf16_f32 v65, v82, v83
  v_cvt_pk_bf16_f32 v66, v84, v85
  v_cvt_pk_bf16_f32 v67, v86, v87
  buffer_store_dwordx4 v[64:67], v12, s[4:7], s76 offen offset:0 sc1
  v_cvt_pk_bf16_f32 v68, v88, v89
  v_cvt_pk_bf16_f32 v69, v90, v91
  v_cvt_pk_bf16_f32 v70, v92, v93
  v_cvt_pk_bf16_f32 v71, v94, v95
  buffer_store_dwordx4 v[68:71], v12, s[4:7], s76 offen offset:256 sc1
  s_mov_b32 s88, s78
  s_mov_b32 s55, s74
  s_cmp_lt_u32 s55, s57
  s_cbranch_scc1 L_s3h0_165
  s_waitcnt vmcnt(0)
  s_cmp_eq_u32 s88, 0
  s_cbranch_scc1 L_nofl_214
  s_mov_b64 exec, 1
  buffer_store_dword v10, v9, s[4:7], s88 offen sc1
  s_mov_b64 exec, -1
  s_mov_b32 s88, 0
L_nofl_214:
  s_endpgm
L_hwo_179:
  s_mov_b32 s64, 0x10000
  s_and_b32 s61, s74, 7
  s_lshl_b32 s61, s61, 18
  s_lshl_b32 s68, s73, 16
  s_add_u32 s61, s61, s68
  s_add_u32 s61, s61, 0x2000000
  s_add_u32 s61, s61, s52
  s_lshl_b32 s62, s58, 12
  s_add_u32 m0, s62, s64
  s_nop 0
  buffer_load_dwordx4 v6, s[4:7], s61 offen offset:0 sc1 lds
  buffer_load_dwordx4 v6, s[4:7], s61 offen offset:1024 sc1 lds
  buffer_load_dwordx4 v6, s[4:7], s61 offen offset:2048 sc1 lds
  buffer_load_dwordx4 v6, s[4:7], s61 offen offset:3072 sc1 lds
  s_add_u32 m0, m0, 0x4000
  s_add_u32 s61, s61, 0x4000
  buffer_load_dwordx4 v6, s[4:7], s61 offen offset:0 sc1 lds
  buffer_load_dwordx4 v6, s[4:7], s61 offen offset:1024 sc1 lds
  buffer_load_dwordx4 v6, s[4:7], s61 offen offset:2048 sc1 lds
  buffer_load_dwordx4 v6, s[4:7], s61 offen offset:3072 sc1 lds
  s_add_u32 m0, m0, 0x4000
  s_add_u32 s61, s61, 0x4000
  buffer_load_dwordx4 v6, s[4:7], s61 offen offset:0 sc1 lds
  buffer_load_dwordx4 v6, s[4:7], s61 offen offset:1024 sc1 lds
  buffer_load_dwordx4 v6, s[4:7], s61 offen offset:2048 sc1 lds
  buffer_load_dwordx4 v6, s[4:7], s61 offen offset:3072 sc1 lds
  s_add_u32 m0, m0, 0x4000
  s_add_u32 s61, s61, 0x4000
  buffer_load_dwordx4 v6, s[4:7], s61 offen offset:0 sc1 lds
  buffer_load_dwordx4 v6, s[4:7], s61 offen offset:1024 sc1 lds
  buffer_load_dwordx4 v6, s[4:7], s61 offen offset:2048 sc1 lds
  buffer_load_dwordx4 v6, s[4:7], s61 offen offset:3072 sc1 lds
  s_mov_b32 s59, 1
  s_branch L_hwb_180
L_hwo_181:
  s_mov_b32 s64, 0x10000
  s_and_b32 s61, s74, 7
  s_lshl_b32 s61, s61, 18
  s_lshl_b32 s68, s73, 16
  s_add_u32 s61, s61, s68
  s_add_u32 s61, s61, 0x2000000
  s_add_u32 s61, s61, s52
  s_lshl_b32 s62, s58, 12
  s_add_u32 m0, s62, s64
  s_nop 0
  buffer_load_dwordx4 v6, s[4:7], s61 offen offset:0 sc1 lds
  buffer_load_dwordx4 v6, s[4:7], s61 offen offset:1024 sc1 lds
  buffer_load_dwordx4 v6, s[4:7], s61 offen offset:2048 sc1 lds
  buffer_load_dwordx4 v6, s[4:7], s61 offen offset:3072 sc1 lds
  s_add_u32 m0, m0, 0x4000
  s_add_u32 s61, s61, 0x4000
  buffer_load_dwordx4 v6, s[4:7], s61 offen offset:0 sc1 lds
  buffer_load_dwordx4 v6, s[4:7], s61 offen offset:1024 sc1 lds
  buffer_load_dwordx4 v6, s[4:7], s61 offen offset:2048 sc1 lds
  buffer_load_dwordx4 v6, s[4:7], s61 offen offset:3072 sc1 lds
  s_add_u32 m0, m0, 0x4000
  s_add_u32 s61, s61, 0x4000
  buffer_load_dwordx4 v6, s[4:7], s61 offen offset:0 sc1 lds
  buffer_load_dwordx4 v6, s[4:7], s61 offen offset:1024 sc1 lds
  buffer_load_dwordx4 v6, s[4:7], s61 offen offset:2048 sc1 lds
  buffer_load_dwordx4 v6, s[4:7], s61 offen offset:3072 sc1 lds
  s_add_u32 m0, m0, 0x4000
  s_add_u32 s61, s61, 0x4000
  buffer_load_dwordx4 v6, s[4:7], s61 offen offset:0 sc1 lds
  buffer_load_dwordx4 v6, s[4:7], s61 offen offset:1024 sc1 lds
  buffer_load_dwordx4 v6, s[4:7], s61 offen offset:2048 sc1 lds
  buffer_load_dwordx4 v6, s[4:7], s61 offen offset:3072 sc1 lds
  s_mov_b32 s59, 1
  s_branch L_hwb_182
L_hwo_183:
  s_mov_b32 s64, 0x10000
  s_and_b32 s61, s74, 7
  s_lshl_b32 s61, s61, 18
  s_lshl_b32 s68, s73, 16
  s_add_u32 s61, s61, s68
  s_add_u32 s61, s61, 0x2000000
  s_add_u32 s61, s61, s52
  s_lshl_b32 s62, s58, 12
  s_add_u32 m0, s62, s64
  s_nop 0
  buffer_load_dwordx4 v6, s[4:7], s61 offen offset:0 sc1 lds
  buffer_load_dwordx4 v6, s[4:7], s61 offen offset:1024 sc1 lds
  buffer_load_dwordx4 v6, s[4:7], s61 offen offset:2048 sc1 lds
  buffer_load_dwordx4 v6, s[4:7], s61 offen offset:3072 sc1 lds
  s_add_u32 m0, m0, 0x4000
  s_add_u32 s61, s61, 0x4000
  buffer_load_dwordx4 v6, s[4:7], s61 offen offset:0 sc1 lds
  buffer_load_dwordx4 v6, s[4:7], s61 offen offset:1024 sc1 lds
  buffer_load_dwordx4 v6, s[4:7], s61 offen offset:2048 sc1 lds
  buffer_load_dwordx4 v6, s[4:7], s61 offen offset:3072 sc1 lds
  s_add_u32 m0, m0, 0x4000
  s_add_u32 s61, s61, 0x4000
  buffer_load_dwordx4 v6, s[4:7], s61 offen offset:0 sc1 lds
  buffer_load_dwordx4 v6, s[4:7], s61 offen offset:1024 sc1 lds
  buffer_load_dwordx4 v6, s[4:7], s61 offen offset:2048 sc1 lds
  buffer_load_dwordx4 v6, s[4:7], s61 offen offset:3072 sc1 lds
  s_add_u32 m0, m0, 0x4000
  s_add_u32 s61, s61, 0x4000
  buffer_load_dwordx4 v6, s[4:7], s61 offen offset:0 sc1 lds
  buffer_load_dwordx4 v6, s[4:7], s61 offen offset:1024 sc1 lds
  buffer_load_dwordx4 v6, s[4:7], s61 offen offset:2048 sc1 lds
  buffer_load_dwordx4 v6, s[4:7], s61 offen offset:3072 sc1 lds
  s_mov_b32 s59, 1
  s_branch L_hwb_184
L_hwo_186:
  s_mov_b32 s64, 0x10000
  s_and_b32 s61, s74, 7
  s_lshl_b32 s61, s61, 18
  s_lshl_b32 s68, s73, 16
  s_add_u32 s61, s61, s68
  s_add_u32 s61, s61, 0x2000000
  s_add_u32 s61, s61, s52
  s_lshl_b32 s62, s58, 12
  s_add_u32 m0, s62, s64
  s_nop 0
  buffer_load_dwordx4 v6, s[4:7], s61 offen offset:0 sc1 lds
  buffer_load_dwordx4 v6, s[4:7], s61 offen offset:1024 sc1 lds
  buffer_load_dwordx4 v6, s[4:7], s61 offen offset:2048 sc1 lds
  buffer_load_dwordx4 v6, s[4:7], s61 offen offset:3072 sc1 lds
  s_add_u32 m0, m0, 0x4000
  s_add_u32 s61, s61, 0x4000
  buffer_load_dwordx4 v6, s[4:7], s61 offen offset:0 sc1 lds
  buffer_load_dwordx4 v6, s[4:7], s61 offen offset:1024 sc1 lds
  buffer_load_dwordx4 v6, s[4:7], s61 offen offset:2048 sc1 lds
  buffer_load_dwordx4 v6, s[4:7], s61 offen offset:3072 sc1 lds
  s_add_u32 m0, m0, 0x4000
  s_add_u32 s61, s61, 0x4000
  buffer_load_dwordx4 v6, s[4:7], s61 offen offset:0 sc1 lds
  buffer_load_dwordx4 v6, s[4:7], s61 offen offset:1024 sc1 lds
  buffer_load_dwordx4 v6, s[4:7], s61 offen offset:2048 sc1 lds
  buffer_load_dwordx4 v6, s[4:7], s61 offen offset:3072 sc1 lds
  s_add_u32 m0, m0, 0x4000
  s_add_u32 s61, s61, 0x4000
  buffer_load_dwordx4 v6, s[4:7], s61 offen offset:0 sc1 lds
  buffer_load_dwordx4 v6, s[4:7], s61 offen offset:1024 sc1 lds
  buffer_load_dwordx4 v6, s[4:7], s61 offen offset:2048 sc1 lds
  buffer_load_dwordx4 v6, s[4:7], s61 offen offset:3072 sc1 lds
  s_mov_b32 s59, 1
  s_branch L_hwb_187
L_hwo_202:
  s_mov_b32 s64, 0x0
  s_and_b32 s61, s74, 7
  s_lshl_b32 s61, s61, 18
  s_lshl_b32 s68, s73, 16
  s_add_u32 s61, s61, s68
  s_add_u32 s61, s61, 0x2000000
  s_add_u32 s61, s61, s52
  s_lshl_b32 s62, s58, 12
  s_add_u32 m0, s62, s64
  s_nop 0
  buffer_load_dwordx4 v6, s[4:7], s61 offen offset:0 sc1 lds
  buffer_load_dwordx4 v6, s[4:7], s61 offen offset:1024 sc1 lds
  buffer_load_dwordx4 v6, s[4:7], s61 offen offset:2048 sc1 lds
  buffer_load_dwordx4 v6, s[4:7], s61 offen offset:3072 sc1 lds
  s_add_u32 m0, m0, 0x4000
  s_add_u32 s61, s61, 0x4000
  buffer_load_dwordx4 v6, s[4:7], s61 offen offset:0 sc1 lds
  buffer_load_dwordx4 v6, s[4:7], s61 offen offset:1024 sc1 lds
  buffer_load_dwordx4 v6, s[4:7], s61 offen offset:2048 sc1 lds
  buffer_load_dwordx4 v6, s[4:7], s61 offen offset:3072 sc1 lds
  s_add_u32 m0, m0, 0x4000
  s_add_u32 s61, s61, 0x4000
  buffer_load_dwordx4 v6, s[4:7], s61 offen offset:0 sc1 lds
  buffer_load_dwordx4 v6, s[4:7], s61 offen offset:1024 sc1 lds
  buffer_load_dwordx4 v6, s[4:7], s61 offen offset:2048 sc1 lds
  buffer_load_dwordx4 v6, s[4:7], s61 offen offset:3072 sc1 lds
  s_add_u32 m0, m0, 0x4000
  s_add_u32 s61, s61, 0x4000
  buffer_load_dwordx4 v6, s[4:7], s61 offen offset:0 sc1 lds
  buffer_load_dwordx4 v6, s[4:7], s61 offen offset:1024 sc1 lds
  buffer_load_dwordx4 v6, s[4:7], s61 offen offset:2048 sc1 lds
  buffer_load_dwordx4 v6, s[4:7], s61 offen offset:3072 sc1 lds
  s_mov_b32 s59, 1
  s_branch L_hwb_203
L_hwo_204:
  s_mov_b32 s64, 0x0
  s_and_b32 s61, s74, 7
  s_lshl_b32 s61, s61, 18
  s_lshl_b32 s68, s73, 16
  s_add_u32 s61, s61, s68
  s_add_u32 s61, s61, 0x2000000
  s_add_u32 s61, s61, s52
  s_lshl_b32 s62, s58, 12
  s_add_u32 m0, s62, s64
  s_nop 0
  buffer_load_dwordx4 v6, s[4:7], s61 offen offset:0 sc1 lds
  buffer_load_dwordx4 v6, s[4:7], s61 offen offset:1024 sc1 lds
  buffer_load_dwordx4 v6, s[4:7], s61 offen offset:2048 sc1 lds
  buffer_load_dwordx4 v6, s[4:7], s61 offen offset:3072 sc1 lds
  s_add_u32 m0, m0, 0x4000
  s_add_u32 s61, s61, 0x4000
  buffer_load_dwordx4 v6, s[4:7], s61 offen offset:0 sc1 lds
  buffer_load_dwordx4 v6, s[4:7], s61 offen offset:1024 sc1 lds
  buffer_load_dwordx4 v6, s[4:7], s61 offen offset:2048 sc1 lds
  buffer_load_dwordx4 v6, s[4:7], s61 offen offset:3072 sc1 lds
  s_add_u32 m0, m0, 0x4000
  s_add_u32 s61, s61, 0x4000
  buffer_load_dwordx4 v6, s[4:7], s61 offen offset:0 sc1 lds
  buffer_load_dwordx4 v6, s[4:7], s61 offen offset:1024 sc1 lds
  buffer_load_dwordx4 v6, s[4:7], s61 offen offset:2048 sc1 lds
  buffer_load_dwordx4 v6, s[4:7], s61 offen offset:3072 sc1 lds
  s_add_u32 m0, m0, 0x4000
  s_add_u32 s61, s61, 0x4000
  buffer_load_dwordx4 v6, s[4:7], s61 offen offset:0 sc1 lds
  buffer_load_dwordx4 v6, s[4:7], s61 offen offset:1024 sc1 lds
  buffer_load_dwordx4 v6, s[4:7], s61 offen offset:2048 sc1 lds
  buffer_load_dwordx4 v6, s[4:7], s61 offen offset:3072 sc1 lds
  s_mov_b32 s59, 1
  s_branch L_hwb_205
L_hwo_206:
  s_mov_b32 s64, 0x0
  s_and_b32 s61, s74, 7
  s_lshl_b32 s61, s61, 18
  s_lshl_b32 s68, s73, 16
  s_add_u32 s61, s61, s68
  s_add_u32 s61, s61, 0x2000000
  s_add_u32 s61, s61, s52
  s_lshl_b32 s62, s58, 12
  s_add_u32 m0, s62, s64
  s_nop 0
  buffer_load_dwordx4 v6, s[4:7], s61 offen offset:0 sc1 lds
  buffer_load_dwordx4 v6, s[4:7], s61 offen offset:1024 sc1 lds
  buffer_load_dwordx4 v6, s[4:7], s61 offen offset:2048 sc1 lds
  buffer_load_dwordx4 v6, s[4:7], s61 offen offset:3072 sc1 lds
  s_add_u32 m0, m0, 0x4000
  s_add_u32 s61, s61, 0x4000
  buffer_load_dwordx4 v6, s[4:7], s61 offen offset:0 sc1 lds
  buffer_load_dwordx4 v6, s[4:7], s61 offen offset:1024 sc1 lds
  buffer_load_dwordx4 v6, s[4:7], s61 offen offset:2048 sc1 lds
  buffer_load_dwordx4 v6, s[4:7], s61 offen offset:3072 sc1 lds
  s_add_u32 m0, m0, 0x4000
  s_add_u32 s61, s61, 0x4000
  buffer_load_dwordx4 v6, s[4:7], s61 offen offset:0 sc1 lds
  buffer_load_dwordx4 v6, s[4:7], s61 offen offset:1024 sc1 lds
  buffer_load_dwordx4 v6, s[4:7], s61 offen offset:2048 sc1 lds
  buffer_load_dwordx4 v6, s[4:7], s61 offen offset:3072 sc1 lds
  s_add_u32 m0, m0, 0x4000
  s_add_u32 s61, s61, 0x4000
  buffer_load_dwordx4 v6, s[4:7], s61 offen offset:0 sc1 lds
  buffer_load_dwordx4 v6, s[4:7], s61 offen offset:1024 sc1 lds
  buffer_load_dwordx4 v6, s[4:7], s61 offen offset:2048 sc1 lds
  buffer_load_dwordx4 v6, s[4:7], s61 offen offset:3072 sc1 lds
  s_mov_b32 s59, 1
  s_branch L_hwb_207
L_hwo_209:
  s_mov_b32 s64, 0x0
  s_and_b32 s61, s74, 7
  s_lshl_b32 s61, s61, 18
  s_lshl_b32 s68, s73, 16
  s_add_u32 s61, s61, s68
  s_add_u32 s61, s61, 0x2000000
  s_add_u32 s61, s61, s52
  s_lshl_b32 s62, s58, 12
  s_add_u32 m0, s62, s64
  s_nop 0
  buffer_load_dwordx4 v6, s[4:7], s61 offen offset:0 sc1 lds
  buffer_load_dwordx4 v6, s[4:7], s61 offen offset:1024 sc1 lds
  buffer_load_dwordx4 v6, s[4:7], s61 offen offset:2048 sc1 lds
  buffer_load_dwordx4 v6, s[4:7], s61 offen offset:3072 sc1 lds
  s_add_u32 m0, m0, 0x4000
  s_add_u32 s61, s61, 0x4000
  buffer_load_dwordx4 v6, s[4:7], s61 offen offset:0 sc1 lds
  buffer_load_dwordx4 v6, s[4:7], s61 offen offset:1024 sc1 lds
  buffer_load_dwordx4 v6, s[4:7], s61 offen offset:2048 sc1 lds
  buffer_load_dwordx4 v6, s[4:7], s61 offen offset:3072 sc1 lds
  s_add_u32 m0, m0, 0x4000
  s_add_u32 s61, s61, 0x4000
  buffer_load_dwordx4 v6, s[4:7], s61 offen offset:0 sc1 lds
  buffer_load_dwordx4 v6, s[4:7], s61 offen offset:1024 sc1 lds
  buffer_load_dwordx4 v6, s[4:7], s61 offen offset:2048 sc1 lds
  buffer_load_dwordx4 v6, s[4:7], s61 offen offset:3072 sc1 lds
  s_add_u32 m0, m0, 0x4000
  s_add_u32 s61, s61, 0x4000
  buffer_load_dwordx4 v6, s[4:7], s61 offen offset:0 sc1 lds
  buffer_load_dwordx4 v6, s[4:7], s61 offen offset:1024 sc1 lds
  buffer_load_dwordx4 v6, s[4:7], s61 offen offset:2048 sc1 lds
  buffer_load_dwordx4 v6, s[4:7], s61 offen offset:3072 sc1 lds
  s_mov_b32 s59, 1
  s_branch L_hwb_210
  s_endpgm
B_s4:
  v_mov_b32 v6, 0x0
  v_bfe_i32 v2, v0, 0, 1
  v_and_b32 v2, 0x10, v2
  v_add_u32 v6, v6, v2
  v_bfe_i32 v2, v0, 1, 1
  v_and_b32 v2, 0x20, v2
  v_add_u32 v6, v6, v2
  v_bfe_i32 v2, v0, 2, 1
  v_and_b32 v2, 0x40, v2
  v_add_u32 v6, v6, v2
  v_bfe_i32 v2, v0, 3, 1
  v_and_b32 v2, 0x80, v2
  v_add_u32 v6, v6, v2
  v_bfe_i32 v2, v0, 4, 1
  v_and_b32 v2, 0x100, v2
  v_add_u32 v6, v6, v2
  v_bfe_i32 v2, v0, 5, 1
  v_and_b32 v2, 0x200, v2
  v_add_u32 v6, v6, v2
  v_bfe_i32 v2, v0, 6, 1
  v_and_b32 v2, 0x1000, v2
  v_add_u32 v6, v6, v2
  v_bfe_i32 v2, v0, 7, 1
  v_and_b32 v2, 0x2000, v2
  v_add_u32 v6, v6, v2
  v_mov_b32 v7, 0x0
  v_bfe_i32 v2, v0, 0, 1
  v_and_b32 v2, 0x10, v2
  v_add_u32 v7, v7, v2
  v_bfe_i32 v2, v0, 1, 1
  v_and_b32 v2, 0x20, v2
  v_add_u32 v7, v7, v2
  v_bfe_i32 v2, v0, 2, 1
  v_and_b32 v2, 0x40, v2
  v_add_u32 v7, v7, v2
  v_bfe_i32 v2, v0, 3, 1
  v_and_b32 v2, 0x80, v2
  v_add_u32 v7, v7, v2
  v_bfe_i32 v2, v0, 4, 1
  v_and_b32 v2, 0x100, v2
  v_add_u32 v7, v7, v2
  v_bfe_i32 v2, v0, 5, 1
  v_and_b32 v2, 0x200, v2
  v_add_u32 v7, v7, v2
  v_mov_b32 v8, 0x0
  v_bfe_i32 v2, v0, 0, 1
  v_and_b32 v2, 0x4, v2
  v_add_u32 v8, v8, v2
  v_bfe_i32 v2, v0, 1, 1
  v_and_b32 v2, 0x8, v2
  v_add_u32 v8, v8, v2
  v_bfe_i32 v2, v0, 2, 1
  v_and_b32 v2, 0x10, v2
  v_add_u32 v8, v8, v2
  v_bfe_i32 v2, v0, 3, 1
  v_and_b32 v2, 0x20, v2
  v_add_u32 v8, v8, v2
  v_mov_b32 v9, 0x0
  v_bfe_i32 v2, v0, 6, 1
  v_and_b32 v2, 0x4, v2
  v_add_u32 v9, v9, v2
  v_bfe_i32 v2, v0, 7, 1
  v_and_b32 v2, 0x8, v2
  v_add_u32 v9, v9, v2
  v_mov_b32 v10, 1
  v_mov_b32 v12, 0x0
  v_bfe_i32 v2, v0, 0, 1
  v_and_b32 v2, 0x10, v2
  v_add_u32 v12, v12, v2
  v_bfe_i32 v2, v0, 1, 1
  v_and_b32 v2, 0x20, v2
  v_add_u32 v12, v12, v2
  v_bfe_i32 v2, v0, 2, 1
  v_and_b32 v2, 0x40, v2
  v_add_u32 v12, v12, v2
  v_bfe_i32 v2, v0, 3, 1
  v_and_b32 v2, 0x80, v2
  v_add_u32 v12, v12, v2
  v_bfe_i32 v2, v0, 4, 1
  v_and_b32 v2, 0x100, v2
  v_add_u32 v12, v12, v2
  v_bfe_i32 v2, v0, 5, 1
  v_and_b32 v2, 0x200, v2
  v_add_u32 v12, v12, v2
  v_bfe_i32 v2, v0, 6, 1
  v_and_b32 v2, 0x800, v2
  v_add_u32 v12, v12, v2
  v_bfe_i32 v2, v0, 7, 1
  v_and_b32 v2, 0x1000, v2
  v_add_u32_e64 v12, v12, v2
  s_mov_b32 s8, s40
  s_and_b32 s9, s41, 0xffff
  s_mov_b32 s10, 0x1c0000
  s_mov_b32 s11, 0x20000
  s_mov_b32 s12, s42
  s_and_b32 s13, s43, 0xffff
  s_mov_b32 s14, 0x1c0000
  s_mov_b32 s15, 0x20000
  v_mov_b32 v3, 0x0
  v_bfe_i32 v2, v0, 0, 1
  v_and_b32 v2, 0x10, v2
  v_xor_b32 v3, v3, v2
  v_bfe_i32 v2, v0, 1, 1
  v_and_b32 v2, 0x20, v2
  v_xor_b32 v3, v3, v2
  v_bfe_i32 v2, v0, 2, 1
  v_and_b32 v2, 0x40, v2
  v_xor_b32 v3, v3, v2
  v_bfe_i32 v2, v0, 3, 1
  v_and_b32 v2, 0x80, v2
  v_xor_b32 v3, v3, v2
  v_bfe_i32 v2, v0, 4, 1
  v_and_b32 v2, 0x40, v2
  v_xor_b32 v3, v3, v2
  v_bfe_i32 v2, v0, 5, 1
  v_and_b32 v2, 0x80, v2
  v_xor_b32 v3, v3, v2
  v_mov_b32 v5, 0x0
  v_bfe_i32 v2, v0, 4, 1
  v_and_b32 v2, 0xe00, v2
  v_add_u32 v5, v5, v2
  v_bfe_i32 v2, v0, 5, 1
  v_and_b32 v2, 0x1c00, v2
  v_add_u32 v5, v5, v2
  v_add_u32 v3, v3, v5
  v_mov_b32 v4, 0x0
  v_bfe_i32 v2, v0, 0, 1
  v_and_b32 v2, 0x8, v2
  v_xor_b32 v4, v4, v2
  v_bfe_i32 v2, v0, 1, 1
  v_and_b32 v2, 0x10, v2
  v_xor_b32 v4, v4, v2
  v_bfe_i32 v2, v0, 2, 1
  v_and_b32 v2, 0x140, v2
  v_xor_b32 v4, v4, v2
  v_bfe_i32 v2, v0, 3, 1
  v_and_b32 v2, 0x280, v2
  v_xor_b32 v4, v4, v2
  v_bfe_i32 v2, v0, 4, 1
  v_and_b32 v2, 0x20, v2
  v_xor_b32 v4, v4, v2
  v_bfe_i32 v2, v0, 5, 1
  v_and_b32 v2, 0x800, v2
  v_xor_b32 v4, v4, v2
  v_bfe_i32 v2, v0, 6, 1
  v_and_b32 v2, 0x40, v2
  v_xor_b32 v4, v4, v2
  v_bfe_i32 v2, v0, 7, 1
  v_and_b32 v2, 0x80, v2
  v_xor_b32 v4, v4, v2
  v_add_u32 v5, 0x10000, v4
  s_lshl_b32 s76, s54, 8
  s_barrier
  s_mul_i32 s61, s58, 458752
  s_add_u32 s61, s61, s76
  s_add_u32 s61, s61, 0
  s_mul_i32 s62, s58, 32768
  s_mov_b32 s63, 0
L_wdma_215:
  s_mov_b32 m0, s62
  s_add_u32 s62, s62, 1024
  buffer_load_dwordx4 v3, s[8:11], s61 offen lds
  s_add_u32 s61, s61, 14336
  s_add_u32 s63, s63, 1
  s_cmp_lt_u32 s63, 32
  s_cbranch_scc1 L_wdma_215
  s_waitcnt vmcnt(0)
  s_barrier
  ds_read_b64_tr_b16 a[0:1], v4 offset:0
  ds_read_b64_tr_b16 a[2:3], v4 offset:1024
  ds_read_b64_tr_b16 a[4:5], v4 offset:4096
  ds_read_b64_tr_b16 a[6:7], v4 offset:5120
  ds_read_b64_tr_b16 a[8:9], v4 offset:8192
  ds_read_b64_tr_b16 a[10:11], v4 offset:9216
  ds_read_b64_tr_b16 a[12:13], v4 offset:12288
  ds_read_b64_tr_b16 a[14:15], v4 offset:13312
  s_waitcnt lgkmcnt(0)
  ds_read_b64_tr_b16 a[16:17], v4 offset:16384
  ds_read_b64_tr_b16 a[18:19], v4 offset:17408
  ds_read_b64_tr_b16 a[20:21], v4 offset:20480
  ds_read_b64_tr_b16 a[22:23], v4 offset:21504
  ds_read_b64_tr_b16 a[24:25], v4 offset:24576
  ds_read_b64_tr_b16 a[26:27], v4 offset:25600
  ds_read_b64_tr_b16 a[28:29], v4 offset:28672
  ds_read_b64_tr_b16 a[30:31], v4 offset:29696
  s_waitcnt lgkmcnt(0)
  ds_read_b64_tr_b16 a[32:33], v4 offset:32768
  ds_read_b64_tr_b16 a[34:35], v4 offset:33792
  ds_read_b64_tr_b16 a[36:37], v4 offset:36864
  ds_read_b64_tr_b16 a[38:39], v4 offset:37888
  ds_read_b64_tr_b16 a[40:41], v4 offset:40960
  ds_read_b64_tr_b16 a[42:43], v4 offset:41984
  ds_read_b64_tr_b16 a[44:45], v4 offset:45056
  ds_read_b64_tr_b16 a[46:47], v4 offset:46080
  s_waitcnt lgkmcnt(0)
  ds_read_b64_tr_b16 a[48:49], v4 offset:49152
  ds_read_b64_tr_b16 a[50:51], v4 offset:50176
  ds_read_b64_tr_b16 a[52:53], v4 offset:53248
  ds_read_b64_tr_b16 a[54:55], v4 offset:54272
  ds_read_b64_tr_b16 a[56:57], v4 offset:57344
  ds_read_b64_tr_b16 a[58:59], v4 offset:58368
  ds_read_b64_tr_b16 a[60:61], v4 offset:61440
  ds_read_b64_tr_b16 a[62:63], v4 offset:62464
  s_waitcnt lgkmcnt(0)
  ds_read_b64_tr_b16 a[64:65], v5 offset:0
  ds_read_b64_tr_b16 a[66:67], v5 offset:1024
  ds_read_b64_tr_b16 a[68:69], v5 offset:4096
  ds_read_b64_tr_b16 a[70:71], v5 offset:5120
  ds_read_b64_tr_b16 a[72:73], v5 offset:8192
  ds_read_b64_tr_b16 a[74:75], v5 offset:9216
  ds_read_b64_tr_b16 a[76:77], v5 offset:12288
  ds_read_b64_tr_b16 a[78:79], v5 offset:13312
  s_waitcnt lgkmcnt(0)
  ds_read_b64_tr_b16 a[80:81], v5 offset:16384
  ds_read_b64_tr_b16 a[82:83], v5 offset:17408
  ds_read_b64_tr_b16 a[84:85], v5 offset:20480
  ds_read_b64_tr_b16 a[86:87], v5 offset:21504
  ds_read_b64_tr_b16 a[88:89], v5 offset:24576
  ds_read_b64_tr_b16 a[90:91], v5 offset:25600
  ds_read_b64_tr_b16 a[92:93], v5 offset:28672
  ds_read_b64_tr_b16 a[94:95], v5 offset:29696
  s_waitcnt lgkmcnt(0)
  ds_read_b64_tr_b16 a[96:97], v5 offset:32768
  ds_read_b64_tr_b16 a[98:99], v5 offset:33792
  ds_read_b64_tr_b16 a[100:101], v5 offset:36864
  ds_read_b64_tr_b16 a[102:103], v5 offset:37888
  ds_read_b64_tr_b16 a[104:105], v5 offset:40960
  ds_read_b64_tr_b16 a[106:107], v5 offset:41984
  ds_read_b64_tr_b16 a[108:109], v5 offset:45056
  ds_read_b64_tr_b16 a[110:111], v5 offset:46080
  s_waitcnt lgkmcnt(0)
  ds_read_b64_tr_b16 a[112:113], v5 offset:49152
  ds_read_b64_tr_b16 a[114:115], v5 offset:50176
  ds_read_b64_tr_b16 a[116:117], v5 offset:53248
  ds_read_b64_tr_b16 a[118:119], v5 offset:54272
  ds_read_b64_tr_b16 a[120:121], v5 offset:57344
  ds_read_b64_tr_b16 a[122:123], v5 offset:58368
  ds_read_b64_tr_b16 a[124:125], v5 offset:61440
  ds_read_b64_tr_b16 a[126:127], v5 offset:62464
  s_waitcnt lgkmcnt(0)
  s_waitcnt lgkmcnt(0)
  s_barrier
  s_mul_i32 s61, s58, 458752
  s_add_u32 s61, s61, s76
  s_add_u32 s61, s61, 0
  s_mul_i32 s62, s58, 32768
  s_mov_b32 s63, 0
L_wdma_216:
  s_mov_b32 m0, s62
  s_add_u32 s62, s62, 1024
  buffer_load_dwordx4 v3, s[12:15], s61 offen lds
  s_add_u32 s61, s61, 14336
  s_add_u32 s63, s63, 1
  s_cmp_lt_u32 s63, 32
  s_cbranch_scc1 L_wdma_216
  s_waitcnt vmcnt(0)
  s_barrier
  ds_read_b64_tr_b16 a[128:129], v4 offset:0
  ds_read_b64_tr_b16 a[130:131], v4 offset:1024
  ds_read_b64_tr_b16 a[132:133], v4 offset:4096
  ds_read_b64_tr_b16 a[134:135], v4 offset:5120
  ds_read_b64_tr_b16 a[136:137], v4 offset:8192
  ds_read_b64_tr_b16 a[138:139], v4 offset:9216
  ds_read_b64_tr_b16 a[140:141], v4 offset:12288
  ds_read_b64_tr_b16 a[142:143], v4 offset:13312
  s_waitcnt lgkmcnt(0)
  ds_read_b64_tr_b16 a[144:145], v4 offset:16384
  ds_read_b64_tr_b16 a[146:147], v4 offset:17408
  ds_read_b64_tr_b16 a[148:149], v4 offset:20480
  ds_read_b64_tr_b16 a[150:151], v4 offset:21504
  ds_read_b64_tr_b16 a[152:153], v4 offset:24576
  ds_read_b64_tr_b16 a[154:155], v4 offset:25600
  ds_read_b64_tr_b16 a[156:157], v4 offset:28672
  ds_read_b64_tr_b16 a[158:159], v4 offset:29696
  s_waitcnt lgkmcnt(0)
  ds_read_b64_tr_b16 a[160:161], v4 offset:32768
  ds_read_b64_tr_b16 a[162:163], v4 offset:33792
  ds_read_b64_tr_b16 a[164:165], v4 offset:36864
  ds_read_b64_tr_b16 a[166:167], v4 offset:37888
  ds_read_b64_tr_b16 a[168:169], v4 offset:40960
  ds_read_b64_tr_b16 a[170:171], v4 offset:41984
  ds_read_b64_tr_b16 a[172:173], v4 offset:45056
  ds_read_b64_tr_b16 a[174:175], v4 offset:46080
  s_waitcnt lgkmcnt(0)
  ds_read_b64_tr_b16 a[176:177], v4 offset:49152
  ds_read_b64_tr_b16 a[178:179], v4 offset:50176
  ds_read_b64_tr_b16 a[180:181], v4 offset:53248
  ds_read_b64_tr_b16 a[182:183], v4 offset:54272
  ds_read_b64_tr_b16 a[184:185], v4 offset:57344
  ds_read_b64_tr_b16 a[186:187], v4 offset:58368
  ds_read_b64_tr_b16 a[188:189], v4 offset:61440
  ds_read_b64_tr_b16 a[190:191], v4 offset:62464
  s_waitcnt lgkmcnt(0)
  ds_read_b64_tr_b16 a[192:193], v5 offset:0
  ds_read_b64_tr_b16 a[194:195], v5 offset:1024
  ds_read_b64_tr_b16 a[196:197], v5 offset:4096
  ds_read_b64_tr_b16 a[198:199], v5 offset:5120
  ds_read_b64_tr_b16 a[200:201], v5 offset:8192
  ds_read_b64_tr_b16 a[202:203], v5 offset:9216
  ds_read_b64_tr_b16 a[204:205], v5 offset:12288
  ds_read_b64_tr_b16 a[206:207], v5 offset:13312
  s_waitcnt lgkmcnt(0)
  ds_read_b64_tr_b16 a[208:209], v5 offset:16384
  ds_read_b64_tr_b16 a[210:211], v5 offset:17408
  ds_read_b64_tr_b16 a[212:213], v5 offset:20480
  ds_read_b64_tr_b16 a[214:215], v5 offset:21504
  ds_read_b64_tr_b16 a[216:217], v5 offset:24576
  ds_read_b64_tr_b16 a[218:219], v5 offset:25600
  ds_read_b64_tr_b16 a[220:221], v5 offset:28672
  ds_read_b64_tr_b16 a[222:223], v5 offset:29696
  s_waitcnt lgkmcnt(0)
  ds_read_b64_tr_b16 a[224:225], v5 offset:32768
  ds_read_b64_tr_b16 a[226:227], v5 offset:33792
  ds_read_b64_tr_b16 a[228:229], v5 offset:36864
  ds_read_b64_tr_b16 a[230:231], v5 offset:37888
  ds_read_b64_tr_b16 a[232:233], v5 offset:40960
  ds_read_b64_tr_b16 a[234:235], v5 offset:41984
  ds_read_b64_tr_b16 a[236:237], v5 offset:45056
  ds_read_b64_tr_b16 a[238:239], v5 offset:46080
  s_waitcnt lgkmcnt(0)
  ds_read_b64_tr_b16 a[240:241], v5 offset:49152
  ds_read_b64_tr_b16 a[242:243], v5 offset:50176
  ds_read_b64_tr_b16 a[244:245], v5 offset:53248
  ds_read_b64_tr_b16 a[246:247], v5 offset:54272
  ds_read_b64_tr_b16 a[248:249], v5 offset:57344
  ds_read_b64_tr_b16 a[250:251], v5 offset:58368
  ds_read_b64_tr_b16 a[252:253], v5 offset:61440
  ds_read_b64_tr_b16 a[254:255], v5 offset:62464
  s_waitcnt lgkmcnt(0)
  s_waitcnt lgkmcnt(0)
  s_barrier
  s_mov_b32 s20, s50
  s_and_b32 s21, s51, 0xffff
  s_mov_b32 s22, 0x0
  s_mov_b32 s23, 0x20000
  s_mov_b32 s8, s48
  s_and_b32 s9, s49, 0xffff
  s_mov_b32 s10, 0x100
  s_mov_b32 s11, 0x20000
  v_and_b32 v2, 3, v0
  v_lshlrev_b32 v2, 6, v2
L_gate_217:
  buffer_load_dword v11, v2, s[8:11], 0 offen offset:8 sc1
  s_waitcnt vmcnt(0)
  v_cmp_gt_u32 vcc, 48, v11
  s_cbranch_vccz L_gateok_218
  s_add_u32 s72, s72, 1
  s_cmp_gt_u32 s72, 0x80000
  s_cbranch_scc1 L_exit
  s_sleep 2
  s_branch L_gate_217
L_gateok_218:
  s_mov_b32 s59, 0
  s_mov_b32 s88, 0
  s_mov_b32 s60, 0
  v_mov_b32 v113, 0
  v_add_u32 v112, 0x8000, v7
  s_mov_b32 s60, 0
L_s4h0_219:
  s_cmp_eq_u32 s60, 1
  s_cbranch_scc1 L_hp_223
  s_lshl_b32 s63, s55, 6
  s_add_u32 s63, s63, 0x1c000
  s_add_u32 s63, s63, s53
  s_and_b32 s61, s55, 7
  s_lshl_b32 s61, s61, 15
  s_add_u32 s61, s61, 0x5e00000
  s_add_u32 s61, s61, s52
  s_lshl_b32 s62, s58, 12
  s_add_u32 m0, s62, 0x0
L_poll_225:
  buffer_load_dword v11, v8, s[4:7], s63 offen sc1
  s_waitcnt vmcnt(0)
  s_cmp_eq_u32 s88, 0
  s_cbranch_scc1 L_nofl_227
  s_mov_b64 exec, 1
  buffer_store_dword v10, v9, s[4:7], s88 offen sc1
  s_mov_b64 exec, -1
  s_mov_b32 s88, 0
L_nofl_227:
  v_cmp_eq_u32 vcc, 0, v11
  s_cbranch_vccz L_pollok_226
  s_add_u32 s72, s72, 1
  s_cmp_gt_u32 s72, 0x80000
  s_cbranch_scc1 L_exit
  s_branch L_poll_225
L_pollok_226:
  buffer_load_dwordx4 v6, s[4:7], s61 offen offset:0 sc1 lds
  buffer_load_dwordx4 v6, s[4:7], s61 offen offset:1024 sc1 lds
  buffer_load_dwordx4 v6, s[4:7], s61 offen offset:2048 sc1 lds
  buffer_load_dwordx4 v6, s[4:7], s61 offen offset:3072 sc1 lds
  s_add_u32 m0, m0, 0x4000
  s_add_u32 s61, s61, 0x4000
  buffer_load_dwordx4 v6, s[4:7], s61 offen offset:0 sc1 lds
  buffer_load_dwordx4 v6, s[4:7], s61 offen offset:1024 sc1 lds
  buffer_load_dwordx4 v6, s[4:7], s61 offen offset:2048 sc1 lds
  buffer_load_dwordx4 v6, s[4:7], s61 offen offset:3072 sc1 lds
  s_waitcnt vmcnt(4)
  s_branch L_hj_224
L_hp_223:
  s_waitcnt vmcnt(2)
L_hj_224:
  s_barrier
  ds_read_b128 v[16:19], v7 offset:0
  ds_read_b128 v[20:23], v7 offset:1024
  ds_read_b128 v[24:27], v7 offset:2048
L_s4b0_221:
  s_add_u32 s74, s55, s56
  s_min_u32 s64, s74, 63
  s_lshl_b32 s96, s64, 6
  s_add_u32 s96, s96, 0x1c000
  s_add_u32 s96, s96, s53
  s_mov_b32 s59, 0
  s_mov_b32 s80, 0
  ds_read_b128 v[28:31], v7 offset:3072
  s_waitcnt lgkmcnt(3)
  v_mfma_f32_32x32x16_bf16 v[32:47], a[0:3], v[16:19], 0
  buffer_load_dword v11, v8, s[4:7], s96 offen sc1
  v_mfma_f32_32x32x16_bf16 v[48:63], a[128:131], v[16:19], 0
  ds_read_b128 v[16:19], v7 offset:4096
  s_waitcnt lgkmcnt(3)
  v_mfma_f32_32x32x16_bf16 v[32:47], a[4:7], v[20:23], v[32:47]
  v_mfma_f32_32x32x16_bf16 v[48:63], a[132:135], v[20:23], v[48:63]
  ds_read_b128 v[20:23], v7 offset:5120
  s_waitcnt lgkmcnt(3)
  v_mfma_f32_32x32x16_bf16 v[32:47], a[8:11], v[24:27], v[32:47]
  v_mfma_f32_32x32x16_bf16 v[48:63], a[136:139], v[24:27], v[48:63]
  ds_read_b128 v[24:27], v7 offset:6144
  s_waitcnt lgkmcnt(3)
  v_mfma_f32_32x32x16_bf16 v[32:47], a[12:15], v[28:31], v[32:47]
  v_mfma_f32_32x32x16_bf16 v[48:63], a[140:143], v[28:31], v[48:63]
  ds_read_b128 v[28:31], v7 offset:7168
  s_waitcnt lgkmcnt(3)
  v_mfma_f32_32x32x16_bf16 v[32:47], a[16:19], v[16:19], v[32:47]
  v_mfma_f32_32x32x16_bf16 v[48:63], a[144:147], v[16:19], v[48:63]
  ds_read_b128 v[16:19], v7 offset:8192
  s_waitcnt lgkmcnt(3)
  v_mfma_f32_32x32x16_bf16 v[32:47], a[20:23], v[20:23], v[32:47]
  v_mfma_f32_32x32x16_bf16 v[48:63], a[148:151], v[20:23], v[48:63]
  ds_read_b128 v[20:23], v7 offset:9216
  s_waitcnt lgkmcnt(3)
  v_mfma_f32_32x32x16_bf16 v[32:47], a[24:27], v[24:27], v[32:47]
  v_mfma_f32_32x32x16_bf16 v[48:63], a[152:155], v[24:27], v[48:63]
  ds_read_b128 v[24:27], v7 offset:10240
  s_waitcnt lgkmcnt(3)
  v_mfma_f32_32x32x16_bf16 v[32:47], a[28:31], v[28:31], v[32:47]
  v_mfma_f32_32x32x16_bf16 v[48:63], a[156:159], v[28:31], v[48:63]
  ds_read_b128 v[28:31], v7 offset:11264
  s_waitcnt lgkmcnt(3)
  v_mfma_f32_32x32x16_bf16 v[32:47], a[32:35], v[16:19], v[32:47]
  v_mfma_f32_32x32x16_bf16 v[48:63], a[160:163], v[16:19], v[48:63]
  ds_read_b128 v[16:19], v7 offset:12288
  s_waitcnt lgkmcnt(3)
  v_mfma_f32_32x32x16_bf16 v[32:47], a[36:39], v[20:23], v[32:47]
  v_mfma_f32_32x32x16_bf16 v[48:63], a[164:167], v[20:23], v[48:63]
  ds_read_b128 v[20:23], v7 offset:13312
  s_waitcnt lgkmcnt(3)
  v_mfma_f32_32x32x16_bf16 v[32:47], a[40:43], v[24:27], v[32:47]
  v_mfma_f32_32x32x16_bf16 v[48:63], a[168:171], v[24:27], v[48:63]
  s_cmp_lg_u32 s60, 1
  s_cbranch_scc1 L_hfa_228
  s_waitcnt vmcnt(1)
  s_mov_b64 exec, 1
  buffer_store_dword v10, v9, s[4:7], s88 offen sc1
  s_mov_b64 exec, -1
  s_mov_b32 s88, 0
L_hfa_228:
  ds_read_b128 v[24:27], v7 offset:14336
  s_waitcnt lgkmcnt(3)
  v_mfma_f32_32x32x16_bf16 v[32:47], a[44:47], v[28:31], v[32:47]
  v_mfma_f32_32x32x16_bf16 v[48:63], a[172:175], v[28:31], v[48:63]
  ds_read_b128 v[28:31], v7 offset:15360
  s_waitcnt lgkmcnt(3)
  v_mfma_f32_32x32x16_bf16 v[32:47], a[48:51], v[16:19], v[32:47]
  v_mfma_f32_32x32x16_bf16 v[48:63], a[176:179], v[16:19], v[48:63]
  s_cmp_eq_u32 s60, 2
  s_cbranch_scc1 L_h1b_230
  s_cmp_eq_u32 s60, 1
  s_cbranch_scc1 L_h1a_229
  s_waitcnt vmcnt(0)
L_h1a_229:
  s_waitcnt vmcnt(1)
L_h1b_230:
  s_waitcnt vmcnt(2)
  v_cmp_eq_u32 vcc, 0, v11
  s_cmp_lt_u32 s74, s57
  s_cselect_b64 s[70:71], vcc, -1
  s_cmp_eq_u64 s[70:71], 0
  s_cselect_b32 s89, s58, 7
L_h1c_231:
  s_barrier
  ds_read_b128 v[16:19], v7 offset:16384
  s_waitcnt lgkmcnt(3)
  v_mfma_f32_32x32x16_bf16 v[32:47], a[52:55], v[20:23], v[32:47]
  v_mfma_f32_32x32x16_bf16 v[48:63], a[180:183], v[20:23], v[48:63]
  s_cmp_eq_u32 s89, 0
  s_cbranch_scc1 L_hwo_232
L_hwb_233:
  ds_read_b128 v[20:23], v7 offset:17408
  s_waitcnt lgkmcnt(3)
  v_mfma_f32_32x32x16_bf16 v[32:47], a[56:59], v[24:27], v[32:47]
  v_mfma_f32_32x32x16_bf16 v[48:63], a[184:187], v[24:27], v[48:63]
  ds_read_b128 v[24:27], v7 offset:18432
  s_waitcnt lgkmcnt(3)
  v_mfma_f32_32x32x16_bf16 v[32:47], a[60:63], v[28:31], v[32:47]
  v_mfma_f32_32x32x16_bf16 v[48:63], a[188:191], v[28:31], v[48:63]
  s_cmp_eq_u32 s89, 1
  s_cbranch_scc1 L_hwo_234
L_hwb_235:
  ds_read_b128 v[28:31], v7 offset:19456
  s_waitcnt lgkmcnt(3)
  v_mfma_f32_32x32x16_bf16 v[32:47], a[64:67], v[16:19], v[32:47]
  v_mfma_f32_32x32x16_bf16 v[48:63], a[192:195], v[16:19], v[48:63]
  ds_read_b128 v[16:19], v7 offset:20480
  s_waitcnt lgkmcnt(3)
  v_mfma_f32_32x32x16_bf16 v[32:47], a[68:71], v[20:23], v[32:47]
  v_mfma_f32_32x32x16_bf16 v[48:63], a[196:199], v[20:23], v[48:63]
  s_cmp_eq_u32 s89, 2
  s_cbranch_scc1 L_hwo_236
L_hwb_237:
  ds_read_b128 v[20:23], v7 offset:21504
  s_waitcnt lgkmcnt(3)
  v_mfma_f32_32x32x16_bf16 v[32:47], a[72:75], v[24:27], v[32:47]
  v_mfma_f32_32x32x16_bf16 v[48:63], a[200:203], v[24:27], v[48:63]
  ds_read_b128 v[24:27], v7 offset:22528
  s_waitcnt lgkmcnt(3)
  v_mfma_f32_32x32x16_bf16 v[32:47], a[76:79], v[28:31], v[32:47]
  v_mfma_f32_32x32x16_bf16 v[48:63], a[204:207], v[28:31], v[48:63]
  s_cmp_eq_u32 s89, 3
  s_cbranch_scc1 L_hwo_238
L_hwb_239:
  s_cmp_lg_u32 s89, 7
  s_cbranch_scc1 L_hre_240
  buffer_load_dword v11, v8, s[4:7], s96 offen sc1
L_hre_240:
  ds_read_b128 v[28:31], v7 offset:23552
  s_waitcnt lgkmcnt(3)
  v_mfma_f32_32x32x16_bf16 v[32:47], a[80:83], v[16:19], v[32:47]
  v_mfma_f32_32x32x16_bf16 v[48:63], a[208:211], v[16:19], v[48:63]
  ds_read_b128 v[16:19], v7 offset:24576
  s_waitcnt lgkmcnt(3)
  v_mfma_f32_32x32x16_bf16 v[32:47], a[84:87], v[20:23], v[32:47]
  v_mfma_f32_32x32x16_bf16 v[48:63], a[212:215], v[20:23], v[48:63]
  ds_read_b128 v[20:23], v7 offset:25600
  s_waitcnt lgkmcnt(3)
  v_mfma_f32_32x32x16_bf16 v[32:47], a[88:91], v[24:27], v[32:47]
  v_mfma_f32_32x32x16_bf16 v[48:63], a[216:219], v[24:27], v[48:63]
  ds_read_b128 v[24:27], v7 offset:26624
  s_waitcnt lgkmcnt(3)
  v_mfma_f32_32x32x16_bf16 v[32:47], a[92:95], v[28:31], v[32:47]
  v_mfma_f32_32x32x16_bf16 v[48:63], a[220:223], v[28:31], v[48:63]
  ds_read_b128 v[28:31], v7 offset:27648
  s_waitcnt lgkmcnt(3)
  v_mfma_f32_32x32x16_bf16 v[32:47], a[96:99], v[16:19], v[32:47]
  v_mfma_f32_32x32x16_bf16 v[48:63], a[224:227], v[16:19], v[48:63]
  ds_read_b128 v[16:19], v7 offset:28672
  s_waitcnt lgkmcnt(3)
  v_mfma_f32_32x32x16_bf16 v[32:47], a[100:103], v[20:23], v[32:47]
  v_mfma_f32_32x32x16_bf16 v[48:63], a[228:231], v[20:23], v[48:63]
  ds_read_b128 v[20:23], v7 offset:29696
  s_waitcnt lgkmcnt(3)
  v_mfma_f32_32x32x16_bf16 v[32:47], a[104:107], v[24:27], v[32:47]
  v_mfma_f32_32x32x16_bf16 v[48:63], a[232:235], v[24:27], v[48:63]
  ds_read_b128 v[24:27], v7 offset:30720
  s_waitcnt lgkmcnt(3)
  v_mfma_f32_32x32x16_bf16 v[32:47], a[108:111], v[28:31], v[32:47]
  v_mfma_f32_32x32x16_bf16 v[48:63], a[236:239], v[28:31], v[48:63]
  ds_read_b128 v[28:31], v7 offset:31744
  s_waitcnt lgkmcnt(3)
  v_mfma_f32_32x32x16_bf16 v[32:47], a[112:115], v[16:19], v[32:47]
  s_and_b32 s76, s55, 7
  s_mul_i32 s76, s76, 114688
  s_lshl_b32 s77, s54, 13
  s_add_u32 s76, s76, s77
  v_mfma_f32_32x32x16_bf16 v[48:63], a[240:243], v[16:19], v[48:63]
  s_waitcnt lgkmcnt(2)
  v_mfma_f32_32x32x16_bf16 v[32:47], a[116:119], v[20:23], v[32:47]
  s_add_u32 s76, s76, s52
  s_add_u32 s76, s76, 0x4800000
  s_lshl_b32 s78, s55, 8
  s_lshl_b32 s79, s54, 4
  v_mfma_f32_32x32x16_bf16 v[48:63], a[244:247], v[20:23], v[48:63]
  s_waitcnt lgkmcnt(1)
  v_mfma_f32_32x32x16_bf16 v[32:47], a[120:123], v[24:27], v[32:47]
  s_add_u32 s78, s78, s79
  s_add_u32 s78, s78, 0x1d000
  s_add_u32 s78, s78, s53
  v_mfma_f32_32x32x16_bf16 v[48:63], a[248:251], v[24:27], v[48:63]
  s_waitcnt lgkmcnt(0)
  v_mfma_f32_32x32x16_bf16 v[32:47], a[124:127], v[28:31], v[32:47]
  v_mfma_f32_32x32x16_bf16 v[48:63], a[252:255], v[28:31], v[48:63]
  s_cmp_lg_u32 s59, 1
  s_cbranch_scc1 L_late_241
  s_mov_b32 s60, 1
  s_branch L_nl_243
  s_cmp_eq_u32 s80, 1
  s_cbranch_scc1 L_st1_242
  s_waitcnt vmcnt(0)
L_st1_242:
  s_waitcnt vmcnt(1)
  s_barrier
  ds_read_b128 v[16:19], v112 offset:0
  ds_read_b128 v[20:23], v112 offset:1024
  ds_read_b128 v[24:27], v112 offset:2048
  s_mov_b32 s60, 2
  s_mov_b32 s55, s74
  s_branch L_s4b1_222
L_late_241:
  s_mov_b32 s60, 0
  s_waitcnt vmcnt(0)
  s_cmp_ge_u32 s74, s57
  s_cbranch_scc1 L_nl_243
  v_cmp_eq_u32 vcc, 0, v11
  s_cbranch_vccnz L_nl_243
  s_mov_b32 s64, 0x8000
  s_and_b32 s61, s74, 7
  s_lshl_b32 s61, s61, 15
  s_add_u32 s61, s61, 0x5e00000
  s_add_u32 s61, s61, s52
  s_lshl_b32 s62, s58, 12
  s_add_u32 m0, s62, s64
  s_nop 0
  buffer_load_dwordx4 v6, s[4:7], s61 offen offset:0 sc1 lds
  buffer_load_dwordx4 v6, s[4:7], s61 offen offset:1024 sc1 lds
  buffer_load_dwordx4 v6, s[4:7], s61 offen offset:2048 sc1 lds
  buffer_load_dwordx4 v6, s[4:7], s61 offen offset:3072 sc1 lds
  s_add_u32 m0, m0, 0x4000
  s_add_u32 s61, s61, 0x4000
  buffer_load_dwordx4 v6, s[4:7], s61 offen offset:0 sc1 lds
  buffer_load_dwordx4 v6, s[4:7], s61 offen offset:1024 sc1 lds
  buffer_load_dwordx4 v6, s[4:7], s61 offen offset:2048 sc1 lds
  buffer_load_dwordx4 v6, s[4:7], s61 offen offset:3072 sc1 lds
  s_mov_b32 s60, 1
L_nl_243:
  s_nop 7
  v_max_f32 v32, 0, v32
  v_max_f32 v33, 0, v33
  v_max_f32 v34, 0, v34
  v_max_f32 v35, 0, v35
  v_max_f32 v36, 0, v36
  v_max_f32 v37, 0, v37
  v_max_f32 v38, 0, v38
  v_max_f32 v39, 0, v39
  v_mul_f32 v32, v32, v48
  v_mul_f32 v33, v33, v49
  v_mul_f32 v34, v34, v50
  v_mul_f32 v35, v35, v51
  v_mul_f32 v36, v36, v52
  v_mul_f32 v37, v37, v53
  v_mul_f32 v38, v38, v54
  v_mul_f32_e64 v39, v39, v55
  v_cvt_pk_bf16_f32 v64, v32, v33
  v_cvt_pk_bf16_f32 v65, v34, v35
  v_cvt_pk_bf16_f32 v66, v36, v37
  v_cvt_pk_bf16_f32 v67, v38, v39
  buffer_store_dwordx4 v[64:67], v12, s[4:7], s76 offen offset:0 sc1
  v_max_f32 v40, 0, v40
  v_max_f32 v41, 0, v41
  v_max_f32 v42, 0, v42
  v_max_f32 v43, 0, v43
  v_max_f32 v44, 0, v44
  v_max_f32 v45, 0, v45
  v_max_f32 v46, 0, v46
  v_max_f32 v47, 0, v47
  v_mul_f32 v40, v40, v56
  v_mul_f32 v41, v41, v57
  v_mul_f32 v42, v42, v58
  v_mul_f32 v43, v43, v59
  v_mul_f32 v44, v44, v60
  v_mul_f32 v45, v45, v61
  v_mul_f32 v46, v46, v62
  v_mul_f32 v47, v47, v63
  v_cvt_pk_bf16_f32 v68, v40, v41
  v_cvt_pk_bf16_f32 v69, v42, v43
  v_cvt_pk_bf16_f32 v70, v44, v45
  v_cvt_pk_bf16_f32 v71, v46, v47
  buffer_store_dwordx4 v[68:71], v12, s[4:7], s76 offen offset:1024 sc1
  s_mov_b32 s88, s78
  s_mov_b32 s55, s74
  s_cmp_lt_u32 s55, s57
  s_cbranch_scc1 L_s4h1_220
  s_waitcnt vmcnt(0)
  s_cmp_eq_u32 s88, 0
  s_cbranch_scc1 L_nofl_244
  s_mov_b64 exec, 1
  buffer_store_dword v10, v9, s[4:7], s88 offen sc1
  s_mov_b64 exec, -1
  s_mov_b32 s88, 0
L_nofl_244:
  s_endpgm
L_s4h1_220:
  s_cmp_eq_u32 s60, 1
  s_cbranch_scc1 L_hp_245
  s_lshl_b32 s63, s55, 6
  s_add_u32 s63, s63, 0x1c000
  s_add_u32 s63, s63, s53
  s_and_b32 s61, s55, 7
  s_lshl_b32 s61, s61, 15
  s_add_u32 s61, s61, 0x5e00000
  s_add_u32 s61, s61, s52
  s_lshl_b32 s62, s58, 12
  s_add_u32 m0, s62, 0x8000
L_poll_247:
  buffer_load_dword v11, v8, s[4:7], s63 offen sc1
  s_waitcnt vmcnt(0)
  s_cmp_eq_u32 s88, 0
  s_cbranch_scc1 L_nofl_249
  s_mov_b64 exec, 1
  buffer_store_dword v10, v9, s[4:7], s88 offen sc1
  s_mov_b64 exec, -1
  s_mov_b32 s88, 0
L_nofl_249:
  v_cmp_eq_u32 vcc, 0, v11
  s_cbranch_vccz L_pollok_248
  s_add_u32 s72, s72, 1
  s_cmp_gt_u32 s72, 0x80000
  s_cbranch_scc1 L_exit
  s_branch L_poll_247
L_pollok_248:
  buffer_load_dwordx4 v6, s[4:7], s61 offen offset:0 sc1 lds
  buffer_load_dwordx4 v6, s[4:7], s61 offen offset:1024 sc1 lds
  buffer_load_dwordx4 v6, s[4:7], s61 offen offset:2048 sc1 lds
  buffer_load_dwordx4 v6, s[4:7], s61 offen offset:3072 sc1 lds
  s_add_u32 m0, m0, 0x4000
  s_add_u32 s61, s61, 0x4000
  buffer_load_dwordx4 v6, s[4:7], s61 offen offset:0 sc1 lds
  buffer_load_dwordx4 v6, s[4:7], s61 offen offset:1024 sc1 lds
  buffer_load_dwordx4 v6, s[4:7], s61 offen offset:2048 sc1 lds
  buffer_load_dwordx4 v6, s[4:7], s61 offen offset:3072 sc1 lds
  s_waitcnt vmcnt(4)
  s_branch L_hj_246
L_hp_245:
  s_waitcnt vmcnt(2)
L_hj_246:
  s_barrier
  ds_read_b128 v[16:19], v112 offset:0
  ds_read_b128 v[20:23], v112 offset:1024
  ds_read_b128 v[24:27], v112 offset:2048
L_s4b1_222:
  s_add_u32 s74, s55, s56
  s_min_u32 s64, s74, 63
  s_lshl_b32 s96, s64, 6
  s_add_u32 s96, s96, 0x1c000
  s_add_u32 s96, s96, s53
  s_mov_b32 s59, 0
  s_mov_b32 s80, 0
  ds_read_b128 v[28:31], v112 offset:3072
  s_waitcnt lgkmcnt(3)
  v_mfma_f32_32x32x16_bf16 v[80:95], a[0:3], v[16:19], 0
  buffer_load_dword v11, v8, s[4:7], s96 offen sc1
  v_mfma_f32_32x32x16_bf16 v[96:111], a[128:131], v[16:19], 0
  ds_read_b128 v[16:19], v112 offset:4096
  s_waitcnt lgkmcnt(3)
  v_mfma_f32_32x32x16_bf16 v[80:95], a[4:7], v[20:23], v[80:95]
  v_mfma_f32_32x32x16_bf16 v[96:111], a[132:135], v[20:23], v[96:111]
  ds_read_b128 v[20:23], v112 offset:5120
  s_waitcnt lgkmcnt(3)
  v_mfma_f32_32x32x16_bf16 v[80:95], a[8:11], v[24:27], v[80:95]
  v_mfma_f32_32x32x16_bf16 v[96:111], a[136:139], v[24:27], v[96:111]
  ds_read_b128 v[24:27], v112 offset:6144
  s_waitcnt lgkmcnt(3)
  v_mfma_f32_32x32x16_bf16 v[80:95], a[12:15], v[28:31], v[80:95]
  v_mfma_f32_32x32x16_bf16 v[96:111], a[140:143], v[28:31], v[96:111]
  ds_read_b128 v[28:31], v112 offset:7168
  s_waitcnt lgkmcnt(3)
  v_mfma_f32_32x32x16_bf16 v[80:95], a[16:19], v[16:19], v[80:95]
  v_mfma_f32_32x32x16_bf16 v[96:111], a[144:147], v[16:19], v[96:111]
  ds_read_b128 v[16:19], v112 offset:8192
  s_waitcnt lgkmcnt(3)
  v_mfma_f32_32x32x16_bf16 v[80:95], a[20:23], v[20:23], v[80:95]
  v_mfma_f32_32x32x16_bf16 v[96:111], a[148:151], v[20:23], v[96:111]
  ds_read_b128 v[20:23], v112 offset:9216
  s_waitcnt lgkmcnt(3)
  v_mfma_f32_32x32x16_bf16 v[80:95], a[24:27], v[24:27], v[80:95]
  v_mfma_f32_32x32x16_bf16 v[96:111], a[152:155], v[24:27], v[96:111]
  ds_read_b128 v[24:27], v112 offset:10240
  s_waitcnt lgkmcnt(3)
  v_mfma_f32_32x32x16_bf16 v[80:95], a[28:31], v[28:31], v[80:95]
  v_mfma_f32_32x32x16_bf16 v[96:111], a[156:159], v[28:31], v[96:111]
  ds_read_b128 v[28:31], v112 offset:11264
  s_waitcnt lgkmcnt(3)
  v_mfma_f32_32x32x16_bf16 v[80:95], a[32:35], v[16:19], v[80:95]
  v_mfma_f32_32x32x16_bf16 v[96:111], a[160:163], v[16:19], v[96:111]
  ds_read_b128 v[16:19], v112 offset:12288
  s_waitcnt lgkmcnt(3)
  v_mfma_f32_32x32x16_bf16 v[80:95], a[36:39], v[20:23], v[80:95]
  v_mfma_f32_32x32x16_bf16 v[96:111], a[164:167], v[20:23], v[96:111]
  ds_read_b128 v[20:23], v112 offset:13312
  s_waitcnt lgkmcnt(3)
  v_mfma_f32_32x32x16_bf16 v[80:95], a[40:43], v[24:27], v[80:95]
  v_mfma_f32_32x32x16_bf16 v[96:111], a[168:171], v[24:27], v[96:111]
  s_cmp_lg_u32 s60, 1
  s_cbranch_scc1 L_hfa_250
  s_waitcnt vmcnt(1)
  s_mov_b64 exec, 1
  buffer_store_dword v10, v9, s[4:7], s88 offen sc1
  s_mov_b64 exec, -1
  s_mov_b32 s88, 0
L_hfa_250:
  ds_read_b128 v[24:27], v112 offset:14336
  s_waitcnt lgkmcnt(3)
  v_mfma_f32_32x32x16_bf16 v[80:95], a[44:47], v[28:31], v[80:95]
  v_mfma_f32_32x32x16_bf16 v[96:111], a[172:175], v[28:31], v[96:111]
  ds_read_b128 v[28:31], v112 offset:15360
  s_waitcnt lgkmcnt(3)
  v_mfma_f32_32x32x16_bf16 v[80:95], a[48:51], v[16:19], v[80:95]
  v_mfma_f32_32x32x16_bf16 v[96:111], a[176:179], v[16:19], v[96:111]
  s_cmp_eq_u32 s60, 2
  s_cbranch_scc1 L_h1b_252
  s_cmp_eq_u32 s60, 1
  s_cbranch_scc1 L_h1a_251
  s_waitcnt vmcnt(0)
L_h1a_251:
  s_waitcnt vmcnt(1)
L_h1b_252:
  s_waitcnt vmcnt(2)
  v_cmp_eq_u32 vcc, 0, v11
  s_cmp_lt_u32 s74, s57
  s_cselect_b64 s[70:71], vcc, -1
  s_cmp_eq_u64 s[70:71], 0
  s_cselect_b32 s89, s58, 7
L_h1c_253:
  s_barrier
  ds_read_b128 v[16:19], v112 offset:16384
  s_waitcnt lgkmcnt(3)
  v_mfma_f32_32x32x16_bf16 v[80:95], a[52:55], v[20:23], v[80:95]
  v_mfma_f32_32x32x16_bf16 v[96:111], a[180:183], v[20:23], v[96:111]
  s_cmp_eq_u32 s89, 0
  s_cbranch_scc1 L_hwo_254
L_hwb_255:
  ds_read_b128 v[20:23], v112 offset:17408
  s_waitcnt lgkmcnt(3)
  v_mfma_f32_32x32x16_bf16 v[80:95], a[56:59], v[24:27], v[80:95]
  v_mfma_f32_32x32x16_bf16 v[96:111], a[184:187], v[24:27], v[96:111]
  ds_read_b128 v[24:27], v112 offset:18432
  s_waitcnt lgkmcnt(3)
  v_mfma_f32_32x32x16_bf16 v[80:95], a[60:63], v[28:31], v[80:95]
  v_mfma_f32_32x32x16_bf16 v[96:111], a[188:191], v[28:31], v[96:111]
  s_cmp_eq_u32 s89, 1
  s_cbranch_scc1 L_hwo_256
L_hwb_257:
  ds_read_b128 v[28:31], v112 offset:19456
  s_waitcnt lgkmcnt(3)
  v_mfma_f32_32x32x16_bf16 v[80:95], a[64:67], v[16:19], v[80:95]
  v_mfma_f32_32x32x16_bf16 v[96:111], a[192:195], v[16:19], v[96:111]
  ds_read_b128 v[16:19], v112 offset:20480
  s_waitcnt lgkmcnt(3)
  v_mfma_f32_32x32x16_bf16 v[80:95], a[68:71], v[20:23], v[80:95]
  v_mfma_f32_32x32x16_bf16 v[96:111], a[196:199], v[20:23], v[96:111]
  s_cmp_eq_u32 s89, 2
  s_cbranch_scc1 L_hwo_258
L_hwb_259:
  ds_read_b128 v[20:23], v112 offset:21504
  s_waitcnt lgkmcnt(3)
  v_mfma_f32_32x32x16_bf16 v[80:95], a[72:75], v[24:27], v[80:95]
  v_mfma_f32_32x32x16_bf16 v[96:111], a[200:203], v[24:27], v[96:111]
  ds_read_b128 v[24:27], v112 offset:22528
  s_waitcnt lgkmcnt(3)
  v_mfma_f32_32x32x16_bf16 v[80:95], a[76:79], v[28:31], v[80:95]
  v_mfma_f32_32x32x16_bf16 v[96:111], a[204:207], v[28:31], v[96:111]
  s_cmp_eq_u32 s89, 3
  s_cbranch_scc1 L_hwo_260
L_hwb_261:
  s_cmp_lg_u32 s89, 7
  s_cbranch_scc1 L_hre_262
  buffer_load_dword v11, v8, s[4:7], s96 offen sc1
L_hre_262:
  ds_read_b128 v[28:31], v112 offset:23552
  s_waitcnt lgkmcnt(3)
  v_mfma_f32_32x32x16_bf16 v[80:95], a[80:83], v[16:19], v[80:95]
  v_mfma_f32_32x32x16_bf16 v[96:111], a[208:211], v[16:19], v[96:111]
  ds_read_b128 v[16:19], v112 offset:24576
  s_waitcnt lgkmcnt(3)
  v_mfma_f32_32x32x16_bf16 v[80:95], a[84:87], v[20:23], v[80:95]
  v_mfma_f32_32x32x16_bf16 v[96:111], a[212:215], v[20:23], v[96:111]
  ds_read_b128 v[20:23], v112 offset:25600
  s_waitcnt lgkmcnt(3)
  v_mfma_f32_32x32x16_bf16 v[80:95], a[88:91], v[24:27], v[80:95]
  v_mfma_f32_32x32x16_bf16 v[96:111], a[216:219], v[24:27], v[96:111]
  ds_read_b128 v[24:27], v112 offset:26624
  s_waitcnt lgkmcnt(3)
  v_mfma_f32_32x32x16_bf16 v[80:95], a[92:95], v[28:31], v[80:95]
  v_mfma_f32_32x32x16_bf16 v[96:111], a[220:223], v[28:31], v[96:111]
  ds_read_b128 v[28:31], v112 offset:27648
  s_waitcnt lgkmcnt(3)
  v_mfma_f32_32x32x16_bf16 v[80:95], a[96:99], v[16:19], v[80:95]
  v_mfma_f32_32x32x16_bf16 v[96:111], a[224:227], v[16:19], v[96:111]
  ds_read_b128 v[16:19], v112 offset:28672
  s_waitcnt lgkmcnt(3)
  v_mfma_f32_32x32x16_bf16 v[80:95], a[100:103], v[20:23], v[80:95]
  v_mfma_f32_32x32x16_bf16 v[96:111], a[228:231], v[20:23], v[96:111]
  ds_read_b128 v[20:23], v112 offset:29696
  s_waitcnt lgkmcnt(3)
  v_mfma_f32_32x32x16_bf16 v[80:95], a[104:107], v[24:27], v[80:95]
  v_mfma_f32_32x32x16_bf16 v[96:111], a[232:235], v[24:27], v[96:111]
  ds_read_b128 v[24:27], v112 offset:30720
  s_waitcnt lgkmcnt(3)
  v_mfma_f32_32x32x16_bf16 v[80:95], a[108:111], v[28:31], v[80:95]
  v_mfma_f32_32x32x16_bf16 v[96:111], a[236:239], v[28:31], v[96:111]
  ds_read_b128 v[28:31], v112 offset:31744
  s_waitcnt lgkmcnt(3)
  v_mfma_f32_32x32x16_bf16 v[80:95], a[112:115], v[16:19], v[80:95]
  s_and_b32 s76, s55, 7
  s_mul_i32 s76, s76, 114688
  s_lshl_b32 s77, s54, 13
  s_add_u32 s76, s76, s77
  v_mfma_f32_32x32x16_bf16 v[96:111], a[240:243], v[16:19], v[96:111]
  s_waitcnt lgkmcnt(2)
  v_mfma_f32_32x32x16_bf16 v[80:95], a[116:119], v[20:23], v[80:95]
  s_add_u32 s76, s76, s52
  s_add_u32 s76, s76, 0x4800000
  s_lshl_b32 s78, s55, 8
  s_lshl_b32 s79, s54, 4
  v_mfma_f32_32x32x16_bf16 v[96:111], a[244:247], v[20:23], v[96:111]
  s_waitcnt lgkmcnt(1)
  v_mfma_f32_32x32x16_bf16 v[80:95], a[120:123], v[24:27], v[80:95]
  s_add_u32 s78, s78, s79
  s_add_u32 s78, s78, 0x1d000
  s_add_u32 s78, s78, s53
  v_mfma_f32_32x32x16_bf16 v[96:111], a[248:251], v[24:27], v[96:111]
  s_waitcnt lgkmcnt(0)
  v_mfma_f32_32x32x16_bf16 v[80:95], a[124:127], v[28:31], v[80:95]
  v_mfma_f32_32x32x16_bf16 v[96:111], a[252:255], v[28:31], v[96:111]
  s_cmp_lg_u32 s59, 1
  s_cbranch_scc1 L_late_263
  s_mov_b32 s60, 1
  s_branch L_nl_265
  s_cmp_eq_u32 s80, 1
  s_cbranch_scc1 L_st1_264
  s_waitcnt vmcnt(0)
L_st1_264:
  s_waitcnt vmcnt(1)
  s_barrier
  ds_read_b128 v[16:19], v7 offset:0
  ds_read_b128 v[20:23], v7 offset:1024
  ds_read_b128 v[24:27], v7 offset:2048
  s_mov_b32 s60, 2
  s_mov_b32 s55, s74
  s_branch L_s4b0_221
L_late_263:
  s_mov_b32 s60, 0
  s_waitcnt vmcnt(0)
  s_cmp_ge_u32 s74, s57
  s_cbranch_scc1 L_nl_265
  v_cmp_eq_u32 vcc, 0, v11
  s_cbranch_vccnz L_nl_265
  s_mov_b32 s64, 0x0
  s_and_b32 s61, s74, 7
  s_lshl_b32 s61, s61, 15
  s_add_u32 s61, s61, 0x5e00000
  s_add_u32 s61, s61, s52
  s_lshl_b32 s62, s58, 12
  s_add_u32 m0, s62, s64
  s_nop 0
  buffer_load_dwordx4 v6, s[4:7], s61 offen offset:0 sc1 lds
  buffer_load_dwordx4 v6, s[4:7], s61 offen offset:1024 sc1 lds
  buffer_load_dwordx4 v6, s[4:7], s61 offen offset:2048 sc1 lds
  buffer_load_dwordx4 v6, s[4:7], s61 offen offset:3072 sc1 lds
  s_add_u32 m0, m0, 0x4000
  s_add_u32 s61, s61, 0x4000
  buffer_load_dwordx4 v6, s[4:7], s61 offen offset:0 sc1 lds
  buffer_load_dwordx4 v6, s[4:7], s61 offen offset:1024 sc1 lds
  buffer_load_dwordx4 v6, s[4:7], s61 offen offset:2048 sc1 lds
  buffer_load_dwordx4 v6, s[4:7], s61 offen offset:3072 sc1 lds
  s_mov_b32 s60, 1
L_nl_265:
  s_nop 7
  v_max_f32 v80, 0, v80
  v_max_f32 v81, 0, v81
  v_max_f32 v82, 0, v82
  v_max_f32 v83, 0, v83
  v_max_f32 v84, 0, v84
  v_max_f32 v85, 0, v85
  v_max_f32 v86, 0, v86
  v_max_f32 v87, 0, v87
  v_mul_f32 v80, v80, v96
  v_mul_f32 v81, v81, v97
  v_mul_f32 v82, v82, v98
  v_mul_f32 v83, v83, v99
  v_mul_f32 v84, v84, v100
  v_mul_f32 v85, v85, v101
  v_mul_f32 v86, v86, v102
  v_mul_f32 v87, v87, v103
  v_cvt_pk_bf16_f32 v64, v80, v81
  v_cvt_pk_bf16_f32 v65, v82, v83
  v_cvt_pk_bf16_f32 v66, v84, v85
  v_cvt_pk_bf16_f32 v67, v86, v87
  buffer_store_dwordx4 v[64:67], v12, s[4:7], s76 offen offset:0 sc1
  v_max_f32 v88, 0, v88
  v_max_f32 v89, 0, v89
  v_max_f32 v90, 0, v90
  v_max_f32 v91, 0, v91
  v_max_f32 v92, 0, v92
  v_max_f32 v93, 0, v93
  v_max_f32 v94, 0, v94
  v_max_f32 v95, 0, v95
  v_mul_f32 v88, v88, v104
  v_mul_f32 v89, v89, v105
  v_mul_f32 v90, v90, v106
  v_mul_f32 v91, v91, v107
  v_mul_f32 v92, v92, v108
  v_mul_f32 v93, v93, v109
  v_mul_f32 v94, v94, v110
  v_mul_f32 v95, v95, v111
  v_cvt_pk_bf16_f32 v68, v88, v89
  v_cvt_pk_bf16_f32 v69, v90, v91
  v_cvt_pk_bf16_f32 v70, v92, v93
  v_cvt_pk_bf16_f32 v71, v94, v95
  buffer_store_dwordx4 v[68:71], v12, s[4:7], s76 offen offset:1024 sc1
  s_mov_b32 s88, s78
  s_mov_b32 s55, s74
  s_cmp_lt_u32 s55, s57
  s_cbranch_scc1 L_s4h0_219
  s_waitcnt vmcnt(0)
  s_cmp_eq_u32 s88, 0
  s_cbranch_scc1 L_nofl_266
  s_mov_b64 exec, 1
  buffer_store_dword v10, v9, s[4:7], s88 offen sc1
  s_mov_b64 exec, -1
  s_mov_b32 s88, 0
L_nofl_266:
  s_endpgm
L_hwo_232:
  s_mov_b32 s64, 0x8000
  s_and_b32 s61, s74, 7
  s_lshl_b32 s61, s61, 15
  s_add_u32 s61, s61, 0x5e00000
  s_add_u32 s61, s61, s52
  s_lshl_b32 s62, s58, 12
  s_add_u32 m0, s62, s64
  s_nop 0
  buffer_load_dwordx4 v6, s[4:7], s61 offen offset:0 sc1 lds
  buffer_load_dwordx4 v6, s[4:7], s61 offen offset:1024 sc1 lds
  buffer_load_dwordx4 v6, s[4:7], s61 offen offset:2048 sc1 lds
  buffer_load_dwordx4 v6, s[4:7], s61 offen offset:3072 sc1 lds
  s_add_u32 m0, m0, 0x4000
  s_add_u32 s61, s61, 0x4000
  buffer_load_dwordx4 v6, s[4:7], s61 offen offset:0 sc1 lds
  buffer_load_dwordx4 v6, s[4:7], s61 offen offset:1024 sc1 lds
  buffer_load_dwordx4 v6, s[4:7], s61 offen offset:2048 sc1 lds
  buffer_load_dwordx4 v6, s[4:7], s61 offen offset:3072 sc1 lds
  s_mov_b32 s59, 1
  s_branch L_hwb_233
L_hwo_234:
  s_mov_b32 s64, 0x8000
  s_and_b32 s61, s74, 7
  s_lshl_b32 s61, s61, 15
  s_add_u32 s61, s61, 0x5e00000
  s_add_u32 s61, s61, s52
  s_lshl_b32 s62, s58, 12
  s_add_u32 m0, s62, s64
  s_nop 0
  buffer_load_dwordx4 v6, s[4:7], s61 offen offset:0 sc1 lds
  buffer_load_dwordx4 v6, s[4:7], s61 offen offset:1024 sc1 lds
  buffer_load_dwordx4 v6, s[4:7], s61 offen offset:2048 sc1 lds
  buffer_load_dwordx4 v6, s[4:7], s61 offen offset:3072 sc1 lds
  s_add_u32 m0, m0, 0x4000
  s_add_u32 s61, s61, 0x4000
  buffer_load_dwordx4 v6, s[4:7], s61 offen offset:0 sc1 lds
  buffer_load_dwordx4 v6, s[4:7], s61 offen offset:1024 sc1 lds
  buffer_load_dwordx4 v6, s[4:7], s61 offen offset:2048 sc1 lds
  buffer_load_dwordx4 v6, s[4:7], s61 offen offset:3072 sc1 lds
  s_mov_b32 s59, 1
  s_branch L_hwb_235
L_hwo_236:
  s_mov_b32 s64, 0x8000
  s_and_b32 s61, s74, 7
  s_lshl_b32 s61, s61, 15
  s_add_u32 s61, s61, 0x5e00000
  s_add_u32 s61, s61, s52
  s_lshl_b32 s62, s58, 12
  s_add_u32 m0, s62, s64
  s_nop 0
  buffer_load_dwordx4 v6, s[4:7], s61 offen offset:0 sc1 lds
  buffer_load_dwordx4 v6, s[4:7], s61 offen offset:1024 sc1 lds
  buffer_load_dwordx4 v6, s[4:7], s61 offen offset:2048 sc1 lds
  buffer_load_dwordx4 v6, s[4:7], s61 offen offset:3072 sc1 lds
  s_add_u32 m0, m0, 0x4000
  s_add_u32 s61, s61, 0x4000
  buffer_load_dwordx4 v6, s[4:7], s61 offen offset:0 sc1 lds
  buffer_load_dwordx4 v6, s[4:7], s61 offen offset:1024 sc1 lds
  buffer_load_dwordx4 v6, s[4:7], s61 offen offset:2048 sc1 lds
  buffer_load_dwordx4 v6, s[4:7], s61 offen offset:3072 sc1 lds
  s_mov_b32 s59, 1
  s_branch L_hwb_237
L_hwo_238:
  s_mov_b32 s64, 0x8000
  s_and_b32 s61, s74, 7
  s_lshl_b32 s61, s61, 15
  s_add_u32 s61, s61, 0x5e00000
  s_add_u32 s61, s61, s52
  s_lshl_b32 s62, s58, 12
  s_add_u32 m0, s62, s64
  s_nop 0
  buffer_load_dwordx4 v6, s[4:7], s61 offen offset:0 sc1 lds
  buffer_load_dwordx4 v6, s[4:7], s61 offen offset:1024 sc1 lds
  buffer_load_dwordx4 v6, s[4:7], s61 offen offset:2048 sc1 lds
  buffer_load_dwordx4 v6, s[4:7], s61 offen offset:3072 sc1 lds
  s_add_u32 m0, m0, 0x4000
  s_add_u32 s61, s61, 0x4000
  buffer_load_dwordx4 v6, s[4:7], s61 offen offset:0 sc1 lds
  buffer_load_dwordx4 v6, s[4:7], s61 offen offset:1024 sc1 lds
  buffer_load_dwordx4 v6, s[4:7], s61 offen offset:2048 sc1 lds
  buffer_load_dwordx4 v6, s[4:7], s61 offen offset:3072 sc1 lds
  s_mov_b32 s59, 1
  s_branch L_hwb_239
L_hwo_254:
  s_mov_b32 s64, 0x0
  s_and_b32 s61, s74, 7
  s_lshl_b32 s61, s61, 15
  s_add_u32 s61, s61, 0x5e00000
  s_add_u32 s61, s61, s52
  s_lshl_b32 s62, s58, 12
  s_add_u32 m0, s62, s64
  s_nop 0
  buffer_load_dwordx4 v6, s[4:7], s61 offen offset:0 sc1 lds
  buffer_load_dwordx4 v6, s[4:7], s61 offen offset:1024 sc1 lds
  buffer_load_dwordx4 v6, s[4:7], s61 offen offset:2048 sc1 lds
  buffer_load_dwordx4 v6, s[4:7], s61 offen offset:3072 sc1 lds
  s_add_u32 m0, m0, 0x4000
  s_add_u32 s61, s61, 0x4000
  buffer_load_dwordx4 v6, s[4:7], s61 offen offset:0 sc1 lds
  buffer_load_dwordx4 v6, s[4:7], s61 offen offset:1024 sc1 lds
  buffer_load_dwordx4 v6, s[4:7], s61 offen offset:2048 sc1 lds
  buffer_load_dwordx4 v6, s[4:7], s61 offen offset:3072 sc1 lds
  s_mov_b32 s59, 1
  s_branch L_hwb_255
L_hwo_256:
  s_mov_b32 s64, 0x0
  s_and_b32 s61, s74, 7
  s_lshl_b32 s61, s61, 15
  s_add_u32 s61, s61, 0x5e00000
  s_add_u32 s61, s61, s52
  s_lshl_b32 s62, s58, 12
  s_add_u32 m0, s62, s64
  s_nop 0
  buffer_load_dwordx4 v6, s[4:7], s61 offen offset:0 sc1 lds
  buffer_load_dwordx4 v6, s[4:7], s61 offen offset:1024 sc1 lds
  buffer_load_dwordx4 v6, s[4:7], s61 offen offset:2048 sc1 lds
  buffer_load_dwordx4 v6, s[4:7], s61 offen offset:3072 sc1 lds
  s_add_u32 m0, m0, 0x4000
  s_add_u32 s61, s61, 0x4000
  buffer_load_dwordx4 v6, s[4:7], s61 offen offset:0 sc1 lds
  buffer_load_dwordx4 v6, s[4:7], s61 offen offset:1024 sc1 lds
  buffer_load_dwordx4 v6, s[4:7], s61 offen offset:2048 sc1 lds
  buffer_load_dwordx4 v6, s[4:7], s61 offen offset:3072 sc1 lds
  s_mov_b32 s59, 1
  s_branch L_hwb_257
L_hwo_258:
  s_mov_b32 s64, 0x0
  s_and_b32 s61, s74, 7
  s_lshl_b32 s61, s61, 15
  s_add_u32 s61, s61, 0x5e00000
  s_add_u32 s61, s61, s52
  s_lshl_b32 s62, s58, 12
  s_add_u32 m0, s62, s64
  s_nop 0
  buffer_load_dwordx4 v6, s[4:7], s61 offen offset:0 sc1 lds
  buffer_load_dwordx4 v6, s[4:7], s61 offen offset:1024 sc1 lds
  buffer_load_dwordx4 v6, s[4:7], s61 offen offset:2048 sc1 lds
  buffer_load_dwordx4 v6, s[4:7], s61 offen offset:3072 sc1 lds
  s_add_u32 m0, m0, 0x4000
  s_add_u32 s61, s61, 0x4000
  buffer_load_dwordx4 v6, s[4:7], s61 offen offset:0 sc1 lds
  buffer_load_dwordx4 v6, s[4:7], s61 offen offset:1024 sc1 lds
  buffer_load_dwordx4 v6, s[4:7], s61 offen offset:2048 sc1 lds
  buffer_load_dwordx4 v6, s[4:7], s61 offen offset:3072 sc1 lds
  s_mov_b32 s59, 1
  s_branch L_hwb_259
L_hwo_260:
  s_mov_b32 s64, 0x0
  s_and_b32 s61, s74, 7
  s_lshl_b32 s61, s61, 15
  s_add_u32 s61, s61, 0x5e00000
  s_add_u32 s61, s61, s52
  s_lshl_b32 s62, s58, 12
  s_add_u32 m0, s62, s64
  s_nop 0
  buffer_load_dwordx4 v6, s[4:7], s61 offen offset:0 sc1 lds
  buffer_load_dwordx4 v6, s[4:7], s61 offen offset:1024 sc1 lds
  buffer_load_dwordx4 v6, s[4:7], s61 offen offset:2048 sc1 lds
  buffer_load_dwordx4 v6, s[4:7], s61 offen offset:3072 sc1 lds
  s_add_u32 m0, m0, 0x4000
  s_add_u32 s61, s61, 0x4000
  buffer_load_dwordx4 v6, s[4:7], s61 offen offset:0 sc1 lds
  buffer_load_dwordx4 v6, s[4:7], s61 offen offset:1024 sc1 lds
  buffer_load_dwordx4 v6, s[4:7], s61 offen offset:2048 sc1 lds
  buffer_load_dwordx4 v6, s[4:7], s61 offen offset:3072 sc1 lds
  s_mov_b32 s59, 1
  s_branch L_hwb_261
  s_endpgm
B_s4_f:
  v_mov_b32 v6, 0x0
  v_bfe_i32 v2, v0, 0, 1
  v_and_b32 v2, 0x10, v2
  v_add_u32 v6, v6, v2
  v_bfe_i32 v2, v0, 1, 1
  v_and_b32 v2, 0x20, v2
  v_add_u32 v6, v6, v2
  v_bfe_i32 v2, v0, 2, 1
  v_and_b32 v2, 0x40, v2
  v_add_u32 v6, v6, v2
  v_bfe_i32 v2, v0, 3, 1
  v_and_b32 v2, 0x80, v2
  v_add_u32 v6, v6, v2
  v_bfe_i32 v2, v0, 4, 1
  v_and_b32 v2, 0x100, v2
  v_add_u32 v6, v6, v2
  v_bfe_i32 v2, v0, 5, 1
  v_and_b32 v2, 0x200, v2
  v_add_u32 v6, v6, v2
  v_bfe_i32 v2, v0, 6, 1
  v_and_b32 v2, 0x1000, v2
  v_add_u32 v6, v6, v2
  v_bfe_i32 v2, v0, 7, 1
  v_and_b32 v2, 0x2000, v2
  v_add_u32 v6, v6, v2
  v_mov_b32 v7, 0x0
  v_bfe_i32 v2, v0, 0, 1
  v_and_b32 v2, 0x10, v2
  v_add_u32 v7, v7, v2
  v_bfe_i32 v2, v0, 1, 1
  v_and_b32 v2, 0x20, v2
  v_add_u32 v7, v7, v2
  v_bfe_i32 v2, v0, 2, 1
  v_and_b32 v2, 0x40, v2
  v_add_u32 v7, v7, v2
  v_bfe_i32 v2, v0, 3, 1
  v_and_b32 v2, 0x80, v2
  v_add_u32 v7, v7, v2
  v_bfe_i32 v2, v0, 4, 1
  v_and_b32 v2, 0x100, v2
  v_add_u32 v7, v7, v2
  v_bfe_i32 v2, v0, 5, 1
  v_and_b32 v2, 0x200, v2
  v_add_u32 v7, v7, v2
  v_mov_b32 v8, 0x0
  v_bfe_i32 v2, v0, 0, 1
  v_and_b32 v2, 0x4, v2
  v_add_u32 v8, v8, v2
  v_bfe_i32 v2, v0, 1, 1
  v_and_b32 v2, 0x8, v2
  v_add_u32 v8, v8, v2
  v_bfe_i32 v2, v0, 2, 1
  v_and_b32 v2, 0x10, v2
  v_add_u32 v8, v8, v2
  v_bfe_i32 v2, v0, 3, 1
  v_and_b32 v2, 0x20, v2
  v_add_u32 v8, v8, v2
  v_mov_b32 v9, 0x0
  v_bfe_i32 v2, v0, 6, 1
  v_and_b32 v2, 0x4, v2
  v_add_u32 v9, v9, v2
  v_bfe_i32 v2, v0, 7, 1
  v_and_b32 v2, 0x8, v2
  v_add_u32 v9, v9, v2
  v_mov_b32 v10, 1
  v_mov_b32 v12, 0x0
  v_bfe_i32 v2, v0, 0, 1
  v_and_b32 v2, 0x10, v2
  v_add_u32 v12, v12, v2
  v_bfe_i32 v2, v0, 1, 1
  v_and_b32 v2, 0x20, v2
  v_add_u32 v12, v12, v2
  v_bfe_i32 v2, v0, 2, 1
  v_and_b32 v2, 0x40, v2
  v_add_u32 v12, v12, v2
  v_bfe_i32 v2, v0, 3, 1
  v_and_b32 v2, 0x80, v2
  v_add_u32 v12, v12, v2
  v_bfe_i32 v2, v0, 4, 1
  v_and_b32 v2, 0x100, v2
  v_add_u32 v12, v12, v2
  v_bfe_i32 v2, v0, 5, 1
  v_and_b32 v2, 0x200, v2
  v_add_u32 v12, v12, v2
  v_bfe_i32 v2, v0, 6, 1
  v_and_b32 v2, 0x800, v2
  v_add_u32 v12, v12, v2
  v_bfe_i32 v2, v0, 7, 1
  v_and_b32 v2, 0x1000, v2
  v_add_u32 v12, v12, v2
  s_mov_b32 s8, s40
  s_and_b32 s9, s41, 0xffff
  s_mov_b32 s10, 0x1c0000
  s_mov_b32 s11, 0x20000
  s_mov_b32 s12, s42
  s_and_b32 s13, s43, 0xffff
  s_mov_b32 s14, 0x1c0000
  s_mov_b32 s15, 0x20000
  v_mov_b32 v3, 0x0
  v_bfe_i32 v2, v0, 0, 1
  v_and_b32 v2, 0x10, v2
  v_xor_b32 v3, v3, v2
  v_bfe_i32 v2, v0, 1, 1
  v_and_b32 v2, 0x20, v2
  v_xor_b32 v3, v3, v2
  v_bfe_i32 v2, v0, 2, 1
  v_and_b32 v2, 0x40, v2
  v_xor_b32 v3, v3, v2
  v_bfe_i32 v2, v0, 3, 1
  v_and_b32 v2, 0x80, v2
  v_xor_b32 v3, v3, v2
  v_bfe_i32 v2, v0, 4, 1
  v_and_b32 v2, 0x40, v2
  v_xor_b32 v3, v3, v2
  v_bfe_i32 v2, v0, 5, 1
  v_and_b32 v2, 0x80, v2
  v_xor_b32 v3, v3, v2
  v_mov_b32 v5, 0x0
  v_bfe_i32 v2, v0, 4, 1
  v_and_b32 v2, 0xe00, v2
  v_add_u32 v5, v5, v2
  v_bfe_i32 v2, v0, 5, 1
  v_and_b32 v2, 0x1c00, v2
  v_add_u32 v5, v5, v2
  v_add_u32 v3, v3, v5
  v_mov_b32 v4, 0x0
  v_bfe_i32 v2, v0, 0, 1
  v_and_b32 v2, 0x8, v2
  v_xor_b32 v4, v4, v2
  v_bfe_i32 v2, v0, 1, 1
  v_and_b32 v2, 0x10, v2
  v_xor_b32 v4, v4, v2
  v_bfe_i32 v2, v0, 2, 1
  v_and_b32 v2, 0x140, v2
  v_xor_b32 v4, v4, v2
  v_bfe_i32 v2, v0, 3, 1
  v_and_b32 v2, 0x280, v2
  v_xor_b32 v4, v4, v2
  v_bfe_i32 v2, v0, 4, 1
  v_and_b32 v2, 0x20, v2
  v_xor_b32 v4, v4, v2
  v_bfe_i32 v2, v0, 5, 1
  v_and_b32 v2, 0x800, v2
  v_xor_b32 v4, v4, v2
  v_bfe_i32 v2, v0, 6, 1
  v_and_b32 v2, 0x40, v2
  v_xor_b32 v4, v4, v2
  v_bfe_i32 v2, v0, 7, 1
  v_and_b32 v2, 0x80, v2
  v_xor_b32 v4, v4, v2
  v_add_u32 v5, 0x10000, v4
  s_lshl_b32 s76, s54, 8
  s_barrier
  s_mul_i32 s61, s58, 458752
  s_add_u32 s61, s61, s76
  s_add_u32 s61, s61, 0
  s_mul_i32 s62, s58, 32768
  s_mov_b32 s63, 0
L_wdma_267:
  s_mov_b32 m0, s62
  s_add_u32 s62, s62, 1024
  buffer_load_dwordx4 v3, s[8:11], s61 offen lds
  s_add_u32 s61, s61, 14336
  s_add_u32 s63, s63, 1
  s_cmp_lt_u32 s63, 32
  s_cbranch_scc1 L_wdma_267
  s_waitcnt vmcnt(0)
  s_barrier
  ds_read_b64_tr_b16 a[0:1], v4 offset:0
  ds_read_b64_tr_b16 a[2:3], v4 offset:1024
  ds_read_b64_tr_b16 a[4:5], v4 offset:4096
  ds_read_b64_tr_b16 a[6:7], v4 offset:5120
  ds_read_b64_tr_b16 a[8:9], v4 offset:8192
  ds_read_b64_tr_b16 a[10:11], v4 offset:9216
  ds_read_b64_tr_b16 a[12:13], v4 offset:12288
  ds_read_b64_tr_b16 a[14:15], v4 offset:13312
  s_waitcnt lgkmcnt(0)
  ds_read_b64_tr_b16 a[16:17], v4 offset:16384
  ds_read_b64_tr_b16 a[18:19], v4 offset:17408
  ds_read_b64_tr_b16 a[20:21], v4 offset:20480
  ds_read_b64_tr_b16 a[22:23], v4 offset:21504
  ds_read_b64_tr_b16 a[24:25], v4 offset:24576
  ds_read_b64_tr_b16 a[26:27], v4 offset:25600
  ds_read_b64_tr_b16 a[28:29], v4 offset:28672
  ds_read_b64_tr_b16 a[30:31], v4 offset:29696
  s_waitcnt lgkmcnt(0)
  ds_read_b64_tr_b16 a[32:33], v4 offset:32768
  ds_read_b64_tr_b16 a[34:35], v4 offset:33792
  ds_read_b64_tr_b16 a[36:37], v4 offset:36864
  ds_read_b64_tr_b16 a[38:39], v4 offset:37888
  ds_read_b64_tr_b16 a[40:41], v4 offset:40960
  ds_read_b64_tr_b16 a[42:43], v4 offset:41984
  ds_read_b64_tr_b16 a[44:45], v4 offset:45056
  ds_read_b64_tr_b16 a[46:47], v4 offset:46080
  s_waitcnt lgkmcnt(0)
  ds_read_b64_tr_b16 a[48:49], v4 offset:49152
  ds_read_b64_tr_b16 a[50:51], v4 offset:50176
  ds_read_b64_tr_b16 a[52:53], v4 offset:53248
  ds_read_b64_tr_b16 a[54:55], v4 offset:54272
  ds_read_b64_tr_b16 a[56:57], v4 offset:57344
  ds_read_b64_tr_b16 a[58:59], v4 offset:58368
  ds_read_b64_tr_b16 a[60:61], v4 offset:61440
  ds_read_b64_tr_b16 a[62:63], v4 offset:62464
  s_waitcnt lgkmcnt(0)
  ds_read_b64_tr_b16 a[64:65], v5 offset:0
  ds_read_b64_tr_b16 a[66:67], v5 offset:1024
  ds_read_b64_tr_b16 a[68:69], v5 offset:4096
  ds_read_b64_tr_b16 a[70:71], v5 offset:5120
  ds_read_b64_tr_b16 a[72:73], v5 offset:8192
  ds_read_b64_tr_b16 a[74:75], v5 offset:9216
  ds_read_b64_tr_b16 a[76:77], v5 offset:12288
  ds_read_b64_tr_b16 a[78:79], v5 offset:13312
  s_waitcnt lgkmcnt(0)
  ds_read_b64_tr_b16 a[80:81], v5 offset:16384
  ds_read_b64_tr_b16 a[82:83], v5 offset:17408
  ds_read_b64_tr_b16 a[84:85], v5 offset:20480
  ds_read_b64_tr_b16 a[86:87], v5 offset:21504
  ds_read_b64_tr_b16 a[88:89], v5 offset:24576
  ds_read_b64_tr_b16 a[90:91], v5 offset:25600
  ds_read_b64_tr_b16 a[92:93], v5 offset:28672
  ds_read_b64_tr_b16 a[94:95], v5 offset:29696
  s_waitcnt lgkmcnt(0)
  ds_read_b64_tr_b16 a[96:97], v5 offset:32768
  ds_read_b64_tr_b16 a[98:99], v5 offset:33792
  ds_read_b64_tr_b16 a[100:101], v5 offset:36864
  ds_read_b64_tr_b16 a[102:103], v5 offset:37888
  ds_read_b64_tr_b16 a[104:105], v5 offset:40960
  ds_read_b64_tr_b16 a[106:107], v5 offset:41984
  ds_read_b64_tr_b16 a[108:109], v5 offset:45056
  ds_read_b64_tr_b16 a[110:111], v5 offset:46080
  s_waitcnt lgkmcnt(0)
  ds_read_b64_tr_b16 a[112:113], v5 offset:49152
  ds_read_b64_tr_b16 a[114:115], v5 offset:50176
  ds_read_b64_tr_b16 a[116:117], v5 offset:53248
  ds_read_b64_tr_b16 a[118:119], v5 offset:54272
  ds_read_b64_tr_b16 a[120:121], v5 offset:57344
  ds_read_b64_tr_b16 a[122:123], v5 offset:58368
  ds_read_b64_tr_b16 a[124:125], v5 offset:61440
  ds_read_b64_tr_b16 a[126:127], v5 offset:62464
  s_waitcnt lgkmcnt(0)
  s_waitcnt lgkmcnt(0)
  s_barrier
  s_mul_i32 s61, s58, 458752
  s_add_u32 s61, s61, s76
  s_add_u32 s61, s61, 0
  s_mul_i32 s62, s58, 32768
  s_mov_b32 s63, 0
L_wdma_268:
  s_mov_b32 m0, s62
  s_add_u32 s62, s62, 1024
  buffer_load_dwordx4 v3, s[12:15], s61 offen lds
  s_add_u32 s61, s61, 14336
  s_add_u32 s63, s63, 1
  s_cmp_lt_u32 s63, 32
  s_cbranch_scc1 L_wdma_268
  s_waitcnt vmcnt(0)
  s_barrier
  ds_read_b64_tr_b16 a[128:129], v4 offset:0
  ds_read_b64_tr_b16 a[130:131], v4 offset:1024
  ds_read_b64_tr_b16 a[132:133], v4 offset:4096
  ds_read_b64_tr_b16 a[134:135], v4 offset:5120
  ds_read_b64_tr_b16 a[136:137], v4 offset:8192
  ds_read_b64_tr_b16 a[138:139], v4 offset:9216
  ds_read_b64_tr_b16 a[140:141], v4 offset:12288
  ds_read_b64_tr_b16 a[142:143], v4 offset:13312
  s_waitcnt lgkmcnt(0)
  ds_read_b64_tr_b16 a[144:145], v4 offset:16384
  ds_read_b64_tr_b16 a[146:147], v4 offset:17408
  ds_read_b64_tr_b16 a[148:149], v4 offset:20480
  ds_read_b64_tr_b16 a[150:151], v4 offset:21504
  ds_read_b64_tr_b16 a[152:153], v4 offset:24576
  ds_read_b64_tr_b16 a[154:155], v4 offset:25600
  ds_read_b64_tr_b16 a[156:157], v4 offset:28672
  ds_read_b64_tr_b16 a[158:159], v4 offset:29696
  s_waitcnt lgkmcnt(0)
  ds_read_b64_tr_b16 a[160:161], v4 offset:32768
  ds_read_b64_tr_b16 a[162:163], v4 offset:33792
  ds_read_b64_tr_b16 a[164:165], v4 offset:36864
  ds_read_b64_tr_b16 a[166:167], v4 offset:37888
  ds_read_b64_tr_b16 a[168:169], v4 offset:40960
  ds_read_b64_tr_b16 a[170:171], v4 offset:41984
  ds_read_b64_tr_b16 a[172:173], v4 offset:45056
  ds_read_b64_tr_b16 a[174:175], v4 offset:46080
  s_waitcnt lgkmcnt(0)
  ds_read_b64_tr_b16 a[176:177], v4 offset:49152
  ds_read_b64_tr_b16 a[178:179], v4 offset:50176
  ds_read_b64_tr_b16 a[180:181], v4 offset:53248
  ds_read_b64_tr_b16 a[182:183], v4 offset:54272
  ds_read_b64_tr_b16 a[184:185], v4 offset:57344
  ds_read_b64_tr_b16 a[186:187], v4 offset:58368
  ds_read_b64_tr_b16 a[188:189], v4 offset:61440
  ds_read_b64_tr_b16 a[190:191], v4 offset:62464
  s_waitcnt lgkmcnt(0)
  ds_read_b64_tr_b16 a[192:193], v5 offset:0
  ds_read_b64_tr_b16 a[194:195], v5 offset:1024
  ds_read_b64_tr_b16 a[196:197], v5 offset:4096
  ds_read_b64_tr_b16 a[198:199], v5 offset:5120
  ds_read_b64_tr_b16 a[200:201], v5 offset:8192
  ds_read_b64_tr_b16 a[202:203], v5 offset:9216
  ds_read_b64_tr_b16 a[204:205], v5 offset:12288
  ds_read_b64_tr_b16 a[206:207], v5 offset:13312
  s_waitcnt lgkmcnt(0)
  ds_read_b64_tr_b16 a[208:209], v5 offset:16384
  ds_read_b64_tr_b16 a[210:211], v5 offset:17408
  ds_read_b64_tr_b16 a[212:213], v5 offset:20480
  ds_read_b64_tr_b16 a[214:215], v5 offset:21504
  ds_read_b64_tr_b16 a[216:217], v5 offset:24576
  ds_read_b64_tr_b16 a[218:219], v5 offset:25600
  ds_read_b64_tr_b16 a[220:221], v5 offset:28672
  ds_read_b64_tr_b16 a[222:223], v5 offset:29696
  s_waitcnt lgkmcnt(0)
  ds_read_b64_tr_b16 a[224:225], v5 offset:32768
  ds_read_b64_tr_b16 a[226:227], v5 offset:33792
  ds_read_b64_tr_b16 a[228:229], v5 offset:36864
  ds_read_b64_tr_b16 a[230:231], v5 offset:37888
  ds_read_b64_tr_b16 a[232:233], v5 offset:40960
  ds_read_b64_tr_b16 a[234:235], v5 offset:41984
  ds_read_b64_tr_b16 a[236:237], v5 offset:45056
  ds_read_b64_tr_b16 a[238:239], v5 offset:46080
  s_waitcnt lgkmcnt(0)
  ds_read_b64_tr_b16 a[240:241], v5 offset:49152
  ds_read_b64_tr_b16 a[242:243], v5 offset:50176
  ds_read_b64_tr_b16 a[244:245], v5 offset:53248
  ds_read_b64_tr_b16 a[246:247], v5 offset:54272
  ds_read_b64_tr_b16 a[248:249], v5 offset:57344
  ds_read_b64_tr_b16 a[250:251], v5 offset:58368
  ds_read_b64_tr_b16 a[252:253], v5 offset:61440
  ds_read_b64_tr_b16 a[254:255], v5 offset:62464
  s_waitcnt lgkmcnt(0)
  s_waitcnt lgkmcnt(0)
  s_barrier
  s_mov_b32 s20, s50
  s_and_b32 s21, s51, 0xffff
  s_mov_b32 s22, 0x0
  s_mov_b32 s23, 0x20000
  s_mov_b32 s8, s48
  s_and_b32 s9, s49, 0xffff
  s_mov_b32 s10, 0x100
  s_mov_b32 s11, 0x20000
  v_and_b32 v2, 3, v0
  v_lshlrev_b32 v2, 6, v2
L_gate_269:
  buffer_load_dword v11, v2, s[8:11], 0 offen offset:8 sc1
  s_waitcnt vmcnt(0)
  v_cmp_gt_u32 vcc, 48, v11
  s_cbranch_vccz L_gateok_270
  s_add_u32 s72, s72, 1
  s_cmp_gt_u32 s72, 0x80000
  s_cbranch_scc1 L_exit
  s_sleep 2
  s_branch L_gate_269
L_gateok_270:
  s_mov_b32 s59, 0
  s_mov_b32 s88, 0
  s_mov_b32 s60, 0
  s_lshl_b32 s61, s54, 13
  s_add_u32 s61, s61, 0x4800000
  s_add_u32 s61, s61, s52
  buffer_load_dwordx4 v[64:67], v12, s[4:7], s61 offen offset:0 sc1
  buffer_load_dwordx4 v[64:67], v12, s[4:7], s61 offen offset:1024 sc1
  s_add_u32 s61, s61, 0x1c000
  buffer_load_dwordx4 v[64:67], v12, s[4:7], s61 offen offset:0 sc1
  buffer_load_dwordx4 v[64:67], v12, s[4:7], s61 offen offset:1024 sc1
  s_add_u32 s61, s61, 0x1c000
  buffer_load_dwordx4 v[64:67], v12, s[4:7], s61 offen offset:0 sc1
  buffer_load_dwordx4 v[64:67], v12, s[4:7], s61 offen offset:1024 sc1
  s_add_u32 s61, s61, 0x1c000
  buffer_load_dwordx4 v[64:67], v12, s[4:7], s61 offen offset:0 sc1
  buffer_load_dwordx4 v[64:67], v12, s[4:7], s61 offen offset:1024 sc1
  s_add_u32 s61, s61, 0x1c000
  buffer_load_dwordx4 v[64:67], v12, s[4:7], s61 offen offset:0 sc1
  buffer_load_dwordx4 v[64:67], v12, s[4:7], s61 offen offset:1024 sc1
  s_add_u32 s61, s61, 0x1c000
  buffer_load_dwordx4 v[64:67], v12, s[4:7], s61 offen offset:0 sc1
  buffer_load_dwordx4 v[64:67], v12, s[4:7], s61 offen offset:1024 sc1
  s_add_u32 s61, s61, 0x1c000
  buffer_load_dwordx4 v[64:67], v12, s[4:7], s61 offen offset:0 sc1
  buffer_load_dwordx4 v[64:67], v12, s[4:7], s61 offen offset:1024 sc1
  s_add_u32 s61, s61, 0x1c000
  buffer_load_dwordx4 v[64:67], v12, s[4:7], s61 offen offset:0 sc1
  buffer_load_dwordx4 v[64:67], v12, s[4:7], s61 offen offset:1024 sc1
  s_add_u32 s61, s61, 0x1c000
  v_mov_b32 v113, 0
  v_add_u32 v112, 0x8000, v7
  s_mov_b32 s60, 0
L_s4h0_271:
  s_cmp_eq_u32 s60, 1
  s_cbranch_scc1 L_hp_275
  s_lshl_b32 s63, s55, 6
  s_add_u32 s63, s63, 0x1c000
  s_add_u32 s63, s63, s53
  s_and_b32 s61, s55, 7
  s_lshl_b32 s61, s61, 15
  s_add_u32 s61, s61, 0x5e00000
  s_add_u32 s61, s61, s52
  s_lshl_b32 s62, s58, 12
  s_add_u32 m0, s62, 0x0
L_poll_277:
  buffer_load_dword v11, v8, s[4:7], s63 offen sc1
  s_waitcnt vmcnt(0)
  s_cmp_eq_u32 s88, 0
  s_cbranch_scc1 L_nofl_279
  s_mov_b64 exec, 1
  buffer_store_dword v10, v9, s[4:7], s88 offen
  s_mov_b64 exec, -1
  s_mov_b32 s88, 0
L_nofl_279:
  v_cmp_eq_u32 vcc, 0, v11
  s_cbranch_vccz L_pollok_278
  s_add_u32 s72, s72, 1
  s_cmp_gt_u32 s72, 0x80000
  s_cbranch_scc1 L_exit
  s_branch L_poll_277
L_pollok_278:
  buffer_load_dwordx4 v6, s[4:7], s61 offen offset:0 sc1 lds
  buffer_load_dwordx4 v6, s[4:7], s61 offen offset:1024 sc1 lds
  buffer_load_dwordx4 v6, s[4:7], s61 offen offset:2048 sc1 lds
  buffer_load_dwordx4 v6, s[4:7], s61 offen offset:3072 sc1 lds
  s_add_u32 m0, m0, 0x4000
  s_add_u32 s61, s61, 0x4000
  buffer_load_dwordx4 v6, s[4:7], s61 offen offset:0 sc1 lds
  buffer_load_dwordx4 v6, s[4:7], s61 offen offset:1024 sc1 lds
  buffer_load_dwordx4 v6, s[4:7], s61 offen offset:2048 sc1 lds
  buffer_load_dwordx4 v6, s[4:7], s61 offen offset:3072 sc1 lds
  s_waitcnt vmcnt(4)
  s_branch L_hj_276
L_hp_275:
  s_waitcnt vmcnt(2)
L_hj_276:
  s_barrier
  ds_read_b128 v[16:19], v7 offset:0
  ds_read_b128 v[20:23], v7 offset:1024
  ds_read_b128 v[24:27], v7 offset:2048
L_s4b0_273:
  s_add_u32 s74, s55, s56
  s_min_u32 s64, s74, 63
  s_lshl_b32 s96, s64, 6
  s_add_u32 s96, s96, 0x1c000
  s_add_u32 s96, s96, s53
  s_mov_b32 s59, 0
  s_mov_b32 s80, 0
  ds_read_b128 v[28:31], v7 offset:3072
  s_waitcnt lgkmcnt(3)
  v_mfma_f32_32x32x16_bf16 v[32:47], a[0:3], v[16:19], 0
  buffer_load_dword v11, v8, s[4:7], s96 offen sc1
  v_mfma_f32_32x32x16_bf16 v[48:63], a[128:131], v[16:19], 0
  ds_read_b128 v[16:19], v7 offset:4096
  s_waitcnt lgkmcnt(3)
  v_mfma_f32_32x32x16_bf16 v[32:47], a[4:7], v[20:23], v[32:47]
  v_mfma_f32_32x32x16_bf16 v[48:63], a[132:135], v[20:23], v[48:63]
  ds_read_b128 v[20:23], v7 offset:5120
  s_waitcnt lgkmcnt(3)
  v_mfma_f32_32x32x16_bf16 v[32:47], a[8:11], v[24:27], v[32:47]
  v_mfma_f32_32x32x16_bf16 v[48:63], a[136:139], v[24:27], v[48:63]
  ds_read_b128 v[24:27], v7 offset:6144
  s_waitcnt lgkmcnt(3)
  v_mfma_f32_32x32x16_bf16 v[32:47], a[12:15], v[28:31], v[32:47]
  v_mfma_f32_32x32x16_bf16 v[48:63], a[140:143], v[28:31], v[48:63]
  ds_read_b128 v[28:31], v7 offset:7168
  s_waitcnt lgkmcnt(3)
  v_mfma_f32_32x32x16_bf16 v[32:47], a[16:19], v[16:19], v[32:47]
  v_mfma_f32_32x32x16_bf16 v[48:63], a[144:147], v[16:19], v[48:63]
  s_cmp_lg_u32 s60, 1
  s_cbranch_scc1 L_hfa_280
  s_waitcnt vmcnt(1)
  s_mov_b64 exec, 1
  buffer_store_dword v10, v9, s[4:7], s88 offen
  s_mov_b64 exec, -1
  s_mov_b32 s88, 0
L_hfa_280:
  ds_read_b128 v[16:19], v7 offset:8192
  s_waitcnt lgkmcnt(3)
  v_mfma_f32_32x32x16_bf16 v[32:47], a[20:23], v[20:23], v[32:47]
  v_mfma_f32_32x32x16_bf16 v[48:63], a[148:151], v[20:23], v[48:63]
  ds_read_b128 v[20:23], v7 offset:9216
  s_waitcnt lgkmcnt(3)
  v_mfma_f32_32x32x16_bf16 v[32:47], a[24:27], v[24:27], v[32:47]
  v_mfma_f32_32x32x16_bf16 v[48:63], a[152:155], v[24:27], v[48:63]
  ds_read_b128 v[24:27], v7 offset:10240
  s_waitcnt lgkmcnt(3)
  v_mfma_f32_32x32x16_bf16 v[32:47], a[28:31], v[28:31], v[32:47]
  v_mfma_f32_32x32x16_bf16 v[48:63], a[156:159], v[28:31], v[48:63]
  ds_read_b128 v[28:31], v7 offset:11264
  s_waitcnt lgkmcnt(3)
  v_mfma_f32_32x32x16_bf16 v[32:47], a[32:35], v[16:19], v[32:47]
  v_mfma_f32_32x32x16_bf16 v[48:63], a[160:163], v[16:19], v[48:63]
  ds_read_b128 v[16:19], v7 offset:12288
  s_waitcnt lgkmcnt(3)
  v_mfma_f32_32x32x16_bf16 v[32:47], a[36:39], v[20:23], v[32:47]
  v_mfma_f32_32x32x16_bf16 v[48:63], a[164:167], v[20:23], v[48:63]
  ds_read_b128 v[20:23], v7 offset:13312
  s_waitcnt lgkmcnt(3)
  v_mfma_f32_32x32x16_bf16 v[32:47], a[40:43], v[24:27], v[32:47]
  v_mfma_f32_32x32x16_bf16 v[48:63], a[168:171], v[24:27], v[48:63]
  ds_read_b128 v[24:27], v7 offset:14336
  s_waitcnt lgkmcnt(3)
  v_mfma_f32_32x32x16_bf16 v[32:47], a[44:47], v[28:31], v[32:47]
  v_mfma_f32_32x32x16_bf16 v[48:63], a[172:175], v[28:31], v[48:63]
  ds_read_b128 v[28:31], v7 offset:15360
  s_waitcnt lgkmcnt(3)
  v_mfma_f32_32x32x16_bf16 v[32:47], a[48:51], v[16:19], v[32:47]
  v_mfma_f32_32x32x16_bf16 v[48:63], a[176:179], v[16:19], v[48:63]
  s_cmp_eq_u32 s60, 2
  s_cbranch_scc1 L_h1b_282
  s_cmp_eq_u32 s60, 1
  s_cbranch_scc1 L_h1a_281
  s_waitcnt vmcnt(0)
L_h1a_281:
  s_waitcnt vmcnt(1)
L_h1b_282:
  s_waitcnt vmcnt(2)
  v_cmp_eq_u32 vcc, 0, v11
  s_cmp_lt_u32 s74, s57
  s_cselect_b64 s[70:71], vcc, -1
  s_cmp_eq_u64 s[70:71], 0
  s_cselect_b32 s89, s58, 7
L_h1c_283:
  s_barrier
  ds_read_b128 v[16:19], v7 offset:16384
  s_waitcnt lgkmcnt(3)
  v_mfma_f32_32x32x16_bf16 v[32:47], a[52:55], v[20:23], v[32:47]
  v_mfma_f32_32x32x16_bf16 v[48:63], a[180:183], v[20:23], v[48:63]
  s_cmp_eq_u32 s89, 0
  s_cbranch_scc1 L_hwo_284
L_hwb_285:
  ds_read_b128 v[20:23], v7 offset:17408
  s_waitcnt lgkmcnt(3)
  v_mfma_f32_32x32x16_bf16 v[32:47], a[56:59], v[24:27], v[32:47]
  v_mfma_f32_32x32x16_bf16 v[48:63], a[184:187], v[24:27], v[48:63]
  ds_read_b128 v[24:27], v7 offset:18432
  s_waitcnt lgkmcnt(3)
  v_mfma_f32_32x32x16_bf16 v[32:47], a[60:63], v[28:31], v[32:47]
  v_mfma_f32_32x32x16_bf16 v[48:63], a[188:191], v[28:31], v[48:63]
  s_cmp_eq_u32 s89, 1
  s_cbranch_scc1 L_hwo_286
L_hwb_287:
  ds_read_b128 v[28:31], v7 offset:19456
  s_waitcnt lgkmcnt(3)
  v_mfma_f32_32x32x16_bf16 v[32:47], a[64:67], v[16:19], v[32:47]
  v_mfma_f32_32x32x16_bf16 v[48:63], a[192:195], v[16:19], v[48:63]
  ds_read_b128 v[16:19], v7 offset:20480
  s_waitcnt lgkmcnt(3)
  v_mfma_f32_32x32x16_bf16 v[32:47], a[68:71], v[20:23], v[32:47]
  v_mfma_f32_32x32x16_bf16 v[48:63], a[196:199], v[20:23], v[48:63]
  s_cmp_eq_u32 s89, 2
  s_cbranch_scc1 L_hwo_288
L_hwb_289:
  ds_read_b128 v[20:23], v7 offset:21504
  s_waitcnt lgkmcnt(3)
  v_mfma_f32_32x32x16_bf16 v[32:47], a[72:75], v[24:27], v[32:47]
  v_mfma_f32_32x32x16_bf16 v[48:63], a[200:203], v[24:27], v[48:63]
  ds_read_b128 v[24:27], v7 offset:22528
  s_waitcnt lgkmcnt(3)
  v_mfma_f32_32x32x16_bf16 v[32:47], a[76:79], v[28:31], v[32:47]
  v_mfma_f32_32x32x16_bf16 v[48:63], a[204:207], v[28:31], v[48:63]
  s_cmp_eq_u32 s89, 3
  s_cbranch_scc1 L_hwo_290
L_hwb_291:
  ds_read_b128 v[28:31], v7 offset:23552
  s_waitcnt lgkmcnt(3)
  v_mfma_f32_32x32x16_bf16 v[32:47], a[80:83], v[16:19], v[32:47]
  v_mfma_f32_32x32x16_bf16 v[48:63], a[208:211], v[16:19], v[48:63]
  ds_read_b128 v[16:19], v7 offset:24576
  s_waitcnt lgkmcnt(3)
  v_mfma_f32_32x32x16_bf16 v[32:47], a[84:87], v[20:23], v[32:47]
  v_mfma_f32_32x32x16_bf16 v[48:63], a[212:215], v[20:23], v[48:63]
  ds_read_b128 v[20:23], v7 offset:25600
  s_waitcnt lgkmcnt(3)
  v_mfma_f32_32x32x16_bf16 v[32:47], a[88:91], v[24:27], v[32:47]
  v_mfma_f32_32x32x16_bf16 v[48:63], a[216:219], v[24:27], v[48:63]
  ds_read_b128 v[24:27], v7 offset:26624
  s_waitcnt lgkmcnt(3)
  v_mfma_f32_32x32x16_bf16 v[32:47], a[92:95], v[28:31], v[32:47]
  v_mfma_f32_32x32x16_bf16 v[48:63], a[220:223], v[28:31], v[48:63]
  ds_read_b128 v[28:31], v7 offset:27648
  s_waitcnt lgkmcnt(3)
  v_mfma_f32_32x32x16_bf16 v[32:47], a[96:99], v[16:19], v[32:47]
  v_mfma_f32_32x32x16_bf16 v[48:63], a[224:227], v[16:19], v[48:63]
  ds_read_b128 v[16:19], v7 offset:28672
  s_waitcnt lgkmcnt(3)
  v_mfma_f32_32x32x16_bf16 v[32:47], a[100:103], v[20:23], v[32:47]
  v_mfma_f32_32x32x16_bf16 v[48:63], a[228:231], v[20:23], v[48:63]
  s_cmp_lg_u32 s89, 7
  s_cbranch_scc1 L_hre_292
  buffer_load_dword v11, v8, s[4:7], s96 offen sc1
L_hre_292:
  ds_read_b128 v[20:23], v7 offset:29696
  s_waitcnt lgkmcnt(3)
  v_mfma_f32_32x32x16_bf16 v[32:47], a[104:107], v[24:27], v[32:47]
  v_mfma_f32_32x32x16_bf16 v[48:63], a[232:235], v[24:27], v[48:63]
  ds_read_b128 v[24:27], v7 offset:30720
  s_waitcnt lgkmcnt(3)
  v_mfma_f32_32x32x16_bf16 v[32:47], a[108:111], v[28:31], v[32:47]
  v_mfma_f32_32x32x16_bf16 v[48:63], a[236:239], v[28:31], v[48:63]
  ds_read_b128 v[28:31], v7 offset:31744
  s_waitcnt lgkmcnt(3)
  v_mfma_f32_32x32x16_bf16 v[32:47], a[112:115], v[16:19], v[32:47]
  s_and_b32 s76, s55, 7
  s_mul_i32 s76, s76, 114688
  s_lshl_b32 s77, s54, 13
  s_add_u32 s76, s76, s77
  v_mfma_f32_32x32x16_bf16 v[48:63], a[240:243], v[16:19], v[48:63]
  s_waitcnt lgkmcnt(2)
  v_mfma_f32_32x32x16_bf16 v[32:47], a[116:119], v[20:23], v[32:47]
  s_add_u32 s76, s76, s52
  s_add_u32 s76, s76, 0x4800000
  s_lshl_b32 s78, s55, 8
  s_lshl_b32 s79, s54, 4
  v_mfma_f32_32x32x16_bf16 v[48:63], a[244:247], v[20:23], v[48:63]
  s_waitcnt lgkmcnt(1)
  v_mfma_f32_32x32x16_bf16 v[32:47], a[120:123], v[24:27], v[32:47]
  s_add_u32 s78, s78, s79
  s_add_u32 s78, s78, 0x1d000
  s_add_u32 s78, s78, s53
  v_mfma_f32_32x32x16_bf16 v[48:63], a[248:251], v[24:27], v[48:63]
  s_waitcnt lgkmcnt(0)
  v_mfma_f32_32x32x16_bf16 v[32:47], a[124:127], v[28:31], v[32:47]
  v_mfma_f32_32x32x16_bf16 v[48:63], a[252:255], v[28:31], v[48:63]
  s_cmp_lg_u32 s59, 1
  s_cbranch_scc1 L_late_293
  s_mov_b32 s60, 1
  s_branch L_nl_295
  s_cmp_eq_u32 s80, 1
  s_cbranch_scc1 L_st1_294
  s_waitcnt vmcnt(0)
L_st1_294:
  s_waitcnt vmcnt(1)
  s_barrier
  ds_read_b128 v[16:19], v112 offset:0
  ds_read_b128 v[20:23], v112 offset:1024
  ds_read_b128 v[24:27], v112 offset:2048
  s_mov_b32 s60, 2
  s_mov_b32 s55, s74
  s_branch L_s4b1_274
L_late_293:
  s_mov_b32 s60, 0
  s_waitcnt vmcnt(0)
  s_cmp_ge_u32 s74, s57
  s_cbranch_scc1 L_nl_295
  v_cmp_eq_u32 vcc, 0, v11
  s_cbranch_vccnz L_nl_295
  s_mov_b32 s64, 0x8000
  s_and_b32 s61, s74, 7
  s_lshl_b32 s61, s61, 15
  s_add_u32 s61, s61, 0x5e00000
  s_add_u32 s61, s61, s52
  s_lshl_b32 s62, s58, 12
  s_add_u32 m0, s62, s64
  s_nop 0
  buffer_load_dwordx4 v6, s[4:7], s61 offen offset:0 sc1 lds
  buffer_load_dwordx4 v6, s[4:7], s61 offen offset:1024 sc1 lds
  buffer_load_dwordx4 v6, s[4:7], s61 offen offset:2048 sc1 lds
  buffer_load_dwordx4 v6, s[4:7], s61 offen offset:3072 sc1 lds
  s_add_u32 m0, m0, 0x4000
  s_add_u32 s61, s61, 0x4000
  buffer_load_dwordx4 v6, s[4:7], s61 offen offset:0 sc1 lds
  buffer_load_dwordx4 v6, s[4:7], s61 offen offset:1024 sc1 lds
  buffer_load_dwordx4 v6, s[4:7], s61 offen offset:2048 sc1 lds
  buffer_load_dwordx4 v6, s[4:7], s61 offen offset:3072 sc1 lds
  s_mov_b32 s60, 1
L_nl_295:
  s_nop 7
  v_max_f32 v32, 0, v32
  v_max_f32 v33, 0, v33
  v_max_f32 v34, 0, v34
  v_max_f32 v35, 0, v35
  v_max_f32 v36, 0, v36
  v_max_f32 v37, 0, v37
  v_max_f32 v38, 0, v38
  v_max_f32 v39, 0, v39
  v_mul_f32 v32, v32, v48
  v_mul_f32 v33, v33, v49
  v_mul_f32 v34, v34, v50
  v_mul_f32 v35, v35, v51
  v_mul_f32 v36, v36, v52
  v_mul_f32 v37, v37, v53
  v_mul_f32 v38, v38, v54
  v_mul_f32_e64 v39, v39, v55
  v_cvt_pk_bf16_f32 v64, v32, v33
  v_cvt_pk_bf16_f32 v65, v34, v35
  v_cvt_pk_bf16_f32 v66, v36, v37
  v_cvt_pk_bf16_f32 v67, v38, v39
  buffer_store_dwordx4 v[64:67], v12, s[4:7], s76 offen offset:0
  v_max_f32 v40, 0, v40
  v_max_f32 v41, 0, v41
  v_max_f32 v42, 0, v42
  v_max_f32 v43, 0, v43
  v_max_f32 v44, 0, v44
  v_max_f32 v45, 0, v45
  v_max_f32 v46, 0, v46
  v_max_f32 v47, 0, v47
  v_mul_f32 v40, v40, v56
  v_mul_f32 v41, v41, v57
  v_mul_f32 v42, v42, v58
  v_mul_f32 v43, v43, v59
  v_mul_f32 v44, v44, v60
  v_mul_f32 v45, v45, v61
  v_mul_f32 v46, v46, v62
  v_mul_f32 v47, v47, v63
  v_cvt_pk_bf16_f32 v68, v40, v41
  v_cvt_pk_bf16_f32 v69, v42, v43
  v_cvt_pk_bf16_f32 v70, v44, v45
  v_cvt_pk_bf16_f32 v71, v46, v47
  buffer_store_dwordx4 v[68:71], v12, s[4:7], s76 offen offset:1024
  s_mov_b32 s88, s78
  s_mov_b32 s55, s74
  s_cmp_lt_u32 s55, s57
  s_cbranch_scc1 L_s4h1_272
  s_waitcnt vmcnt(0)
  s_cmp_eq_u32 s88, 0
  s_cbranch_scc1 L_nofl_296
  s_mov_b64 exec, 1
  buffer_store_dword v10, v9, s[4:7], s88 offen
  s_mov_b64 exec, -1
  s_mov_b32 s88, 0
L_nofl_296:
  s_endpgm
L_s4h1_272:
  s_cmp_eq_u32 s60, 1
  s_cbranch_scc1 L_hp_297
  s_lshl_b32 s63, s55, 6
  s_add_u32 s63, s63, 0x1c000
  s_add_u32 s63, s63, s53
  s_and_b32 s61, s55, 7
  s_lshl_b32 s61, s61, 15
  s_add_u32 s61, s61, 0x5e00000
  s_add_u32 s61, s61, s52
  s_lshl_b32 s62, s58, 12
  s_add_u32 m0, s62, 0x8000
L_poll_299:
  buffer_load_dword v11, v8, s[4:7], s63 offen sc1
  s_waitcnt vmcnt(0)
  s_cmp_eq_u32 s88, 0
  s_cbranch_scc1 L_nofl_301
  s_mov_b64 exec, 1
  buffer_store_dword v10, v9, s[4:7], s88 offen
  s_mov_b64 exec, -1
  s_mov_b32 s88, 0
L_nofl_301:
  v_cmp_eq_u32 vcc, 0, v11
  s_cbranch_vccz L_pollok_300
  s_add_u32 s72, s72, 1
  s_cmp_gt_u32 s72, 0x80000
  s_cbranch_scc1 L_exit
  s_branch L_poll_299
L_pollok_300:
  buffer_load_dwordx4 v6, s[4:7], s61 offen offset:0 sc1 lds
  buffer_load_dwordx4 v6, s[4:7], s61 offen offset:1024 sc1 lds
  buffer_load_dwordx4 v6, s[4:7], s61 offen offset:2048 sc1 lds
  buffer_load_dwordx4 v6, s[4:7], s61 offen offset:3072 sc1 lds
  s_add_u32 m0, m0, 0x4000
  s_add_u32 s61, s61, 0x4000
  buffer_load_dwordx4 v6, s[4:7], s61 offen offset:0 sc1 lds
  buffer_load_dwordx4 v6, s[4:7], s61 offen offset:1024 sc1 lds
  buffer_load_dwordx4 v6, s[4:7], s61 offen offset:2048 sc1 lds
  buffer_load_dwordx4 v6, s[4:7], s61 offen offset:3072 sc1 lds
  s_waitcnt vmcnt(4)
  s_branch L_hj_298
L_hp_297:
  s_waitcnt vmcnt(2)
L_hj_298:
  s_barrier
  ds_read_b128 v[16:19], v112 offset:0
  ds_read_b128 v[20:23], v112 offset:1024
  ds_read_b128 v[24:27], v112 offset:2048
L_s4b1_274:
  s_add_u32 s74, s55, s56
  s_min_u32 s64, s74, 63
  s_lshl_b32 s96, s64, 6
  s_add_u32 s96, s96, 0x1c000
  s_add_u32 s96, s96, s53
  s_mov_b32 s59, 0
  s_mov_b32 s80, 0
  ds_read_b128 v[28:31], v112 offset:3072
  s_waitcnt lgkmcnt(3)
  v_mfma_f32_32x32x16_bf16 v[80:95], a[0:3], v[16:19], 0
  buffer_load_dword v11, v8, s[4:7], s96 offen sc1
  v_mfma_f32_32x32x16_bf16 v[96:111], a[128:131], v[16:19], 0
  ds_read_b128 v[16:19], v112 offset:4096
  s_waitcnt lgkmcnt(3)
  v_mfma_f32_32x32x16_bf16 v[80:95], a[4:7], v[20:23], v[80:95]
  v_mfma_f32_32x32x16_bf16 v[96:111], a[132:135], v[20:23], v[96:111]
  ds_read_b128 v[20:23], v112 offset:5120
  s_waitcnt lgkmcnt(3)
  v_mfma_f32_32x32x16_bf16 v[80:95], a[8:11], v[24:27], v[80:95]
  v_mfma_f32_32x32x16_bf16 v[96:111], a[136:139], v[24:27], v[96:111]
  ds_read_b128 v[24:27], v112 offset:6144
  s_waitcnt lgkmcnt(3)
  v_mfma_f32_32x32x16_bf16 v[80:95], a[12:15], v[28:31], v[80:95]
  v_mfma_f32_32x32x16_bf16 v[96:111], a[140:143], v[28:31], v[96:111]
  ds_read_b128 v[28:31], v112 offset:7168
  s_waitcnt lgkmcnt(3)
  v_mfma_f32_32x32x16_bf16 v[80:95], a[16:19], v[16:19], v[80:95]
  v_mfma_f32_32x32x16_bf16 v[96:111], a[144:147], v[16:19], v[96:111]
  s_cmp_lg_u32 s60, 1
  s_cbranch_scc1 L_hfa_302
  s_waitcnt vmcnt(1)
  s_mov_b64 exec, 1
  buffer_store_dword v10, v9, s[4:7], s88 offen
  s_mov_b64 exec, -1
  s_mov_b32 s88, 0
L_hfa_302:
  ds_read_b128 v[16:19], v112 offset:8192
  s_waitcnt lgkmcnt(3)
  v_mfma_f32_32x32x16_bf16 v[80:95], a[20:23], v[20:23], v[80:95]
  v_mfma_f32_32x32x16_bf16 v[96:111], a[148:151], v[20:23], v[96:111]
  ds_read_b128 v[20:23], v112 offset:9216
  s_waitcnt lgkmcnt(3)
  v_mfma_f32_32x32x16_bf16 v[80:95], a[24:27], v[24:27], v[80:95]
  v_mfma_f32_32x32x16_bf16 v[96:111], a[152:155], v[24:27], v[96:111]
  ds_read_b128 v[24:27], v112 offset:10240
  s_waitcnt lgkmcnt(3)
  v_mfma_f32_32x32x16_bf16 v[80:95], a[28:31], v[28:31], v[80:95]
  v_mfma_f32_32x32x16_bf16 v[96:111], a[156:159], v[28:31], v[96:111]
  ds_read_b128 v[28:31], v112 offset:11264
  s_waitcnt lgkmcnt(3)
  v_mfma_f32_32x32x16_bf16 v[80:95], a[32:35], v[16:19], v[80:95]
  v_mfma_f32_32x32x16_bf16 v[96:111], a[160:163], v[16:19], v[96:111]
  ds_read_b128 v[16:19], v112 offset:12288
  s_waitcnt lgkmcnt(3)
  v_mfma_f32_32x32x16_bf16 v[80:95], a[36:39], v[20:23], v[80:95]
  v_mfma_f32_32x32x16_bf16 v[96:111], a[164:167], v[20:23], v[96:111]
  ds_read_b128 v[20:23], v112 offset:13312
  s_waitcnt lgkmcnt(3)
  v_mfma_f32_32x32x16_bf16 v[80:95], a[40:43], v[24:27], v[80:95]
  v_mfma_f32_32x32x16_bf16 v[96:111], a[168:171], v[24:27], v[96:111]
  ds_read_b128 v[24:27], v112 offset:14336
  s_waitcnt lgkmcnt(3)
  v_mfma_f32_32x32x16_bf16 v[80:95], a[44:47], v[28:31], v[80:95]
  v_mfma_f32_32x32x16_bf16 v[96:111], a[172:175], v[28:31], v[96:111]
  ds_read_b128 v[28:31], v112 offset:15360
  s_waitcnt lgkmcnt(3)
  v_mfma_f32_32x32x16_bf16 v[80:95], a[48:51], v[16:19], v[80:95]
  v_mfma_f32_32x32x16_bf16 v[96:111], a[176:179], v[16:19], v[96:111]
  s_cmp_eq_u32 s60, 2
  s_cbranch_scc1 L_h1b_304
  s_cmp_eq_u32 s60, 1
  s_cbranch_scc1 L_h1a_303
  s_waitcnt vmcnt(0)
L_h1a_303:
  s_waitcnt vmcnt(1)
L_h1b_304:
  s_waitcnt vmcnt(2)
  v_cmp_eq_u32 vcc, 0, v11
  s_cmp_lt_u32 s74, s57
  s_cselect_b64 s[70:71], vcc, -1
  s_cmp_eq_u64 s[70:71], 0
  s_cselect_b32 s89, s58, 7
L_h1c_305:
  s_barrier
  ds_read_b128 v[16:19], v112 offset:16384
  s_waitcnt lgkmcnt(3)
  v_mfma_f32_32x32x16_bf16 v[80:95], a[52:55], v[20:23], v[80:95]
  v_mfma_f32_32x32x16_bf16 v[96:111], a[180:183], v[20:23], v[96:111]
  s_cmp_eq_u32 s89, 0
  s_cbranch_scc1 L_hwo_306
L_hwb_307:
  ds_read_b128 v[20:23], v112 offset:17408
  s_waitcnt lgkmcnt(3)
  v_mfma_f32_32x32x16_bf16 v[80:95], a[56:59], v[24:27], v[80:95]
  v_mfma_f32_32x32x16_bf16 v[96:111], a[184:187], v[24:27], v[96:111]
  ds_read_b128 v[24:27], v112 offset:18432
  s_waitcnt lgkmcnt(3)
  v_mfma_f32_32x32x16_bf16 v[80:95], a[60:63], v[28:31], v[80:95]
  v_mfma_f32_32x32x16_bf16 v[96:111], a[188:191], v[28:31], v[96:111]
  s_cmp_eq_u32 s89, 1
  s_cbranch_scc1 L_hwo_308
L_hwb_309:
  ds_read_b128 v[28:31], v112 offset:19456
  s_waitcnt lgkmcnt(3)
  v_mfma_f32_32x32x16_bf16 v[80:95], a[64:67], v[16:19], v[80:95]
  v_mfma_f32_32x32x16_bf16 v[96:111], a[192:195], v[16:19], v[96:111]
  ds_read_b128 v[16:19], v112 offset:20480
  s_waitcnt lgkmcnt(3)
  v_mfma_f32_32x32x16_bf16 v[80:95], a[68:71], v[20:23], v[80:95]
  v_mfma_f32_32x32x16_bf16 v[96:111], a[196:199], v[20:23], v[96:111]
  s_cmp_eq_u32 s89, 2
  s_cbranch_scc1 L_hwo_310
L_hwb_311:
  ds_read_b128 v[20:23], v112 offset:21504
  s_waitcnt lgkmcnt(3)
  v_mfma_f32_32x32x16_bf16 v[80:95], a[72:75], v[24:27], v[80:95]
  v_mfma_f32_32x32x16_bf16 v[96:111], a[200:203], v[24:27], v[96:111]
  ds_read_b128 v[24:27], v112 offset:22528
  s_waitcnt lgkmcnt(3)
  v_mfma_f32_32x32x16_bf16 v[80:95], a[76:79], v[28:31], v[80:95]
  v_mfma_f32_32x32x16_bf16 v[96:111], a[204:207], v[28:31], v[96:111]
  s_cmp_eq_u32 s89, 3
  s_cbranch_scc1 L_hwo_312
L_hwb_313:
  ds_read_b128 v[28:31], v112 offset:23552
  s_waitcnt lgkmcnt(3)
  v_mfma_f32_32x32x16_bf16 v[80:95], a[80:83], v[16:19], v[80:95]
  v_mfma_f32_32x32x16_bf16 v[96:111], a[208:211], v[16:19], v[96:111]
  ds_read_b128 v[16:19], v112 offset:24576
  s_waitcnt lgkmcnt(3)
  v_mfma_f32_32x32x16_bf16 v[80:95], a[84:87], v[20:23], v[80:95]
  v_mfma_f32_32x32x16_bf16 v[96:111], a[212:215], v[20:23], v[96:111]
  ds_read_b128 v[20:23], v112 offset:25600
  s_waitcnt lgkmcnt(3)
  v_mfma_f32_32x32x16_bf16 v[80:95], a[88:91], v[24:27], v[80:95]
  v_mfma_f32_32x32x16_bf16 v[96:111], a[216:219], v[24:27], v[96:111]
  ds_read_b128 v[24:27], v112 offset:26624
  s_waitcnt lgkmcnt(3)
  v_mfma_f32_32x32x16_bf16 v[80:95], a[92:95], v[28:31], v[80:95]
  v_mfma_f32_32x32x16_bf16 v[96:111], a[220:223], v[28:31], v[96:111]
  ds_read_b128 v[28:31], v112 offset:27648
  s_waitcnt lgkmcnt(3)
  v_mfma_f32_32x32x16_bf16 v[80:95], a[96:99], v[16:19], v[80:95]
  v_mfma_f32_32x32x16_bf16 v[96:111], a[224:227], v[16:19], v[96:111]
  ds_read_b128 v[16:19], v112 offset:28672
  s_waitcnt lgkmcnt(3)
  v_mfma_f32_32x32x16_bf16 v[80:95], a[100:103], v[20:23], v[80:95]
  v_mfma_f32_32x32x16_bf16 v[96:111], a[228:231], v[20:23], v[96:111]
  s_cmp_lg_u32 s89, 7
  s_cbranch_scc1 L_hre_314
  buffer_load_dword v11, v8, s[4:7], s96 offen sc1
L_hre_314:
  ds_read_b128 v[20:23], v112 offset:29696
  s_waitcnt lgkmcnt(3)
  v_mfma_f32_32x32x16_bf16 v[80:95], a[104:107], v[24:27], v[80:95]
  v_mfma_f32_32x32x16_bf16 v[96:111], a[232:235], v[24:27], v[96:111]
  ds_read_b128 v[24:27], v112 offset:30720
  s_waitcnt lgkmcnt(3)
  v_mfma_f32_32x32x16_bf16 v[80:95], a[108:111], v[28:31], v[80:95]
  v_mfma_f32_32x32x16_bf16 v[96:111], a[236:239], v[28:31], v[96:111]
  ds_read_b128 v[28:31], v112 offset:31744
  s_waitcnt lgkmcnt(3)
  v_mfma_f32_32x32x16_bf16 v[80:95], a[112:115], v[16:19], v[80:95]
  s_and_b32 s76, s55, 7
  s_mul_i32 s76, s76, 114688
  s_lshl_b32 s77, s54, 13
  s_add_u32 s76, s76, s77
  v_mfma_f32_32x32x16_bf16 v[96:111], a[240:243], v[16:19], v[96:111]
  s_waitcnt lgkmcnt(2)
  v_mfma_f32_32x32x16_bf16 v[80:95], a[116:119], v[20:23], v[80:95]
  s_add_u32 s76, s76, s52
  s_add_u32 s76, s76, 0x4800000
  s_lshl_b32 s78, s55, 8
  s_lshl_b32 s79, s54, 4
  v_mfma_f32_32x32x16_bf16 v[96:111], a[244:247], v[20:23], v[96:111]
  s_waitcnt lgkmcnt(1)
  v_mfma_f32_32x32x16_bf16 v[80:95], a[120:123], v[24:27], v[80:95]
  s_add_u32 s78, s78, s79
  s_add_u32 s78, s78, 0x1d000
  s_add_u32 s78, s78, s53
  v_mfma_f32_32x32x16_bf16 v[96:111], a[248:251], v[24:27], v[96:111]
  s_waitcnt lgkmcnt(0)
  v_mfma_f32_32x32x16_bf16 v[80:95], a[124:127], v[28:31], v[80:95]
  v_mfma_f32_32x32x16_bf16 v[96:111], a[252:255], v[28:31], v[96:111]
  s_cmp_lg_u32 s59, 1
  s_cbranch_scc1 L_late_315
  s_mov_b32 s60, 1
  s_branch L_nl_317
  s_cmp_eq_u32 s80, 1
  s_cbranch_scc1 L_st1_316
  s_waitcnt vmcnt(0)
L_st1_316:
  s_waitcnt vmcnt(1)
  s_barrier
  ds_read_b128 v[16:19], v7 offset:0
  ds_read_b128 v[20:23], v7 offset:1024
  ds_read_b128 v[24:27], v7 offset:2048
  s_mov_b32 s60, 2
  s_mov_b32 s55, s74
  s_branch L_s4b0_273
L_late_315:
  s_mov_b32 s60, 0
  s_waitcnt vmcnt(0)
  s_cmp_ge_u32 s74, s57
  s_cbranch_scc1 L_nl_317
  v_cmp_eq_u32 vcc, 0, v11
  s_cbranch_vccnz L_nl_317
  s_mov_b32 s64, 0x0
  s_and_b32 s61, s74, 7
  s_lshl_b32 s61, s61, 15
  s_add_u32 s61, s61, 0x5e00000
  s_add_u32 s61, s61, s52
  s_lshl_b32 s62, s58, 12
  s_add_u32 m0, s62, s64
  s_nop 0
  buffer_load_dwordx4 v6, s[4:7], s61 offen offset:0 sc1 lds
  buffer_load_dwordx4 v6, s[4:7], s61 offen offset:1024 sc1 lds
  buffer_load_dwordx4 v6, s[4:7], s61 offen offset:2048 sc1 lds
  buffer_load_dwordx4 v6, s[4:7], s61 offen offset:3072 sc1 lds
  s_add_u32 m0, m0, 0x4000
  s_add_u32 s61, s61, 0x4000
  buffer_load_dwordx4 v6, s[4:7], s61 offen offset:0 sc1 lds
  buffer_load_dwordx4 v6, s[4:7], s61 offen offset:1024 sc1 lds
  buffer_load_dwordx4 v6, s[4:7], s61 offen offset:2048 sc1 lds
  buffer_load_dwordx4 v6, s[4:7], s61 offen offset:3072 sc1 lds
  s_mov_b32 s60, 1
L_nl_317:
  s_nop 7
  v_max_f32 v80, 0, v80
  v_max_f32 v81, 0, v81
  v_max_f32 v82, 0, v82
  v_max_f32 v83, 0, v83
  v_max_f32 v84, 0, v84
  v_max_f32 v85, 0, v85
  v_max_f32 v86, 0, v86
  v_max_f32 v87, 0, v87
  v_mul_f32 v80, v80, v96
  v_mul_f32 v81, v81, v97
  v_mul_f32 v82, v82, v98
  v_mul_f32 v83, v83, v99
  v_mul_f32 v84, v84, v100
  v_mul_f32 v85, v85, v101
  v_mul_f32 v86, v86, v102
  v_mul_f32 v87, v87, v103
  v_cvt_pk_bf16_f32 v64, v80, v81
  v_cvt_pk_bf16_f32 v65, v82, v83
  v_cvt_pk_bf16_f32 v66, v84, v85
  v_cvt_pk_bf16_f32 v67, v86, v87
  buffer_store_dwordx4 v[64:67], v12, s[4:7], s76 offen offset:0
  v_max_f32 v88, 0, v88
  v_max_f32 v89, 0, v89
  v_max_f32 v90, 0, v90
  v_max_f32 v91, 0, v91
  v_max_f32 v92, 0, v92
  v_max_f32 v93, 0, v93
  v_max_f32 v94, 0, v94
  v_max_f32 v95, 0, v95
  v_mul_f32 v88, v88, v104
  v_mul_f32 v89, v89, v105
  v_mul_f32 v90, v90, v106
  v_mul_f32 v91, v91, v107
  v_mul_f32 v92, v92, v108
  v_mul_f32 v93, v93, v109
  v_mul_f32 v94, v94, v110
  v_mul_f32 v95, v95, v111
  v_cvt_pk_bf16_f32 v68, v88, v89
  v_cvt_pk_bf16_f32 v69, v90, v91
  v_cvt_pk_bf16_f32 v70, v92, v93
  v_cvt_pk_bf16_f32 v71, v94, v95
  buffer_store_dwordx4 v[68:71], v12, s[4:7], s76 offen offset:1024
  s_mov_b32 s88, s78
  s_mov_b32 s55, s74
  s_cmp_lt_u32 s55, s57
  s_cbranch_scc1 L_s4h0_271
  s_waitcnt vmcnt(0)
  s_cmp_eq_u32 s88, 0
  s_cbranch_scc1 L_nofl_318
  s_mov_b64 exec, 1
  buffer_store_dword v10, v9, s[4:7], s88 offen
  s_mov_b64 exec, -1
  s_mov_b32 s88, 0
L_nofl_318:
  s_endpgm
L_hwo_284:
  s_mov_b32 s64, 0x8000
  s_and_b32 s61, s74, 7
  s_lshl_b32 s61, s61, 15
  s_add_u32 s61, s61, 0x5e00000
  s_add_u32 s61, s61, s52
  s_lshl_b32 s62, s58, 12
  s_add_u32 m0, s62, s64
  s_nop 0
  buffer_load_dwordx4 v6, s[4:7], s61 offen offset:0 sc1 lds
  buffer_load_dwordx4 v6, s[4:7], s61 offen offset:1024 sc1 lds
  buffer_load_dwordx4 v6, s[4:7], s61 offen offset:2048 sc1 lds
  buffer_load_dwordx4 v6, s[4:7], s61 offen offset:3072 sc1 lds
  s_add_u32 m0, m0, 0x4000
  s_add_u32 s61, s61, 0x4000
  buffer_load_dwordx4 v6, s[4:7], s61 offen offset:0 sc1 lds
  buffer_load_dwordx4 v6, s[4:7], s61 offen offset:1024 sc1 lds
  buffer_load_dwordx4 v6, s[4:7], s61 offen offset:2048 sc1 lds
  buffer_load_dwordx4 v6, s[4:7], s61 offen offset:3072 sc1 lds
  s_mov_b32 s59, 1
  s_branch L_hwb_285
L_hwo_286:
  s_mov_b32 s64, 0x8000
  s_and_b32 s61, s74, 7
  s_lshl_b32 s61, s61, 15
  s_add_u32 s61, s61, 0x5e00000
  s_add_u32 s61, s61, s52
  s_lshl_b32 s62, s58, 12
  s_add_u32 m0, s62, s64
  s_nop 0
  buffer_load_dwordx4 v6, s[4:7], s61 offen offset:0 sc1 lds
  buffer_load_dwordx4 v6, s[4:7], s61 offen offset:1024 sc1 lds
  buffer_load_dwordx4 v6, s[4:7], s61 offen offset:2048 sc1 lds
  buffer_load_dwordx4 v6, s[4:7], s61 offen offset:3072 sc1 lds
  s_add_u32 m0, m0, 0x4000
  s_add_u32 s61, s61, 0x4000
  buffer_load_dwordx4 v6, s[4:7], s61 offen offset:0 sc1 lds
  buffer_load_dwordx4 v6, s[4:7], s61 offen offset:1024 sc1 lds
  buffer_load_dwordx4 v6, s[4:7], s61 offen offset:2048 sc1 lds
  buffer_load_dwordx4 v6, s[4:7], s61 offen offset:3072 sc1 lds
  s_mov_b32 s59, 1
  s_branch L_hwb_287
L_hwo_288:
  s_mov_b32 s64, 0x8000
  s_and_b32 s61, s74, 7
  s_lshl_b32 s61, s61, 15
  s_add_u32 s61, s61, 0x5e00000
  s_add_u32 s61, s61, s52
  s_lshl_b32 s62, s58, 12
  s_add_u32 m0, s62, s64
  s_nop 0
  buffer_load_dwordx4 v6, s[4:7], s61 offen offset:0 sc1 lds
  buffer_load_dwordx4 v6, s[4:7], s61 offen offset:1024 sc1 lds
  buffer_load_dwordx4 v6, s[4:7], s61 offen offset:2048 sc1 lds
  buffer_load_dwordx4 v6, s[4:7], s61 offen offset:3072 sc1 lds
  s_add_u32 m0, m0, 0x4000
  s_add_u32 s61, s61, 0x4000
  buffer_load_dwordx4 v6, s[4:7], s61 offen offset:0 sc1 lds
  buffer_load_dwordx4 v6, s[4:7], s61 offen offset:1024 sc1 lds
  buffer_load_dwordx4 v6, s[4:7], s61 offen offset:2048 sc1 lds
  buffer_load_dwordx4 v6, s[4:7], s61 offen offset:3072 sc1 lds
  s_mov_b32 s59, 1
  s_branch L_hwb_289
L_hwo_290:
  s_mov_b32 s64, 0x8000
  s_and_b32 s61, s74, 7
  s_lshl_b32 s61, s61, 15
  s_add_u32 s61, s61, 0x5e00000
  s_add_u32 s61, s61, s52
  s_lshl_b32 s62, s58, 12
  s_add_u32 m0, s62, s64
  s_nop 0
  buffer_load_dwordx4 v6, s[4:7], s61 offen offset:0 sc1 lds
  buffer_load_dwordx4 v6, s[4:7], s61 offen offset:1024 sc1 lds
  buffer_load_dwordx4 v6, s[4:7], s61 offen offset:2048 sc1 lds
  buffer_load_dwordx4 v6, s[4:7], s61 offen offset:3072 sc1 lds
  s_add_u32 m0, m0, 0x4000
  s_add_u32 s61, s61, 0x4000
  buffer_load_dwordx4 v6, s[4:7], s61 offen offset:0 sc1 lds
  buffer_load_dwordx4 v6, s[4:7], s61 offen offset:1024 sc1 lds
  buffer_load_dwordx4 v6, s[4:7], s61 offen offset:2048 sc1 lds
  buffer_load_dwordx4 v6, s[4:7], s61 offen offset:3072 sc1 lds
  s_mov_b32 s59, 1
  s_branch L_hwb_291
L_hwo_306:
  s_mov_b32 s64, 0x0
  s_and_b32 s61, s74, 7
  s_lshl_b32 s61, s61, 15
  s_add_u32 s61, s61, 0x5e00000
  s_add_u32 s61, s61, s52
  s_lshl_b32 s62, s58, 12
  s_add_u32 m0, s62, s64
  s_nop 0
  buffer_load_dwordx4 v6, s[4:7], s61 offen offset:0 sc1 lds
  buffer_load_dwordx4 v6, s[4:7], s61 offen offset:1024 sc1 lds
  buffer_load_dwordx4 v6, s[4:7], s61 offen offset:2048 sc1 lds
  buffer_load_dwordx4 v6, s[4:7], s61 offen offset:3072 sc1 lds
  s_add_u32 m0, m0, 0x4000
  s_add_u32 s61, s61, 0x4000
  buffer_load_dwordx4 v6, s[4:7], s61 offen offset:0 sc1 lds
  buffer_load_dwordx4 v6, s[4:7], s61 offen offset:1024 sc1 lds
  buffer_load_dwordx4 v6, s[4:7], s61 offen offset:2048 sc1 lds
  buffer_load_dwordx4 v6, s[4:7], s61 offen offset:3072 sc1 lds
  s_mov_b32 s59, 1
  s_branch L_hwb_307
L_hwo_308:
  s_mov_b32 s64, 0x0
  s_and_b32 s61, s74, 7
  s_lshl_b32 s61, s61, 15
  s_add_u32 s61, s61, 0x5e00000
  s_add_u32 s61, s61, s52
  s_lshl_b32 s62, s58, 12
  s_add_u32 m0, s62, s64
  s_nop 0
  buffer_load_dwordx4 v6, s[4:7], s61 offen offset:0 sc1 lds
  buffer_load_dwordx4 v6, s[4:7], s61 offen offset:1024 sc1 lds
  buffer_load_dwordx4 v6, s[4:7], s61 offen offset:2048 sc1 lds
  buffer_load_dwordx4 v6, s[4:7], s61 offen offset:3072 sc1 lds
  s_add_u32 m0, m0, 0x4000
  s_add_u32 s61, s61, 0x4000
  buffer_load_dwordx4 v6, s[4:7], s61 offen offset:0 sc1 lds
  buffer_load_dwordx4 v6, s[4:7], s61 offen offset:1024 sc1 lds
  buffer_load_dwordx4 v6, s[4:7], s61 offen offset:2048 sc1 lds
  buffer_load_dwordx4 v6, s[4:7], s61 offen offset:3072 sc1 lds
  s_mov_b32 s59, 1
  s_branch L_hwb_309
L_hwo_310:
  s_mov_b32 s64, 0x0
  s_and_b32 s61, s74, 7
  s_lshl_b32 s61, s61, 15
  s_add_u32 s61, s61, 0x5e00000
  s_add_u32 s61, s61, s52
  s_lshl_b32 s62, s58, 12
  s_add_u32 m0, s62, s64
  s_nop 0
  buffer_load_dwordx4 v6, s[4:7], s61 offen offset:0 sc1 lds
  buffer_load_dwordx4 v6, s[4:7], s61 offen offset:1024 sc1 lds
  buffer_load_dwordx4 v6, s[4:7], s61 offen offset:2048 sc1 lds
  buffer_load_dwordx4 v6, s[4:7], s61 offen offset:3072 sc1 lds
  s_add_u32 m0, m0, 0x4000
  s_add_u32 s61, s61, 0x4000
  buffer_load_dwordx4 v6, s[4:7], s61 offen offset:0 sc1 lds
  buffer_load_dwordx4 v6, s[4:7], s61 offen offset:1024 sc1 lds
  buffer_load_dwordx4 v6, s[4:7], s61 offen offset:2048 sc1 lds
  buffer_load_dwordx4 v6, s[4:7], s61 offen offset:3072 sc1 lds
  s_mov_b32 s59, 1
  s_branch L_hwb_311
L_hwo_312:
  s_mov_b32 s64, 0x0
  s_and_b32 s61, s74, 7
  s_lshl_b32 s61, s61, 15
  s_add_u32 s61, s61, 0x5e00000
  s_add_u32 s61, s61, s52
  s_lshl_b32 s62, s58, 12
  s_add_u32 m0, s62, s64
  s_nop 0
  buffer_load_dwordx4 v6, s[4:7], s61 offen offset:0 sc1 lds
  buffer_load_dwordx4 v6, s[4:7], s61 offen offset:1024 sc1 lds
  buffer_load_dwordx4 v6, s[4:7], s61 offen offset:2048 sc1 lds
  buffer_load_dwordx4 v6, s[4:7], s61 offen offset:3072 sc1 lds
  s_add_u32 m0, m0, 0x4000
  s_add_u32 s61, s61, 0x4000
  buffer_load_dwordx4 v6, s[4:7], s61 offen offset:0 sc1 lds
  buffer_load_dwordx4 v6, s[4:7], s61 offen offset:1024 sc1 lds
  buffer_load_dwordx4 v6, s[4:7], s61 offen offset:2048 sc1 lds
  buffer_load_dwordx4 v6, s[4:7], s61 offen offset:3072 sc1 lds
  s_mov_b32 s59, 1
  s_branch L_hwb_313
  s_endpgm
B_s5:
  v_mov_b32 v6, 0x0
  v_bfe_i32 v2, v0, 0, 1
  v_and_b32 v2, 0x10, v2
  v_add_u32 v6, v6, v2
  v_bfe_i32 v2, v0, 1, 1
  v_and_b32 v2, 0x20, v2
  v_add_u32 v6, v6, v2
  v_bfe_i32 v2, v0, 2, 1
  v_and_b32 v2, 0x40, v2
  v_add_u32 v6, v6, v2
  v_bfe_i32 v2, v0, 3, 1
  v_and_b32 v2, 0x80, v2
  v_add_u32 v6, v6, v2
  v_bfe_i32 v2, v0, 4, 1
  v_and_b32 v2, 0x100, v2
  v_add_u32 v6, v6, v2
  v_bfe_i32 v2, v0, 5, 1
  v_and_b32 v2, 0x200, v2
  v_add_u32 v6, v6, v2
  v_bfe_i32 v2, v0, 6, 1
  v_and_b32 v2, 0x1000, v2
  v_add_u32 v6, v6, v2
  v_bfe_i32 v2, v0, 7, 1
  v_and_b32 v2, 0x2000, v2
  v_add_u32 v6, v6, v2
  v_mov_b32 v7, 0x0
  v_bfe_i32 v2, v0, 0, 1
  v_and_b32 v2, 0x10, v2
  v_add_u32 v7, v7, v2
  v_bfe_i32 v2, v0, 1, 1
  v_and_b32 v2, 0x20, v2
  v_add_u32 v7, v7, v2
  v_bfe_i32 v2, v0, 2, 1
  v_and_b32 v2, 0x40, v2
  v_add_u32 v7, v7, v2
  v_bfe_i32 v2, v0, 3, 1
  v_and_b32 v2, 0x80, v2
  v_add_u32 v7, v7, v2
  v_bfe_i32 v2, v0, 4, 1
  v_and_b32 v2, 0x100, v2
  v_add_u32 v7, v7, v2
  v_bfe_i32 v2, v0, 5, 1
  v_and_b32 v2, 0x200, v2
  v_add_u32 v7, v7, v2
  v_and_b32 v8, 31, v0
  v_min_u32 v8, 27, v8
  v_lshlrev_b32 v8, 2, v8
  v_mov_b32 v9, 0x0
  v_bfe_i32 v2, v0, 6, 1
  v_and_b32 v2, 0x4, v2
  v_add_u32 v9, v9, v2
  v_bfe_i32 v2, v0, 7, 1
  v_and_b32 v2, 0x8, v2
  v_add_u32 v9, v9, v2
  v_mov_b32 v10, 1
  v_mov_b32 v12, 0x0
  v_bfe_i32 v2, v0, 0, 1
  v_and_b32 v2, 0x10, v2
  v_add_u32 v12, v12, v2
  v_bfe_i32 v2, v0, 1, 1
  v_and_b32 v2, 0x20, v2
  v_add_u32 v12, v12, v2
  v_bfe_i32 v2, v0, 2, 1
  v_and_b32 v2, 0x40, v2
  v_add_u32 v12, v12, v2
  v_bfe_i32 v2, v0, 3, 1
  v_and_b32 v2, 0x2000, v2
  v_add_u32 v12, v12, v2
  v_bfe_i32 v2, v0, 4, 1
  v_and_b32 v2, 0x4000, v2
  v_add_u32 v12, v12, v2
  v_bfe_i32 v2, v0, 5, 1
  v_and_b32 v2, 0x80, v2
  v_add_u32 v12, v12, v2
  v_bfe_i32 v2, v0, 6, 1
  v_and_b32 v2, 0x200, v2
  v_add_u32 v12, v12, v2
  v_bfe_i32 v2, v0, 7, 1
  v_and_b32 v2, 0x400, v2
  v_add_u32 v12, v12, v2
  s_mov_b32 s8, s44
  s_and_b32 s9, s45, 0xffff
  s_mov_b32 s10, 0x1c0000
  s_mov_b32 s11, 0x20000
  v_mov_b32 v3, 0x0
  v_bfe_i32 v2, v0, 0, 1
  v_and_b32 v2, 0x10, v2
  v_xor_b32 v3, v3, v2
  v_bfe_i32 v2, v0, 1, 1
  v_and_b32 v2, 0x20, v2
  v_xor_b32 v3, v3, v2
  v_bfe_i32 v2, v0, 2, 1
  v_and_b32 v2, 0x40, v2
  v_xor_b32 v3, v3, v2
  v_bfe_i32 v2, v0, 3, 1
  v_and_b32 v2, 0x80, v2
  v_xor_b32 v3, v3, v2
  v_bfe_i32 v2, v0, 4, 1
  v_and_b32 v2, 0x40, v2
  v_xor_b32 v3, v3, v2
  v_bfe_i32 v2, v0, 5, 1
  v_and_b32 v2, 0x80, v2
  v_xor_b32 v3, v3, v2
  v_mov_b32 v5, 0x0
  v_bfe_i32 v2, v0, 4, 1
  v_and_b32 v2, 0x400, v2
  v_add_u32 v5, v5, v2
  v_bfe_i32 v2, v0, 5, 1
  v_and_b32 v2, 0x800, v2
  v_add_u32 v5, v5, v2
  v_add_u32 v3, v3, v5
  v_mov_b32 v4, 0x0
  v_bfe_i32 v2, v0, 0, 1
  v_and_b32 v2, 0x8, v2
  v_xor_b32 v4, v4, v2
  v_bfe_i32 v2, v0, 1, 1
  v_and_b32 v2, 0x10, v2
  v_xor_b32 v4, v4, v2
  v_bfe_i32 v2, v0, 2, 1
  v_and_b32 v2, 0x140, v2
  v_xor_b32 v4, v4, v2
  v_bfe_i32 v2, v0, 3, 1
  v_and_b32 v2, 0x280, v2
  v_xor_b32 v4, v4, v2
  v_bfe_i32 v2, v0, 4, 1
  v_and_b32 v2, 0x20, v2
  v_xor_b32 v4, v4, v2
  v_bfe_i32 v2, v0, 5, 1
  v_and_b32 v2, 0x400, v2
  v_xor_b32 v4, v4, v2
  v_bfe_i32 v2, v0, 6, 1
  v_and_b32 v2, 0x40, v2
  v_xor_b32 v4, v4, v2
  v_bfe_i32 v2, v0, 7, 1
  v_and_b32 v2, 0x80, v2
  v_xor_b32 v4, v4, v2
  v_add_u32 v5, 0x10000, v4
  s_lshl_b32 s76, s54, 8
  s_mul_i32 s77, s73, 917504
  s_add_u32 s76, s76, s77
  s_barrier
  s_mul_i32 s61, s58, 131072
  s_add_u32 s61, s61, s76
  s_add_u32 s61, s61, 0
  s_mul_i32 s62, s58, 32768
  s_mov_b32 s63, 0
L_wdma_319:
  s_mov_b32 m0, s62
  s_add_u32 s62, s62, 1024
  buffer_load_dwordx4 v3, s[8:11], s61 offen lds
  s_add_u32 s61, s61, 4096
  s_add_u32 s63, s63, 1
  s_cmp_lt_u32 s63, 32
  s_cbranch_scc1 L_wdma_319
  s_waitcnt vmcnt(0)
  s_barrier
  ds_read_b64_tr_b16 a[0:1], v4 offset:0
  ds_read_b64_tr_b16 a[2:3], v4 offset:2048
  ds_read_b64_tr_b16 a[4:5], v4 offset:4096
  ds_read_b64_tr_b16 a[6:7], v4 offset:6144
  ds_read_b64_tr_b16 a[8:9], v4 offset:8192
  ds_read_b64_tr_b16 a[10:11], v4 offset:10240
  ds_read_b64_tr_b16 a[12:13], v4 offset:12288
  ds_read_b64_tr_b16 a[14:15], v4 offset:14336
  s_waitcnt lgkmcnt(0)
  ds_read_b64_tr_b16 a[16:17], v4 offset:16384
  ds_read_b64_tr_b16 a[18:19], v4 offset:18432
  ds_read_b64_tr_b16 a[20:21], v4 offset:20480
  ds_read_b64_tr_b16 a[22:23], v4 offset:22528
  ds_read_b64_tr_b16 a[24:25], v4 offset:24576
  ds_read_b64_tr_b16 a[26:27], v4 offset:26624
  ds_read_b64_tr_b16 a[28:29], v4 offset:28672
  ds_read_b64_tr_b16 a[30:31], v4 offset:30720
  s_waitcnt lgkmcnt(0)
  ds_read_b64_tr_b16 a[32:33], v4 offset:32768
  ds_read_b64_tr_b16 a[34:35], v4 offset:34816
  ds_read_b64_tr_b16 a[36:37], v4 offset:36864
  ds_read_b64_tr_b16 a[38:39], v4 offset:38912
  ds_read_b64_tr_b16 a[40:41], v4 offset:40960
  ds_read_b64_tr_b16 a[42:43], v4 offset:43008
  ds_read_b64_tr_b16 a[44:45], v4 offset:45056
  ds_read_b64_tr_b16 a[46:47], v4 offset:47104
  s_waitcnt lgkmcnt(0)
  ds_read_b64_tr_b16 a[48:49], v4 offset:49152
  ds_read_b64_tr_b16 a[50:51], v4 offset:51200
  ds_read_b64_tr_b16 a[52:53], v4 offset:53248
  ds_read_b64_tr_b16 a[54:55], v4 offset:55296
  ds_read_b64_tr_b16 a[56:57], v4 offset:57344
  ds_read_b64_tr_b16 a[58:59], v4 offset:59392
  ds_read_b64_tr_b16 a[60:61], v4 offset:61440
  ds_read_b64_tr_b16 a[62:63], v4 offset:63488
  s_waitcnt lgkmcnt(0)
  ds_read_b64_tr_b16 a[64:65], v5 offset:0
  ds_read_b64_tr_b16 a[66:67], v5 offset:2048
  ds_read_b64_tr_b16 a[68:69], v5 offset:4096
  ds_read_b64_tr_b16 a[70:71], v5 offset:6144
  ds_read_b64_tr_b16 a[72:73], v5 offset:8192
  ds_read_b64_tr_b16 a[74:75], v5 offset:10240
  ds_read_b64_tr_b16 a[76:77], v5 offset:12288
  ds_read_b64_tr_b16 a[78:79], v5 offset:14336
  s_waitcnt lgkmcnt(0)
  ds_read_b64_tr_b16 a[80:81], v5 offset:16384
  ds_read_b64_tr_b16 a[82:83], v5 offset:18432
  ds_read_b64_tr_b16 a[84:85], v5 offset:20480
  ds_read_b64_tr_b16 a[86:87], v5 offset:22528
  ds_read_b64_tr_b16 a[88:89], v5 offset:24576
  ds_read_b64_tr_b16 a[90:91], v5 offset:26624
  ds_read_b64_tr_b16 a[92:93], v5 offset:28672
  ds_read_b64_tr_b16 a[94:95], v5 offset:30720
  s_waitcnt lgkmcnt(0)
  ds_read_b64_tr_b16 a[96:97], v5 offset:32768
  ds_read_b64_tr_b16 a[98:99], v5 offset:34816
  ds_read_b64_tr_b16 a[100:101], v5 offset:36864
  ds_read_b64_tr_b16 a[102:103], v5 offset:38912
  ds_read_b64_tr_b16 a[104:105], v5 offset:40960
  ds_read_b64_tr_b16 a[106:107], v5 offset:43008
  ds_read_b64_tr_b16 a[108:109], v5 offset:45056
  ds_read_b64_tr_b16 a[110:111], v5 offset:47104
  s_waitcnt lgkmcnt(0)
  ds_read_b64_tr_b16 a[112:113], v5 offset:49152
  ds_read_b64_tr_b16 a[114:115], v5 offset:51200
  ds_read_b64_tr_b16 a[116:117], v5 offset:53248
  ds_read_b64_tr_b16 a[118:119], v5 offset:55296
  ds_read_b64_tr_b16 a[120:121], v5 offset:57344
  ds_read_b64_tr_b16 a[122:123], v5 offset:59392
  ds_read_b64_tr_b16 a[124:125], v5 offset:61440
  ds_read_b64_tr_b16 a[126:127], v5 offset:63488
  s_waitcnt lgkmcnt(0)
  s_waitcnt lgkmcnt(0)
  s_barrier
  s_mul_i32 s61, s58, 98304
  s_add_u32 s61, s61, s76
  s_add_u32 s61, s61, 524288
  s_mul_i32 s62, s58, 24576
  s_mov_b32 s63, 0
L_wdma_320:
  s_mov_b32 m0, s62
  s_add_u32 s62, s62, 1024
  buffer_load_dwordx4 v3, s[8:11], s61 offen lds
  s_add_u32 s61, s61, 4096
  s_add_u32 s63, s63, 1
  s_cmp_lt_u32 s63, 24
  s_cbranch_scc1 L_wdma_320
  s_waitcnt vmcnt(0)
  s_barrier
  ds_read_b64_tr_b16 a[128:129], v4 offset:0
  ds_read_b64_tr_b16 a[130:131], v4 offset:2048
  ds_read_b64_tr_b16 a[132:133], v4 offset:4096
  ds_read_b64_tr_b16 a[134:135], v4 offset:6144
  ds_read_b64_tr_b16 a[136:137], v4 offset:8192
  ds_read_b64_tr_b16 a[138:139], v4 offset:10240
  ds_read_b64_tr_b16 a[140:141], v4 offset:12288
  ds_read_b64_tr_b16 a[142:143], v4 offset:14336
  s_waitcnt lgkmcnt(0)
  ds_read_b64_tr_b16 a[144:145], v4 offset:16384
  ds_read_b64_tr_b16 a[146:147], v4 offset:18432
  ds_read_b64_tr_b16 a[148:149], v4 offset:20480
  ds_read_b64_tr_b16 a[150:151], v4 offset:22528
  ds_read_b64_tr_b16 a[152:153], v4 offset:24576
  ds_read_b64_tr_b16 a[154:155], v4 offset:26624
  ds_read_b64_tr_b16 a[156:157], v4 offset:28672
  ds_read_b64_tr_b16 a[158:159], v4 offset:30720
  s_waitcnt lgkmcnt(0)
  ds_read_b64_tr_b16 a[160:161], v4 offset:32768
  ds_read_b64_tr_b16 a[162:163], v4 offset:34816
  ds_read_b64_tr_b16 a[164:165], v4 offset:36864
  ds_read_b64_tr_b16 a[166:167], v4 offset:38912
  ds_read_b64_tr_b16 a[168:169], v4 offset:40960
  ds_read_b64_tr_b16 a[170:171], v4 offset:43008
  ds_read_b64_tr_b16 a[172:173], v4 offset:45056
  ds_read_b64_tr_b16 a[174:175], v4 offset:47104
  s_waitcnt lgkmcnt(0)
  ds_read_b64_tr_b16 a[176:177], v4 offset:49152
  ds_read_b64_tr_b16 a[178:179], v4 offset:51200
  ds_read_b64_tr_b16 a[180:181], v4 offset:53248
  ds_read_b64_tr_b16 a[182:183], v4 offset:55296
  ds_read_b64_tr_b16 a[184:185], v4 offset:57344
  ds_read_b64_tr_b16 a[186:187], v4 offset:59392
  ds_read_b64_tr_b16 a[188:189], v4 offset:61440
  ds_read_b64_tr_b16 a[190:191], v4 offset:63488
  s_waitcnt lgkmcnt(0)
  ds_read_b64_tr_b16 a[192:193], v5 offset:0
  ds_read_b64_tr_b16 a[194:195], v5 offset:2048
  ds_read_b64_tr_b16 a[196:197], v5 offset:4096
  ds_read_b64_tr_b16 a[198:199], v5 offset:6144
  ds_read_b64_tr_b16 a[200:201], v5 offset:8192
  ds_read_b64_tr_b16 a[202:203], v5 offset:10240
  ds_read_b64_tr_b16 a[204:205], v5 offset:12288
  ds_read_b64_tr_b16 a[206:207], v5 offset:14336
  s_waitcnt lgkmcnt(0)
  ds_read_b64_tr_b16 a[208:209], v5 offset:16384
  ds_read_b64_tr_b16 a[210:211], v5 offset:18432
  ds_read_b64_tr_b16 a[212:213], v5 offset:20480
  ds_read_b64_tr_b16 a[214:215], v5 offset:22528
  ds_read_b64_tr_b16 a[216:217], v5 offset:24576
  ds_read_b64_tr_b16 a[218:219], v5 offset:26624
  ds_read_b64_tr_b16 a[220:221], v5 offset:28672
  ds_read_b64_tr_b16 a[222:223], v5 offset:30720
  s_waitcnt lgkmcnt(0)
  s_waitcnt lgkmcnt(0)
  s_barrier
  s_mov_b32 s20, s50
  s_and_b32 s21, s51, 0xffff
  s_mov_b32 s22, 0x0
  s_mov_b32 s23, 0x20000
  s_mov_b32 s8, s48
  s_and_b32 s9, s49, 0xffff
  s_mov_b32 s10, 0x100
  s_mov_b32 s11, 0x20000
  v_and_b32 v2, 3, v0
  v_lshlrev_b32 v2, 6, v2
L_gate_321:
  buffer_load_dword v11, v2, s[8:11], 0 offen offset:8 sc1
  s_waitcnt vmcnt(0)
  v_cmp_gt_u32 vcc, 48, v11
  s_cbranch_vccz L_gateok_322
  s_add_u32 s72, s72, 1
  s_cmp_gt_u32 s72, 0x80000
  s_cbranch_scc1 L_exit
  s_sleep 2
  s_branch L_gate_321
L_gateok_322:
  s_mov_b32 s59, 0
  s_mov_b32 s88, 0
  s_mov_b32 s60, 0
  v_mov_b32 v113, 0
  v_add_u32 v112, 0x10000, v7
  s_mov_b32 s60, 0
L_s5h0_323:
  s_cmp_eq_u32 s60, 1
  s_cbranch_scc1 L_hp_327
  s_lshl_b32 s63, s55, 8
  s_mul_i32 s68, s73, 112
  s_add_u32 s63, s63, s68
  s_add_u32 s63, s63, 0x1d000
  s_add_u32 s63, s63, s53
  s_and_b32 s61, s55, 7
  s_mul_i32 s61, s61, 114688
  s_mul_i32 s68, s73, 57344
  s_add_u32 s61, s61, s68
  s_add_u32 s61, s61, 0x4800000
  s_add_u32 s61, s61, s52
  s_lshl_b32 s62, s58, 12
  s_add_u32 m0, s62, 0x0
L_poll_329:
  buffer_load_dword v11, v8, s[4:7], s63 offen sc1
  s_waitcnt vmcnt(0)
  s_cmp_eq_u32 s88, 0
  s_cbranch_scc1 L_nofl_331
  s_mov_b64 exec, 1
  buffer_store_dword v10, v9, s[4:7], s88 offen sc1
  s_mov_b64 exec, -1
  s_mov_b32 s88, 0
L_nofl_331:
  v_cmp_eq_u32 vcc, 0, v11
  s_cbranch_vccz L_pollok_330
  s_add_u32 s72, s72, 1
  s_cmp_gt_u32 s72, 0x80000
  s_cbranch_scc1 L_exit
  s_branch L_poll_329
L_pollok_330:
  buffer_load_dwordx4 v6, s[4:7], s61 offen offset:0 sc1 lds
  buffer_load_dwordx4 v6, s[4:7], s61 offen offset:1024 sc1 lds
  buffer_load_dwordx4 v6, s[4:7], s61 offen offset:2048 sc1 lds
  buffer_load_dwordx4 v6, s[4:7], s61 offen offset:3072 sc1 lds
  s_add_u32 m0, m0, 0x4000
  s_add_u32 s61, s61, 0x4000
  buffer_load_dwordx4 v6, s[4:7], s61 offen offset:0 sc1 lds
  buffer_load_dwordx4 v6, s[4:7], s61 offen offset:1024 sc1 lds
  buffer_load_dwordx4 v6, s[4:7], s61 offen offset:2048 sc1 lds
  buffer_load_dwordx4 v6, s[4:7], s61 offen offset:3072 sc1 lds
  s_add_u32 m0, m0, 0x4000
  s_add_u32 s61, s61, 0x4000
  buffer_load_dwordx4 v6, s[4:7], s61 offen offset:0 sc1 lds
  buffer_load_dwordx4 v6, s[4:7], s61 offen offset:1024 sc1 lds
  buffer_load_dwordx4 v6, s[4:7], s61 offen offset:2048 sc1 lds
  buffer_load_dwordx4 v6, s[4:7], s61 offen offset:3072 sc1 lds
  s_add_u32 m0, m0, 0x4000
  s_add_u32 s61, s61, 0x4000
  buffer_load_dwordx4 v6, s[4:7], s61 offen offset:0 sc1 lds
  buffer_load_dwordx4 v6, s[4:7], s61 offen offset:1024 sc1 lds
  buffer_load_dwordx4 v6, s[4:7], s61 offen offset:2048 sc1 lds
  buffer_load_dwordx4 v6, s[4:7], s61 offen offset:3072 sc1 lds
  s_waitcnt vmcnt(12)
  s_branch L_hj_328
L_hp_327:
  s_waitcnt vmcnt(2)
L_hj_328:
  s_barrier
  ds_read_b128 v[16:19], v7 offset:0
  ds_read_b128 v[20:23], v7 offset:1024
  ds_read_b128 v[24:27], v7 offset:2048
L_s5b0_325:
  s_add_u32 s74, s55, s56
  s_min_u32 s64, s74, 63
  s_lshl_b32 s96, s64, 8
  s_mul_i32 s68, s73, 112
  s_add_u32 s96, s96, s68
  s_add_u32 s96, s96, 0x1d000
  s_add_u32 s96, s96, s53
  s_mov_b32 s59, 0
  s_mov_b32 s80, 0
  ds_read_b128 v[28:31], v7 offset:3072
  s_waitcnt lgkmcnt(3)
  v_mfma_f32_32x32x16_bf16 v[32:47], a[0:3], v[16:19], 0
  buffer_load_dword v11, v8, s[4:7], s96 offen sc1
  ds_read_b128 v[16:19], v7 offset:4096
  s_waitcnt lgkmcnt(3)
  v_mfma_f32_32x32x16_bf16 v[32:47], a[4:7], v[20:23], v[32:47]
  ds_read_b128 v[20:23], v7 offset:5120
  s_waitcnt lgkmcnt(3)
  v_mfma_f32_32x32x16_bf16 v[32:47], a[8:11], v[24:27], v[32:47]
  ds_read_b128 v[24:27], v7 offset:6144
  s_waitcnt lgkmcnt(3)
  v_mfma_f32_32x32x16_bf16 v[32:47], a[12:15], v[28:31], v[32:47]
  ds_read_b128 v[28:31], v7 offset:7168
  s_waitcnt lgkmcnt(3)
  v_mfma_f32_32x32x16_bf16 v[32:47], a[16:19], v[16:19], v[32:47]
  ds_read_b128 v[16:19], v7 offset:8192
  s_waitcnt lgkmcnt(3)
  v_mfma_f32_32x32x16_bf16 v[32:47], a[20:23], v[20:23], v[32:47]
  ds_read_b128 v[20:23], v7 offset:9216
  s_waitcnt lgkmcnt(3)
  v_mfma_f32_32x32x16_bf16 v[32:47], a[24:27], v[24:27], v[32:47]
  ds_read_b128 v[24:27], v7 offset:10240
  s_waitcnt lgkmcnt(3)
  v_mfma_f32_32x32x16_bf16 v[32:47], a[28:31], v[28:31], v[32:47]
  ds_read_b128 v[28:31], v7 offset:11264
  s_waitcnt lgkmcnt(3)
  v_mfma_f32_32x32x16_bf16 v[32:47], a[32:35], v[16:19], v[32:47]
  ds_read_b128 v[16:19], v7 offset:12288
  s_waitcnt lgkmcnt(3)
  v_mfma_f32_32x32x16_bf16 v[32:47], a[36:39], v[20:23], v[32:47]
  ds_read_b128 v[20:23], v7 offset:13312
  s_waitcnt lgkmcnt(3)
  v_mfma_f32_32x32x16_bf16 v[32:47], a[40:43], v[24:27], v[32:47]
  ds_read_b128 v[24:27], v7 offset:14336
  s_waitcnt lgkmcnt(3)
  v_mfma_f32_32x32x16_bf16 v[32:47], a[44:47], v[28:31], v[32:47]
  ds_read_b128 v[28:31], v7 offset:15360
  s_waitcnt lgkmcnt(3)
  v_mfma_f32_32x32x16_bf16 v[32:47], a[48:51], v[16:19], v[32:47]
  s_cmp_lg_u32 s60, 0
  s_cbranch_scc1 L_hm_332
  s_waitcnt vmcnt(9)
L_hm_332:
  s_barrier
  ds_read_b128 v[16:19], v7 offset:16384
  s_waitcnt lgkmcnt(3)
  v_mfma_f32_32x32x16_bf16 v[32:47], a[52:55], v[20:23], v[32:47]
  ds_read_b128 v[20:23], v7 offset:17408
  s_waitcnt lgkmcnt(3)
  v_mfma_f32_32x32x16_bf16 v[32:47], a[56:59], v[24:27], v[32:47]
  ds_read_b128 v[24:27], v7 offset:18432
  s_waitcnt lgkmcnt(3)
  v_mfma_f32_32x32x16_bf16 v[32:47], a[60:63], v[28:31], v[32:47]
  ds_read_b128 v[28:31], v7 offset:19456
  s_waitcnt lgkmcnt(3)
  v_mfma_f32_32x32x16_bf16 v[32:47], a[64:67], v[16:19], v[32:47]
  ds_read_b128 v[16:19], v7 offset:20480
  s_waitcnt lgkmcnt(3)
  v_mfma_f32_32x32x16_bf16 v[32:47], a[68:71], v[20:23], v[32:47]
  ds_read_b128 v[20:23], v7 offset:21504
  s_waitcnt lgkmcnt(3)
  v_mfma_f32_32x32x16_bf16 v[32:47], a[72:75], v[24:27], v[32:47]
  ds_read_b128 v[24:27], v7 offset:22528
  s_waitcnt lgkmcnt(3)
  v_mfma_f32_32x32x16_bf16 v[32:47], a[76:79], v[28:31], v[32:47]
  ds_read_b128 v[28:31], v7 offset:23552
  s_waitcnt lgkmcnt(3)
  v_mfma_f32_32x32x16_bf16 v[32:47], a[80:83], v[16:19], v[32:47]
  ds_read_b128 v[16:19], v7 offset:24576
  s_waitcnt lgkmcnt(3)
  v_mfma_f32_32x32x16_bf16 v[32:47], a[84:87], v[20:23], v[32:47]
  s_cmp_lg_u32 s60, 1
  s_cbranch_scc1 L_hfa_333
  s_waitcnt vmcnt(1)
  s_mov_b64 exec, 1
  buffer_store_dword v10, v9, s[4:7], s88 offen sc1
  s_mov_b64 exec, -1
  s_mov_b32 s88, 0
L_hfa_333:
  ds_read_b128 v[20:23], v7 offset:25600
  s_waitcnt lgkmcnt(3)
  v_mfma_f32_32x32x16_bf16 v[32:47], a[88:91], v[24:27], v[32:47]
  ds_read_b128 v[24:27], v7 offset:26624
  s_waitcnt lgkmcnt(3)
  v_mfma_f32_32x32x16_bf16 v[32:47], a[92:95], v[28:31], v[32:47]
  ds_read_b128 v[28:31], v7 offset:27648
  s_waitcnt lgkmcnt(3)
  v_mfma_f32_32x32x16_bf16 v[32:47], a[96:99], v[16:19], v[32:47]
  ds_read_b128 v[16:19], v7 offset:28672
  s_waitcnt lgkmcnt(3)
  v_mfma_f32_32x32x16_bf16 v[32:47], a[100:103], v[20:23], v[32:47]
  ds_read_b128 v[20:23], v7 offset:29696
  s_waitcnt lgkmcnt(3)
  v_mfma_f32_32x32x16_bf16 v[32:47], a[104:107], v[24:27], v[32:47]
  ds_read_b128 v[24:27], v7 offset:30720
  s_waitcnt lgkmcnt(3)
  v_mfma_f32_32x32x16_bf16 v[32:47], a[108:111], v[28:31], v[32:47]
  ds_read_b128 v[28:31], v7 offset:31744
  s_waitcnt lgkmcnt(3)
  v_mfma_f32_32x32x16_bf16 v[32:47], a[112:115], v[16:19], v[32:47]
  s_cmp_eq_u32 s60, 2
  s_cbranch_scc1 L_h1b_335
  s_cmp_eq_u32 s60, 1
  s_cbranch_scc1 L_h1a_334
  s_waitcnt vmcnt(0)
L_h1a_334:
  s_waitcnt vmcnt(1)
L_h1b_335:
  s_waitcnt vmcnt(2)
  v_cmp_eq_u32 vcc, 0, v11
  s_cmp_lt_u32 s74, s57
  s_cselect_b64 s[70:71], vcc, -1
  s_cmp_eq_u64 s[70:71], 0
  s_cselect_b32 s89, s58, 7
L_h1c_336:
  s_barrier
  ds_read_b128 v[16:19], v7 offset:32768
  s_waitcnt lgkmcnt(3)
  v_mfma_f32_32x32x16_bf16 v[32:47], a[116:119], v[20:23], v[32:47]
  s_cmp_eq_u32 s89, 0
  s_cbranch_scc1 L_hwo_337
L_hwb_338:
  ds_read_b128 v[20:23], v7 offset:33792
  s_waitcnt lgkmcnt(3)
  v_mfma_f32_32x32x16_bf16 v[32:47], a[120:123], v[24:27], v[32:47]
  ds_read_b128 v[24:27], v7 offset:34816
  s_waitcnt lgkmcnt(3)
  v_mfma_f32_32x32x16_bf16 v[32:47], a[124:127], v[28:31], v[32:47]
  s_cmp_lg_u32 s89, 7
  s_cbranch_scc1 L_hre_339
  buffer_load_dword v11, v8, s[4:7], s96 offen sc1
L_hre_339:
  ds_read_b128 v[28:31], v7 offset:35840
  s_waitcnt lgkmcnt(3)
  v_mfma_f32_32x32x16_bf16 v[32:47], a[128:131], v[16:19], v[32:47]
  ds_read_b128 v[16:19], v7 offset:36864
  s_waitcnt lgkmcnt(3)
  v_mfma_f32_32x32x16_bf16 v[32:47], a[132:135], v[20:23], v[32:47]
  ds_read_b128 v[20:23], v7 offset:37888
  s_waitcnt lgkmcnt(3)
  v_mfma_f32_32x32x16_bf16 v[32:47], a[136:139], v[24:27], v[32:47]
  s_cmp_eq_u32 s89, 1
  s_cbranch_scc1 L_hwo_340
L_hwb_341:
  ds_read_b128 v[24:27], v7 offset:38912
  s_waitcnt lgkmcnt(3)
  v_mfma_f32_32x32x16_bf16 v[32:47], a[140:143], v[28:31], v[32:47]
  ds_read_b128 v[28:31], v7 offset:39936
  s_waitcnt lgkmcnt(3)
  v_mfma_f32_32x32x16_bf16 v[32:47], a[144:147], v[16:19], v[32:47]
  ds_read_b128 v[16:19], v7 offset:40960
  s_waitcnt lgkmcnt(3)
  v_mfma_f32_32x32x16_bf16 v[32:47], a[148:151], v[20:23], v[32:47]
  ds_read_b128 v[20:23], v7 offset:41984
  s_waitcnt lgkmcnt(3)
  v_mfma_f32_32x32x16_bf16 v[32:47], a[152:155], v[24:27], v[32:47]
  ds_read_b128 v[24:27], v7 offset:43008
  s_waitcnt lgkmcnt(3)
  v_mfma_f32_32x32x16_bf16 v[32:47], a[156:159], v[28:31], v[32:47]
  s_cmp_eq_u32 s89, 2
  s_cbranch_scc1 L_hwo_342
L_hwb_343:
  ds_read_b128 v[28:31], v7 offset:44032
  s_waitcnt lgkmcnt(3)
  v_mfma_f32_32x32x16_bf16 v[32:47], a[160:163], v[16:19], v[32:47]
  ds_read_b128 v[16:19], v7 offset:45056
  s_waitcnt lgkmcnt(3)
  v_mfma_f32_32x32x16_bf16 v[32:47], a[164:167], v[20:23], v[32:47]
  ds_read_b128 v[20:23], v7 offset:46080
  s_waitcnt lgkmcnt(3)
  v_mfma_f32_32x32x16_bf16 v[32:47], a[168:171], v[24:27], v[32:47]
  ds_read_b128 v[24:27], v7 offset:47104
  s_waitcnt lgkmcnt(3)
  v_mfma_f32_32x32x16_bf16 v[32:47], a[172:175], v[28:31], v[32:47]
  ds_read_b128 v[28:31], v7 offset:48128
  s_waitcnt lgkmcnt(3)
  v_mfma_f32_32x32x16_bf16 v[32:47], a[176:179], v[16:19], v[32:47]
  s_cmp_eq_u32 s89, 3
  s_cbranch_scc1 L_hwo_344
L_hwb_345:
  ds_read_b128 v[16:19], v7 offset:49152
  s_waitcnt lgkmcnt(3)
  v_mfma_f32_32x32x16_bf16 v[32:47], a[180:183], v[20:23], v[32:47]
  ds_read_b128 v[20:23], v7 offset:50176
  s_waitcnt lgkmcnt(3)
  v_mfma_f32_32x32x16_bf16 v[32:47], a[184:187], v[24:27], v[32:47]
  ds_read_b128 v[24:27], v7 offset:51200
  s_waitcnt lgkmcnt(3)
  v_mfma_f32_32x32x16_bf16 v[32:47], a[188:191], v[28:31], v[32:47]
  s_and_b32 s76, s55, 7
  s_lshl_b32 s76, s76, 17
  ds_read_b128 v[28:31], v7 offset:52224
  s_waitcnt lgkmcnt(3)
  v_mfma_f32_32x32x16_bf16 v[32:47], a[192:195], v[16:19], v[32:47]
  s_lshl_b32 s77, s73, 15
  s_add_u32 s76, s76, s77
  ds_read_b128 v[16:19], v7 offset:53248
  s_waitcnt lgkmcnt(3)
  v_mfma_f32_32x32x16_bf16 v[32:47], a[196:199], v[20:23], v[32:47]
  s_lshl_b32 s77, s54, 11
  s_add_u32 s76, s76, s77
  ds_read_b128 v[20:23], v7 offset:54272
  s_waitcnt lgkmcnt(3)
  v_mfma_f32_32x32x16_bf16 v[32:47], a[200:203], v[24:27], v[32:47]
  s_add_u32 s76, s76, s52
  s_add_u32 s76, s76, 0x4000000
  ds_read_b128 v[24:27], v7 offset:55296
  s_waitcnt lgkmcnt(3)
  v_mfma_f32_32x32x16_bf16 v[32:47], a[204:207], v[28:31], v[32:47]
  s_lshl_b32 s78, s55, 7
  s_lshl_b32 s79, s54, 5
  ds_read_b128 v[28:31], v7 offset:56320
  s_waitcnt lgkmcnt(3)
  v_mfma_f32_32x32x16_bf16 v[32:47], a[208:211], v[16:19], v[32:47]
  s_add_u32 s78, s78, s79
  s_lshl_b32 s79, s73, 4
  s_waitcnt lgkmcnt(2)
  v_mfma_f32_32x32x16_bf16 v[32:47], a[212:215], v[20:23], v[32:47]
  s_add_u32 s78, s78, s79
  s_add_u32 s78, s78, 0x21000
  s_waitcnt lgkmcnt(1)
  v_mfma_f32_32x32x16_bf16 v[32:47], a[216:219], v[24:27], v[32:47]
  s_add_u32 s78, s78, s53
  s_waitcnt lgkmcnt(0)
  v_mfma_f32_32x32x16_bf16 v[32:47], a[220:223], v[28:31], v[32:47]
  s_cmp_lg_u32 s59, 1
  s_cbranch_scc1 L_late_346
  s_mov_b32 s60, 1
  s_branch L_nl_348
  s_cmp_eq_u32 s80, 1
  s_cbranch_scc1 L_st1_347
  s_waitcnt vmcnt(0)
L_st1_347:
  s_waitcnt vmcnt(1)
  s_barrier
  ds_read_b128 v[16:19], v112 offset:0
  ds_read_b128 v[20:23], v112 offset:1024
  ds_read_b128 v[24:27], v112 offset:2048
  s_mov_b32 s60, 2
  s_mov_b32 s55, s74
  s_branch L_s5b1_326
L_late_346:
  s_mov_b32 s60, 0
  s_waitcnt vmcnt(0)
  s_cmp_ge_u32 s74, s57
  s_cbranch_scc1 L_nl_348
  v_cmp_eq_u32 vcc, 0, v11
  s_cbranch_vccnz L_nl_348
  s_mov_b32 s64, 0x10000
  s_and_b32 s61, s74, 7
  s_mul_i32 s61, s61, 114688
  s_mul_i32 s68, s73, 57344
  s_add_u32 s61, s61, s68
  s_add_u32 s61, s61, 0x4800000
  s_add_u32 s61, s61, s52
  s_lshl_b32 s62, s58, 12
  s_add_u32 m0, s62, s64
  s_nop 0
  buffer_load_dwordx4 v6, s[4:7], s61 offen offset:0 sc1 lds
  buffer_load_dwordx4 v6, s[4:7], s61 offen offset:1024 sc1 lds
  buffer_load_dwordx4 v6, s[4:7], s61 offen offset:2048 sc1 lds
  buffer_load_dwordx4 v6, s[4:7], s61 offen offset:3072 sc1 lds
  s_add_u32 m0, m0, 0x4000
  s_add_u32 s61, s61, 0x4000
  buffer_load_dwordx4 v6, s[4:7], s61 offen offset:0 sc1 lds
  buffer_load_dwordx4 v6, s[4:7], s61 offen offset:1024 sc1 lds
  buffer_load_dwordx4 v6, s[4:7], s61 offen offset:2048 sc1 lds
  buffer_load_dwordx4 v6, s[4:7], s61 offen offset:3072 sc1 lds
  s_add_u32 m0, m0, 0x4000
  s_add_u32 s61, s61, 0x4000
  buffer_load_dwordx4 v6, s[4:7], s61 offen offset:0 sc1 lds
  buffer_load_dwordx4 v6, s[4:7], s61 offen offset:1024 sc1 lds
  buffer_load_dwordx4 v6, s[4:7], s61 offen offset:2048 sc1 lds
  buffer_load_dwordx4 v6, s[4:7], s61 offen offset:3072 sc1 lds
  s_add_u32 m0, m0, 0x4000
  s_add_u32 s61, s61, 0x4000
  buffer_load_dwordx4 v6, s[4:7], s61 offen offset:0 sc1 lds
  buffer_load_dwordx4 v6, s[4:7], s61 offen offset:1024 sc1 lds
  buffer_load_dwordx4 v6, s[4:7], s61 offen offset:2048 sc1 lds
  buffer_load_dwordx4 v6, s[4:7], s61 offen offset:3072 sc1 lds
  s_mov_b32 s60, 1
L_nl_348:
  s_nop 7
  v_cvt_pk_bf16_f32 v64, v32, v33
  v_cvt_pk_bf16_f32 v65, v34, v35
  v_cvt_pk_bf16_f32 v66, v36, v37
  v_cvt_pk_bf16_f32 v67, v38, v39
  buffer_store_dwordx4 v[64:67], v12, s[4:7], s76 offen offset:0 sc1
  v_cvt_pk_bf16_f32 v68, v40, v41
  v_cvt_pk_bf16_f32 v69, v42, v43
  v_cvt_pk_bf16_f32 v70, v44, v45
  v_cvt_pk_bf16_f32 v71, v46, v47
  buffer_store_dwordx4 v[68:71], v12, s[4:7], s76 offen offset:256 sc1
  s_mov_b32 s88, s78
  s_mov_b32 s55, s74
  s_cmp_lt_u32 s55, s57
  s_cbranch_scc1 L_s5h1_324
  s_waitcnt vmcnt(0)
  s_cmp_eq_u32 s88, 0
  s_cbranch_scc1 L_nofl_349
  s_mov_b64 exec, 1
  buffer_store_dword v10, v9, s[4:7], s88 offen sc1
  s_mov_b64 exec, -1
  s_mov_b32 s88, 0
L_nofl_349:
  s_endpgm
L_s5h1_324:
  s_cmp_eq_u32 s60, 1
  s_cbranch_scc1 L_hp_350
  s_lshl_b32 s63, s55, 8
  s_mul_i32 s68, s73, 112
  s_add_u32 s63, s63, s68
  s_add_u32 s63, s63, 0x1d000
  s_add_u32 s63, s63, s53
  s_and_b32 s61, s55, 7
  s_mul_i32 s61, s61, 114688
  s_mul_i32 s68, s73, 57344
  s_add_u32 s61, s61, s68
  s_add_u32 s61, s61, 0x4800000
  s_add_u32 s61, s61, s52
  s_lshl_b32 s62, s58, 12
  s_add_u32 m0, s62, 0x10000
L_poll_352:
  buffer_load_dword v11, v8, s[4:7], s63 offen sc1
  s_waitcnt vmcnt(0)
  s_cmp_eq_u32 s88, 0
  s_cbranch_scc1 L_nofl_354
  s_mov_b64 exec, 1
  buffer_store_dword v10, v9, s[4:7], s88 offen sc1
  s_mov_b64 exec, -1
  s_mov_b32 s88, 0
L_nofl_354:
  v_cmp_eq_u32 vcc, 0, v11
  s_cbranch_vccz L_pollok_353
  s_add_u32 s72, s72, 1
  s_cmp_gt_u32 s72, 0x80000
  s_cbranch_scc1 L_exit
  s_branch L_poll_352
L_pollok_353:
  buffer_load_dwordx4 v6, s[4:7], s61 offen offset:0 sc1 lds
  buffer_load_dwordx4 v6, s[4:7], s61 offen offset:1024 sc1 lds
  buffer_load_dwordx4 v6, s[4:7], s61 offen offset:2048 sc1 lds
  buffer_load_dwordx4 v6, s[4:7], s61 offen offset:3072 sc1 lds
  s_add_u32 m0, m0, 0x4000
  s_add_u32 s61, s61, 0x4000
  buffer_load_dwordx4 v6, s[4:7], s61 offen offset:0 sc1 lds
  buffer_load_dwordx4 v6, s[4:7], s61 offen offset:1024 sc1 lds
  buffer_load_dwordx4 v6, s[4:7], s61 offen offset:2048 sc1 lds
  buffer_load_dwordx4 v6, s[4:7], s61 offen offset:3072 sc1 lds
  s_add_u32 m0, m0, 0x4000
  s_add_u32 s61, s61, 0x4000
  buffer_load_dwordx4 v6, s[4:7], s61 offen offset:0 sc1 lds
  buffer_load_dwordx4 v6, s[4:7], s61 offen offset:1024 sc1 lds
  buffer_load_dwordx4 v6, s[4:7], s61 offen offset:2048 sc1 lds
  buffer_load_dwordx4 v6, s[4:7], s61 offen offset:3072 sc1 lds
  s_add_u32 m0, m0, 0x4000
  s_add_u32 s61, s61, 0x4000
  buffer_load_dwordx4 v6, s[4:7], s61 offen offset:0 sc1 lds
  buffer_load_dwordx4 v6, s[4:7], s61 offen offset:1024 sc1 lds
  buffer_load_dwordx4 v6, s[4:7], s61 offen offset:2048 sc1 lds
  buffer_load_dwordx4 v6, s[4:7], s61 offen offset:3072 sc1 lds
  s_waitcnt vmcnt(12)
  s_branch L_hj_351
L_hp_350:
  s_waitcnt vmcnt(2)
L_hj_351:
  s_barrier
  ds_read_b128 v[16:19], v112 offset:0
  ds_read_b128 v[20:23], v112 offset:1024
  ds_read_b128 v[24:27], v112 offset:2048
L_s5b1_326:
  s_add_u32 s74, s55, s56
  s_min_u32 s64, s74, 63
  s_lshl_b32 s96, s64, 8
  s_mul_i32 s68, s73, 112
  s_add_u32 s96, s96, s68
  s_add_u32 s96, s96, 0x1d000
  s_add_u32 s96, s96, s53
  s_mov_b32 s59, 0
  s_mov_b32 s80, 0
  ds_read_b128 v[28:31], v112 offset:3072
  s_waitcnt lgkmcnt(3)
  v_mfma_f32_32x32x16_bf16 v[80:95], a[0:3], v[16:19], 0
  buffer_load_dword v11, v8, s[4:7], s96 offen sc1
  ds_read_b128 v[16:19], v112 offset:4096
  s_waitcnt lgkmcnt(3)
  v_mfma_f32_32x32x16_bf16 v[80:95], a[4:7], v[20:23], v[80:95]
  ds_read_b128 v[20:23], v112 offset:5120
  s_waitcnt lgkmcnt(3)
  v_mfma_f32_32x32x16_bf16 v[80:95], a[8:11], v[24:27], v[80:95]
  ds_read_b128 v[24:27], v112 offset:6144
  s_waitcnt lgkmcnt(3)
  v_mfma_f32_32x32x16_bf16 v[80:95], a[12:15], v[28:31], v[80:95]
  ds_read_b128 v[28:31], v112 offset:7168
  s_waitcnt lgkmcnt(3)
  v_mfma_f32_32x32x16_bf16 v[80:95], a[16:19], v[16:19], v[80:95]
  ds_read_b128 v[16:19], v112 offset:8192
  s_waitcnt lgkmcnt(3)
  v_mfma_f32_32x32x16_bf16 v[80:95], a[20:23], v[20:23], v[80:95]
  ds_read_b128 v[20:23], v112 offset:9216
  s_waitcnt lgkmcnt(3)
  v_mfma_f32_32x32x16_bf16 v[80:95], a[24:27], v[24:27], v[80:95]
  ds_read_b128 v[24:27], v112 offset:10240
  s_waitcnt lgkmcnt(3)
  v_mfma_f32_32x32x16_bf16 v[80:95], a[28:31], v[28:31], v[80:95]
  ds_read_b128 v[28:31], v112 offset:11264
  s_waitcnt lgkmcnt(3)
  v_mfma_f32_32x32x16_bf16 v[80:95], a[32:35], v[16:19], v[80:95]
  ds_read_b128 v[16:19], v112 offset:12288
  s_waitcnt lgkmcnt(3)
  v_mfma_f32_32x32x16_bf16 v[80:95], a[36:39], v[20:23], v[80:95]
  ds_read_b128 v[20:23], v112 offset:13312
  s_waitcnt lgkmcnt(3)
  v_mfma_f32_32x32x16_bf16 v[80:95], a[40:43], v[24:27], v[80:95]
  ds_read_b128 v[24:27], v112 offset:14336
  s_waitcnt lgkmcnt(3)
  v_mfma_f32_32x32x16_bf16 v[80:95], a[44:47], v[28:31], v[80:95]
  ds_read_b128 v[28:31], v112 offset:15360
  s_waitcnt lgkmcnt(3)
  v_mfma_f32_32x32x16_bf16 v[80:95], a[48:51], v[16:19], v[80:95]
  s_cmp_lg_u32 s60, 0
  s_cbranch_scc1 L_hm_355
  s_waitcnt vmcnt(9)
L_hm_355:
  s_barrier
  ds_read_b128 v[16:19], v112 offset:16384
  s_waitcnt lgkmcnt(3)
  v_mfma_f32_32x32x16_bf16 v[80:95], a[52:55], v[20:23], v[80:95]
  ds_read_b128 v[20:23], v112 offset:17408
  s_waitcnt lgkmcnt(3)
  v_mfma_f32_32x32x16_bf16 v[80:95], a[56:59], v[24:27], v[80:95]
  ds_read_b128 v[24:27], v112 offset:18432
  s_waitcnt lgkmcnt(3)
  v_mfma_f32_32x32x16_bf16 v[80:95], a[60:63], v[28:31], v[80:95]
  ds_read_b128 v[28:31], v112 offset:19456
  s_waitcnt lgkmcnt(3)
  v_mfma_f32_32x32x16_bf16 v[80:95], a[64:67], v[16:19], v[80:95]
  ds_read_b128 v[16:19], v112 offset:20480
  s_waitcnt lgkmcnt(3)
  v_mfma_f32_32x32x16_bf16 v[80:95], a[68:71], v[20:23], v[80:95]
  ds_read_b128 v[20:23], v112 offset:21504
  s_waitcnt lgkmcnt(3)
  v_mfma_f32_32x32x16_bf16 v[80:95], a[72:75], v[24:27], v[80:95]
  ds_read_b128 v[24:27], v112 offset:22528
  s_waitcnt lgkmcnt(3)
  v_mfma_f32_32x32x16_bf16 v[80:95], a[76:79], v[28:31], v[80:95]
  ds_read_b128 v[28:31], v112 offset:23552
  s_waitcnt lgkmcnt(3)
  v_mfma_f32_32x32x16_bf16 v[80:95], a[80:83], v[16:19], v[80:95]
  ds_read_b128 v[16:19], v112 offset:24576
  s_waitcnt lgkmcnt(3)
  v_mfma_f32_32x32x16_bf16 v[80:95], a[84:87], v[20:23], v[80:95]
  s_cmp_lg_u32 s60, 1
  s_cbranch_scc1 L_hfa_356
  s_waitcnt vmcnt(1)
  s_mov_b64 exec, 1
  buffer_store_dword v10, v9, s[4:7], s88 offen sc1
  s_mov_b64 exec, -1
  s_mov_b32 s88, 0
L_hfa_356:
  ds_read_b128 v[20:23], v112 offset:25600
  s_waitcnt lgkmcnt(3)
  v_mfma_f32_32x32x16_bf16 v[80:95], a[88:91], v[24:27], v[80:95]
  ds_read_b128 v[24:27], v112 offset:26624
  s_waitcnt lgkmcnt(3)
  v_mfma_f32_32x32x16_bf16 v[80:95], a[92:95], v[28:31], v[80:95]
  ds_read_b128 v[28:31], v112 offset:27648
  s_waitcnt lgkmcnt(3)
  v_mfma_f32_32x32x16_bf16 v[80:95], a[96:99], v[16:19], v[80:95]
  ds_read_b128 v[16:19], v112 offset:28672
  s_waitcnt lgkmcnt(3)
  v_mfma_f32_32x32x16_bf16 v[80:95], a[100:103], v[20:23], v[80:95]
  ds_read_b128 v[20:23], v112 offset:29696
  s_waitcnt lgkmcnt(3)
  v_mfma_f32_32x32x16_bf16 v[80:95], a[104:107], v[24:27], v[80:95]
  ds_read_b128 v[24:27], v112 offset:30720
  s_waitcnt lgkmcnt(3)
  v_mfma_f32_32x32x16_bf16 v[80:95], a[108:111], v[28:31], v[80:95]
  ds_read_b128 v[28:31], v112 offset:31744
  s_waitcnt lgkmcnt(3)
  v_mfma_f32_32x32x16_bf16 v[80:95], a[112:115], v[16:19], v[80:95]
  s_cmp_eq_u32 s60, 2
  s_cbranch_scc1 L_h1b_358
  s_cmp_eq_u32 s60, 1
  s_cbranch_scc1 L_h1a_357
  s_waitcnt vmcnt(0)
L_h1a_357:
  s_waitcnt vmcnt(1)
L_h1b_358:
  s_waitcnt vmcnt(2)
  v_cmp_eq_u32 vcc, 0, v11
  s_cmp_lt_u32 s74, s57
  s_cselect_b64 s[70:71], vcc, -1
  s_cmp_eq_u64 s[70:71], 0
  s_cselect_b32 s89, s58, 7
L_h1c_359:
  s_barrier
  ds_read_b128 v[16:19], v112 offset:32768
  s_waitcnt lgkmcnt(3)
  v_mfma_f32_32x32x16_bf16 v[80:95], a[116:119], v[20:23], v[80:95]
  s_cmp_eq_u32 s89, 0
  s_cbranch_scc1 L_hwo_360
L_hwb_361:
  ds_read_b128 v[20:23], v112 offset:33792
  s_waitcnt lgkmcnt(3)
  v_mfma_f32_32x32x16_bf16 v[80:95], a[120:123], v[24:27], v[80:95]
  ds_read_b128 v[24:27], v112 offset:34816
  s_waitcnt lgkmcnt(3)
  v_mfma_f32_32x32x16_bf16 v[80:95], a[124:127], v[28:31], v[80:95]
  s_cmp_lg_u32 s89, 7
  s_cbranch_scc1 L_hre_362
  buffer_load_dword v11, v8, s[4:7], s96 offen sc1
L_hre_362:
  ds_read_b128 v[28:31], v112 offset:35840
  s_waitcnt lgkmcnt(3)
  v_mfma_f32_32x32x16_bf16 v[80:95], a[128:131], v[16:19], v[80:95]
  ds_read_b128 v[16:19], v112 offset:36864
  s_waitcnt lgkmcnt(3)
  v_mfma_f32_32x32x16_bf16 v[80:95], a[132:135], v[20:23], v[80:95]
  ds_read_b128 v[20:23], v112 offset:37888
  s_waitcnt lgkmcnt(3)
  v_mfma_f32_32x32x16_bf16 v[80:95], a[136:139], v[24:27], v[80:95]
  s_cmp_eq_u32 s89, 1
  s_cbranch_scc1 L_hwo_363
L_hwb_364:
  ds_read_b128 v[24:27], v112 offset:38912
  s_waitcnt lgkmcnt(3)
  v_mfma_f32_32x32x16_bf16 v[80:95], a[140:143], v[28:31], v[80:95]
  ds_read_b128 v[28:31], v112 offset:39936
  s_waitcnt lgkmcnt(3)
  v_mfma_f32_32x32x16_bf16 v[80:95], a[144:147], v[16:19], v[80:95]
  ds_read_b128 v[16:19], v112 offset:40960
  s_waitcnt lgkmcnt(3)
  v_mfma_f32_32x32x16_bf16 v[80:95], a[148:151], v[20:23], v[80:95]
  ds_read_b128 v[20:23], v112 offset:41984
  s_waitcnt lgkmcnt(3)
  v_mfma_f32_32x32x16_bf16 v[80:95], a[152:155], v[24:27], v[80:95]
  ds_read_b128 v[24:27], v112 offset:43008
  s_waitcnt lgkmcnt(3)
  v_mfma_f32_32x32x16_bf16 v[80:95], a[156:159], v[28:31], v[80:95]
  s_cmp_eq_u32 s89, 2
  s_cbranch_scc1 L_hwo_365
L_hwb_366:
  ds_read_b128 v[28:31], v112 offset:44032
  s_waitcnt lgkmcnt(3)
  v_mfma_f32_32x32x16_bf16 v[80:95], a[160:163], v[16:19], v[80:95]
  ds_read_b128 v[16:19], v112 offset:45056
  s_waitcnt lgkmcnt(3)
  v_mfma_f32_32x32x16_bf16 v[80:95], a[164:167], v[20:23], v[80:95]
  ds_read_b128 v[20:23], v112 offset:46080
  s_waitcnt lgkmcnt(3)
  v_mfma_f32_32x32x16_bf16 v[80:95], a[168:171], v[24:27], v[80:95]
  ds_read_b128 v[24:27], v112 offset:47104
  s_waitcnt lgkmcnt(3)
  v_mfma_f32_32x32x16_bf16 v[80:95], a[172:175], v[28:31], v[80:95]
  ds_read_b128 v[28:31], v112 offset:48128
  s_waitcnt lgkmcnt(3)
  v_mfma_f32_32x32x16_bf16 v[80:95], a[176:179], v[16:19], v[80:95]
  s_cmp_eq_u32 s89, 3
  s_cbranch_scc1 L_hwo_367
L_hwb_368:
  ds_read_b128 v[16:19], v112 offset:49152
  s_waitcnt lgkmcnt(3)
  v_mfma_f32_32x32x16_bf16 v[80:95], a[180:183], v[20:23], v[80:95]
  ds_read_b128 v[20:23], v112 offset:50176
  s_waitcnt lgkmcnt(3)
  v_mfma_f32_32x32x16_bf16 v[80:95], a[184:187], v[24:27], v[80:95]
  ds_read_b128 v[24:27], v112 offset:51200
  s_waitcnt lgkmcnt(3)
  v_mfma_f32_32x32x16_bf16 v[80:95], a[188:191], v[28:31], v[80:95]
  s_and_b32 s76, s55, 7
  s_lshl_b32 s76, s76, 17
  ds_read_b128 v[28:31], v112 offset:52224
  s_waitcnt lgkmcnt(3)
  v_mfma_f32_32x32x16_bf16 v[80:95], a[192:195], v[16:19], v[80:95]
  s_lshl_b32 s77, s73, 15
  s_add_u32 s76, s76, s77
  ds_read_b128 v[16:19], v112 offset:53248
  s_waitcnt lgkmcnt(3)
  v_mfma_f32_32x32x16_bf16 v[80:95], a[196:199], v[20:23], v[80:95]
  s_lshl_b32 s77, s54, 11
  s_add_u32 s76, s76, s77
  ds_read_b128 v[20:23], v112 offset:54272
  s_waitcnt lgkmcnt(3)
  v_mfma_f32_32x32x16_bf16 v[80:95], a[200:203], v[24:27], v[80:95]
  s_add_u32 s76, s76, s52
  s_add_u32 s76, s76, 0x4000000
  ds_read_b128 v[24:27], v112 offset:55296
  s_waitcnt lgkmcnt(3)
  v_mfma_f32_32x32x16_bf16 v[80:95], a[204:207], v[28:31], v[80:95]
  s_lshl_b32 s78, s55, 7
  s_lshl_b32 s79, s54, 5
  ds_read_b128 v[28:31], v112 offset:56320
  s_waitcnt lgkmcnt(3)
  v_mfma_f32_32x32x16_bf16 v[80:95], a[208:211], v[16:19], v[80:95]
  s_add_u32 s78, s78, s79
  s_lshl_b32 s79, s73, 4
  s_waitcnt lgkmcnt(2)
  v_mfma_f32_32x32x16_bf16 v[80:95], a[212:215], v[20:23], v[80:95]
  s_add_u32 s78, s78, s79
  s_add_u32 s78, s78, 0x21000
  s_waitcnt lgkmcnt(1)
  v_mfma_f32_32x32x16_bf16 v[80:95], a[216:219], v[24:27], v[80:95]
  s_add_u32 s78, s78, s53
  s_waitcnt lgkmcnt(0)
  v_mfma_f32_32x32x16_bf16 v[80:95], a[220:223], v[28:31], v[80:95]
  s_cmp_lg_u32 s59, 1
  s_cbranch_scc1 L_late_369
  s_mov_b32 s60, 1
  s_branch L_nl_371
  s_cmp_eq_u32 s80, 1
  s_cbranch_scc1 L_st1_370
  s_waitcnt vmcnt(0)
L_st1_370:
  s_waitcnt vmcnt(1)
  s_barrier
  ds_read_b128 v[16:19], v7 offset:0
  ds_read_b128 v[20:23], v7 offset:1024
  ds_read_b128 v[24:27], v7 offset:2048
  s_mov_b32 s60, 2
  s_mov_b32 s55, s74
  s_branch L_s5b0_325
L_late_369:
  s_mov_b32 s60, 0
  s_waitcnt vmcnt(0)
  s_cmp_ge_u32 s74, s57
  s_cbranch_scc1 L_nl_371
  v_cmp_eq_u32 vcc, 0, v11
  s_cbranch_vccnz L_nl_371
  s_mov_b32 s64, 0x0
  s_and_b32 s61, s74, 7
  s_mul_i32 s61, s61, 114688
  s_mul_i32 s68, s73, 57344
  s_add_u32 s61, s61, s68
  s_add_u32 s61, s61, 0x4800000
  s_add_u32 s61, s61, s52
  s_lshl_b32 s62, s58, 12
  s_add_u32 m0, s62, s64
  s_nop 0
  buffer_load_dwordx4 v6, s[4:7], s61 offen offset:0 sc1 lds
  buffer_load_dwordx4 v6, s[4:7], s61 offen offset:1024 sc1 lds
  buffer_load_dwordx4 v6, s[4:7], s61 offen offset:2048 sc1 lds
  buffer_load_dwordx4 v6, s[4:7], s61 offen offset:3072 sc1 lds
  s_add_u32 m0, m0, 0x4000
  s_add_u32 s61, s61, 0x4000
  buffer_load_dwordx4 v6, s[4:7], s61 offen offset:0 sc1 lds
  buffer_load_dwordx4 v6, s[4:7], s61 offen offset:1024 sc1 lds
  buffer_load_dwordx4 v6, s[4:7], s61 offen offset:2048 sc1 lds
  buffer_load_dwordx4 v6, s[4:7], s61 offen offset:3072 sc1 lds
  s_add_u32 m0, m0, 0x4000
  s_add_u32 s61, s61, 0x4000
  buffer_load_dwordx4 v6, s[4:7], s61 offen offset:0 sc1 lds
  buffer_load_dwordx4 v6, s[4:7], s61 offen offset:1024 sc1 lds
  buffer_load_dwordx4 v6, s[4:7], s61 offen offset:2048 sc1 lds
  buffer_load_dwordx4 v6, s[4:7], s61 offen offset:3072 sc1 lds
  s_add_u32 m0, m0, 0x4000
  s_add_u32 s61, s61, 0x4000
  buffer_load_dwordx4 v6, s[4:7], s61 offen offset:0 sc1 lds
  buffer_load_dwordx4 v6, s[4:7], s61 offen offset:1024 sc1 lds
  buffer_load_dwordx4 v6, s[4:7], s61 offen offset:2048 sc1 lds
  buffer_load_dwordx4 v6, s[4:7], s61 offen offset:3072 sc1 lds
  s_mov_b32 s60, 1
L_nl_371:
  s_nop 7
  v_cvt_pk_bf16_f32 v64, v80, v81
  v_cvt_pk_bf16_f32 v65, v82, v83
  v_cvt_pk_bf16_f32 v66, v84, v85
  v_cvt_pk_bf16_f32 v67, v86, v87
  buffer_store_dwordx4 v[64:67], v12, s[4:7], s76 offen offset:0 sc1
  v_cvt_pk_bf16_f32 v68, v88, v89
  v_cvt_pk_bf16_f32 v69, v90, v91
  v_cvt_pk_bf16_f32 v70, v92, v93
  v_cvt_pk_bf16_f32 v71, v94, v95
  buffer_store_dwordx4 v[68:71], v12, s[4:7], s76 offen offset:256 sc1
  s_mov_b32 s88, s78
  s_mov_b32 s55, s74
  s_cmp_lt_u32 s55, s57
  s_cbranch_scc1 L_s5h0_323
  s_waitcnt vmcnt(0)
  s_cmp_eq_u32 s88, 0
  s_cbranch_scc1 L_nofl_372
  s_mov_b64 exec, 1
  buffer_store_dword v10, v9, s[4:7], s88 offen sc1
  s_mov_b64 exec, -1
  s_mov_b32 s88, 0
L_nofl_372:
  s_endpgm
L_hwo_337:
  s_mov_b32 s64, 0x10000
  s_and_b32 s61, s74, 7
  s_mul_i32 s61, s61, 114688
  s_mul_i32 s68, s73, 57344
  s_add_u32 s61, s61, s68
  s_add_u32 s61, s61, 0x4800000
  s_add_u32 s61, s61, s52
  s_lshl_b32 s62, s58, 12
  s_add_u32 m0, s62, s64
  s_nop 0
  buffer_load_dwordx4 v6, s[4:7], s61 offen offset:0 sc1 lds
  buffer_load_dwordx4 v6, s[4:7], s61 offen offset:1024 sc1 lds
  buffer_load_dwordx4 v6, s[4:7], s61 offen offset:2048 sc1 lds
  buffer_load_dwordx4 v6, s[4:7], s61 offen offset:3072 sc1 lds
  s_add_u32 m0, m0, 0x4000
  s_add_u32 s61, s61, 0x4000
  buffer_load_dwordx4 v6, s[4:7], s61 offen offset:0 sc1 lds
  buffer_load_dwordx4 v6, s[4:7], s61 offen offset:1024 sc1 lds
  buffer_load_dwordx4 v6, s[4:7], s61 offen offset:2048 sc1 lds
  buffer_load_dwordx4 v6, s[4:7], s61 offen offset:3072 sc1 lds
  s_add_u32 m0, m0, 0x4000
  s_add_u32 s61, s61, 0x4000
  buffer_load_dwordx4 v6, s[4:7], s61 offen offset:0 sc1 lds
  buffer_load_dwordx4 v6, s[4:7], s61 offen offset:1024 sc1 lds
  buffer_load_dwordx4 v6, s[4:7], s61 offen offset:2048 sc1 lds
  buffer_load_dwordx4 v6, s[4:7], s61 offen offset:3072 sc1 lds
  s_add_u32 m0, m0, 0x4000
  s_add_u32 s61, s61, 0x4000
  buffer_load_dwordx4 v6, s[4:7], s61 offen offset:0 sc1 lds
  buffer_load_dwordx4 v6, s[4:7], s61 offen offset:1024 sc1 lds
  buffer_load_dwordx4 v6, s[4:7], s61 offen offset:2048 sc1 lds
  buffer_load_dwordx4 v6, s[4:7], s61 offen offset:3072 sc1 lds
  s_mov_b32 s59, 1
  s_branch L_hwb_338
L_hwo_340:
  s_mov_b32 s64, 0x10000
  s_and_b32 s61, s74, 7
  s_mul_i32 s61, s61, 114688
  s_mul_i32 s68, s73, 57344
  s_add_u32 s61, s61, s68
  s_add_u32 s61, s61, 0x4800000
  s_add_u32 s61, s61, s52
  s_lshl_b32 s62, s58, 12
  s_add_u32 m0, s62, s64
  s_nop 0
  buffer_load_dwordx4 v6, s[4:7], s61 offen offset:0 sc1 lds
  buffer_load_dwordx4 v6, s[4:7], s61 offen offset:1024 sc1 lds
  buffer_load_dwordx4 v6, s[4:7], s61 offen offset:2048 sc1 lds
  buffer_load_dwordx4 v6, s[4:7], s61 offen offset:3072 sc1 lds
  s_add_u32 m0, m0, 0x4000
  s_add_u32 s61, s61, 0x4000
  buffer_load_dwordx4 v6, s[4:7], s61 offen offset:0 sc1 lds
  buffer_load_dwordx4 v6, s[4:7], s61 offen offset:1024 sc1 lds
  buffer_load_dwordx4 v6, s[4:7], s61 offen offset:2048 sc1 lds
  buffer_load_dwordx4 v6, s[4:7], s61 offen offset:3072 sc1 lds
  s_add_u32 m0, m0, 0x4000
  s_add_u32 s61, s61, 0x4000
  buffer_load_dwordx4 v6, s[4:7], s61 offen offset:0 sc1 lds
  buffer_load_dwordx4 v6, s[4:7], s61 offen offset:1024 sc1 lds
  buffer_load_dwordx4 v6, s[4:7], s61 offen offset:2048 sc1 lds
  buffer_load_dwordx4 v6, s[4:7], s61 offen offset:3072 sc1 lds
  s_add_u32 m0, m0, 0x4000
  s_add_u32 s61, s61, 0x4000
  buffer_load_dwordx4 v6, s[4:7], s61 offen offset:0 sc1 lds
  buffer_load_dwordx4 v6, s[4:7], s61 offen offset:1024 sc1 lds
  buffer_load_dwordx4 v6, s[4:7], s61 offen offset:2048 sc1 lds
  buffer_load_dwordx4 v6, s[4:7], s61 offen offset:3072 sc1 lds
  s_mov_b32 s59, 1
  s_branch L_hwb_341
L_hwo_342:
  s_mov_b32 s64, 0x10000
  s_and_b32 s61, s74, 7
  s_mul_i32 s61, s61, 114688
  s_mul_i32 s68, s73, 57344
  s_add_u32 s61, s61, s68
  s_add_u32 s61, s61, 0x4800000
  s_add_u32 s61, s61, s52
  s_lshl_b32 s62, s58, 12
  s_add_u32 m0, s62, s64
  s_nop 0
  buffer_load_dwordx4 v6, s[4:7], s61 offen offset:0 sc1 lds
  buffer_load_dwordx4 v6, s[4:7], s61 offen offset:1024 sc1 lds
  buffer_load_dwordx4 v6, s[4:7], s61 offen offset:2048 sc1 lds
  buffer_load_dwordx4 v6, s[4:7], s61 offen offset:3072 sc1 lds
  s_add_u32 m0, m0, 0x4000
  s_add_u32 s61, s61, 0x4000
  buffer_load_dwordx4 v6, s[4:7], s61 offen offset:0 sc1 lds
  buffer_load_dwordx4 v6, s[4:7], s61 offen offset:1024 sc1 lds
  buffer_load_dwordx4 v6, s[4:7], s61 offen offset:2048 sc1 lds
  buffer_load_dwordx4 v6, s[4:7], s61 offen offset:3072 sc1 lds
  s_add_u32 m0, m0, 0x4000
  s_add_u32 s61, s61, 0x4000
  buffer_load_dwordx4 v6, s[4:7], s61 offen offset:0 sc1 lds
  buffer_load_dwordx4 v6, s[4:7], s61 offen offset:1024 sc1 lds
  buffer_load_dwordx4 v6, s[4:7], s61 offen offset:2048 sc1 lds
  buffer_load_dwordx4 v6, s[4:7], s61 offen offset:3072 sc1 lds
  s_add_u32 m0, m0, 0x4000
  s_add_u32 s61, s61, 0x4000
  buffer_load_dwordx4 v6, s[4:7], s61 offen offset:0 sc1 lds
  buffer_load_dwordx4 v6, s[4:7], s61 offen offset:1024 sc1 lds
  buffer_load_dwordx4 v6, s[4:7], s61 offen offset:2048 sc1 lds
  buffer_load_dwordx4 v6, s[4:7], s61 offen offset:3072 sc1 lds
  s_mov_b32 s59, 1
  s_branch L_hwb_343
L_hwo_344:
  s_mov_b32 s64, 0x10000
  s_and_b32 s61, s74, 7
  s_mul_i32 s61, s61, 114688
  s_mul_i32 s68, s73, 57344
  s_add_u32 s61, s61, s68
  s_add_u32 s61, s61, 0x4800000
  s_add_u32 s61, s61, s52
  s_lshl_b32 s62, s58, 12
  s_add_u32 m0, s62, s64
  s_nop 0
  buffer_load_dwordx4 v6, s[4:7], s61 offen offset:0 sc1 lds
  buffer_load_dwordx4 v6, s[4:7], s61 offen offset:1024 sc1 lds
  buffer_load_dwordx4 v6, s[4:7], s61 offen offset:2048 sc1 lds
  buffer_load_dwordx4 v6, s[4:7], s61 offen offset:3072 sc1 lds
  s_add_u32 m0, m0, 0x4000
  s_add_u32 s61, s61, 0x4000
  buffer_load_dwordx4 v6, s[4:7], s61 offen offset:0 sc1 lds
  buffer_load_dwordx4 v6, s[4:7], s61 offen offset:1024 sc1 lds
  buffer_load_dwordx4 v6, s[4:7], s61 offen offset:2048 sc1 lds
  buffer_load_dwordx4 v6, s[4:7], s61 offen offset:3072 sc1 lds
  s_add_u32 m0, m0, 0x4000
  s_add_u32 s61, s61, 0x4000
  buffer_load_dwordx4 v6, s[4:7], s61 offen offset:0 sc1 lds
  buffer_load_dwordx4 v6, s[4:7], s61 offen offset:1024 sc1 lds
  buffer_load_dwordx4 v6, s[4:7], s61 offen offset:2048 sc1 lds
  buffer_load_dwordx4 v6, s[4:7], s61 offen offset:3072 sc1 lds
  s_add_u32 m0, m0, 0x4000
  s_add_u32 s61, s61, 0x4000
  buffer_load_dwordx4 v6, s[4:7], s61 offen offset:0 sc1 lds
  buffer_load_dwordx4 v6, s[4:7], s61 offen offset:1024 sc1 lds
  buffer_load_dwordx4 v6, s[4:7], s61 offen offset:2048 sc1 lds
  buffer_load_dwordx4 v6, s[4:7], s61 offen offset:3072 sc1 lds
  s_mov_b32 s59, 1
  s_branch L_hwb_345
L_hwo_360:
  s_mov_b32 s64, 0x0
  s_and_b32 s61, s74, 7
  s_mul_i32 s61, s61, 114688
  s_mul_i32 s68, s73, 57344
  s_add_u32 s61, s61, s68
  s_add_u32 s61, s61, 0x4800000
  s_add_u32 s61, s61, s52
  s_lshl_b32 s62, s58, 12
  s_add_u32 m0, s62, s64
  s_nop 0
  buffer_load_dwordx4 v6, s[4:7], s61 offen offset:0 sc1 lds
  buffer_load_dwordx4 v6, s[4:7], s61 offen offset:1024 sc1 lds
  buffer_load_dwordx4 v6, s[4:7], s61 offen offset:2048 sc1 lds
  buffer_load_dwordx4 v6, s[4:7], s61 offen offset:3072 sc1 lds
  s_add_u32 m0, m0, 0x4000
  s_add_u32 s61, s61, 0x4000
  buffer_load_dwordx4 v6, s[4:7], s61 offen offset:0 sc1 lds
  buffer_load_dwordx4 v6, s[4:7], s61 offen offset:1024 sc1 lds
  buffer_load_dwordx4 v6, s[4:7], s61 offen offset:2048 sc1 lds
  buffer_load_dwordx4 v6, s[4:7], s61 offen offset:3072 sc1 lds
  s_add_u32 m0, m0, 0x4000
  s_add_u32 s61, s61, 0x4000
  buffer_load_dwordx4 v6, s[4:7], s61 offen offset:0 sc1 lds
  buffer_load_dwordx4 v6, s[4:7], s61 offen offset:1024 sc1 lds
  buffer_load_dwordx4 v6, s[4:7], s61 offen offset:2048 sc1 lds
  buffer_load_dwordx4 v6, s[4:7], s61 offen offset:3072 sc1 lds
  s_add_u32 m0, m0, 0x4000
  s_add_u32 s61, s61, 0x4000
  buffer_load_dwordx4 v6, s[4:7], s61 offen offset:0 sc1 lds
  buffer_load_dwordx4 v6, s[4:7], s61 offen offset:1024 sc1 lds
  buffer_load_dwordx4 v6, s[4:7], s61 offen offset:2048 sc1 lds
  buffer_load_dwordx4 v6, s[4:7], s61 offen offset:3072 sc1 lds
  s_mov_b32 s59, 1
  s_branch L_hwb_361
L_hwo_363:
  s_mov_b32 s64, 0x0
  s_and_b32 s61, s74, 7
  s_mul_i32 s61, s61, 114688
  s_mul_i32 s68, s73, 57344
  s_add_u32 s61, s61, s68
  s_add_u32 s61, s61, 0x4800000
  s_add_u32 s61, s61, s52
  s_lshl_b32 s62, s58, 12
  s_add_u32 m0, s62, s64
  s_nop 0
  buffer_load_dwordx4 v6, s[4:7], s61 offen offset:0 sc1 lds
  buffer_load_dwordx4 v6, s[4:7], s61 offen offset:1024 sc1 lds
  buffer_load_dwordx4 v6, s[4:7], s61 offen offset:2048 sc1 lds
  buffer_load_dwordx4 v6, s[4:7], s61 offen offset:3072 sc1 lds
  s_add_u32 m0, m0, 0x4000
  s_add_u32 s61, s61, 0x4000
  buffer_load_dwordx4 v6, s[4:7], s61 offen offset:0 sc1 lds
  buffer_load_dwordx4 v6, s[4:7], s61 offen offset:1024 sc1 lds
  buffer_load_dwordx4 v6, s[4:7], s61 offen offset:2048 sc1 lds
  buffer_load_dwordx4 v6, s[4:7], s61 offen offset:3072 sc1 lds
  s_add_u32 m0, m0, 0x4000
  s_add_u32 s61, s61, 0x4000
  buffer_load_dwordx4 v6, s[4:7], s61 offen offset:0 sc1 lds
  buffer_load_dwordx4 v6, s[4:7], s61 offen offset:1024 sc1 lds
  buffer_load_dwordx4 v6, s[4:7], s61 offen offset:2048 sc1 lds
  buffer_load_dwordx4 v6, s[4:7], s61 offen offset:3072 sc1 lds
  s_add_u32 m0, m0, 0x4000
  s_add_u32 s61, s61, 0x4000
  buffer_load_dwordx4 v6, s[4:7], s61 offen offset:0 sc1 lds
  buffer_load_dwordx4 v6, s[4:7], s61 offen offset:1024 sc1 lds
  buffer_load_dwordx4 v6, s[4:7], s61 offen offset:2048 sc1 lds
  buffer_load_dwordx4 v6, s[4:7], s61 offen offset:3072 sc1 lds
  s_mov_b32 s59, 1
  s_branch L_hwb_364
L_hwo_365:
  s_mov_b32 s64, 0x0
  s_and_b32 s61, s74, 7
  s_mul_i32 s61, s61, 114688
  s_mul_i32 s68, s73, 57344
  s_add_u32 s61, s61, s68
  s_add_u32 s61, s61, 0x4800000
  s_add_u32 s61, s61, s52
  s_lshl_b32 s62, s58, 12
  s_add_u32 m0, s62, s64
  s_nop 0
  buffer_load_dwordx4 v6, s[4:7], s61 offen offset:0 sc1 lds
  buffer_load_dwordx4 v6, s[4:7], s61 offen offset:1024 sc1 lds
  buffer_load_dwordx4 v6, s[4:7], s61 offen offset:2048 sc1 lds
  buffer_load_dwordx4 v6, s[4:7], s61 offen offset:3072 sc1 lds
  s_add_u32 m0, m0, 0x4000
  s_add_u32 s61, s61, 0x4000
  buffer_load_dwordx4 v6, s[4:7], s61 offen offset:0 sc1 lds
  buffer_load_dwordx4 v6, s[4:7], s61 offen offset:1024 sc1 lds
  buffer_load_dwordx4 v6, s[4:7], s61 offen offset:2048 sc1 lds
  buffer_load_dwordx4 v6, s[4:7], s61 offen offset:3072 sc1 lds
  s_add_u32 m0, m0, 0x4000
  s_add_u32 s61, s61, 0x4000
  buffer_load_dwordx4 v6, s[4:7], s61 offen offset:0 sc1 lds
  buffer_load_dwordx4 v6, s[4:7], s61 offen offset:1024 sc1 lds
  buffer_load_dwordx4 v6, s[4:7], s61 offen offset:2048 sc1 lds
  buffer_load_dwordx4 v6, s[4:7], s61 offen offset:3072 sc1 lds
  s_add_u32 m0, m0, 0x4000
  s_add_u32 s61, s61, 0x4000
  buffer_load_dwordx4 v6, s[4:7], s61 offen offset:0 sc1 lds
  buffer_load_dwordx4 v6, s[4:7], s61 offen offset:1024 sc1 lds
  buffer_load_dwordx4 v6, s[4:7], s61 offen offset:2048 sc1 lds
  buffer_load_dwordx4 v6, s[4:7], s61 offen offset:3072 sc1 lds
  s_mov_b32 s59, 1
  s_branch L_hwb_366
L_hwo_367:
  s_mov_b32 s64, 0x0
  s_and_b32 s61, s74, 7
  s_mul_i32 s61, s61, 114688
  s_mul_i32 s68, s73, 57344
  s_add_u32 s61, s61, s68
  s_add_u32 s61, s61, 0x4800000
  s_add_u32 s61, s61, s52
  s_lshl_b32 s62, s58, 12
  s_add_u32 m0, s62, s64
  s_nop 0
  buffer_load_dwordx4 v6, s[4:7], s61 offen offset:0 sc1 lds
  buffer_load_dwordx4 v6, s[4:7], s61 offen offset:1024 sc1 lds
  buffer_load_dwordx4 v6, s[4:7], s61 offen offset:2048 sc1 lds
  buffer_load_dwordx4 v6, s[4:7], s61 offen offset:3072 sc1 lds
  s_add_u32 m0, m0, 0x4000
  s_add_u32 s61, s61, 0x4000
  buffer_load_dwordx4 v6, s[4:7], s61 offen offset:0 sc1 lds
  buffer_load_dwordx4 v6, s[4:7], s61 offen offset:1024 sc1 lds
  buffer_load_dwordx4 v6, s[4:7], s61 offen offset:2048 sc1 lds
  buffer_load_dwordx4 v6, s[4:7], s61 offen offset:3072 sc1 lds
  s_add_u32 m0, m0, 0x4000
  s_add_u32 s61, s61, 0x4000
  buffer_load_dwordx4 v6, s[4:7], s61 offen offset:0 sc1 lds
  buffer_load_dwordx4 v6, s[4:7], s61 offen offset:1024 sc1 lds
  buffer_load_dwordx4 v6, s[4:7], s61 offen offset:2048 sc1 lds
  buffer_load_dwordx4 v6, s[4:7], s61 offen offset:3072 sc1 lds
  s_add_u32 m0, m0, 0x4000
  s_add_u32 s61, s61, 0x4000
  buffer_load_dwordx4 v6, s[4:7], s61 offen offset:0 sc1 lds
  buffer_load_dwordx4 v6, s[4:7], s61 offen offset:1024 sc1 lds
  buffer_load_dwordx4 v6, s[4:7], s61 offen offset:2048 sc1 lds
  buffer_load_dwordx4 v6, s[4:7], s61 offen offset:3072 sc1 lds
  s_mov_b32 s59, 1
  s_branch L_hwb_368
  s_endpgm
B_s5_f:
  v_mov_b32 v6, 0x0
  v_bfe_i32 v2, v0, 0, 1
  v_and_b32 v2, 0x10, v2
  v_add_u32 v6, v6, v2
  v_bfe_i32 v2, v0, 1, 1
  v_and_b32 v2, 0x20, v2
  v_add_u32 v6, v6, v2
  v_bfe_i32 v2, v0, 2, 1
  v_and_b32 v2, 0x40, v2
  v_add_u32 v6, v6, v2
  v_bfe_i32 v2, v0, 3, 1
  v_and_b32 v2, 0x80, v2
  v_add_u32 v6, v6, v2
  v_bfe_i32 v2, v0, 4, 1
  v_and_b32 v2, 0x100, v2
  v_add_u32 v6, v6, v2
  v_bfe_i32 v2, v0, 5, 1
  v_and_b32 v2, 0x200, v2
  v_add_u32 v6, v6, v2
  v_bfe_i32 v2, v0, 6, 1
  v_and_b32 v2, 0x1000, v2
  v_add_u32 v6, v6, v2
  v_bfe_i32 v2, v0, 7, 1
  v_and_b32 v2, 0x2000, v2
  v_add_u32 v6, v6, v2
  v_mov_b32 v7, 0x0
  v_bfe_i32 v2, v0, 0, 1
  v_and_b32 v2, 0x10, v2
  v_add_u32 v7, v7, v2
  v_bfe_i32 v2, v0, 1, 1
  v_and_b32 v2, 0x20, v2
  v_add_u32 v7, v7, v2
  v_bfe_i32 v2, v0, 2, 1
  v_and_b32 v2, 0x40, v2
  v_add_u32 v7, v7, v2
  v_bfe_i32 v2, v0, 3, 1
  v_and_b32 v2, 0x80, v2
  v_add_u32 v7, v7, v2
  v_bfe_i32 v2, v0, 4, 1
  v_and_b32 v2, 0x100, v2
  v_add_u32 v7, v7, v2
  v_bfe_i32 v2, v0, 5, 1
  v_and_b32 v2, 0x200, v2
  v_add_u32 v7, v7, v2
  v_and_b32 v8, 31, v0
  v_min_u32 v8, 27, v8
  v_lshlrev_b32 v8, 2, v8
  v_mov_b32 v9, 0x0
  v_bfe_i32 v2, v0, 6, 1
  v_and_b32 v2, 0x4, v2
  v_add_u32 v9, v9, v2
  v_bfe_i32 v2, v0, 7, 1
  v_and_b32 v2, 0x8, v2
  v_add_u32 v9, v9, v2
  v_mov_b32 v10, 1
  v_mov_b32 v12, 0x0
  v_bfe_i32 v2, v0, 0, 1
  v_and_b32 v2, 0x10, v2
  v_add_u32 v12, v12, v2
  v_bfe_i32 v2, v0, 1, 1
  v_and_b32 v2, 0x20, v2
  v_add_u32 v12, v12, v2
  v_bfe_i32 v2, v0, 2, 1
  v_and_b32 v2, 0x40, v2
  v_add_u32 v12, v12, v2
  v_bfe_i32 v2, v0, 3, 1
  v_and_b32 v2, 0x2000, v2
  v_add_u32 v12, v12, v2
  v_bfe_i32 v2, v0, 4, 1
  v_and_b32 v2, 0x4000, v2
  v_add_u32 v12, v12, v2
  v_bfe_i32 v2, v0, 5, 1
  v_and_b32 v2, 0x80, v2
  v_add_u32 v12, v12, v2
  v_bfe_i32 v2, v0, 6, 1
  v_and_b32 v2, 0x200, v2
  v_add_u32 v12, v12, v2
  v_bfe_i32 v2, v0, 7, 1
  v_and_b32 v2, 0x400, v2
  v_add_u32 v12, v12, v2
  s_mov_b32 s8, s44
  s_and_b32 s9, s45, 0xffff
  s_mov_b32 s10, 0x1c0000
  s_mov_b32 s11, 0x20000
  v_mov_b32 v3, 0x0
  v_bfe_i32 v2, v0, 0, 1
  v_and_b32 v2, 0x10, v2
  v_xor_b32 v3, v3, v2
  v_bfe_i32 v2, v0, 1, 1
  v_and_b32 v2, 0x20, v2
  v_xor_b32 v3, v3, v2
  v_bfe_i32 v2, v0, 2, 1
  v_and_b32 v2, 0x40, v2
  v_xor_b32 v3, v3, v2
  v_bfe_i32 v2, v0, 3, 1
  v_and_b32 v2, 0x80, v2
  v_xor_b32 v3, v3, v2
  v_bfe_i32 v2, v0, 4, 1
  v_and_b32 v2, 0x40, v2
  v_xor_b32 v3, v3, v2
  v_bfe_i32 v2, v0, 5, 1
  v_and_b32 v2, 0x80, v2
  v_xor_b32 v3, v3, v2
  v_mov_b32 v5, 0x0
  v_bfe_i32 v2, v0, 4, 1
  v_and_b32 v2, 0x400, v2
  v_add_u32 v5, v5, v2
  v_bfe_i32 v2, v0, 5, 1
  v_and_b32 v2, 0x800, v2
  v_add_u32 v5, v5, v2
  v_add_u32 v3, v3, v5
  v_mov_b32 v4, 0x0
  v_bfe_i32 v2, v0, 0, 1
  v_and_b32 v2, 0x8, v2
  v_xor_b32 v4, v4, v2
  v_bfe_i32 v2, v0, 1, 1
  v_and_b32 v2, 0x10, v2
  v_xor_b32 v4, v4, v2
  v_bfe_i32 v2, v0, 2, 1
  v_and_b32 v2, 0x140, v2
  v_xor_b32 v4, v4, v2
  v_bfe_i32 v2, v0, 3, 1
  v_and_b32 v2, 0x280, v2
  v_xor_b32 v4, v4, v2
  v_bfe_i32 v2, v0, 4, 1
  v_and_b32 v2, 0x20, v2
  v_xor_b32 v4, v4, v2
  v_bfe_i32 v2, v0, 5, 1
  v_and_b32 v2, 0x400, v2
  v_xor_b32 v4, v4, v2
  v_bfe_i32 v2, v0, 6, 1
  v_and_b32 v2, 0x40, v2
  v_xor_b32 v4, v4, v2
  v_bfe_i32 v2, v0, 7, 1
  v_and_b32 v2, 0x80, v2
  v_xor_b32 v4, v4, v2
  v_add_u32 v5, 0x10000, v4
  s_lshl_b32 s76, s54, 8
  s_mul_i32 s77, s73, 917504
  s_add_u32 s76, s76, s77
  s_barrier
  s_mul_i32 s61, s58, 131072
  s_add_u32 s61, s61, s76
  s_add_u32 s61, s61, 0
  s_mul_i32 s62, s58, 32768
  s_mov_b32 s63, 0
L_wdma_373:
  s_mov_b32 m0, s62
  s_add_u32 s62, s62, 1024
  buffer_load_dwordx4 v3, s[8:11], s61 offen lds
  s_add_u32 s61, s61, 4096
  s_add_u32 s63, s63, 1
  s_cmp_lt_u32 s63, 32
  s_cbranch_scc1 L_wdma_373
  s_waitcnt vmcnt(0)
  s_barrier
  ds_read_b64_tr_b16 a[0:1], v4 offset:0
  ds_read_b64_tr_b16 a[2:3], v4 offset:2048
  ds_read_b64_tr_b16 a[4:5], v4 offset:4096
  ds_read_b64_tr_b16 a[6:7], v4 offset:6144
  ds_read_b64_tr_b16 a[8:9], v4 offset:8192
  ds_read_b64_tr_b16 a[10:11], v4 offset:10240
  ds_read_b64_tr_b16 a[12:13], v4 offset:12288
  ds_read_b64_tr_b16 a[14:15], v4 offset:14336
  s_waitcnt lgkmcnt(0)
  ds_read_b64_tr_b16 a[16:17], v4 offset:16384
  ds_read_b64_tr_b16 a[18:19], v4 offset:18432
  ds_read_b64_tr_b16 a[20:21], v4 offset:20480
  ds_read_b64_tr_b16 a[22:23], v4 offset:22528
  ds_read_b64_tr_b16 a[24:25], v4 offset:24576
  ds_read_b64_tr_b16 a[26:27], v4 offset:26624
  ds_read_b64_tr_b16 a[28:29], v4 offset:28672
  ds_read_b64_tr_b16 a[30:31], v4 offset:30720
  s_waitcnt lgkmcnt(0)
  ds_read_b64_tr_b16 a[32:33], v4 offset:32768
  ds_read_b64_tr_b16 a[34:35], v4 offset:34816
  ds_read_b64_tr_b16 a[36:37], v4 offset:36864
  ds_read_b64_tr_b16 a[38:39], v4 offset:38912
  ds_read_b64_tr_b16 a[40:41], v4 offset:40960
  ds_read_b64_tr_b16 a[42:43], v4 offset:43008
  ds_read_b64_tr_b16 a[44:45], v4 offset:45056
  ds_read_b64_tr_b16 a[46:47], v4 offset:47104
  s_waitcnt lgkmcnt(0)
  ds_read_b64_tr_b16 a[48:49], v4 offset:49152
  ds_read_b64_tr_b16 a[50:51], v4 offset:51200
  ds_read_b64_tr_b16 a[52:53], v4 offset:53248
  ds_read_b64_tr_b16 a[54:55], v4 offset:55296
  ds_read_b64_tr_b16 a[56:57], v4 offset:57344
  ds_read_b64_tr_b16 a[58:59], v4 offset:59392
  ds_read_b64_tr_b16 a[60:61], v4 offset:61440
  ds_read_b64_tr_b16 a[62:63], v4 offset:63488
  s_waitcnt lgkmcnt(0)
  ds_read_b64_tr_b16 a[64:65], v5 offset:0
  ds_read_b64_tr_b16 a[66:67], v5 offset:2048
  ds_read_b64_tr_b16 a[68:69], v5 offset:4096
  ds_read_b64_tr_b16 a[70:71], v5 offset:6144
  ds_read_b64_tr_b16 a[72:73], v5 offset:8192
  ds_read_b64_tr_b16 a[74:75], v5 offset:10240
  ds_read_b64_tr_b16 a[76:77], v5 offset:12288
  ds_read_b64_tr_b16 a[78:79], v5 offset:14336
  s_waitcnt lgkmcnt(0)
  ds_read_b64_tr_b16 a[80:81], v5 offset:16384
  ds_read_b64_tr_b16 a[82:83], v5 offset:18432
  ds_read_b64_tr_b16 a[84:85], v5 offset:20480
  ds_read_b64_tr_b16 a[86:87], v5 offset:22528
  ds_read_b64_tr_b16 a[88:89], v5 offset:24576
  ds_read_b64_tr_b16 a[90:91], v5 offset:26624
  ds_read_b64_tr_b16 a[92:93], v5 offset:28672
  ds_read_b64_tr_b16 a[94:95], v5 offset:30720
  s_waitcnt lgkmcnt(0)
  ds_read_b64_tr_b16 a[96:97], v5 offset:32768
  ds_read_b64_tr_b16 a[98:99], v5 offset:34816
  ds_read_b64_tr_b16 a[100:101], v5 offset:36864
  ds_read_b64_tr_b16 a[102:103], v5 offset:38912
  ds_read_b64_tr_b16 a[104:105], v5 offset:40960
  ds_read_b64_tr_b16 a[106:107], v5 offset:43008
  ds_read_b64_tr_b16 a[108:109], v5 offset:45056
  ds_read_b64_tr_b16 a[110:111], v5 offset:47104
  s_waitcnt lgkmcnt(0)
  ds_read_b64_tr_b16 a[112:113], v5 offset:49152
  ds_read_b64_tr_b16 a[114:115], v5 offset:51200
  ds_read_b64_tr_b16 a[116:117], v5 offset:53248
  ds_read_b64_tr_b16 a[118:119], v5 offset:55296
  ds_read_b64_tr_b16 a[120:121], v5 offset:57344
  ds_read_b64_tr_b16 a[122:123], v5 offset:59392
  ds_read_b64_tr_b16 a[124:125], v5 offset:61440
  ds_read_b64_tr_b16 a[126:127], v5 offset:63488
  s_waitcnt lgkmcnt(0)
  s_waitcnt lgkmcnt(0)
  s_barrier
  s_mul_i32 s61, s58, 98304
  s_add_u32 s61, s61, s76
  s_add_u32 s61, s61, 524288
  s_mul_i32 s62, s58, 24576
  s_mov_b32 s63, 0
L_wdma_374:
  s_mov_b32 m0, s62
  s_add_u32 s62, s62, 1024
  buffer_load_dwordx4 v3, s[8:11], s61 offen lds
  s_add_u32 s61, s61, 4096
  s_add_u32 s63, s63, 1
  s_cmp_lt_u32 s63, 24
  s_cbranch_scc1 L_wdma_374
  s_waitcnt vmcnt(0)
  s_barrier
  ds_read_b64_tr_b16 a[128:129], v4 offset:0
  ds_read_b64_tr_b16 a[130:131], v4 offset:2048
  ds_read_b64_tr_b16 a[132:133], v4 offset:4096
  ds_read_b64_tr_b16 a[134:135], v4 offset:6144
  ds_read_b64_tr_b16 a[136:137], v4 offset:8192
  ds_read_b64_tr_b16 a[138:139], v4 offset:10240
  ds_read_b64_tr_b16 a[140:141], v4 offset:12288
  ds_read_b64_tr_b16 a[142:143], v4 offset:14336
  s_waitcnt lgkmcnt(0)
  ds_read_b64_tr_b16 a[144:145], v4 offset:16384
  ds_read_b64_tr_b16 a[146:147], v4 offset:18432
  ds_read_b64_tr_b16 a[148:149], v4 offset:20480
  ds_read_b64_tr_b16 a[150:151], v4 offset:22528
  ds_read_b64_tr_b16 a[152:153], v4 offset:24576
  ds_read_b64_tr_b16 a[154:155], v4 offset:26624
  ds_read_b64_tr_b16 a[156:157], v4 offset:28672
  ds_read_b64_tr_b16 a[158:159], v4 offset:30720
  s_waitcnt lgkmcnt(0)
  ds_read_b64_tr_b16 a[160:161], v4 offset:32768
  ds_read_b64_tr_b16 a[162:163], v4 offset:34816
  ds_read_b64_tr_b16 a[164:165], v4 offset:36864
  ds_read_b64_tr_b16 a[166:167], v4 offset:38912
  ds_read_b64_tr_b16 a[168:169], v4 offset:40960
  ds_read_b64_tr_b16 a[170:171], v4 offset:43008
  ds_read_b64_tr_b16 a[172:173], v4 offset:45056
  ds_read_b64_tr_b16 a[174:175], v4 offset:47104
  s_waitcnt lgkmcnt(0)
  ds_read_b64_tr_b16 a[176:177], v4 offset:49152
  ds_read_b64_tr_b16 a[178:179], v4 offset:51200
  ds_read_b64_tr_b16 a[180:181], v4 offset:53248
  ds_read_b64_tr_b16 a[182:183], v4 offset:55296
  ds_read_b64_tr_b16 a[184:185], v4 offset:57344
  ds_read_b64_tr_b16 a[186:187], v4 offset:59392
  ds_read_b64_tr_b16 a[188:189], v4 offset:61440
  ds_read_b64_tr_b16 a[190:191], v4 offset:63488
  s_waitcnt lgkmcnt(0)
  ds_read_b64_tr_b16 a[192:193], v5 offset:0
  ds_read_b64_tr_b16 a[194:195], v5 offset:2048
  ds_read_b64_tr_b16 a[196:197], v5 offset:4096
  ds_read_b64_tr_b16 a[198:199], v5 offset:6144
  ds_read_b64_tr_b16 a[200:201], v5 offset:8192
  ds_read_b64_tr_b16 a[202:203], v5 offset:10240
  ds_read_b64_tr_b16 a[204:205], v5 offset:12288
  ds_read_b64_tr_b16 a[206:207], v5 offset:14336
  s_waitcnt lgkmcnt(0)
  ds_read_b64_tr_b16 a[208:209], v5 offset:16384
  ds_read_b64_tr_b16 a[210:211], v5 offset:18432
  ds_read_b64_tr_b16 a[212:213], v5 offset:20480
  ds_read_b64_tr_b16 a[214:215], v5 offset:22528
  ds_read_b64_tr_b16 a[216:217], v5 offset:24576
  ds_read_b64_tr_b16 a[218:219], v5 offset:26624
  ds_read_b64_tr_b16 a[220:221], v5 offset:28672
  ds_read_b64_tr_b16 a[222:223], v5 offset:30720
  s_waitcnt lgkmcnt(0)
  s_waitcnt lgkmcnt(0)
  s_barrier
  s_mov_b32 s20, s50
  s_and_b32 s21, s51, 0xffff
  s_mov_b32 s22, 0x0
  s_mov_b32 s23, 0x20000
  s_mov_b32 s8, s48
  s_and_b32 s9, s49, 0xffff
  s_mov_b32 s10, 0x100
  s_mov_b32 s11, 0x20000
  v_and_b32 v2, 3, v0
  v_lshlrev_b32 v2, 6, v2
L_gate_375:
  buffer_load_dword v11, v2, s[8:11], 0 offen offset:8 sc1
  s_waitcnt vmcnt(0)
  v_cmp_gt_u32 vcc, 48, v11
  s_cbranch_vccz L_gateok_376
  s_add_u32 s72, s72, 1
  s_cmp_gt_u32 s72, 0x80000
  s_cbranch_scc1 L_exit
  s_sleep 2
  s_branch L_gate_375
L_gateok_376:
  s_mov_b32 s59, 0
  s_mov_b32 s88, 0
  s_mov_b32 s60, 0
  s_lshl_b32 s61, s73, 15
  s_lshl_b32 s62, s54, 11
  s_add_u32 s61, s61, s62
  s_add_u32 s61, s61, 0x4000000
  s_add_u32 s61, s61, s52
  buffer_load_dwordx4 v[64:67], v12, s[4:7], s61 offen offset:0 sc1
  buffer_load_dwordx4 v[64:67], v12, s[4:7], s61 offen offset:256 sc1
  s_add_u32 s61, s61, 0x20000
  buffer_load_dwordx4 v[64:67], v12, s[4:7], s61 offen offset:0 sc1
  buffer_load_dwordx4 v[64:67], v12, s[4:7], s61 offen offset:256 sc1
  s_add_u32 s61, s61, 0x20000
  buffer_load_dwordx4 v[64:67], v12, s[4:7], s61 offen offset:0 sc1
  buffer_load_dwordx4 v[64:67], v12, s[4:7], s61 offen offset:256 sc1
  s_add_u32 s61, s61, 0x20000
  buffer_load_dwordx4 v[64:67], v12, s[4:7], s61 offen offset:0 sc1
  buffer_load_dwordx4 v[64:67], v12, s[4:7], s61 offen offset:256 sc1
  s_add_u32 s61, s61, 0x20000
  buffer_load_dwordx4 v[64:67], v12, s[4:7], s61 offen offset:0 sc1
  buffer_load_dwordx4 v[64:67], v12, s[4:7], s61 offen offset:256 sc1
  s_add_u32 s61, s61, 0x20000
  buffer_load_dwordx4 v[64:67], v12, s[4:7], s61 offen offset:0 sc1
  buffer_load_dwordx4 v[64:67], v12, s[4:7], s61 offen offset:256 sc1
  s_add_u32 s61, s61, 0x20000
  buffer_load_dwordx4 v[64:67], v12, s[4:7], s61 offen offset:0 sc1
  buffer_load_dwordx4 v[64:67], v12, s[4:7], s61 offen offset:256 sc1
  s_add_u32 s61, s61, 0x20000
  buffer_load_dwordx4 v[64:67], v12, s[4:7], s61 offen offset:0 sc1
  buffer_load_dwordx4 v[64:67], v12, s[4:7], s61 offen offset:256 sc1
  s_add_u32 s61, s61, 0x20000
  v_mov_b32 v113, 0
  v_add_u32 v112, 0x10000, v7
  s_mov_b32 s60, 0
L_s5h0_377:
  s_cmp_eq_u32 s60, 1
  s_cbranch_scc1 L_hp_381
  s_lshl_b32 s63, s55, 8
  s_mul_i32 s68, s73, 112
  s_add_u32 s63, s63, s68
  s_add_u32 s63, s63, 0x1d000
  s_add_u32 s63, s63, s53
  s_and_b32 s61, s55, 7
  s_mul_i32 s61, s61, 114688
  s_mul_i32 s68, s73, 57344
  s_add_u32 s61, s61, s68
  s_add_u32 s61, s61, 0x4800000
  s_add_u32 s61, s61, s52
  s_lshl_b32 s62, s58, 12
  s_add_u32 m0, s62, 0x0
L_poll_383:
  buffer_load_dword v11, v8, s[4:7], s63 offen sc1
  s_waitcnt vmcnt(0)
  s_cmp_eq_u32 s88, 0
  s_cbranch_scc1 L_nofl_385
  s_mov_b64 exec, 1
  buffer_store_dword v10, v9, s[4:7], s88 offen
  s_mov_b64 exec, -1
  s_mov_b32 s88, 0
L_nofl_385:
  v_cmp_eq_u32 vcc, 0, v11
  s_cbranch_vccz L_pollok_384
  s_add_u32 s72, s72, 1
  s_cmp_gt_u32 s72, 0x80000
  s_cbranch_scc1 L_exit
  s_branch L_poll_383
L_pollok_384:
  buffer_load_dwordx4 v6, s[4:7], s61 offen offset:0 sc1 lds
  buffer_load_dwordx4 v6, s[4:7], s61 offen offset:1024 sc1 lds
  buffer_load_dwordx4 v6, s[4:7], s61 offen offset:2048 sc1 lds
  buffer_load_dwordx4 v6, s[4:7], s61 offen offset:3072 sc1 lds
  s_add_u32 m0, m0, 0x4000
  s_add_u32 s61, s61, 0x4000
  buffer_load_dwordx4 v6, s[4:7], s61 offen offset:0 sc1 lds
  buffer_load_dwordx4 v6, s[4:7], s61 offen offset:1024 sc1 lds
  buffer_load_dwordx4 v6, s[4:7], s61 offen offset:2048 sc1 lds
  buffer_load_dwordx4 v6, s[4:7], s61 offen offset:3072 sc1 lds
  s_add_u32 m0, m0, 0x4000
  s_add_u32 s61, s61, 0x4000
  buffer_load_dwordx4 v6, s[4:7], s61 offen offset:0 sc1 lds
  buffer_load_dwordx4 v6, s[4:7], s61 offen offset:1024 sc1 lds
  buffer_load_dwordx4 v6, s[4:7], s61 offen offset:2048 sc1 lds
  buffer_load_dwordx4 v6, s[4:7], s61 offen offset:3072 sc1 lds
  s_add_u32 m0, m0, 0x4000
  s_add_u32 s61, s61, 0x4000
  buffer_load_dwordx4 v6, s[4:7], s61 offen offset:0 sc1 lds
  buffer_load_dwordx4 v6, s[4:7], s61 offen offset:1024 sc1 lds
  buffer_load_dwordx4 v6, s[4:7], s61 offen offset:2048 sc1 lds
  buffer_load_dwordx4 v6, s[4:7], s61 offen offset:3072 sc1 lds
  s_waitcnt vmcnt(12)
  s_branch L_hj_382
L_hp_381:
  s_waitcnt vmcnt(2)
L_hj_382:
  s_barrier
  ds_read_b128 v[16:19], v7 offset:0
  ds_read_b128 v[20:23], v7 offset:1024
  ds_read_b128 v[24:27], v7 offset:2048
L_s5b0_379:
  s_add_u32 s74, s55, s56
  s_min_u32 s64, s74, 63
  s_lshl_b32 s96, s64, 8
  s_mul_i32 s68, s73, 112
  s_add_u32 s96, s96, s68
  s_add_u32 s96, s96, 0x1d000
  s_add_u32 s96, s96, s53
  s_mov_b32 s59, 0
  s_mov_b32 s80, 0
  ds_read_b128 v[28:31], v7 offset:3072
  s_waitcnt lgkmcnt(3)
  v_mfma_f32_32x32x16_bf16 v[32:47], a[0:3], v[16:19], 0
  buffer_load_dword v11, v8, s[4:7], s96 offen sc1
  ds_read_b128 v[16:19], v7 offset:4096
  s_waitcnt lgkmcnt(3)
  v_mfma_f32_32x32x16_bf16 v[32:47], a[4:7], v[20:23], v[32:47]
  ds_read_b128 v[20:23], v7 offset:5120
  s_waitcnt lgkmcnt(3)
  v_mfma_f32_32x32x16_bf16 v[32:47], a[8:11], v[24:27], v[32:47]
  ds_read_b128 v[24:27], v7 offset:6144
  s_waitcnt lgkmcnt(3)
  v_mfma_f32_32x32x16_bf16 v[32:47], a[12:15], v[28:31], v[32:47]
  ds_read_b128 v[28:31], v7 offset:7168
  s_waitcnt lgkmcnt(3)
  v_mfma_f32_32x32x16_bf16 v[32:47], a[16:19], v[16:19], v[32:47]
  ds_read_b128 v[16:19], v7 offset:8192
  s_waitcnt lgkmcnt(3)
  v_mfma_f32_32x32x16_bf16 v[32:47], a[20:23], v[20:23], v[32:47]
  ds_read_b128 v[20:23], v7 offset:9216
  s_waitcnt lgkmcnt(3)
  v_mfma_f32_32x32x16_bf16 v[32:47], a[24:27], v[24:27], v[32:47]
  ds_read_b128 v[24:27], v7 offset:10240
  s_waitcnt lgkmcnt(3)
  v_mfma_f32_32x32x16_bf16 v[32:47], a[28:31], v[28:31], v[32:47]
  ds_read_b128 v[28:31], v7 offset:11264
  s_waitcnt lgkmcnt(3)
  v_mfma_f32_32x32x16_bf16 v[32:47], a[32:35], v[16:19], v[32:47]
  ds_read_b128 v[16:19], v7 offset:12288
  s_waitcnt lgkmcnt(3)
  v_mfma_f32_32x32x16_bf16 v[32:47], a[36:39], v[20:23], v[32:47]
  s_cmp_lg_u32 s60, 1
  s_cbranch_scc1 L_hfa_386
  s_waitcnt vmcnt(1)
  s_mov_b64 exec, 1
  buffer_store_dword v10, v9, s[4:7], s88 offen
  s_mov_b64 exec, -1
  s_mov_b32 s88, 0
L_hfa_386:
  ds_read_b128 v[20:23], v7 offset:13312
  s_waitcnt lgkmcnt(3)
  v_mfma_f32_32x32x16_bf16 v[32:47], a[40:43], v[24:27], v[32:47]
  ds_read_b128 v[24:27], v7 offset:14336
  s_waitcnt lgkmcnt(3)
  v_mfma_f32_32x32x16_bf16 v[32:47], a[44:47], v[28:31], v[32:47]
  ds_read_b128 v[28:31], v7 offset:15360
  s_waitcnt lgkmcnt(3)
  v_mfma_f32_32x32x16_bf16 v[32:47], a[48:51], v[16:19], v[32:47]
  s_cmp_lg_u32 s60, 0
  s_cbranch_scc1 L_hm_387
  s_waitcnt vmcnt(9)
L_hm_387:
  s_barrier
  ds_read_b128 v[16:19], v7 offset:16384
  s_waitcnt lgkmcnt(3)
  v_mfma_f32_32x32x16_bf16 v[32:47], a[52:55], v[20:23], v[32:47]
  ds_read_b128 v[20:23], v7 offset:17408
  s_waitcnt lgkmcnt(3)
  v_mfma_f32_32x32x16_bf16 v[32:47], a[56:59], v[24:27], v[32:47]
  ds_read_b128 v[24:27], v7 offset:18432
  s_waitcnt lgkmcnt(3)
  v_mfma_f32_32x32x16_bf16 v[32:47], a[60:63], v[28:31], v[32:47]
  ds_read_b128 v[28:31], v7 offset:19456
  s_waitcnt lgkmcnt(3)
  v_mfma_f32_32x32x16_bf16 v[32:47], a[64:67], v[16:19], v[32:47]
  ds_read_b128 v[16:19], v7 offset:20480
  s_waitcnt lgkmcnt(3)
  v_mfma_f32_32x32x16_bf16 v[32:47], a[68:71], v[20:23], v[32:47]
  ds_read_b128 v[20:23], v7 offset:21504
  s_waitcnt lgkmcnt(3)
  v_mfma_f32_32x32x16_bf16 v[32:47], a[72:75], v[24:27], v[32:47]
  ds_read_b128 v[24:27], v7 offset:22528
  s_waitcnt lgkmcnt(3)
  v_mfma_f32_32x32x16_bf16 v[32:47], a[76:79], v[28:31], v[32:47]
  ds_read_b128 v[28:31], v7 offset:23552
  s_waitcnt lgkmcnt(3)
  v_mfma_f32_32x32x16_bf16 v[32:47], a[80:83], v[16:19], v[32:47]
  ds_read_b128 v[16:19], v7 offset:24576
  s_waitcnt lgkmcnt(3)
  v_mfma_f32_32x32x16_bf16 v[32:47], a[84:87], v[20:23], v[32:47]
  ds_read_b128 v[20:23], v7 offset:25600
  s_waitcnt lgkmcnt(3)
  v_mfma_f32_32x32x16_bf16 v[32:47], a[88:91], v[24:27], v[32:47]
  ds_read_b128 v[24:27], v7 offset:26624
  s_waitcnt lgkmcnt(3)
  v_mfma_f32_32x32x16_bf16 v[32:47], a[92:95], v[28:31], v[32:47]
  ds_read_b128 v[28:31], v7 offset:27648
  s_waitcnt lgkmcnt(3)
  v_mfma_f32_32x32x16_bf16 v[32:47], a[96:99], v[16:19], v[32:47]
  ds_read_b128 v[16:19], v7 offset:28672
  s_waitcnt lgkmcnt(3)
  v_mfma_f32_32x32x16_bf16 v[32:47], a[100:103], v[20:23], v[32:47]
  ds_read_b128 v[20:23], v7 offset:29696
  s_waitcnt lgkmcnt(3)
  v_mfma_f32_32x32x16_bf16 v[32:47], a[104:107], v[24:27], v[32:47]
  ds_read_b128 v[24:27], v7 offset:30720
  s_waitcnt lgkmcnt(3)
  v_mfma_f32_32x32x16_bf16 v[32:47], a[108:111], v[28:31], v[32:47]
  ds_read_b128 v[28:31], v7 offset:31744
  s_waitcnt lgkmcnt(3)
  v_mfma_f32_32x32x16_bf16 v[32:47], a[112:115], v[16:19], v[32:47]
  s_cmp_eq_u32 s60, 2
  s_cbranch_scc1 L_h1b_389
  s_cmp_eq_u32 s60, 1
  s_cbranch_scc1 L_h1a_388
  s_waitcnt vmcnt(0)
L_h1a_388:
  s_waitcnt vmcnt(1)
L_h1b_389:
  s_waitcnt vmcnt(2)
  v_cmp_eq_u32 vcc, 0, v11
  s_cmp_lt_u32 s74, s57
  s_cselect_b64 s[70:71], vcc, -1
  s_cmp_eq_u64 s[70:71], 0
  s_cselect_b32 s89, s58, 7
L_h1c_390:
  s_barrier
  ds_read_b128 v[16:19], v7 offset:32768
  s_waitcnt lgkmcnt(3)
  v_mfma_f32_32x32x16_bf16 v[32:47], a[116:119], v[20:23], v[32:47]
  s_cmp_eq_u32 s89, 0
  s_cbranch_scc1 L_hwo_391
L_hwb_392:
  ds_read_b128 v[20:23], v7 offset:33792
  s_waitcnt lgkmcnt(3)
  v_mfma_f32_32x32x16_bf16 v[32:47], a[120:123], v[24:27], v[32:47]
  ds_read_b128 v[24:27], v7 offset:34816
  s_waitcnt lgkmcnt(3)
  v_mfma_f32_32x32x16_bf16 v[32:47], a[124:127], v[28:31], v[32:47]
  ds_read_b128 v[28:31], v7 offset:35840
  s_waitcnt lgkmcnt(3)
  v_mfma_f32_32x32x16_bf16 v[32:47], a[128:131], v[16:19], v[32:47]
  ds_read_b128 v[16:19], v7 offset:36864
  s_waitcnt lgkmcnt(3)
  v_mfma_f32_32x32x16_bf16 v[32:47], a[132:135], v[20:23], v[32:47]
  ds_read_b128 v[20:23], v7 offset:37888
  s_waitcnt lgkmcnt(3)
  v_mfma_f32_32x32x16_bf16 v[32:47], a[136:139], v[24:27], v[32:47]
  s_cmp_eq_u32 s89, 1
  s_cbranch_scc1 L_hwo_393
L_hwb_394:
  ds_read_b128 v[24:27], v7 offset:38912
  s_waitcnt lgkmcnt(3)
  v_mfma_f32_32x32x16_bf16 v[32:47], a[140:143], v[28:31], v[32:47]
  ds_read_b128 v[28:31], v7 offset:39936
  s_waitcnt lgkmcnt(3)
  v_mfma_f32_32x32x16_bf16 v[32:47], a[144:147], v[16:19], v[32:47]
  ds_read_b128 v[16:19], v7 offset:40960
  s_waitcnt lgkmcnt(3)
  v_mfma_f32_32x32x16_bf16 v[32:47], a[148:151], v[20:23], v[32:47]
  ds_read_b128 v[20:23], v7 offset:41984
  s_waitcnt lgkmcnt(3)
  v_mfma_f32_32x32x16_bf16 v[32:47], a[152:155], v[24:27], v[32:47]
  ds_read_b128 v[24:27], v7 offset:43008
  s_waitcnt lgkmcnt(3)
  v_mfma_f32_32x32x16_bf16 v[32:47], a[156:159], v[28:31], v[32:47]
  s_cmp_eq_u32 s89, 2
  s_cbranch_scc1 L_hwo_395
L_hwb_396:
  ds_read_b128 v[28:31], v7 offset:44032
  s_waitcnt lgkmcnt(3)
  v_mfma_f32_32x32x16_bf16 v[32:47], a[160:163], v[16:19], v[32:47]
  ds_read_b128 v[16:19], v7 offset:45056
  s_waitcnt lgkmcnt(3)
  v_mfma_f32_32x32x16_bf16 v[32:47], a[164:167], v[20:23], v[32:47]
  ds_read_b128 v[20:23], v7 offset:46080
  s_waitcnt lgkmcnt(3)
  v_mfma_f32_32x32x16_bf16 v[32:47], a[168:171], v[24:27], v[32:47]
  ds_read_b128 v[24:27], v7 offset:47104
  s_waitcnt lgkmcnt(3)
  v_mfma_f32_32x32x16_bf16 v[32:47], a[172:175], v[28:31], v[32:47]
  s_cmp_lg_u32 s89, 7
  s_cbranch_scc1 L_hre_397
  buffer_load_dword v11, v8, s[4:7], s96 offen sc1
L_hre_397:
  ds_read_b128 v[28:31], v7 offset:48128
  s_waitcnt lgkmcnt(3)
  v_mfma_f32_32x32x16_bf16 v[32:47], a[176:179], v[16:19], v[32:47]
  s_cmp_eq_u32 s89, 3
  s_cbranch_scc1 L_hwo_398
L_hwb_399:
  ds_read_b128 v[16:19], v7 offset:49152
  s_waitcnt lgkmcnt(3)
  v_mfma_f32_32x32x16_bf16 v[32:47], a[180:183], v[20:23], v[32:47]
  ds_read_b128 v[20:23], v7 offset:50176
  s_waitcnt lgkmcnt(3)
  v_mfma_f32_32x32x16_bf16 v[32:47], a[184:187], v[24:27], v[32:47]
  ds_read_b128 v[24:27], v7 offset:51200
  s_waitcnt lgkmcnt(3)
  v_mfma_f32_32x32x16_bf16 v[32:47], a[188:191], v[28:31], v[32:47]
  s_and_b32 s76, s55, 7
  s_lshl_b32 s76, s76, 17
  ds_read_b128 v[28:31], v7 offset:52224
  s_waitcnt lgkmcnt(3)
  v_mfma_f32_32x32x16_bf16 v[32:47], a[192:195], v[16:19], v[32:47]
  s_lshl_b32 s77, s73, 15
  s_add_u32 s76, s76, s77
  ds_read_b128 v[16:19], v7 offset:53248
  s_waitcnt lgkmcnt(3)
  v_mfma_f32_32x32x16_bf16 v[32:47], a[196:199], v[20:23], v[32:47]
  s_lshl_b32 s77, s54, 11
  s_add_u32 s76, s76, s77
  ds_read_b128 v[20:23], v7 offset:54272
  s_waitcnt lgkmcnt(3)
  v_mfma_f32_32x32x16_bf16 v[32:47], a[200:203], v[24:27], v[32:47]
  s_add_u32 s76, s76, s52
  s_add_u32 s76, s76, 0x4000000
  ds_read_b128 v[24:27], v7 offset:55296
  s_waitcnt lgkmcnt(3)
  v_mfma_f32_32x32x16_bf16 v[32:47], a[204:207], v[28:31], v[32:47]
  s_lshl_b32 s78, s55, 7
  s_lshl_b32 s79, s54, 5
  ds_read_b128 v[28:31], v7 offset:56320
  s_waitcnt lgkmcnt(3)
  v_mfma_f32_32x32x16_bf16 v[32:47], a[208:211], v[16:19], v[32:47]
  s_add_u32 s78, s78, s79
  s_lshl_b32 s79, s73, 4
  s_waitcnt lgkmcnt(2)
  v_mfma_f32_32x32x16_bf16 v[32:47], a[212:215], v[20:23], v[32:47]
  s_add_u32 s78, s78, s79
  s_add_u32 s78, s78, 0x21000
  s_waitcnt lgkmcnt(1)
  v_mfma_f32_32x32x16_bf16 v[32:47], a[216:219], v[24:27], v[32:47]
  s_add_u32 s78, s78, s53
  s_waitcnt lgkmcnt(0)
  v_mfma_f32_32x32x16_bf16 v[32:47], a[220:223], v[28:31], v[32:47]
  s_cmp_lg_u32 s59, 1
  s_cbranch_scc1 L_late_400
  s_mov_b32 s60, 1
  s_branch L_nl_402
  s_cmp_eq_u32 s80, 1
  s_cbranch_scc1 L_st1_401
  s_waitcnt vmcnt(0)
L_st1_401:
  s_waitcnt vmcnt(1)
  s_barrier
  ds_read_b128 v[16:19], v112 offset:0
  ds_read_b128 v[20:23], v112 offset:1024
  ds_read_b128 v[24:27], v112 offset:2048
  s_mov_b32 s60, 2
  s_mov_b32 s55, s74
  s_branch L_s5b1_380
L_late_400:
  s_mov_b32 s60, 0
  s_waitcnt vmcnt(0)
  s_cmp_ge_u32 s74, s57
  s_cbranch_scc1 L_nl_402
  v_cmp_eq_u32 vcc, 0, v11
  s_cbranch_vccnz L_nl_402
  s_mov_b32 s64, 0x10000
  s_and_b32 s61, s74, 7
  s_mul_i32 s61, s61, 114688
  s_mul_i32 s68, s73, 57344
  s_add_u32 s61, s61, s68
  s_add_u32 s61, s61, 0x4800000
  s_add_u32 s61, s61, s52
  s_lshl_b32 s62, s58, 12
  s_add_u32 m0, s62, s64
  s_nop 0
  buffer_load_dwordx4 v6, s[4:7], s61 offen offset:0 sc1 lds
  buffer_load_dwordx4 v6, s[4:7], s61 offen offset:1024 sc1 lds
  buffer_load_dwordx4 v6, s[4:7], s61 offen offset:2048 sc1 lds
  buffer_load_dwordx4 v6, s[4:7], s61 offen offset:3072 sc1 lds
  s_add_u32 m0, m0, 0x4000
  s_add_u32 s61, s61, 0x4000
  buffer_load_dwordx4 v6, s[4:7], s61 offen offset:0 sc1 lds
  buffer_load_dwordx4 v6, s[4:7], s61 offen offset:1024 sc1 lds
  buffer_load_dwordx4 v6, s[4:7], s61 offen offset:2048 sc1 lds
  buffer_load_dwordx4 v6, s[4:7], s61 offen offset:3072 sc1 lds
  s_add_u32 m0, m0, 0x4000
  s_add_u32 s61, s61, 0x4000
  buffer_load_dwordx4 v6, s[4:7], s61 offen offset:0 sc1 lds
  buffer_load_dwordx4 v6, s[4:7], s61 offen offset:1024 sc1 lds
  buffer_load_dwordx4 v6, s[4:7], s61 offen offset:2048 sc1 lds
  buffer_load_dwordx4 v6, s[4:7], s61 offen offset:3072 sc1 lds
  s_add_u32 m0, m0, 0x4000
  s_add_u32 s61, s61, 0x4000
  buffer_load_dwordx4 v6, s[4:7], s61 offen offset:0 sc1 lds
  buffer_load_dwordx4 v6, s[4:7], s61 offen offset:1024 sc1 lds
  buffer_load_dwordx4 v6, s[4:7], s61 offen offset:2048 sc1 lds
  buffer_load_dwordx4 v6, s[4:7], s61 offen offset:3072 sc1 lds
  s_mov_b32 s60, 1
L_nl_402:
  s_nop 7
  v_cvt_pk_bf16_f32 v64, v32, v33
  v_cvt_pk_bf16_f32 v65, v34, v35
  v_cvt_pk_bf16_f32 v66, v36, v37
  v_cvt_pk_bf16_f32 v67, v38, v39
  buffer_store_dwordx4 v[64:67], v12, s[4:7], s76 offen offset:0
  v_cvt_pk_bf16_f32 v68, v40, v41
  v_cvt_pk_bf16_f32 v69, v42, v43
  v_cvt_pk_bf16_f32 v70, v44, v45
  v_cvt_pk_bf16_f32 v71, v46, v47
  buffer_store_dwordx4 v[68:71], v12, s[4:7], s76 offen offset:256
  s_mov_b32 s88, s78
  s_mov_b32 s55, s74
  s_cmp_lt_u32 s55, s57
  s_cbranch_scc1 L_s5h1_378
  s_waitcnt vmcnt(0)
  s_cmp_eq_u32 s88, 0
  s_cbranch_scc1 L_nofl_403
  s_mov_b64 exec, 1
  buffer_store_dword v10, v9, s[4:7], s88 offen
  s_mov_b64 exec, -1
  s_mov_b32 s88, 0
L_nofl_403:
  s_endpgm
L_s5h1_378:
  s_cmp_eq_u32 s60, 1
  s_cbranch_scc1 L_hp_404
  s_lshl_b32 s63, s55, 8
  s_mul_i32 s68, s73, 112
  s_add_u32 s63, s63, s68
  s_add_u32 s63, s63, 0x1d000
  s_add_u32 s63, s63, s53
  s_and_b32 s61, s55, 7
  s_mul_i32 s61, s61, 114688
  s_mul_i32 s68, s73, 57344
  s_add_u32 s61, s61, s68
  s_add_u32 s61, s61, 0x4800000
  s_add_u32 s61, s61, s52
  s_lshl_b32 s62, s58, 12
  s_add_u32 m0, s62, 0x10000
L_poll_406:
  buffer_load_dword v11, v8, s[4:7], s63 offen sc1
  s_waitcnt vmcnt(0)
  s_cmp_eq_u32 s88, 0
  s_cbranch_scc1 L_nofl_408
  s_mov_b64 exec, 1
  buffer_store_dword v10, v9, s[4:7], s88 offen
  s_mov_b64 exec, -1
  s_mov_b32 s88, 0
L_nofl_408:
  v_cmp_eq_u32 vcc, 0, v11
  s_cbranch_vccz L_pollok_407
  s_add_u32 s72, s72, 1
  s_cmp_gt_u32 s72, 0x80000
  s_cbranch_scc1 L_exit
  s_branch L_poll_406
L_pollok_407:
  buffer_load_dwordx4 v6, s[4:7], s61 offen offset:0 sc1 lds
  buffer_load_dwordx4 v6, s[4:7], s61 offen offset:1024 sc1 lds
  buffer_load_dwordx4 v6, s[4:7], s61 offen offset:2048 sc1 lds
  buffer_load_dwordx4 v6, s[4:7], s61 offen offset:3072 sc1 lds
  s_add_u32 m0, m0, 0x4000
  s_add_u32 s61, s61, 0x4000
  buffer_load_dwordx4 v6, s[4:7], s61 offen offset:0 sc1 lds
  buffer_load_dwordx4 v6, s[4:7], s61 offen offset:1024 sc1 lds
  buffer_load_dwordx4 v6, s[4:7], s61 offen offset:2048 sc1 lds
  buffer_load_dwordx4 v6, s[4:7], s61 offen offset:3072 sc1 lds
  s_add_u32 m0, m0, 0x4000
  s_add_u32 s61, s61, 0x4000
  buffer_load_dwordx4 v6, s[4:7], s61 offen offset:0 sc1 lds
  buffer_load_dwordx4 v6, s[4:7], s61 offen offset:1024 sc1 lds
  buffer_load_dwordx4 v6, s[4:7], s61 offen offset:2048 sc1 lds
  buffer_load_dwordx4 v6, s[4:7], s61 offen offset:3072 sc1 lds
  s_add_u32 m0, m0, 0x4000
  s_add_u32 s61, s61, 0x4000
  buffer_load_dwordx4 v6, s[4:7], s61 offen offset:0 sc1 lds
  buffer_load_dwordx4 v6, s[4:7], s61 offen offset:1024 sc1 lds
  buffer_load_dwordx4 v6, s[4:7], s61 offen offset:2048 sc1 lds
  buffer_load_dwordx4 v6, s[4:7], s61 offen offset:3072 sc1 lds
  s_waitcnt vmcnt(12)
  s_branch L_hj_405
L_hp_404:
  s_waitcnt vmcnt(2)
L_hj_405:
  s_barrier
  ds_read_b128 v[16:19], v112 offset:0
  ds_read_b128 v[20:23], v112 offset:1024
  ds_read_b128 v[24:27], v112 offset:2048
L_s5b1_380:
  s_add_u32 s74, s55, s56
  s_min_u32 s64, s74, 63
  s_lshl_b32 s96, s64, 8
  s_mul_i32 s68, s73, 112
  s_add_u32 s96, s96, s68
  s_add_u32 s96, s96, 0x1d000
  s_add_u32 s96, s96, s53
  s_mov_b32 s59, 0
  s_mov_b32 s80, 0
  ds_read_b128 v[28:31], v112 offset:3072
  s_waitcnt lgkmcnt(3)
  v_mfma_f32_32x32x16_bf16 v[80:95], a[0:3], v[16:19], 0
  buffer_load_dword v11, v8, s[4:7], s96 offen sc1
  ds_read_b128 v[16:19], v112 offset:4096
  s_waitcnt lgkmcnt(3)
  v_mfma_f32_32x32x16_bf16 v[80:95], a[4:7], v[20:23], v[80:95]
  ds_read_b128 v[20:23], v112 offset:5120
  s_waitcnt lgkmcnt(3)
  v_mfma_f32_32x32x16_bf16 v[80:95], a[8:11], v[24:27], v[80:95]
  ds_read_b128 v[24:27], v112 offset:6144
  s_waitcnt lgkmcnt(3)
  v_mfma_f32_32x32x16_bf16 v[80:95], a[12:15], v[28:31], v[80:95]
  ds_read_b128 v[28:31], v112 offset:7168
  s_waitcnt lgkmcnt(3)
  v_mfma_f32_32x32x16_bf16 v[80:95], a[16:19], v[16:19], v[80:95]
  ds_read_b128 v[16:19], v112 offset:8192
  s_waitcnt lgkmcnt(3)
  v_mfma_f32_32x32x16_bf16 v[80:95], a[20:23], v[20:23], v[80:95]
  ds_read_b128 v[20:23], v112 offset:9216
  s_waitcnt lgkmcnt(3)
  v_mfma_f32_32x32x16_bf16 v[80:95], a[24:27], v[24:27], v[80:95]
  ds_read_b128 v[24:27], v112 offset:10240
  s_waitcnt lgkmcnt(3)
  v_mfma_f32_32x32x16_bf16 v[80:95], a[28:31], v[28:31], v[80:95]
  ds_read_b128 v[28:31], v112 offset:11264
  s_waitcnt lgkmcnt(3)
  v_mfma_f32_32x32x16_bf16 v[80:95], a[32:35], v[16:19], v[80:95]
  ds_read_b128 v[16:19], v112 offset:12288
  s_waitcnt lgkmcnt(3)
  v_mfma_f32_32x32x16_bf16 v[80:95], a[36:39], v[20:23], v[80:95]
  s_cmp_lg_u32 s60, 1
  s_cbranch_scc1 L_hfa_409
  s_waitcnt vmcnt(1)
  s_mov_b64 exec, 1
  buffer_store_dword v10, v9, s[4:7], s88 offen
  s_mov_b64 exec, -1
  s_mov_b32 s88, 0
L_hfa_409:
  ds_read_b128 v[20:23], v112 offset:13312
  s_waitcnt lgkmcnt(3)
  v_mfma_f32_32x32x16_bf16 v[80:95], a[40:43], v[24:27], v[80:95]
  ds_read_b128 v[24:27], v112 offset:14336
  s_waitcnt lgkmcnt(3)
  v_mfma_f32_32x32x16_bf16 v[80:95], a[44:47], v[28:31], v[80:95]
  ds_read_b128 v[28:31], v112 offset:15360
  s_waitcnt lgkmcnt(3)
  v_mfma_f32_32x32x16_bf16 v[80:95], a[48:51], v[16:19], v[80:95]
  s_cmp_lg_u32 s60, 0
  s_cbranch_scc1 L_hm_410
  s_waitcnt vmcnt(9)
L_hm_410:
  s_barrier
  ds_read_b128 v[16:19], v112 offset:16384
  s_waitcnt lgkmcnt(3)
  v_mfma_f32_32x32x16_bf16 v[80:95], a[52:55], v[20:23], v[80:95]
  ds_read_b128 v[20:23], v112 offset:17408
  s_waitcnt lgkmcnt(3)
  v_mfma_f32_32x32x16_bf16 v[80:95], a[56:59], v[24:27], v[80:95]
  ds_read_b128 v[24:27], v112 offset:18432
  s_waitcnt lgkmcnt(3)
  v_mfma_f32_32x32x16_bf16 v[80:95], a[60:63], v[28:31], v[80:95]
  ds_read_b128 v[28:31], v112 offset:19456
  s_waitcnt lgkmcnt(3)
  v_mfma_f32_32x32x16_bf16 v[80:95], a[64:67], v[16:19], v[80:95]
  ds_read_b128 v[16:19], v112 offset:20480
  s_waitcnt lgkmcnt(3)
  v_mfma_f32_32x32x16_bf16 v[80:95], a[68:71], v[20:23], v[80:95]
  ds_read_b128 v[20:23], v112 offset:21504
  s_waitcnt lgkmcnt(3)
  v_mfma_f32_32x32x16_bf16 v[80:95], a[72:75], v[24:27], v[80:95]
  ds_read_b128 v[24:27], v112 offset:22528
  s_waitcnt lgkmcnt(3)
  v_mfma_f32_32x32x16_bf16 v[80:95], a[76:79], v[28:31], v[80:95]
  ds_read_b128 v[28:31], v112 offset:23552
  s_waitcnt lgkmcnt(3)
  v_mfma_f32_32x32x16_bf16 v[80:95], a[80:83], v[16:19], v[80:95]
  ds_read_b128 v[16:19], v112 offset:24576
  s_waitcnt lgkmcnt(3)
  v_mfma_f32_32x32x16_bf16 v[80:95], a[84:87], v[20:23], v[80:95]
  ds_read_b128 v[20:23], v112 offset:25600
  s_waitcnt lgkmcnt(3)
  v_mfma_f32_32x32x16_bf16 v[80:95], a[88:91], v[24:27], v[80:95]
  ds_read_b128 v[24:27], v112 offset:26624
  s_waitcnt lgkmcnt(3)
  v_mfma_f32_32x32x16_bf16 v[80:95], a[92:95], v[28:31], v[80:95]
  ds_read_b128 v[28:31], v112 offset:27648
  s_waitcnt lgkmcnt(3)
  v_mfma_f32_32x32x16_bf16 v[80:95], a[96:99], v[16:19], v[80:95]
  ds_read_b128 v[16:19], v112 offset:28672
  s_waitcnt lgkmcnt(3)
  v_mfma_f32_32x32x16_bf16 v[80:95], a[100:103], v[20:23], v[80:95]
  ds_read_b128 v[20:23], v112 offset:29696
  s_waitcnt lgkmcnt(3)
  v_mfma_f32_32x32x16_bf16 v[80:95], a[104:107], v[24:27], v[80:95]
  ds_read_b128 v[24:27], v112 offset:30720
  s_waitcnt lgkmcnt(3)
  v_mfma_f32_32x32x16_bf16 v[80:95], a[108:111], v[28:31], v[80:95]
  ds_read_b128 v[28:31], v112 offset:31744
  s_waitcnt lgkmcnt(3)
  v_mfma_f32_32x32x16_bf16 v[80:95], a[112:115], v[16:19], v[80:95]
  s_cmp_eq_u32 s60, 2
  s_cbranch_scc1 L_h1b_412
  s_cmp_eq_u32 s60, 1
  s_cbranch_scc1 L_h1a_411
  s_waitcnt vmcnt(0)
L_h1a_411:
  s_waitcnt vmcnt(1)
L_h1b_412:
  s_waitcnt vmcnt(2)
  v_cmp_eq_u32 vcc, 0, v11
  s_cmp_lt_u32 s74, s57
  s_cselect_b64 s[70:71], vcc, -1
  s_cmp_eq_u64 s[70:71], 0
  s_cselect_b32 s89, s58, 7
L_h1c_413:
  s_barrier
  ds_read_b128 v[16:19], v112 offset:32768
  s_waitcnt lgkmcnt(3)
  v_mfma_f32_32x32x16_bf16 v[80:95], a[116:119], v[20:23], v[80:95]
  s_cmp_eq_u32 s89, 0
  s_cbranch_scc1 L_hwo_414
L_hwb_415:
  ds_read_b128 v[20:23], v112 offset:33792
  s_waitcnt lgkmcnt(3)
  v_mfma_f32_32x32x16_bf16 v[80:95], a[120:123], v[24:27], v[80:95]
  ds_read_b128 v[24:27], v112 offset:34816
  s_waitcnt lgkmcnt(3)
  v_mfma_f32_32x32x16_bf16 v[80:95], a[124:127], v[28:31], v[80:95]
  ds_read_b128 v[28:31], v112 offset:35840
  s_waitcnt lgkmcnt(3)
  v_mfma_f32_32x32x16_bf16 v[80:95], a[128:131], v[16:19], v[80:95]
  ds_read_b128 v[16:19], v112 offset:36864
  s_waitcnt lgkmcnt(3)
  v_mfma_f32_32x32x16_bf16 v[80:95], a[132:135], v[20:23], v[80:95]
  ds_read_b128 v[20:23], v112 offset:37888
  s_waitcnt lgkmcnt(3)
  v_mfma_f32_32x32x16_bf16 v[80:95], a[136:139], v[24:27], v[80:95]
  s_cmp_eq_u32 s89, 1
  s_cbranch_scc1 L_hwo_416
L_hwb_417:
  ds_read_b128 v[24:27], v112 offset:38912
  s_waitcnt lgkmcnt(3)
  v_mfma_f32_32x32x16_bf16 v[80:95], a[140:143], v[28:31], v[80:95]
  ds_read_b128 v[28:31], v112 offset:39936
  s_waitcnt lgkmcnt(3)
  v_mfma_f32_32x32x16_bf16 v[80:95], a[144:147], v[16:19], v[80:95]
  ds_read_b128 v[16:19], v112 offset:40960
  s_waitcnt lgkmcnt(3)
  v_mfma_f32_32x32x16_bf16 v[80:95], a[148:151], v[20:23], v[80:95]
  ds_read_b128 v[20:23], v112 offset:41984
  s_waitcnt lgkmcnt(3)
  v_mfma_f32_32x32x16_bf16 v[80:95], a[152:155], v[24:27], v[80:95]
  ds_read_b128 v[24:27], v112 offset:43008
  s_waitcnt lgkmcnt(3)
  v_mfma_f32_32x32x16_bf16 v[80:95], a[156:159], v[28:31], v[80:95]
  s_cmp_eq_u32 s89, 2
  s_cbranch_scc1 L_hwo_418
L_hwb_419:
  ds_read_b128 v[28:31], v112 offset:44032
  s_waitcnt lgkmcnt(3)
  v_mfma_f32_32x32x16_bf16 v[80:95], a[160:163], v[16:19], v[80:95]
  ds_read_b128 v[16:19], v112 offset:45056
  s_waitcnt lgkmcnt(3)
  v_mfma_f32_32x32x16_bf16 v[80:95], a[164:167], v[20:23], v[80:95]
  ds_read_b128 v[20:23], v112 offset:46080
  s_waitcnt lgkmcnt(3)
  v_mfma_f32_32x32x16_bf16 v[80:95], a[168:171], v[24:27], v[80:95]
  ds_read_b128 v[24:27], v112 offset:47104
  s_waitcnt lgkmcnt(3)
  v_mfma_f32_32x32x16_bf16 v[80:95], a[172:175], v[28:31], v[80:95]
  s_cmp_lg_u32 s89, 7
  s_cbranch_scc1 L_hre_420
  buffer_load_dword v11, v8, s[4:7], s96 offen sc1
L_hre_420:
  ds_read_b128 v[28:31], v112 offset:48128
  s_waitcnt lgkmcnt(3)
  v_mfma_f32_32x32x16_bf16 v[80:95], a[176:179], v[16:19], v[80:95]
  s_cmp_eq_u32 s89, 3
  s_cbranch_scc1 L_hwo_421
L_hwb_422:
  ds_read_b128 v[16:19], v112 offset:49152
  s_waitcnt lgkmcnt(3)
  v_mfma_f32_32x32x16_bf16 v[80:95], a[180:183], v[20:23], v[80:95]
  ds_read_b128 v[20:23], v112 offset:50176
  s_waitcnt lgkmcnt(3)
  v_mfma_f32_32x32x16_bf16 v[80:95], a[184:187], v[24:27], v[80:95]
  ds_read_b128 v[24:27], v112 offset:51200
  s_waitcnt lgkmcnt(3)
  v_mfma_f32_32x32x16_bf16 v[80:95], a[188:191], v[28:31], v[80:95]
  s_and_b32 s76, s55, 7
  s_lshl_b32 s76, s76, 17
  ds_read_b128 v[28:31], v112 offset:52224
  s_waitcnt lgkmcnt(3)
  v_mfma_f32_32x32x16_bf16 v[80:95], a[192:195], v[16:19], v[80:95]
  s_lshl_b32 s77, s73, 15
  s_add_u32 s76, s76, s77
  ds_read_b128 v[16:19], v112 offset:53248
  s_waitcnt lgkmcnt(3)
  v_mfma_f32_32x32x16_bf16 v[80:95], a[196:199], v[20:23], v[80:95]
  s_lshl_b32 s77, s54, 11
  s_add_u32 s76, s76, s77
  ds_read_b128 v[20:23], v112 offset:54272
  s_waitcnt lgkmcnt(3)
  v_mfma_f32_32x32x16_bf16 v[80:95], a[200:203], v[24:27], v[80:95]
  s_add_u32 s76, s76, s52
  s_add_u32 s76, s76, 0x4000000
  ds_read_b128 v[24:27], v112 offset:55296
  s_waitcnt lgkmcnt(3)
  v_mfma_f32_32x32x16_bf16 v[80:95], a[204:207], v[28:31], v[80:95]
  s_lshl_b32 s78, s55, 7
  s_lshl_b32 s79, s54, 5
  ds_read_b128 v[28:31], v112 offset:56320
  s_waitcnt lgkmcnt(3)
  v_mfma_f32_32x32x16_bf16 v[80:95], a[208:211], v[16:19], v[80:95]
  s_add_u32 s78, s78, s79
  s_lshl_b32 s79, s73, 4
  s_waitcnt lgkmcnt(2)
  v_mfma_f32_32x32x16_bf16 v[80:95], a[212:215], v[20:23], v[80:95]
  s_add_u32 s78, s78, s79
  s_add_u32 s78, s78, 0x21000
  s_waitcnt lgkmcnt(1)
  v_mfma_f32_32x32x16_bf16 v[80:95], a[216:219], v[24:27], v[80:95]
  s_add_u32 s78, s78, s53
  s_waitcnt lgkmcnt(0)
  v_mfma_f32_32x32x16_bf16 v[80:95], a[220:223], v[28:31], v[80:95]
  s_cmp_lg_u32 s59, 1
  s_cbranch_scc1 L_late_423
  s_mov_b32 s60, 1
  s_branch L_nl_425
  s_cmp_eq_u32 s80, 1
  s_cbranch_scc1 L_st1_424
  s_waitcnt vmcnt(0)
L_st1_424:
  s_waitcnt vmcnt(1)
  s_barrier
  ds_read_b128 v[16:19], v7 offset:0
  ds_read_b128 v[20:23], v7 offset:1024
  ds_read_b128 v[24:27], v7 offset:2048
  s_mov_b32 s60, 2
  s_mov_b32 s55, s74
  s_branch L_s5b0_379
L_late_423:
  s_mov_b32 s60, 0
  s_waitcnt vmcnt(0)
  s_cmp_ge_u32 s74, s57
  s_cbranch_scc1 L_nl_425
  v_cmp_eq_u32 vcc, 0, v11
  s_cbranch_vccnz L_nl_425
  s_mov_b32 s64, 0x0
  s_and_b32 s61, s74, 7
  s_mul_i32 s61, s61, 114688
  s_mul_i32 s68, s73, 57344
  s_add_u32 s61, s61, s68
  s_add_u32 s61, s61, 0x4800000
  s_add_u32 s61, s61, s52
  s_lshl_b32 s62, s58, 12
  s_add_u32 m0, s62, s64
  s_nop 0
  buffer_load_dwordx4 v6, s[4:7], s61 offen offset:0 sc1 lds
  buffer_load_dwordx4 v6, s[4:7], s61 offen offset:1024 sc1 lds
  buffer_load_dwordx4 v6, s[4:7], s61 offen offset:2048 sc1 lds
  buffer_load_dwordx4 v6, s[4:7], s61 offen offset:3072 sc1 lds
  s_add_u32 m0, m0, 0x4000
  s_add_u32 s61, s61, 0x4000
  buffer_load_dwordx4 v6, s[4:7], s61 offen offset:0 sc1 lds
  buffer_load_dwordx4 v6, s[4:7], s61 offen offset:1024 sc1 lds
  buffer_load_dwordx4 v6, s[4:7], s61 offen offset:2048 sc1 lds
  buffer_load_dwordx4 v6, s[4:7], s61 offen offset:3072 sc1 lds
  s_add_u32 m0, m0, 0x4000
  s_add_u32 s61, s61, 0x4000
  buffer_load_dwordx4 v6, s[4:7], s61 offen offset:0 sc1 lds
  buffer_load_dwordx4 v6, s[4:7], s61 offen offset:1024 sc1 lds
  buffer_load_dwordx4 v6, s[4:7], s61 offen offset:2048 sc1 lds
  buffer_load_dwordx4 v6, s[4:7], s61 offen offset:3072 sc1 lds
  s_add_u32 m0, m0, 0x4000
  s_add_u32 s61, s61, 0x4000
  buffer_load_dwordx4 v6, s[4:7], s61 offen offset:0 sc1 lds
  buffer_load_dwordx4 v6, s[4:7], s61 offen offset:1024 sc1 lds
  buffer_load_dwordx4 v6, s[4:7], s61 offen offset:2048 sc1 lds
  buffer_load_dwordx4 v6, s[4:7], s61 offen offset:3072 sc1 lds
  s_mov_b32 s60, 1
L_nl_425:
  s_nop 7
  v_cvt_pk_bf16_f32 v64, v80, v81
  v_cvt_pk_bf16_f32 v65, v82, v83
  v_cvt_pk_bf16_f32 v66, v84, v85
  v_cvt_pk_bf16_f32 v67, v86, v87
  buffer_store_dwordx4 v[64:67], v12, s[4:7], s76 offen offset:0
  v_cvt_pk_bf16_f32 v68, v88, v89
  v_cvt_pk_bf16_f32 v69, v90, v91
  v_cvt_pk_bf16_f32 v70, v92, v93
  v_cvt_pk_bf16_f32 v71, v94, v95
  buffer_store_dwordx4 v[68:71], v12, s[4:7], s76 offen offset:256
  s_mov_b32 s88, s78
  s_mov_b32 s55, s74
  s_cmp_lt_u32 s55, s57
  s_cbranch_scc1 L_s5h0_377
  s_waitcnt vmcnt(0)
  s_cmp_eq_u32 s88, 0
  s_cbranch_scc1 L_nofl_426
  s_mov_b64 exec, 1
  buffer_store_dword v10, v9, s[4:7], s88 offen
  s_mov_b64 exec, -1
  s_mov_b32 s88, 0
L_nofl_426:
  s_endpgm
L_hwo_391:
  s_mov_b32 s64, 0x10000
  s_and_b32 s61, s74, 7
  s_mul_i32 s61, s61, 114688
  s_mul_i32 s68, s73, 57344
  s_add_u32 s61, s61, s68
  s_add_u32 s61, s61, 0x4800000
  s_add_u32 s61, s61, s52
  s_lshl_b32 s62, s58, 12
  s_add_u32 m0, s62, s64
  s_nop 0
  buffer_load_dwordx4 v6, s[4:7], s61 offen offset:0 sc1 lds
  buffer_load_dwordx4 v6, s[4:7], s61 offen offset:1024 sc1 lds
  buffer_load_dwordx4 v6, s[4:7], s61 offen offset:2048 sc1 lds
  buffer_load_dwordx4 v6, s[4:7], s61 offen offset:3072 sc1 lds
  s_add_u32 m0, m0, 0x4000
  s_add_u32 s61, s61, 0x4000
  buffer_load_dwordx4 v6, s[4:7], s61 offen offset:0 sc1 lds
  buffer_load_dwordx4 v6, s[4:7], s61 offen offset:1024 sc1 lds
  buffer_load_dwordx4 v6, s[4:7], s61 offen offset:2048 sc1 lds
  buffer_load_dwordx4 v6, s[4:7], s61 offen offset:3072 sc1 lds
  s_add_u32 m0, m0, 0x4000
  s_add_u32 s61, s61, 0x4000
  buffer_load_dwordx4 v6, s[4:7], s61 offen offset:0 sc1 lds
  buffer_load_dwordx4 v6, s[4:7], s61 offen offset:1024 sc1 lds
  buffer_load_dwordx4 v6, s[4:7], s61 offen offset:2048 sc1 lds
  buffer_load_dwordx4 v6, s[4:7], s61 offen offset:3072 sc1 lds
  s_add_u32 m0, m0, 0x4000
  s_add_u32 s61, s61, 0x4000
  buffer_load_dwordx4 v6, s[4:7], s61 offen offset:0 sc1 lds
  buffer_load_dwordx4 v6, s[4:7], s61 offen offset:1024 sc1 lds
  buffer_load_dwordx4 v6, s[4:7], s61 offen offset:2048 sc1 lds
  buffer_load_dwordx4 v6, s[4:7], s61 offen offset:3072 sc1 lds
  s_mov_b32 s59, 1
  s_branch L_hwb_392
L_hwo_393:
  s_mov_b32 s64, 0x10000
  s_and_b32 s61, s74, 7
  s_mul_i32 s61, s61, 114688
  s_mul_i32 s68, s73, 57344
  s_add_u32 s61, s61, s68
  s_add_u32 s61, s61, 0x4800000
  s_add_u32 s61, s61, s52
  s_lshl_b32 s62, s58, 12
  s_add_u32 m0, s62, s64
  s_nop 0
  buffer_load_dwordx4 v6, s[4:7], s61 offen offset:0 sc1 lds
  buffer_load_dwordx4 v6, s[4:7], s61 offen offset:1024 sc1 lds
  buffer_load_dwordx4 v6, s[4:7], s61 offen offset:2048 sc1 lds
  buffer_load_dwordx4 v6, s[4:7], s61 offen offset:3072 sc1 lds
  s_add_u32 m0, m0, 0x4000
  s_add_u32 s61, s61, 0x4000
  buffer_load_dwordx4 v6, s[4:7], s61 offen offset:0 sc1 lds
  buffer_load_dwordx4 v6, s[4:7], s61 offen offset:1024 sc1 lds
  buffer_load_dwordx4 v6, s[4:7], s61 offen offset:2048 sc1 lds
  buffer_load_dwordx4 v6, s[4:7], s61 offen offset:3072 sc1 lds
  s_add_u32 m0, m0, 0x4000
  s_add_u32 s61, s61, 0x4000
  buffer_load_dwordx4 v6, s[4:7], s61 offen offset:0 sc1 lds
  buffer_load_dwordx4 v6, s[4:7], s61 offen offset:1024 sc1 lds
  buffer_load_dwordx4 v6, s[4:7], s61 offen offset:2048 sc1 lds
  buffer_load_dwordx4 v6, s[4:7], s61 offen offset:3072 sc1 lds
  s_add_u32 m0, m0, 0x4000
  s_add_u32 s61, s61, 0x4000
  buffer_load_dwordx4 v6, s[4:7], s61 offen offset:0 sc1 lds
  buffer_load_dwordx4 v6, s[4:7], s61 offen offset:1024 sc1 lds
  buffer_load_dwordx4 v6, s[4:7], s61 offen offset:2048 sc1 lds
  buffer_load_dwordx4 v6, s[4:7], s61 offen offset:3072 sc1 lds
  s_mov_b32 s59, 1
  s_branch L_hwb_394
L_hwo_395:
  s_mov_b32 s64, 0x10000
  s_and_b32 s61, s74, 7
  s_mul_i32 s61, s61, 114688
  s_mul_i32 s68, s73, 57344
  s_add_u32 s61, s61, s68
  s_add_u32 s61, s61, 0x4800000
  s_add_u32 s61, s61, s52
  s_lshl_b32 s62, s58, 12
  s_add_u32 m0, s62, s64
  s_nop 0
  buffer_load_dwordx4 v6, s[4:7], s61 offen offset:0 sc1 lds
  buffer_load_dwordx4 v6, s[4:7], s61 offen offset:1024 sc1 lds
  buffer_load_dwordx4 v6, s[4:7], s61 offen offset:2048 sc1 lds
  buffer_load_dwordx4 v6, s[4:7], s61 offen offset:3072 sc1 lds
  s_add_u32 m0, m0, 0x4000
  s_add_u32 s61, s61, 0x4000
  buffer_load_dwordx4 v6, s[4:7], s61 offen offset:0 sc1 lds
  buffer_load_dwordx4 v6, s[4:7], s61 offen offset:1024 sc1 lds
  buffer_load_dwordx4 v6, s[4:7], s61 offen offset:2048 sc1 lds
  buffer_load_dwordx4 v6, s[4:7], s61 offen offset:3072 sc1 lds
  s_add_u32 m0, m0, 0x4000
  s_add_u32 s61, s61, 0x4000
  buffer_load_dwordx4 v6, s[4:7], s61 offen offset:0 sc1 lds
  buffer_load_dwordx4 v6, s[4:7], s61 offen offset:1024 sc1 lds
  buffer_load_dwordx4 v6, s[4:7], s61 offen offset:2048 sc1 lds
  buffer_load_dwordx4 v6, s[4:7], s61 offen offset:3072 sc1 lds
  s_add_u32 m0, m0, 0x4000
  s_add_u32 s61, s61, 0x4000
  buffer_load_dwordx4 v6, s[4:7], s61 offen offset:0 sc1 lds
  buffer_load_dwordx4 v6, s[4:7], s61 offen offset:1024 sc1 lds
  buffer_load_dwordx4 v6, s[4:7], s61 offen offset:2048 sc1 lds
  buffer_load_dwordx4 v6, s[4:7], s61 offen offset:3072 sc1 lds
  s_mov_b32 s59, 1
  s_branch L_hwb_396
L_hwo_398:
  s_mov_b32 s64, 0x10000
  s_and_b32 s61, s74, 7
  s_mul_i32 s61, s61, 114688
  s_mul_i32 s68, s73, 57344
  s_add_u32 s61, s61, s68
  s_add_u32 s61, s61, 0x4800000
  s_add_u32 s61, s61, s52
  s_lshl_b32 s62, s58, 12
  s_add_u32 m0, s62, s64
  s_nop 0
  buffer_load_dwordx4 v6, s[4:7], s61 offen offset:0 sc1 lds
  buffer_load_dwordx4 v6, s[4:7], s61 offen offset:1024 sc1 lds
  buffer_load_dwordx4 v6, s[4:7], s61 offen offset:2048 sc1 lds
  buffer_load_dwordx4 v6, s[4:7], s61 offen offset:3072 sc1 lds
  s_add_u32 m0, m0, 0x4000
  s_add_u32 s61, s61, 0x4000
  buffer_load_dwordx4 v6, s[4:7], s61 offen offset:0 sc1 lds
  buffer_load_dwordx4 v6, s[4:7], s61 offen offset:1024 sc1 lds
  buffer_load_dwordx4 v6, s[4:7], s61 offen offset:2048 sc1 lds
  buffer_load_dwordx4 v6, s[4:7], s61 offen offset:3072 sc1 lds
  s_add_u32 m0, m0, 0x4000
  s_add_u32 s61, s61, 0x4000
  buffer_load_dwordx4 v6, s[4:7], s61 offen offset:0 sc1 lds
  buffer_load_dwordx4 v6, s[4:7], s61 offen offset:1024 sc1 lds
  buffer_load_dwordx4 v6, s[4:7], s61 offen offset:2048 sc1 lds
  buffer_load_dwordx4 v6, s[4:7], s61 offen offset:3072 sc1 lds
  s_add_u32 m0, m0, 0x4000
  s_add_u32 s61, s61, 0x4000
  buffer_load_dwordx4 v6, s[4:7], s61 offen offset:0 sc1 lds
  buffer_load_dwordx4 v6, s[4:7], s61 offen offset:1024 sc1 lds
  buffer_load_dwordx4 v6, s[4:7], s61 offen offset:2048 sc1 lds
  buffer_load_dwordx4 v6, s[4:7], s61 offen offset:3072 sc1 lds
  s_mov_b32 s59, 1
  s_branch L_hwb_399
L_hwo_414:
  s_mov_b32 s64, 0x0
  s_and_b32 s61, s74, 7
  s_mul_i32 s61, s61, 114688
  s_mul_i32 s68, s73, 57344
  s_add_u32 s61, s61, s68
  s_add_u32 s61, s61, 0x4800000
  s_add_u32 s61, s61, s52
  s_lshl_b32 s62, s58, 12
  s_add_u32 m0, s62, s64
  s_nop 0
  buffer_load_dwordx4 v6, s[4:7], s61 offen offset:0 sc1 lds
  buffer_load_dwordx4 v6, s[4:7], s61 offen offset:1024 sc1 lds
  buffer_load_dwordx4 v6, s[4:7], s61 offen offset:2048 sc1 lds
  buffer_load_dwordx4 v6, s[4:7], s61 offen offset:3072 sc1 lds
  s_add_u32 m0, m0, 0x4000
  s_add_u32 s61, s61, 0x4000
  buffer_load_dwordx4 v6, s[4:7], s61 offen offset:0 sc1 lds
  buffer_load_dwordx4 v6, s[4:7], s61 offen offset:1024 sc1 lds
  buffer_load_dwordx4 v6, s[4:7], s61 offen offset:2048 sc1 lds
  buffer_load_dwordx4 v6, s[4:7], s61 offen offset:3072 sc1 lds
  s_add_u32 m0, m0, 0x4000
  s_add_u32 s61, s61, 0x4000
  buffer_load_dwordx4 v6, s[4:7], s61 offen offset:0 sc1 lds
  buffer_load_dwordx4 v6, s[4:7], s61 offen offset:1024 sc1 lds
  buffer_load_dwordx4 v6, s[4:7], s61 offen offset:2048 sc1 lds
  buffer_load_dwordx4 v6, s[4:7], s61 offen offset:3072 sc1 lds
  s_add_u32 m0, m0, 0x4000
  s_add_u32 s61, s61, 0x4000
  buffer_load_dwordx4 v6, s[4:7], s61 offen offset:0 sc1 lds
  buffer_load_dwordx4 v6, s[4:7], s61 offen offset:1024 sc1 lds
  buffer_load_dwordx4 v6, s[4:7], s61 offen offset:2048 sc1 lds
  buffer_load_dwordx4 v6, s[4:7], s61 offen offset:3072 sc1 lds
  s_mov_b32 s59, 1
  s_branch L_hwb_415
L_hwo_416:
  s_mov_b32 s64, 0x0
  s_and_b32 s61, s74, 7
  s_mul_i32 s61, s61, 114688
  s_mul_i32 s68, s73, 57344
  s_add_u32 s61, s61, s68
  s_add_u32 s61, s61, 0x4800000
  s_add_u32 s61, s61, s52
  s_lshl_b32 s62, s58, 12
  s_add_u32 m0, s62, s64
  s_nop 0
  buffer_load_dwordx4 v6, s[4:7], s61 offen offset:0 sc1 lds
  buffer_load_dwordx4 v6, s[4:7], s61 offen offset:1024 sc1 lds
  buffer_load_dwordx4 v6, s[4:7], s61 offen offset:2048 sc1 lds
  buffer_load_dwordx4 v6, s[4:7], s61 offen offset:3072 sc1 lds
  s_add_u32 m0, m0, 0x4000
  s_add_u32 s61, s61, 0x4000
  buffer_load_dwordx4 v6, s[4:7], s61 offen offset:0 sc1 lds
  buffer_load_dwordx4 v6, s[4:7], s61 offen offset:1024 sc1 lds
  buffer_load_dwordx4 v6, s[4:7], s61 offen offset:2048 sc1 lds
  buffer_load_dwordx4 v6, s[4:7], s61 offen offset:3072 sc1 lds
  s_add_u32 m0, m0, 0x4000
  s_add_u32 s61, s61, 0x4000
  buffer_load_dwordx4 v6, s[4:7], s61 offen offset:0 sc1 lds
  buffer_load_dwordx4 v6, s[4:7], s61 offen offset:1024 sc1 lds
  buffer_load_dwordx4 v6, s[4:7], s61 offen offset:2048 sc1 lds
  buffer_load_dwordx4 v6, s[4:7], s61 offen offset:3072 sc1 lds
  s_add_u32 m0, m0, 0x4000
  s_add_u32 s61, s61, 0x4000
  buffer_load_dwordx4 v6, s[4:7], s61 offen offset:0 sc1 lds
  buffer_load_dwordx4 v6, s[4:7], s61 offen offset:1024 sc1 lds
  buffer_load_dwordx4 v6, s[4:7], s61 offen offset:2048 sc1 lds
  buffer_load_dwordx4 v6, s[4:7], s61 offen offset:3072 sc1 lds
  s_mov_b32 s59, 1
  s_branch L_hwb_417
L_hwo_418:
  s_mov_b32 s64, 0x0
  s_and_b32 s61, s74, 7
  s_mul_i32 s61, s61, 114688
  s_mul_i32 s68, s73, 57344
  s_add_u32 s61, s61, s68
  s_add_u32 s61, s61, 0x4800000
  s_add_u32 s61, s61, s52
  s_lshl_b32 s62, s58, 12
  s_add_u32 m0, s62, s64
  s_nop 0
  buffer_load_dwordx4 v6, s[4:7], s61 offen offset:0 sc1 lds
  buffer_load_dwordx4 v6, s[4:7], s61 offen offset:1024 sc1 lds
  buffer_load_dwordx4 v6, s[4:7], s61 offen offset:2048 sc1 lds
  buffer_load_dwordx4 v6, s[4:7], s61 offen offset:3072 sc1 lds
  s_add_u32 m0, m0, 0x4000
  s_add_u32 s61, s61, 0x4000
  buffer_load_dwordx4 v6, s[4:7], s61 offen offset:0 sc1 lds
  buffer_load_dwordx4 v6, s[4:7], s61 offen offset:1024 sc1 lds
  buffer_load_dwordx4 v6, s[4:7], s61 offen offset:2048 sc1 lds
  buffer_load_dwordx4 v6, s[4:7], s61 offen offset:3072 sc1 lds
  s_add_u32 m0, m0, 0x4000
  s_add_u32 s61, s61, 0x4000
  buffer_load_dwordx4 v6, s[4:7], s61 offen offset:0 sc1 lds
  buffer_load_dwordx4 v6, s[4:7], s61 offen offset:1024 sc1 lds
  buffer_load_dwordx4 v6, s[4:7], s61 offen offset:2048 sc1 lds
  buffer_load_dwordx4 v6, s[4:7], s61 offen offset:3072 sc1 lds
  s_add_u32 m0, m0, 0x4000
  s_add_u32 s61, s61, 0x4000
  buffer_load_dwordx4 v6, s[4:7], s61 offen offset:0 sc1 lds
  buffer_load_dwordx4 v6, s[4:7], s61 offen offset:1024 sc1 lds
  buffer_load_dwordx4 v6, s[4:7], s61 offen offset:2048 sc1 lds
  buffer_load_dwordx4 v6, s[4:7], s61 offen offset:3072 sc1 lds
  s_mov_b32 s59, 1
  s_branch L_hwb_419
L_hwo_421:
  s_mov_b32 s64, 0x0
  s_and_b32 s61, s74, 7
  s_mul_i32 s61, s61, 114688
  s_mul_i32 s68, s73, 57344
  s_add_u32 s61, s61, s68
  s_add_u32 s61, s61, 0x4800000
  s_add_u32 s61, s61, s52
  s_lshl_b32 s62, s58, 12
  s_add_u32 m0, s62, s64
  s_nop 0
  buffer_load_dwordx4 v6, s[4:7], s61 offen offset:0 sc1 lds
  buffer_load_dwordx4 v6, s[4:7], s61 offen offset:1024 sc1 lds
  buffer_load_dwordx4 v6, s[4:7], s61 offen offset:2048 sc1 lds
  buffer_load_dwordx4 v6, s[4:7], s61 offen offset:3072 sc1 lds
  s_add_u32 m0, m0, 0x4000
  s_add_u32 s61, s61, 0x4000
  buffer_load_dwordx4 v6, s[4:7], s61 offen offset:0 sc1 lds
  buffer_load_dwordx4 v6, s[4:7], s61 offen offset:1024 sc1 lds
  buffer_load_dwordx4 v6, s[4:7], s61 offen offset:2048 sc1 lds
  buffer_load_dwordx4 v6, s[4:7], s61 offen offset:3072 sc1 lds
  s_add_u32 m0, m0, 0x4000
  s_add_u32 s61, s61, 0x4000
  buffer_load_dwordx4 v6, s[4:7], s61 offen offset:0 sc1 lds
  buffer_load_dwordx4 v6, s[4:7], s61 offen offset:1024 sc1 lds
  buffer_load_dwordx4 v6, s[4:7], s61 offen offset:2048 sc1 lds
  buffer_load_dwordx4 v6, s[4:7], s61 offen offset:3072 sc1 lds
  s_add_u32 m0, m0, 0x4000
  s_add_u32 s61, s61, 0x4000
  buffer_load_dwordx4 v6, s[4:7], s61 offen offset:0 sc1 lds
  buffer_load_dwordx4 v6, s[4:7], s61 offen offset:1024 sc1 lds
  buffer_load_dwordx4 v6, s[4:7], s61 offen offset:2048 sc1 lds
  buffer_load_dwordx4 v6, s[4:7], s61 offen offset:3072 sc1 lds
  s_mov_b32 s59, 1
  s_branch L_hwb_422
  s_endpgm
B_s2_f:
  v_mov_b32 v6, 0x0
  v_bfe_i32 v2, v0, 0, 1
  v_and_b32 v2, 0x10, v2
  v_add_u32 v6, v6, v2
  v_bfe_i32 v2, v0, 1, 1
  v_and_b32 v2, 0x20, v2
  v_add_u32 v6, v6, v2
  v_bfe_i32 v2, v0, 2, 1
  v_and_b32 v2, 0x40, v2
  v_add_u32 v6, v6, v2
  v_bfe_i32 v2, v0, 3, 1
  v_and_b32 v2, 0x80, v2
  v_add_u32 v6, v6, v2
  v_bfe_i32 v2, v0, 4, 1
  v_and_b32 v2, 0x100, v2
  v_add_u32 v6, v6, v2
  v_bfe_i32 v2, v0, 5, 1
  v_and_b32 v2, 0x200, v2
  v_add_u32 v6, v6, v2
  v_bfe_i32 v2, v0, 6, 1
  v_and_b32 v2, 0x1000, v2
  v_add_u32 v6, v6, v2
  v_bfe_i32 v2, v0, 7, 1
  v_and_b32 v2, 0x2000, v2
  v_add_u32 v6, v6, v2
  v_mov_b32 v7, 0x0
  v_bfe_i32 v2, v0, 0, 1
  v_and_b32 v2, 0x10, v2
  v_add_u32 v7, v7, v2
  v_bfe_i32 v2, v0, 1, 1
  v_and_b32 v2, 0x20, v2
  v_add_u32 v7, v7, v2
  v_bfe_i32 v2, v0, 2, 1
  v_and_b32 v2, 0x40, v2
  v_add_u32 v7, v7, v2
  v_bfe_i32 v2, v0, 3, 1
  v_and_b32 v2, 0x80, v2
  v_add_u32 v7, v7, v2
  v_bfe_i32 v2, v0, 4, 1
  v_and_b32 v2, 0x100, v2
  v_add_u32 v7, v7, v2
  v_bfe_i32 v2, v0, 5, 1
  v_and_b32 v2, 0x200, v2
  v_add_u32 v7, v7, v2
  v_mov_b32 v8, 0x0
  v_bfe_i32 v2, v0, 0, 1
  v_and_b32 v2, 0x4, v2
  v_add_u32 v8, v8, v2
  v_bfe_i32 v2, v0, 1, 1
  v_and_b32 v2, 0x8, v2
  v_add_u32 v8, v8, v2
  v_bfe_i32 v2, v0, 2, 1
  v_and_b32 v2, 0x10, v2
  v_add_u32 v8, v8, v2
  v_bfe_i32 v2, v0, 3, 1
  v_and_b32 v2, 0x20, v2
  v_add_u32 v8, v8, v2
  v_mov_b32 v9, 0x0
  v_bfe_i32 v2, v0, 6, 1
  v_and_b32 v2, 0x4, v2
  v_add_u32 v9, v9, v2
  v_bfe_i32 v2, v0, 7, 1
  v_and_b32 v2, 0x8, v2
  v_add_u32 v9, v9, v2
  v_mov_b32 v10, 1
  v_mov_b32 v12, 0x0
  v_bfe_i32 v2, v0, 0, 1
  v_and_b32 v2, 0x10, v2
  v_add_u32 v12, v12, v2
  v_bfe_i32 v2, v0, 1, 1
  v_and_b32 v2, 0x20, v2
  v_add_u32 v12, v12, v2
  v_bfe_i32 v2, v0, 2, 1
  v_and_b32 v2, 0x40, v2
  v_add_u32 v12, v12, v2
  v_bfe_i32 v2, v0, 3, 1
  v_and_b32 v2, 0x80, v2
  v_add_u32 v12, v12, v2
  v_bfe_i32 v2, v0, 4, 1
  v_and_b32 v2, 0x100, v2
  v_add_u32 v12, v12, v2
  v_bfe_i32 v2, v0, 5, 1
  v_and_b32 v2, 0x200, v2
  v_add_u32 v12, v12, v2
  v_bfe_i32 v2, v0, 6, 1
  v_and_b32 v2, 0x800, v2
  v_add_u32 v12, v12, v2
  v_bfe_i32 v2, v0, 7, 1
  v_and_b32 v2, 0x1000, v2
  v_add_u32 v12, v12, v2
  v_mov_b32 v236, 0x10000
  v_bfe_i32 v2, v0, 0, 1
  v_and_b32 v2, 0x10, v2
  v_add_u32 v236, v236, v2
  v_bfe_i32 v2, v0, 1, 1
  v_and_b32 v2, 0x20, v2
  v_add_u32 v236, v236, v2
  v_bfe_i32 v2, v0, 2, 1
  v_and_b32 v2, 0x40, v2
  v_add_u32 v236, v236, v2
  v_bfe_i32 v2, v0, 3, 1
  v_and_b32 v2, 0x80, v2
  v_add_u32 v236, v236, v2
  v_bfe_i32 v2, v0, 4, 1
  v_and_b32 v2, 0x100, v2
  v_add_u32 v236, v236, v2
  v_bfe_i32 v2, v0, 5, 1
  v_and_b32 v2, 0x200, v2
  v_add_u32 v236, v236, v2
  v_bfe_i32 v2, v0, 6, 1
  v_and_b32 v2, 0x800, v2
  v_add_u32 v236, v236, v2
  v_bfe_i32 v2, v0, 7, 1
  v_and_b32 v2, 0x1000, v2
  v_add_u32 v236, v236, v2
  v_mov_b32 v237, 0x12000
  v_bfe_i32 v2, v0, 0, 1
  v_and_b32 v2, 0x8, v2
  v_add_u32 v237, v237, v2
  v_bfe_i32 v2, v0, 2, 1
  v_and_b32 v2, 0x10, v2
  v_add_u32 v237, v237, v2
  v_bfe_i32 v2, v0, 3, 1
  v_and_b32 v2, 0x20, v2
  v_add_u32 v237, v237, v2
  v_bfe_i32 v2, v0, 5, 1
  v_and_b32 v2, 0x40, v2
  v_add_u32 v237, v237, v2
  v_bfe_i32 v2, v0, 6, 1
  v_and_b32 v2, 0x800, v2
  v_add_u32 v237, v237, v2
  v_bfe_i32 v2, v0, 7, 1
  v_and_b32 v2, 0x1000, v2
  v_add_u32_e64 v237, v237, v2
  s_lshl_b32 s80, s58, 11
  s_add_u32 s80, s80, 73728
  v_mov_b32 v238, 0x800
  v_bfe_i32 v2, v0, 0, 1
  v_and_b32 v2, 0x10, v2
  v_add_u32 v238, v238, v2
  v_bfe_i32 v2, v0, 1, 1
  v_and_b32 v2, 0x20, v2
  v_add_u32 v238, v238, v2
  v_bfe_i32 v2, v0, 2, 1
  v_and_b32 v2, 0x40, v2
  v_add_u32 v238, v238, v2
  v_bfe_i32 v2, v0, 3, 1
  v_and_b32 v2, 0x80, v2
  v_add_u32 v238, v238, v2
  v_bfe_i32 v2, v0, 4, 1
  v_and_b32 v2, 0x100, v2
  v_add_u32 v238, v238, v2
  v_bfe_i32 v2, v0, 5, 1
  v_and_b32 v2, 0x8, v2
  v_add_u32 v238, v238, v2
  v_bfe_i32 v2, v0, 6, 1
  v_and_b32 v2, 0x200, v2
  v_add_u32 v238, v238, v2
  v_bfe_i32 v2, v0, 7, 1
  v_and_b32 v2, 0x400, v2
  v_add_u32 v238, v238, v2
  v_mov_b32 v239, 0x0
  v_bfe_i32 v2, v0, 0, 1
  v_and_b32 v2, 0x4, v2
  v_add_u32 v239, v239, v2
  v_bfe_i32 v2, v0, 1, 1
  v_and_b32 v2, 0x8, v2
  v_add_u32 v239, v239, v2
  v_mov_b32 v11, 0x40
  v_bfe_i32 v2, v0, 0, 1
  v_and_b32 v2, 0x1, v2
  v_add_u32 v11, v11, v2
  v_bfe_i32 v2, v0, 1, 1
  v_and_b32 v2, 0x2, v2
  v_add_u32 v11, v11, v2
  v_bfe_i32 v2, v0, 2, 1
  v_and_b32 v2, 0x4, v2
  v_add_u32 v11, v11, v2
  v_bfe_i32 v2, v0, 3, 1
  v_and_b32 v2, 0x8, v2
  v_add_u32 v11, v11, v2
  v_bfe_i32 v2, v0, 4, 1
  v_and_b32 v2, 0x10, v2
  v_add_u32 v11, v11, v2
  v_bfe_i32 v2, v0, 5, 1
  v_and_b32 v2, 0xfffffffc, v2
  v_add_u32 v11, v11, v2
  v_mov_b32 v240, 0xf149f2ca
  v_mov_b32 v2, 64
  v_cmp_gt_u32 vcc, v2, v11
  s_nop 1
  v_cndmask_b32 v188, 0, v240, vcc
  v_mov_b32 v2, 65
  v_cmp_gt_u32 vcc, v2, v11
  s_nop 1
  v_cndmask_b32 v189, 0, v240, vcc
  v_mov_b32 v2, 66
  v_cmp_gt_u32 vcc, v2, v11
  s_nop 1
  v_cndmask_b32 v190, 0, v240, vcc
  v_mov_b32 v2, 67
  v_cmp_gt_u32 vcc, v2, v11
  s_nop 1
  v_cndmask_b32 v191, 0, v240, vcc
  v_mov_b32 v2, 72
  v_cmp_gt_u32 vcc, v2, v11
  s_nop 1
  v_cndmask_b32 v192, 0, v240, vcc
  v_mov_b32 v2, 73
  v_cmp_gt_u32 vcc, v2, v11
  s_nop 1
  v_cndmask_b32 v193, 0, v240, vcc
  v_mov_b32 v2, 74
  v_cmp_gt_u32 vcc, v2, v11
  s_nop 1
  v_cndmask_b32 v194, 0, v240, vcc
  v_mov_b32 v2, 75
  v_cmp_gt_u32 vcc, v2, v11
  s_nop 1
  v_cndmask_b32 v195, 0, v240, vcc
  v_mov_b32 v2, 80
  v_cmp_gt_u32 vcc, v2, v11
  s_nop 1
  v_cndmask_b32 v196, 0, v240, vcc
  v_mov_b32 v2, 81
  v_cmp_gt_u32 vcc, v2, v11
  s_nop 1
  v_cndmask_b32 v197, 0, v240, vcc
  v_mov_b32 v2, 82
  v_cmp_gt_u32 vcc, v2, v11
  s_nop 1
  v_cndmask_b32 v198, 0, v240, vcc
  v_mov_b32 v2, 83
  v_cmp_gt_u32 vcc, v2, v11
  s_nop 1
  v_cndmask_b32 v199, 0, v240, vcc
  v_mov_b32 v2, 88
  v_cmp_gt_u32 vcc, v2, v11
  s_nop 1
  v_cndmask_b32 v200, 0, v240, vcc
  v_mov_b32 v2, 89
  v_cmp_gt_u32 vcc, v2, v11
  s_nop 1
  v_cndmask_b32 v201, 0, v240, vcc
  v_mov_b32 v2, 90
  v_cmp_gt_u32 vcc, v2, v11
  s_nop 1
  v_cndmask_b32 v202, 0, v240, vcc
  v_mov_b32 v2, 91
  v_cmp_gt_u32 vcc, v2, v11
  s_nop 1
  v_cndmask_b32 v203, 0, v240, vcc
  v_mov_b32 v186, 0
  v_mov_b32 v187, 0
  v_mov_b32 v230, 0
  v_mov_b32 v231, 0
  s_mov_b32 s81, 0x3e0293ee
  s_mov_b32 s8, s28
  s_and_b32 s9, s29, 0xffff
  s_mov_b32 s10, 0x400000
  s_mov_b32 s11, 0x20000
  v_mov_b32 v3, 0x0
  v_bfe_i32 v2, v0, 0, 1
  v_and_b32 v2, 0x10, v2
  v_xor_b32 v3, v3, v2
  v_bfe_i32 v2, v0, 1, 1
  v_and_b32 v2, 0x20, v2
  v_xor_b32 v3, v3, v2
  v_bfe_i32 v2, v0, 2, 1
  v_and_b32 v2, 0x40, v2
  v_xor_b32 v3, v3, v2
  v_bfe_i32 v2, v0, 3, 1
  v_and_b32 v2, 0x80, v2
  v_xor_b32 v3, v3, v2
  v_bfe_i32 v2, v0, 4, 1
  v_and_b32 v2, 0x40, v2
  v_xor_b32 v3, v3, v2
  v_bfe_i32 v2, v0, 5, 1
  v_and_b32 v2, 0x80, v2
  v_xor_b32 v3, v3, v2
  v_mov_b32 v5, 0x0
  v_bfe_i32 v2, v0, 4, 1
  v_and_b32 v2, 0x2000, v2
  v_add_u32 v5, v5, v2
  v_bfe_i32 v2, v0, 5, 1
  v_and_b32 v2, 0x4000, v2
  v_add_u32 v5, v5, v2
  v_add_u32 v3, v3, v5
  v_mov_b32 v4, 0x0
  v_bfe_i32 v2, v0, 0, 1
  v_and_b32 v2, 0x8, v2
  v_xor_b32 v4, v4, v2
  v_bfe_i32 v2, v0, 1, 1
  v_and_b32 v2, 0x10, v2
  v_xor_b32 v4, v4, v2
  v_bfe_i32 v2, v0, 2, 1
  v_and_b32 v2, 0x140, v2
  v_xor_b32 v4, v4, v2
  v_bfe_i32 v2, v0, 3, 1
  v_and_b32 v2, 0x280, v2
  v_xor_b32 v4, v4, v2
  v_bfe_i32 v2, v0, 4, 1
  v_and_b32 v2, 0x20, v2
  v_xor_b32 v4, v4, v2
  v_bfe_i32 v2, v0, 5, 1
  v_and_b32 v2, 0x800, v2
  v_xor_b32 v4, v4, v2
  v_bfe_i32 v2, v0, 6, 1
  v_and_b32 v2, 0x40, v2
  v_xor_b32 v4, v4, v2
  v_bfe_i32 v2, v0, 7, 1
  v_and_b32 v2, 0x80, v2
  v_xor_b32 v4, v4, v2
  v_add_u32 v5, 0x10000, v4
  s_lshl_b32 s76, s54, 8
  s_barrier
  s_mul_i32 s61, s58, 1048576
  s_add_u32 s61, s61, s76
  s_add_u32 s61, s61, 0
  s_mul_i32 s62, s58, 32768
  s_mov_b32 s63, 0
L_wdma_427:
  s_mov_b32 m0, s62
  s_add_u32 s62, s62, 1024
  buffer_load_dwordx4 v3, s[8:11], s61 offen lds
  s_add_u32 s61, s61, 32768
  s_add_u32 s63, s63, 1
  s_cmp_lt_u32 s63, 32
  s_cbranch_scc1 L_wdma_427
  s_waitcnt vmcnt(0)
  s_barrier
  ds_read_b64_tr_b16 a[0:1], v4 offset:0
  ds_read_b64_tr_b16 a[2:3], v4 offset:1024
  ds_read_b64_tr_b16 a[4:5], v4 offset:4096
  ds_read_b64_tr_b16 a[6:7], v4 offset:5120
  ds_read_b64_tr_b16 a[8:9], v4 offset:8192
  ds_read_b64_tr_b16 a[10:11], v4 offset:9216
  ds_read_b64_tr_b16 a[12:13], v4 offset:12288
  ds_read_b64_tr_b16 a[14:15], v4 offset:13312
  s_waitcnt lgkmcnt(0)
  ds_read_b64_tr_b16 a[16:17], v4 offset:16384
  ds_read_b64_tr_b16 a[18:19], v4 offset:17408
  ds_read_b64_tr_b16 a[20:21], v4 offset:20480
  ds_read_b64_tr_b16 a[22:23], v4 offset:21504
  ds_read_b64_tr_b16 a[24:25], v4 offset:24576
  ds_read_b64_tr_b16 a[26:27], v4 offset:25600
  ds_read_b64_tr_b16 a[28:29], v4 offset:28672
  ds_read_b64_tr_b16 a[30:31], v4 offset:29696
  s_waitcnt lgkmcnt(0)
  ds_read_b64_tr_b16 a[32:33], v4 offset:32768
  ds_read_b64_tr_b16 a[34:35], v4 offset:33792
  ds_read_b64_tr_b16 a[36:37], v4 offset:36864
  ds_read_b64_tr_b16 a[38:39], v4 offset:37888
  ds_read_b64_tr_b16 a[40:41], v4 offset:40960
  ds_read_b64_tr_b16 a[42:43], v4 offset:41984
  ds_read_b64_tr_b16 a[44:45], v4 offset:45056
  ds_read_b64_tr_b16 a[46:47], v4 offset:46080
  s_waitcnt lgkmcnt(0)
  ds_read_b64_tr_b16 a[48:49], v4 offset:49152
  ds_read_b64_tr_b16 a[50:51], v4 offset:50176
  ds_read_b64_tr_b16 a[52:53], v4 offset:53248
  ds_read_b64_tr_b16 a[54:55], v4 offset:54272
  ds_read_b64_tr_b16 a[56:57], v4 offset:57344
  ds_read_b64_tr_b16 a[58:59], v4 offset:58368
  ds_read_b64_tr_b16 a[60:61], v4 offset:61440
  ds_read_b64_tr_b16 a[62:63], v4 offset:62464
  s_waitcnt lgkmcnt(0)
  ds_read_b64_tr_b16 a[64:65], v5 offset:0
  ds_read_b64_tr_b16 a[66:67], v5 offset:1024
  ds_read_b64_tr_b16 a[68:69], v5 offset:4096
  ds_read_b64_tr_b16 a[70:71], v5 offset:5120
  ds_read_b64_tr_b16 a[72:73], v5 offset:8192
  ds_read_b64_tr_b16 a[74:75], v5 offset:9216
  ds_read_b64_tr_b16 a[76:77], v5 offset:12288
  ds_read_b64_tr_b16 a[78:79], v5 offset:13312
  s_waitcnt lgkmcnt(0)
  ds_read_b64_tr_b16 a[80:81], v5 offset:16384
  ds_read_b64_tr_b16 a[82:83], v5 offset:17408
  ds_read_b64_tr_b16 a[84:85], v5 offset:20480
  ds_read_b64_tr_b16 a[86:87], v5 offset:21504
  ds_read_b64_tr_b16 a[88:89], v5 offset:24576
  ds_read_b64_tr_b16 a[90:91], v5 offset:25600
  ds_read_b64_tr_b16 a[92:93], v5 offset:28672
  ds_read_b64_tr_b16 a[94:95], v5 offset:29696
  s_waitcnt lgkmcnt(0)
  ds_read_b64_tr_b16 a[96:97], v5 offset:32768
  ds_read_b64_tr_b16 a[98:99], v5 offset:33792
  ds_read_b64_tr_b16 a[100:101], v5 offset:36864
  ds_read_b64_tr_b16 a[102:103], v5 offset:37888
  ds_read_b64_tr_b16 a[104:105], v5 offset:40960
  ds_read_b64_tr_b16 a[106:107], v5 offset:41984
  ds_read_b64_tr_b16 a[108:109], v5 offset:45056
  ds_read_b64_tr_b16 a[110:111], v5 offset:46080
  s_waitcnt lgkmcnt(0)
  ds_read_b64_tr_b16 a[112:113], v5 offset:49152
  ds_read_b64_tr_b16 a[114:115], v5 offset:50176
  ds_read_b64_tr_b16 a[116:117], v5 offset:53248
  ds_read_b64_tr_b16 a[118:119], v5 offset:54272
  ds_read_b64_tr_b16 a[120:121], v5 offset:57344
  ds_read_b64_tr_b16 a[122:123], v5 offset:58368
  ds_read_b64_tr_b16 a[124:125], v5 offset:61440
  ds_read_b64_tr_b16 a[126:127], v5 offset:62464
  s_waitcnt lgkmcnt(0)
  s_waitcnt lgkmcnt(0)
  s_barrier
  s_mov_b32 s20, s50
  s_and_b32 s21, s51, 0xffff
  s_mov_b32 s22, 0x0
  s_mov_b32 s23, 0x20000
  s_mov_b32 s8, s48
  s_and_b32 s9, s49, 0xffff
  s_mov_b32 s10, 0x100
  s_mov_b32 s11, 0x20000
  v_and_b32 v2, 3, v0
  v_lshlrev_b32 v2, 6, v2
L_gate_428:
  buffer_load_dword v11, v2, s[8:11], 0 offen offset:8 sc1
  s_waitcnt vmcnt(0)
  v_cmp_gt_u32 vcc, 48, v11
  s_cbranch_vccz L_gateok_429
  s_add_u32 s72, s72, 1
  s_cmp_gt_u32 s72, 0x80000
  s_cbranch_scc1 L_exit
  s_sleep 2
  s_branch L_gate_428
L_gateok_429:
  s_mov_b32 s59, 0
  s_mov_b32 s88, 0
  s_mov_b32 s60, 0
  v_and_b32 v241, 0x3ff, v7
  v_add_u32 v242, 65536, v241
  s_lshl_b32 s91, s58, 11
  s_add_u32 s91, s91, 81920
  v_add_u32 v246, 81920, v241
  s_mov_b32 s89, 0
  v_mov_b32 v248, 0x0
  v_bfe_i32 v2, v0, 0, 1
  v_and_b32 v2, 0x4, v2
  v_add_u32 v248, v248, v2
  v_bfe_i32 v2, v0, 1, 1
  v_and_b32 v2, 0x8, v2
  v_add_u32 v248, v248, v2
  v_bfe_i32 v2, v0, 2, 1
  v_and_b32 v2, 0x40, v2
  v_add_u32 v248, v248, v2
  v_bfe_i32 v2, v0, 3, 1
  v_and_b32 v2, 0x80, v2
  v_add_u32 v248, v248, v2
  s_lshr_b32 s87, s54, 3
  s_lshl_b32 s87, s87, 4
  s_add_u32 s87, s87, s53
  s_add_u32 s87, s87, 0x18000
  s_lshl_b32 s61, s54, 13
  s_add_u32 s61, s61, s52
  s_add_u32 s61, s61, 0x2000000
  buffer_load_dwordx4 v[64:67], v12, s[4:7], s61 offen sc1
  buffer_load_dwordx4 v[64:67], v12, s[4:7], s61 offen offset:1024 sc1
  s_add_u32 s61, s61, 0x40000
  buffer_load_dwordx4 v[64:67], v12, s[4:7], s61 offen sc1
  buffer_load_dwordx4 v[64:67], v12, s[4:7], s61 offen offset:1024 sc1
  s_add_u32 s61, s61, 0x40000
  buffer_load_dwordx4 v[64:67], v12, s[4:7], s61 offen sc1
  buffer_load_dwordx4 v[64:67], v12, s[4:7], s61 offen offset:1024 sc1
  s_add_u32 s61, s61, 0x40000
  buffer_load_dwordx4 v[64:67], v12, s[4:7], s61 offen sc1
  buffer_load_dwordx4 v[64:67], v12, s[4:7], s61 offen offset:1024 sc1
  s_add_u32 s61, s61, 0x40000
  buffer_load_dwordx4 v[64:67], v12, s[4:7], s61 offen sc1
  buffer_load_dwordx4 v[64:67], v12, s[4:7], s61 offen offset:1024 sc1
  s_add_u32 s61, s61, 0x40000
  buffer_load_dwordx4 v[64:67], v12, s[4:7], s61 offen sc1
  buffer_load_dwordx4 v[64:67], v12, s[4:7], s61 offen offset:1024 sc1
  s_add_u32 s61, s61, 0x40000
  buffer_load_dwordx4 v[64:67], v12, s[4:7], s61 offen sc1
  buffer_load_dwordx4 v[64:67], v12, s[4:7], s61 offen offset:1024 sc1
  s_add_u32 s61, s61, 0x40000
  buffer_load_dwordx4 v[64:67], v12, s[4:7], s61 offen sc1
  buffer_load_dwordx4 v[64:67], v12, s[4:7], s61 offen offset:1024 sc1
  s_add_u32 s61, s61, 0x40000
  s_sub_u32 s92, s53, 0x10000
  s_lshl_b32 s92, s92, 5
  s_add_u32 s92, s92, 0xd000000
  s_lshl_b32 s61, s54, 12
  s_add_u32 s92, s92, s61
L_s2_430:
  s_lshl_b32 s61, s55, 5
  s_add_u32 s61, s61, s54
  s_lshl_b32 s77, s61, 13
  s_add_u32 s77, s77, s52
  s_lshl_b32 s78, s61, 4
  s_add_u32 s78, s78, s53
  s_lshl_b32 s79, s55, 17
  s_add_u32 s79, s79, s92
  s_add_u32 s76, s55, s56
  s_min_u32 s76, s76, 63
  s_lshl_b32 s93, s76, 9
  s_lshl_b32 s61, s54, 4
  s_add_u32 s93, s93, s61
  s_add_u32 s93, s93, s53
  s_sub_u32 s73, s55, 8
  s_lshl_b32 s73, s73, 8
  s_add_u32 s73, s73, s87
  s_cmp_lt_u32 s55, 8
  s_cselect_b32 s73, 0x33000, s73
  s_add_u32 s74, s55, s56
  s_min_u32 s64, s74, 63
  s_lshl_b32 s96, s64, 6
  s_add_u32 s96, s96, 0x23000
  s_add_u32 s96, s96, s53
  s_lshl_b32 s94, s64, 15
  s_add_u32 s94, s94, 0x5a00000
  s_add_u32 s94, s94, s52
  s_lshl_b32 s95, s58, 12
  s_xor_b32 s64, s60, 0x8000
  s_add_u32 s95, s95, s64
  s_cmp_eq_u32 s59, 1
  s_cbranch_scc1 L_havepf_431
  s_lshl_b32 s63, s55, 6
  s_add_u32 s63, s63, 0x23000
  s_add_u32 s63, s63, s53
L_poll_433:
  buffer_load_dword v11, v8, s[4:7], s63 offen sc1
  s_waitcnt vmcnt(0)
  s_cmp_eq_u32 s88, 0
  s_cbranch_scc1 L_nofl_435
  s_mov_b64 exec, 1
  buffer_store_dword v10, v9, s[4:7], s88 offen
  s_mov_b64 exec, -1
  s_mov_b32 s88, 0
L_nofl_435:
  v_cmp_eq_u32 vcc, 0, v11
  s_cbranch_vccz L_pollok_434
  s_add_u32 s72, s72, 1
  s_cmp_gt_u32 s72, 0x80000
  s_cbranch_scc1 L_exit
  s_sleep 1
  s_branch L_poll_433
L_pollok_434:
  s_lshl_b32 s61, s55, 15
  s_add_u32 s61, s61, 0x5a00000
  s_add_u32 s61, s61, s52
  s_lshl_b32 s62, s58, 12
  s_add_u32 m0, s62, s60
  s_nop 0
  buffer_load_dwordx4 v6, s[4:7], s61 offen offset:0 sc1 lds
  buffer_load_dwordx4 v6, s[4:7], s61 offen offset:1024 sc1 lds
  buffer_load_dwordx4 v6, s[4:7], s61 offen offset:2048 sc1 lds
  buffer_load_dwordx4 v6, s[4:7], s61 offen offset:3072 sc1 lds
  s_add_u32 m0, m0, 0x4000
  s_add_u32 s61, s61, 0x4000
  buffer_load_dwordx4 v6, s[4:7], s61 offen offset:0 sc1 lds
  buffer_load_dwordx4 v6, s[4:7], s61 offen offset:1024 sc1 lds
  buffer_load_dwordx4 v6, s[4:7], s61 offen offset:2048 sc1 lds
  buffer_load_dwordx4 v6, s[4:7], s61 offen offset:3072 sc1 lds
  s_waitcnt vmcnt(0)
  s_branch L_head_432
L_havepf_431:
  s_waitcnt vmcnt(2)
L_head_432:
  s_barrier
  s_mov_b32 s59, 0
  ds_read_b128 v[16:19], v7 offset:0
  ds_read_b128 v[20:23], v7 offset:1024
  ds_read_b128 v[24:27], v7 offset:2048
  ds_read_b128 v[28:31], v7 offset:3072
  s_waitcnt lgkmcnt(3)
  v_mfma_f32_32x32x16_bf16 v[32:47], a[0:3], v[16:19], 0
  s_bitcmp1_b32 s89, 0
  s_cselect_b32 s22, 0x10000000, 0
  s_mov_b32 m0, s91
  s_add_u32 s62, s77, 0x1000000
  buffer_load_dwordx4 v12, s[20:23], s77 offen sc1 lds
  ds_read_b128 v[16:19], v7 offset:4096
  s_waitcnt lgkmcnt(3)
  v_mfma_f32_32x32x16_bf16 v[32:47], a[4:7], v[20:23], v[32:47]
  ds_read_b128 v[20:23], v7 offset:5120
  s_waitcnt lgkmcnt(3)
  v_mfma_f32_32x32x16_bf16 v[32:47], a[8:11], v[24:27], v[32:47]
  buffer_load_dwordx4 v12, s[20:23], s77 offen offset:1024 sc1 lds
  ds_read_b128 v[24:27], v7 offset:6144
  s_waitcnt lgkmcnt(3)
  v_mfma_f32_32x32x16_bf16 v[32:47], a[12:15], v[28:31], v[32:47]
  ds_read_b128 v[28:31], v7 offset:7168
  s_waitcnt lgkmcnt(3)
  v_mfma_f32_32x32x16_bf16 v[32:47], a[16:19], v[16:19], v[32:47]
  buffer_load_dwordx4 v[176:179], v12, s[20:23], s62 offen sc1
  ds_read_b128 v[16:19], v7 offset:8192
  s_waitcnt lgkmcnt(3)
  v_mfma_f32_32x32x16_bf16 v[32:47], a[20:23], v[20:23], v[32:47]
  ds_read_b128 v[20:23], v7 offset:9216
  s_waitcnt lgkmcnt(3)
  v_mfma_f32_32x32x16_bf16 v[32:47], a[24:27], v[24:27], v[32:47]
  buffer_load_dwordx4 v[180:183], v12, s[20:23], s62 offen offset:1024 sc1
  ds_read_b128 v[24:27], v7 offset:10240
  s_waitcnt lgkmcnt(3)
  v_mfma_f32_32x32x16_bf16 v[32:47], a[28:31], v[28:31], v[32:47]
  ds_read_b128 v[28:31], v7 offset:11264
  s_waitcnt lgkmcnt(3)
  v_mfma_f32_32x32x16_bf16 v[32:47], a[32:35], v[16:19], v[32:47]
  buffer_load_dword v11, v8, s[4:7], s96 offen sc1
  ds_read_b128 v[16:19], v7 offset:12288
  s_waitcnt lgkmcnt(3)
  v_mfma_f32_32x32x16_bf16 v[32:47], a[36:39], v[20:23], v[32:47]
  ds_read_b128 v[20:23], v7 offset:13312
  s_waitcnt lgkmcnt(3)
  v_mfma_f32_32x32x16_bf16 v[32:47], a[40:43], v[24:27], v[32:47]
  buffer_load_dword v244, v239, s[4:7], s93 offen sc1
  ds_read_b128 v[24:27], v7 offset:14336
  s_waitcnt lgkmcnt(3)
  v_mfma_f32_32x32x16_bf16 v[32:47], a[44:47], v[28:31], v[32:47]
  ds_read_b128 v[28:31], v7 offset:15360
  s_waitcnt lgkmcnt(3)
  v_mfma_f32_32x32x16_bf16 v[32:47], a[48:51], v[16:19], v[32:47]
  buffer_load_dword v247, v248, s[4:7], s73 offen sc1
  ds_read_b128 v[16:19], v7 offset:16384
  s_waitcnt lgkmcnt(3)
  v_mfma_f32_32x32x16_bf16 v[32:47], a[52:55], v[20:23], v[32:47]
  ds_read_b128 v[20:23], v7 offset:17408
  s_waitcnt lgkmcnt(3)
  v_mfma_f32_32x32x16_bf16 v[32:47], a[56:59], v[24:27], v[32:47]
  s_mov_b32 m0, s80
  s_nop 0
  buffer_load_dwordx4 v241, s[4:7], s79 offen sc1 lds
  ds_read_b128 v[24:27], v7 offset:18432
  s_waitcnt lgkmcnt(3)
  v_mfma_f32_32x32x16_bf16 v[32:47], a[60:63], v[28:31], v[32:47]
  ds_read_b128 v[28:31], v7 offset:19456
  s_waitcnt lgkmcnt(3)
  v_mfma_f32_32x32x16_bf16 v[32:47], a[64:67], v[16:19], v[32:47]
  buffer_load_dwordx4 v241, s[4:7], s79 offen offset:1024 sc1 lds
  ds_read_b128 v[16:19], v7 offset:20480
  s_waitcnt lgkmcnt(3)
  v_mfma_f32_32x32x16_bf16 v[32:47], a[68:71], v[20:23], v[32:47]
  ds_read_b128 v[20:23], v7 offset:21504
  s_waitcnt lgkmcnt(3)
  v_mfma_f32_32x32x16_bf16 v[32:47], a[72:75], v[24:27], v[32:47]
  buffer_load_dwordx2 v[184:185], v238, s[4:7], s79 offen sc1
  ds_read_b128 v[24:27], v7 offset:22528
  s_waitcnt lgkmcnt(3)
  v_mfma_f32_32x32x16_bf16 v[32:47], a[76:79], v[28:31], v[32:47]
  s_cmp_eq_u32 s88, 0
  s_cbranch_scc1 L_s2f_436
  s_waitcnt vmcnt(10)
  s_mov_b64 exec, 1
  buffer_store_dword v10, v9, s[4:7], s88 offen
  s_mov_b64 exec, -1
L_s2f_436:
  ds_read_b128 v[28:31], v7 offset:23552
  s_waitcnt lgkmcnt(3)
  v_mfma_f32_32x32x16_bf16 v[32:47], a[80:83], v[16:19], v[32:47]
  ds_read_b128 v[16:19], v7 offset:24576
  s_waitcnt lgkmcnt(3)
  v_mfma_f32_32x32x16_bf16 v[32:47], a[84:87], v[20:23], v[32:47]
  ds_read_b128 v[20:23], v7 offset:25600
  s_waitcnt lgkmcnt(3)
  v_mfma_f32_32x32x16_bf16 v[32:47], a[88:91], v[24:27], v[32:47]
  ds_read_b128 v[24:27], v7 offset:26624
  s_waitcnt lgkmcnt(3)
  v_mfma_f32_32x32x16_bf16 v[32:47], a[92:95], v[28:31], v[32:47]
  ds_read_b128 v[28:31], v7 offset:27648
  s_waitcnt lgkmcnt(3)
  v_mfma_f32_32x32x16_bf16 v[32:47], a[96:99], v[16:19], v[32:47]
  ds_read_b128 v[16:19], v7 offset:28672
  s_waitcnt lgkmcnt(3)
  v_mfma_f32_32x32x16_bf16 v[32:47], a[100:103], v[20:23], v[32:47]
  ds_read_b128 v[20:23], v7 offset:29696
  s_waitcnt lgkmcnt(3)
  v_mfma_f32_32x32x16_bf16 v[32:47], a[104:107], v[24:27], v[32:47]
  ds_read_b128 v[24:27], v7 offset:30720
  s_waitcnt lgkmcnt(3)
  v_mfma_f32_32x32x16_bf16 v[32:47], a[108:111], v[28:31], v[32:47]
  ds_read_b128 v[28:31], v7 offset:31744
  s_waitcnt lgkmcnt(3)
  v_mfma_f32_32x32x16_bf16 v[32:47], a[112:115], v[16:19], v[32:47]
  s_waitcnt lgkmcnt(2)
  v_mfma_f32_32x32x16_bf16 v[32:47], a[116:119], v[20:23], v[32:47]
  s_waitcnt lgkmcnt(1)
  v_mfma_f32_32x32x16_bf16 v[32:47], a[120:123], v[24:27], v[32:47]
  s_waitcnt lgkmcnt(0)
  v_mfma_f32_32x32x16_bf16 v[32:47], a[124:127], v[28:31], v[32:47]
  s_nop 9
  s_cmp_lg_u32 s88, 0
  s_mov_b32 s88, 0
  v_cvt_pk_bf16_f32 v64, v32, v33
  v_cvt_pk_bf16_f32 v65, v34, v35
  v_cvt_pk_bf16_f32 v66, v36, v37
  v_cvt_pk_bf16_f32 v67, v38, v39
  v_cvt_pk_bf16_f32 v68, v40, v41
  v_cvt_pk_bf16_f32 v69, v42, v43
  v_cvt_pk_bf16_f32 v70, v44, v45
  v_cvt_pk_bf16_f32 v71, v46, v47
  ds_write_b128 v236, v[64:67]
  ds_write_b128 v236, v[68:71] offset:1024
  s_cbranch_scc1 L_s2w_437
  s_waitcnt vmcnt(0)
L_s2w_437:
  s_waitcnt vmcnt(1)
  s_bitcmp1_b32 s89, 0
  s_cbranch_scc1 L_s2c_438
L_poll_439:
  buffer_load_dword v232, v239, s[4:7], s78 offen sc1
  s_waitcnt vmcnt(0)
  v_cmp_eq_u32 vcc, 0, v232
  s_cbranch_vccz L_pollok_440
  s_add_u32 s72, s72, 1
  s_cmp_gt_u32 s72, 0x80000
  s_cbranch_scc1 L_exit
  s_sleep 1
  s_branch L_poll_439
L_pollok_440:
  s_mov_b32 m0, s91
  s_add_u32 s62, s77, 0x1000000
  buffer_load_dwordx4 v12, s[4:7], s77 offen sc1 lds
  buffer_load_dwordx4 v12, s[4:7], s77 offen offset:1024 sc1 lds
  buffer_load_dwordx4 v[176:179], v12, s[4:7], s62 offen sc1
  buffer_load_dwordx4 v[180:183], v12, s[4:7], s62 offen offset:1024 sc1
  s_waitcnt vmcnt(0)
L_s2c_438:
  v_cmp_eq_u32 vcc, 0, v11
  s_cmp_lt_u32 s74, s57
  s_cselect_b64 s[70:71], vcc, -1
  s_cmp_eq_u64 s[70:71], 0
  s_cselect_b32 s22, 0x10000000, 0
  s_cselect_b32 s59, 1, 0
  s_waitcnt lgkmcnt(0)
  s_barrier
  ds_read_b128 v[80:83], v242 offset:0
  ds_read_b128 v[112:115], v246 offset:0
  ds_read_b128 v[84:87], v242 offset:1024
  ds_read_b128 v[116:119], v246 offset:1024
  ds_read_b128 v[88:91], v242 offset:2048
  ds_read_b128 v[120:123], v246 offset:2048
  ds_read_b128 v[92:95], v242 offset:3072
  ds_read_b128 v[124:127], v246 offset:3072
  ds_read_b128 v[96:99], v242 offset:4096
  ds_read_b128 v[128:131], v246 offset:4096
  s_waitcnt lgkmcnt(8)
  v_mfma_f32_32x32x16_bf16 v[48:63], v[112:115], v[80:83], v[188:203]
  ds_read_b128 v[100:103], v242 offset:5120
  ds_read_b128 v[132:135], v246 offset:5120
  s_waitcnt lgkmcnt(8)
  v_mfma_f32_32x32x16_bf16 v[48:63], v[116:119], v[84:87], v[48:63]
  s_mov_b32 m0, s95
  s_nop 0
  buffer_load_dwordx4 v6, s[20:23], s94 offen offset:0 sc1 lds
  ds_read_b128 v[104:107], v242 offset:6144
  ds_read_b128 v[136:139], v246 offset:6144
  s_waitcnt lgkmcnt(8)
  v_mfma_f32_32x32x16_bf16 v[48:63], v[120:123], v[88:91], v[48:63]
  ds_read_b128 v[108:111], v242 offset:7168
  ds_read_b128 v[140:143], v246 offset:7168
  s_waitcnt lgkmcnt(8)
  v_mfma_f32_32x32x16_bf16 v[48:63], v[124:127], v[92:95], v[48:63]
  buffer_load_dwordx4 v6, s[20:23], s94 offen offset:1024 sc1 lds
  s_waitcnt lgkmcnt(6)
  v_mfma_f32_32x32x16_bf16 v[48:63], v[128:131], v[96:99], v[48:63]
  s_waitcnt lgkmcnt(4)
  v_mfma_f32_32x32x16_bf16 v[48:63], v[132:135], v[100:103], v[48:63]
  buffer_load_dwordx4 v6, s[20:23], s94 offen offset:2048 sc1 lds
  s_waitcnt lgkmcnt(2)
  v_mfma_f32_32x32x16_bf16 v[48:63], v[136:139], v[104:107], v[48:63]
  s_waitcnt lgkmcnt(0)
  v_mfma_f32_32x32x16_bf16 v[48:63], v[140:143], v[108:111], v[48:63]
  buffer_load_dwordx4 v6, s[20:23], s94 offen offset:3072 sc1 lds
  s_add_u32 s94, s94, 0x4000
  s_add_u32 s95, s95, 0x4000
  s_mov_b32 m0, s95
  s_nop 0
  buffer_load_dwordx4 v6, s[20:23], s94 offen offset:0 sc1 lds
  s_nop 5
  v_max3_f32 v232, v48, v49, v50
  v_max3_f32 v233, v51, v52, v53
  v_max3_f32 v232, v232, v54, v55
  v_max3_f32 v233, v233, v56, v57
  v_max3_f32 v232, v232, v58, v59
  v_max3_f32 v233, v233, v60, v61
  v_max3_f32 v232, v232, v62, v63
  v_max_f32 v232, v232, v233
  v_mov_b32 v233, v232
  buffer_load_dwordx4 v6, s[20:23], s94 offen offset:1024 sc1 lds
  s_nop 0
  v_permlane32_swap_b32 v232, v233
  s_nop 0
  v_max_f32 v232, v232, v233
  v_mul_f32 v232, s81, v232
  v_fma_f32 v48, v48, s81, -v232
  v_fma_f32 v49, v49, s81, -v232
  v_exp_f32 v48, v48
  v_fma_f32 v50, v50, s81, -v232
  v_exp_f32 v49, v49
  v_fma_f32 v51, v51, s81, -v232
  v_exp_f32 v50, v50
  v_fma_f32 v52, v52, s81, -v232
  v_exp_f32 v51, v51
  v_fma_f32 v53, v53, s81, -v232
  v_exp_f32 v52, v52
  v_fma_f32 v54, v54, s81, -v232
  v_exp_f32 v53, v53
  buffer_load_dwordx4 v6, s[20:23], s94 offen offset:2048 sc1 lds
  v_fma_f32 v55, v55, s81, -v232
  v_exp_f32 v54, v54
  v_fma_f32 v56, v56, s81, -v232
  v_exp_f32 v55, v55
  v_fma_f32 v57, v57, s81, -v232
  v_exp_f32 v56, v56
  v_fma_f32 v58, v58, s81, -v232
  v_exp_f32 v57, v57
  v_fma_f32 v59, v59, s81, -v232
  v_exp_f32 v58, v58
  v_fma_f32 v60, v60, s81, -v232
  v_exp_f32 v59, v59
  buffer_load_dwordx4 v6, s[20:23], s94 offen offset:3072 sc1 lds
  v_fma_f32 v61, v61, s81, -v232
  v_exp_f32 v60, v60
  v_fma_f32 v62, v62, s81, -v232
  v_exp_f32 v61, v61
  v_fma_f32 v63, v63, s81, -v232
  v_exp_f32 v62, v62
  v_exp_f32_e64 v63, v63
  v_cvt_pk_bf16_f32 v220, v48, v49
  v_cvt_pk_bf16_f32 v221, v50, v51
  v_cvt_pk_bf16_f32 v222, v52, v53
  v_cvt_pk_bf16_f32 v223, v54, v55
  v_cvt_pk_bf16_f32 v224, v56, v57
  v_cvt_pk_bf16_f32 v225, v58, v59
  v_cvt_pk_bf16_f32 v226, v60, v61
  v_cvt_pk_bf16_f32 v227, v62, v63
  v_add_f32 v234, v48, v49
  v_add_f32 v235, v50, v51
  v_mfma_f32_32x32x16_bf16 v[32:47], v[176:179], v[220:223], 0
  v_add_f32 v234, v234, v52
  v_add_f32 v235, v235, v53
  v_add_f32 v234, v234, v54
  v_add_f32 v235, v235, v55
  v_add_f32 v234, v234, v56
  v_add_f32 v235, v235, v57
  v_mfma_f32_32x32x16_bf16 v[32:47], v[180:183], v[224:227], v[32:47]
  v_add_f32 v234, v234, v58
  v_add_f32 v235, v235, v59
  v_add_f32 v234, v234, v60
  v_add_f32 v235, v235, v61
  v_add_f32 v234, v234, v62
  v_add_f32 v235, v235, v63
  v_add_f32 v234, v234, v235
  v_max_u32 v235, v184, v185
  v_cmp_eq_u32 vcc, -1, v235
  s_cbranch_vccz L_s2d_441
L_s2p_442:
  s_mov_b32 m0, s80
  s_nop 0
  buffer_load_dwordx4 v241, s[4:7], s79 offen sc1 lds
  buffer_load_dwordx4 v241, s[4:7], s79 offen offset:1024 sc1 lds
  buffer_load_dwordx2 v[184:185], v238, s[4:7], s79 offen sc1
  buffer_load_dword v11, v8, s[4:7], s96 offen sc1
  buffer_load_dword v244, v239, s[4:7], s93 offen sc1
  s_waitcnt vmcnt(0)
  v_max_u32 v235, v184, v185
  v_cmp_eq_u32 vcc, -1, v235
  s_cbranch_vccz L_s2d_441
  s_cmp_ge_u32 s74, s57
  s_cbranch_scc1 L_nopf_445
  s_cmp_eq_u32 s59, 1
  s_cbranch_scc1 L_nopf_445
  v_cmp_eq_u32 vcc, 0, v11
  s_cbranch_vccnz L_nopf_445
  s_xor_b32 s64, s60, 0x8000
  s_lshl_b32 s61, s74, 15
  s_add_u32 s61, s61, 0x5a00000
  s_add_u32 s61, s61, s52
  s_lshl_b32 s62, s58, 12
  s_add_u32 m0, s62, s64
  s_nop 0
  buffer_load_dwordx4 v6, s[4:7], s61 offen offset:0 sc1 lds
  buffer_load_dwordx4 v6, s[4:7], s61 offen offset:1024 sc1 lds
  buffer_load_dwordx4 v6, s[4:7], s61 offen offset:2048 sc1 lds
  buffer_load_dwordx4 v6, s[4:7], s61 offen offset:3072 sc1 lds
  s_add_u32 m0, m0, 0x4000
  s_add_u32 s61, s61, 0x4000
  buffer_load_dwordx4 v6, s[4:7], s61 offen offset:0 sc1 lds
  buffer_load_dwordx4 v6, s[4:7], s61 offen offset:1024 sc1 lds
  buffer_load_dwordx4 v6, s[4:7], s61 offen offset:2048 sc1 lds
  buffer_load_dwordx4 v6, s[4:7], s61 offen offset:3072 sc1 lds
  s_mov_b32 s59, 1
L_nopf_445:
  s_add_u32 s72, s72, 1
  s_cmp_gt_u32 s72, 0x80000
  s_cbranch_scc1 L_exit
  s_branch L_s2p_442
L_s2d_441:
  ds_read_b64_tr_b16 v[144:145], v237 offset:0
  ds_read_b64_tr_b16 v[146:147], v237 offset:128
  ds_read_b64_tr_b16 v[148:149], v237 offset:256
  ds_read_b64_tr_b16 v[150:151], v237 offset:384
  ds_read_b64_tr_b16 v[152:153], v237 offset:512
  ds_read_b64_tr_b16 v[154:155], v237 offset:640
  ds_read_b64_tr_b16 v[156:157], v237 offset:768
  ds_read_b64_tr_b16 v[158:159], v237 offset:896
  ds_read_b64_tr_b16 v[160:161], v237 offset:1024
  ds_read_b64_tr_b16 v[162:163], v237 offset:1152
  ds_read_b64_tr_b16 v[164:165], v237 offset:1280
  ds_read_b64_tr_b16 v[166:167], v237 offset:1408
  ds_read_b64_tr_b16 v[168:169], v237 offset:1536
  ds_read_b64_tr_b16 v[170:171], v237 offset:1664
  s_waitcnt lgkmcnt(8)
  ds_read_b64_tr_b16 v[172:173], v237 offset:1792
  ds_read_b64_tr_b16 v[174:175], v237 offset:1920
  s_waitcnt lgkmcnt(8)
  v_mfma_f32_32x32x16_bf16 v[204:219], v[144:147], v[80:83], 0
  s_waitcnt lgkmcnt(8)
  v_mfma_f32_32x32x16_bf16 v[204:219], v[148:151], v[84:87], v[204:219]
  s_waitcnt lgkmcnt(8)
  v_mfma_f32_32x32x16_bf16 v[204:219], v[152:155], v[88:91], v[204:219]
  s_waitcnt lgkmcnt(8)
  v_mfma_f32_32x32x16_bf16 v[204:219], v[156:159], v[92:95], v[204:219]
  s_waitcnt lgkmcnt(6)
  v_mfma_f32_32x32x16_bf16 v[204:219], v[160:163], v[96:99], v[204:219]
  s_waitcnt lgkmcnt(4)
  v_mfma_f32_32x32x16_bf16 v[204:219], v[164:167], v[100:103], v[204:219]
  s_waitcnt lgkmcnt(2)
  v_mfma_f32_32x32x16_bf16 v[204:219], v[168:171], v[104:107], v[204:219]
  s_waitcnt lgkmcnt(0)
  v_mfma_f32_32x32x16_bf16 v[204:219], v[172:175], v[108:111], v[204:219]
L_s2e_444:
  v_cmp_eq_u32 vcc, 0, v244
  s_cmp_eq_u64 vcc, 0
  s_cselect_b32 s89, 1, 0
  s_and_b32 s62, s77, 0x1fffff
  s_add_u32 s62, s62, s52
  s_add_u32 s62, s62, 0x2000000
  s_add_u32 s88, s78, 0x10000
  s_nop 6
  v_max3_f32 v233, v204, v205, v206
  v_cmp_u_f32 vcc, v204, v205
  v_cmp_u_f32 s[70:71], v206, v207
  v_max_f32 v233, v233, v207
  v_mul_f32 v233, s81, v233
  s_or_b64 vcc, vcc, s[70:71]
  s_cbranch_vccnz L_s2bad_443
L_s2good_446:
  v_mov_b32 v235, v233
  s_nop 1
  v_permlane32_swap_b32 v233, v235
  s_nop 0
  v_max3_f32 v233, v233, v235, v232
  v_sub_f32_e64 v235, v232, v233
  v_fma_f32 v204, v204, s81, -v233
  v_fma_f32 v205, v205, s81, -v233
  v_fma_f32 v206, v206, s81, -v233
  v_fma_f32 v207, v207, s81, -v233
  v_exp_f32 v235, v235
  v_exp_f32 v204, v204
  v_exp_f32 v205, v205
  v_exp_f32 v206, v206
  v_exp_f32 v207, v207
  s_nop 0
  v_fma_f32 v232, v234, v235, v204
  v_add_f32 v233, v205, v206
  v_add_f32 v232, v232, v207
  v_add_f32 v232, v232, v233
  v_mov_b32 v233, v232
  s_nop 1
  v_permlane32_swap_b32 v232, v233
  s_nop 0
  v_add_f32 v232, v232, v233
  v_rcp_f32 v232, v232
  s_nop 0
  v_mul_f32 v235, v235, v232
  v_mul_f32 v204, v204, v232
  v_mul_f32 v205, v205, v232
  v_mul_f32 v206, v206, v232
  v_mul_f32 v207, v207, v232
  v_cvt_pk_bf16_f32 v228, v204, v205
  v_cvt_pk_bf16_f32 v229, v206, v207
  v_mul_f32 v32, v32, v235
  v_mul_f32 v33, v33, v235
  v_mul_f32 v34, v34, v235
  v_mul_f32 v35, v35, v235
  v_mul_f32 v36, v36, v235
  v_mul_f32 v37, v37, v235
  v_mul_f32 v38, v38, v235
  v_mul_f32 v39, v39, v235
  v_mul_f32 v40, v40, v235
  v_mul_f32 v41, v41, v235
  v_mul_f32 v42, v42, v235
  v_mul_f32 v43, v43, v235
  v_mul_f32 v44, v44, v235
  v_mul_f32 v45, v45, v235
  v_mul_f32 v46, v46, v235
  v_mul_f32 v47, v47, v235
  s_nop 1
  v_mfma_f32_32x32x16_bf16 v[32:47], v[184:187], v[228:231], v[32:47]
  s_nop 11
  v_cvt_pk_bf16_f32 v64, v32, v33
  v_cvt_pk_bf16_f32 v65, v34, v35
  v_cvt_pk_bf16_f32 v66, v36, v37
  v_cvt_pk_bf16_f32 v67, v38, v39
  v_cvt_pk_bf16_f32 v68, v40, v41
  v_cvt_pk_bf16_f32 v69, v42, v43
  v_cvt_pk_bf16_f32 v70, v44, v45
  v_cvt_pk_bf16_f32 v71, v46, v47
  v_cmp_eq_u32 vcc, 0, v247
  s_cbranch_vccz L_s2cr_447
L_poll_448:
  buffer_load_dword v247, v248, s[4:7], s73 offen sc1
  s_waitcnt vmcnt(0)
  v_cmp_eq_u32 vcc, 0, v247
  s_cbranch_vccz L_pollok_449
  s_add_u32 s72, s72, 1
  s_cmp_gt_u32 s72, 0x80000
  s_cbranch_scc1 L_exit
  s_sleep 1
  s_branch L_poll_448
L_pollok_449:
L_s2cr_447:
  buffer_store_dwordx4 v[64:67], v12, s[4:7], s62 offen
  buffer_store_dwordx4 v[68:71], v12, s[4:7], s62 offen offset:1024
  s_xor_b32 s60, s60, 0x8000
  v_xor_b32 v7, 0x8000, v7
  s_mov_b32 s55, s74
  s_cmp_lt_u32 s55, s57
  s_cbranch_scc1 L_s2_430
  s_waitcnt vmcnt(0)
  s_cmp_eq_u32 s88, 0
  s_cbranch_scc1 L_nofl_450
  s_mov_b64 exec, 1
  buffer_store_dword v10, v9, s[4:7], s88 offen
  s_mov_b64 exec, -1
  s_mov_b32 s88, 0
L_nofl_450:
  s_endpgm
L_s2bad_443:
  v_pk_max_u16 v235, v144, v145
  v_pk_max_u16 v235, v235, v146
  v_pk_max_u16 v235, v235, v147
  v_pk_max_u16 v235, v235, v148
  v_pk_max_u16 v235, v235, v149
  v_pk_max_u16 v235, v235, v150
  v_pk_max_u16 v235, v235, v151
  v_pk_max_u16 v235, v235, v152
  v_pk_max_u16 v235, v235, v153
  v_pk_max_u16 v235, v235, v154
  v_pk_max_u16 v235, v235, v155
  v_pk_max_u16 v235, v235, v156
  v_pk_max_u16 v235, v235, v157
  v_pk_max_u16 v235, v235, v158
  v_pk_max_u16 v235, v235, v159
  v_pk_max_u16 v235, v235, v160
  v_pk_max_u16 v235, v235, v161
  v_pk_max_u16 v235, v235, v162
  v_pk_max_u16 v235, v235, v163
  v_pk_max_u16 v235, v235, v164
  v_pk_max_u16 v235, v235, v165
  v_pk_max_u16 v235, v235, v166
  v_pk_max_u16 v235, v235, v167
  v_pk_max_u16 v235, v235, v168
  v_pk_max_u16 v235, v235, v169
  v_pk_max_u16 v235, v235, v170
  v_pk_max_u16 v235, v235, v171
  v_pk_max_u16 v235, v235, v172
  v_pk_max_u16 v235, v235, v173
  v_pk_max_u16 v235, v235, v174
  v_pk_max_u16 v235, v235, v175
  v_lshrrev_b32 v2, 16, v235
  v_and_b32 v235, 0xffff, v235
  v_max_u32 v235, v235, v2
  v_cmp_eq_u32 vcc, 0xffff, v235
  s_cbranch_vccz L_s2good_446
  s_mov_b32 s88, 0
  s_add_u32 s72, s72, 1
  s_cmp_gt_u32 s72, 0x80000
  s_cbranch_scc1 L_exit
  s_branch L_s2p_442
  s_endpgm
B_s2:
  v_mov_b32 v6, 0x0
  v_bfe_i32 v2, v0, 0, 1
  v_and_b32 v2, 0x10, v2
  v_add_u32 v6, v6, v2
  v_bfe_i32 v2, v0, 1, 1
  v_and_b32 v2, 0x20, v2
  v_add_u32 v6, v6, v2
  v_bfe_i32 v2, v0, 2, 1
  v_and_b32 v2, 0x40, v2
  v_add_u32 v6, v6, v2
  v_bfe_i32 v2, v0, 3, 1
  v_and_b32 v2, 0x80, v2
  v_add_u32 v6, v6, v2
  v_bfe_i32 v2, v0, 4, 1
  v_and_b32 v2, 0x100, v2
  v_add_u32 v6, v6, v2
  v_bfe_i32 v2, v0, 5, 1
  v_and_b32 v2, 0x200, v2
  v_add_u32 v6, v6, v2
  v_bfe_i32 v2, v0, 6, 1
  v_and_b32 v2, 0x1000, v2
  v_add_u32 v6, v6, v2
  v_bfe_i32 v2, v0, 7, 1
  v_and_b32 v2, 0x2000, v2
  v_add_u32 v6, v6, v2
  v_mov_b32 v7, 0x0
  v_bfe_i32 v2, v0, 0, 1
  v_and_b32 v2, 0x10, v2
  v_add_u32 v7, v7, v2
  v_bfe_i32 v2, v0, 1, 1
  v_and_b32 v2, 0x20, v2
  v_add_u32 v7, v7, v2
  v_bfe_i32 v2, v0, 2, 1
  v_and_b32 v2, 0x40, v2
  v_add_u32 v7, v7, v2
  v_bfe_i32 v2, v0, 3, 1
  v_and_b32 v2, 0x80, v2
  v_add_u32 v7, v7, v2
  v_bfe_i32 v2, v0, 4, 1
  v_and_b32 v2, 0x100, v2
  v_add_u32 v7, v7, v2
  v_bfe_i32 v2, v0, 5, 1
  v_and_b32 v2, 0x200, v2
  v_add_u32 v7, v7, v2
  v_mov_b32 v8, 0x0
  v_bfe_i32 v2, v0, 0, 1
  v_and_b32 v2, 0x4, v2
  v_add_u32 v8, v8, v2
  v_bfe_i32 v2, v0, 1, 1
  v_and_b32 v2, 0x8, v2
  v_add_u32 v8, v8, v2
  v_bfe_i32 v2, v0, 2, 1
  v_and_b32 v2, 0x10, v2
  v_add_u32 v8, v8, v2
  v_bfe_i32 v2, v0, 3, 1
  v_and_b32 v2, 0x20, v2
  v_add_u32 v8, v8, v2
  v_mov_b32 v9, 0x0
  v_bfe_i32 v2, v0, 6, 1
  v_and_b32 v2, 0x4, v2
  v_add_u32 v9, v9, v2
  v_bfe_i32 v2, v0, 7, 1
  v_and_b32 v2, 0x8, v2
  v_add_u32 v9, v9, v2
  v_mov_b32 v10, 1
  v_mov_b32 v12, 0x0
  v_bfe_i32 v2, v0, 0, 1
  v_and_b32 v2, 0x10, v2
  v_add_u32 v12, v12, v2
  v_bfe_i32 v2, v0, 1, 1
  v_and_b32 v2, 0x20, v2
  v_add_u32 v12, v12, v2
  v_bfe_i32 v2, v0, 2, 1
  v_and_b32 v2, 0x40, v2
  v_add_u32 v12, v12, v2
  v_bfe_i32 v2, v0, 3, 1
  v_and_b32 v2, 0x80, v2
  v_add_u32 v12, v12, v2
  v_bfe_i32 v2, v0, 4, 1
  v_and_b32 v2, 0x100, v2
  v_add_u32 v12, v12, v2
  v_bfe_i32 v2, v0, 5, 1
  v_and_b32 v2, 0x200, v2
  v_add_u32 v12, v12, v2
  v_bfe_i32 v2, v0, 6, 1
  v_and_b32 v2, 0x800, v2
  v_add_u32 v12, v12, v2
  v_bfe_i32 v2, v0, 7, 1
  v_and_b32 v2, 0x1000, v2
  v_add_u32 v12, v12, v2
  v_mov_b32 v236, 0x10000
  v_bfe_i32 v2, v0, 0, 1
  v_and_b32 v2, 0x10, v2
  v_add_u32 v236, v236, v2
  v_bfe_i32 v2, v0, 1, 1
  v_and_b32 v2, 0x20, v2
  v_add_u32 v236, v236, v2
  v_bfe_i32 v2, v0, 2, 1
  v_and_b32 v2, 0x40, v2
  v_add_u32 v236, v236, v2
  v_bfe_i32 v2, v0, 3, 1
  v_and_b32 v2, 0x80, v2
  v_add_u32 v236, v236, v2
  v_bfe_i32 v2, v0, 4, 1
  v_and_b32 v2, 0x100, v2
  v_add_u32 v236, v236, v2
  v_bfe_i32 v2, v0, 5, 1
  v_and_b32 v2, 0x200, v2
  v_add_u32 v236, v236, v2
  v_bfe_i32 v2, v0, 6, 1
  v_and_b32 v2, 0x800, v2
  v_add_u32 v236, v236, v2
  v_bfe_i32 v2, v0, 7, 1
  v_and_b32 v2, 0x1000, v2
  v_add_u32 v236, v236, v2
  v_mov_b32 v237, 0x12000
  v_bfe_i32 v2, v0, 0, 1
  v_and_b32 v2, 0x8, v2
  v_add_u32 v237, v237, v2
  v_bfe_i32 v2, v0, 2, 1
  v_and_b32 v2, 0x10, v2
  v_add_u32 v237, v237, v2
  v_bfe_i32 v2, v0, 3, 1
  v_and_b32 v2, 0x20, v2
  v_add_u32 v237, v237, v2
  v_bfe_i32 v2, v0, 5, 1
  v_and_b32 v2, 0x40, v2
  v_add_u32 v237, v237, v2
  v_bfe_i32 v2, v0, 6, 1
  v_and_b32 v2, 0x800, v2
  v_add_u32 v237, v237, v2
  v_bfe_i32 v2, v0, 7, 1
  v_and_b32 v2, 0x1000, v2
  v_add_u32_e64 v237, v237, v2
  s_lshl_b32 s80, s58, 11
  s_add_u32 s80, s80, 73728
  v_mov_b32 v238, 0x800
  v_bfe_i32 v2, v0, 0, 1
  v_and_b32 v2, 0x10, v2
  v_add_u32 v238, v238, v2
  v_bfe_i32 v2, v0, 1, 1
  v_and_b32 v2, 0x20, v2
  v_add_u32 v238, v238, v2
  v_bfe_i32 v2, v0, 2, 1
  v_and_b32 v2, 0x40, v2
  v_add_u32 v238, v238, v2
  v_bfe_i32 v2, v0, 3, 1
  v_and_b32 v2, 0x80, v2
  v_add_u32 v238, v238, v2
  v_bfe_i32 v2, v0, 4, 1
  v_and_b32 v2, 0x100, v2
  v_add_u32 v238, v238, v2
  v_bfe_i32 v2, v0, 5, 1
  v_and_b32 v2, 0x8, v2
  v_add_u32 v238, v238, v2
  v_bfe_i32 v2, v0, 6, 1
  v_and_b32 v2, 0x200, v2
  v_add_u32 v238, v238, v2
  v_bfe_i32 v2, v0, 7, 1
  v_and_b32 v2, 0x400, v2
  v_add_u32 v238, v238, v2
  v_mov_b32 v239, 0x0
  v_bfe_i32 v2, v0, 0, 1
  v_and_b32 v2, 0x4, v2
  v_add_u32 v239, v239, v2
  v_bfe_i32 v2, v0, 1, 1
  v_and_b32 v2, 0x8, v2
  v_add_u32 v239, v239, v2
  v_mov_b32 v11, 0x40
  v_bfe_i32 v2, v0, 0, 1
  v_and_b32 v2, 0x1, v2
  v_add_u32 v11, v11, v2
  v_bfe_i32 v2, v0, 1, 1
  v_and_b32 v2, 0x2, v2
  v_add_u32 v11, v11, v2
  v_bfe_i32 v2, v0, 2, 1
  v_and_b32 v2, 0x4, v2
  v_add_u32 v11, v11, v2
  v_bfe_i32 v2, v0, 3, 1
  v_and_b32 v2, 0x8, v2
  v_add_u32 v11, v11, v2
  v_bfe_i32 v2, v0, 4, 1
  v_and_b32 v2, 0x10, v2
  v_add_u32 v11, v11, v2
  v_bfe_i32 v2, v0, 5, 1
  v_and_b32 v2, 0xfffffffc, v2
  v_add_u32 v11, v11, v2
  v_mov_b32 v240, 0xf149f2ca
  v_mov_b32 v2, 64
  v_cmp_gt_u32 vcc, v2, v11
  s_nop 1
  v_cndmask_b32 v188, 0, v240, vcc
  v_mov_b32 v2, 65
  v_cmp_gt_u32 vcc, v2, v11
  s_nop 1
  v_cndmask_b32 v189, 0, v240, vcc
  v_mov_b32 v2, 66
  v_cmp_gt_u32 vcc, v2, v11
  s_nop 1
  v_cndmask_b32 v190, 0, v240, vcc
  v_mov_b32 v2, 67
  v_cmp_gt_u32 vcc, v2, v11
  s_nop 1
  v_cndmask_b32 v191, 0, v240, vcc
  v_mov_b32 v2, 72
  v_cmp_gt_u32 vcc, v2, v11
  s_nop 1
  v_cndmask_b32 v192, 0, v240, vcc
  v_mov_b32 v2, 73
  v_cmp_gt_u32 vcc, v2, v11
  s_nop 1
  v_cndmask_b32 v193, 0, v240, vcc
  v_mov_b32 v2, 74
  v_cmp_gt_u32 vcc, v2, v11
  s_nop 1
  v_cndmask_b32 v194, 0, v240, vcc
  v_mov_b32 v2, 75
  v_cmp_gt_u32 vcc, v2, v11
  s_nop 1
  v_cndmask_b32 v195, 0, v240, vcc
  v_mov_b32 v2, 80
  v_cmp_gt_u32 vcc, v2, v11
  s_nop 1
  v_cndmask_b32 v196, 0, v240, vcc
  v_mov_b32 v2, 81
  v_cmp_gt_u32 vcc, v2, v11
  s_nop 1
  v_cndmask_b32 v197, 0, v240, vcc
  v_mov_b32 v2, 82
  v_cmp_gt_u32 vcc, v2, v11
  s_nop 1
  v_cndmask_b32 v198, 0, v240, vcc
  v_mov_b32 v2, 83
  v_cmp_gt_u32 vcc, v2, v11
  s_nop 1
  v_cndmask_b32 v199, 0, v240, vcc
  v_mov_b32 v2, 88
  v_cmp_gt_u32 vcc, v2, v11
  s_nop 1
  v_cndmask_b32 v200, 0, v240, vcc
  v_mov_b32 v2, 89
  v_cmp_gt_u32 vcc, v2, v11
  s_nop 1
  v_cndmask_b32 v201, 0, v240, vcc
  v_mov_b32 v2, 90
  v_cmp_gt_u32 vcc, v2, v11
  s_nop 1
  v_cndmask_b32 v202, 0, v240, vcc
  v_mov_b32 v2, 91
  v_cmp_gt_u32 vcc, v2, v11
  s_nop 1
  v_cndmask_b32 v203, 0, v240, vcc
  v_mov_b32 v186, 0
  v_mov_b32 v187, 0
  v_mov_b32 v230, 0
  v_mov_b32 v231, 0
  s_mov_b32 s81, 0x3e0293ee
  s_mov_b32 s8, s28
  s_and_b32 s9, s29, 0xffff
  s_mov_b32 s10, 0x400000
  s_mov_b32 s11, 0x20000
  v_mov_b32 v3, 0x0
  v_bfe_i32 v2, v0, 0, 1
  v_and_b32 v2, 0x10, v2
  v_xor_b32 v3, v3, v2
  v_bfe_i32 v2, v0, 1, 1
  v_and_b32 v2, 0x20, v2
  v_xor_b32 v3, v3, v2
  v_bfe_i32 v2, v0, 2, 1
  v_and_b32 v2, 0x40, v2
  v_xor_b32 v3, v3, v2
  v_bfe_i32 v2, v0, 3, 1
  v_and_b32 v2, 0x80, v2
  v_xor_b32 v3, v3, v2
  v_bfe_i32 v2, v0, 4, 1
  v_and_b32 v2, 0x40, v2
  v_xor_b32 v3, v3, v2
  v_bfe_i32 v2, v0, 5, 1
  v_and_b32 v2, 0x80, v2
  v_xor_b32 v3, v3, v2
  v_mov_b32 v5, 0x0
  v_bfe_i32 v2, v0, 4, 1
  v_and_b32 v2, 0x2000, v2
  v_add_u32 v5, v5, v2
  v_bfe_i32 v2, v0, 5, 1
  v_and_b32 v2, 0x4000, v2
  v_add_u32 v5, v5, v2
  v_add_u32 v3, v3, v5
  v_mov_b32 v4, 0x0
  v_bfe_i32 v2, v0, 0, 1
  v_and_b32 v2, 0x8, v2
  v_xor_b32 v4, v4, v2
  v_bfe_i32 v2, v0, 1, 1
  v_and_b32 v2, 0x10, v2
  v_xor_b32 v4, v4, v2
  v_bfe_i32 v2, v0, 2, 1
  v_and_b32 v2, 0x140, v2
  v_xor_b32 v4, v4, v2
  v_bfe_i32 v2, v0, 3, 1
  v_and_b32 v2, 0x280, v2
  v_xor_b32 v4, v4, v2
  v_bfe_i32 v2, v0, 4, 1
  v_and_b32 v2, 0x20, v2
  v_xor_b32 v4, v4, v2
  v_bfe_i32 v2, v0, 5, 1
  v_and_b32 v2, 0x800, v2
  v_xor_b32 v4, v4, v2
  v_bfe_i32 v2, v0, 6, 1
  v_and_b32 v2, 0x40, v2
  v_xor_b32 v4, v4, v2
  v_bfe_i32 v2, v0, 7, 1
  v_and_b32 v2, 0x80, v2
  v_xor_b32 v4, v4, v2
  v_add_u32 v5, 0x10000, v4
  s_lshl_b32 s76, s54, 8
  s_barrier
  s_mul_i32 s61, s58, 1048576
  s_add_u32 s61, s61, s76
  s_add_u32 s61, s61, 0
  s_mul_i32 s62, s58, 32768
  s_mov_b32 s63, 0
L_wdma_451:
  s_mov_b32 m0, s62
  s_add_u32 s62, s62, 1024
  buffer_load_dwordx4 v3, s[8:11], s61 offen lds
  s_add_u32 s61, s61, 32768
  s_add_u32 s63, s63, 1
  s_cmp_lt_u32 s63, 32
  s_cbranch_scc1 L_wdma_451
  s_waitcnt vmcnt(0)
  s_barrier
  ds_read_b64_tr_b16 a[0:1], v4 offset:0
  ds_read_b64_tr_b16 a[2:3], v4 offset:1024
  ds_read_b64_tr_b16 a[4:5], v4 offset:4096
  ds_read_b64_tr_b16 a[6:7], v4 offset:5120
  ds_read_b64_tr_b16 a[8:9], v4 offset:8192
  ds_read_b64_tr_b16 a[10:11], v4 offset:9216
  ds_read_b64_tr_b16 a[12:13], v4 offset:12288
  ds_read_b64_tr_b16 a[14:15], v4 offset:13312
  s_waitcnt lgkmcnt(0)
  ds_read_b64_tr_b16 a[16:17], v4 offset:16384
  ds_read_b64_tr_b16 a[18:19], v4 offset:17408
  ds_read_b64_tr_b16 a[20:21], v4 offset:20480
  ds_read_b64_tr_b16 a[22:23], v4 offset:21504
  ds_read_b64_tr_b16 a[24:25], v4 offset:24576
  ds_read_b64_tr_b16 a[26:27], v4 offset:25600
  ds_read_b64_tr_b16 a[28:29], v4 offset:28672
  ds_read_b64_tr_b16 a[30:31], v4 offset:29696
  s_waitcnt lgkmcnt(0)
  ds_read_b64_tr_b16 a[32:33], v4 offset:32768
  ds_read_b64_tr_b16 a[34:35], v4 offset:33792
  ds_read_b64_tr_b16 a[36:37], v4 offset:36864
  ds_read_b64_tr_b16 a[38:39], v4 offset:37888
  ds_read_b64_tr_b16 a[40:41], v4 offset:40960
  ds_read_b64_tr_b16 a[42:43], v4 offset:41984
  ds_read_b64_tr_b16 a[44:45], v4 offset:45056
  ds_read_b64_tr_b16 a[46:47], v4 offset:46080
  s_waitcnt lgkmcnt(0)
  ds_read_b64_tr_b16 a[48:49], v4 offset:49152
  ds_read_b64_tr_b16 a[50:51], v4 offset:50176
  ds_read_b64_tr_b16 a[52:53], v4 offset:53248
  ds_read_b64_tr_b16 a[54:55], v4 offset:54272
  ds_read_b64_tr_b16 a[56:57], v4 offset:57344
  ds_read_b64_tr_b16 a[58:59], v4 offset:58368
  ds_read_b64_tr_b16 a[60:61], v4 offset:61440
  ds_read_b64_tr_b16 a[62:63], v4 offset:62464
  s_waitcnt lgkmcnt(0)
  ds_read_b64_tr_b16 a[64:65], v5 offset:0
  ds_read_b64_tr_b16 a[66:67], v5 offset:1024
  ds_read_b64_tr_b16 a[68:69], v5 offset:4096
  ds_read_b64_tr_b16 a[70:71], v5 offset:5120
  ds_read_b64_tr_b16 a[72:73], v5 offset:8192
  ds_read_b64_tr_b16 a[74:75], v5 offset:9216
  ds_read_b64_tr_b16 a[76:77], v5 offset:12288
  ds_read_b64_tr_b16 a[78:79], v5 offset:13312
  s_waitcnt lgkmcnt(0)
  ds_read_b64_tr_b16 a[80:81], v5 offset:16384
  ds_read_b64_tr_b16 a[82:83], v5 offset:17408
  ds_read_b64_tr_b16 a[84:85], v5 offset:20480
  ds_read_b64_tr_b16 a[86:87], v5 offset:21504
  ds_read_b64_tr_b16 a[88:89], v5 offset:24576
  ds_read_b64_tr_b16 a[90:91], v5 offset:25600
  ds_read_b64_tr_b16 a[92:93], v5 offset:28672
  ds_read_b64_tr_b16 a[94:95], v5 offset:29696
  s_waitcnt lgkmcnt(0)
  ds_read_b64_tr_b16 a[96:97], v5 offset:32768
  ds_read_b64_tr_b16 a[98:99], v5 offset:33792
  ds_read_b64_tr_b16 a[100:101], v5 offset:36864
  ds_read_b64_tr_b16 a[102:103], v5 offset:37888
  ds_read_b64_tr_b16 a[104:105], v5 offset:40960
  ds_read_b64_tr_b16 a[106:107], v5 offset:41984
  ds_read_b64_tr_b16 a[108:109], v5 offset:45056
  ds_read_b64_tr_b16 a[110:111], v5 offset:46080
  s_waitcnt lgkmcnt(0)
  ds_read_b64_tr_b16 a[112:113], v5 offset:49152
  ds_read_b64_tr_b16 a[114:115], v5 offset:50176
  ds_read_b64_tr_b16 a[116:117], v5 offset:53248
  ds_read_b64_tr_b16 a[118:119], v5 offset:54272
  ds_read_b64_tr_b16 a[120:121], v5 offset:57344
  ds_read_b64_tr_b16 a[122:123], v5 offset:58368
  ds_read_b64_tr_b16 a[124:125], v5 offset:61440
  ds_read_b64_tr_b16 a[126:127], v5 offset:62464
  s_waitcnt lgkmcnt(0)
  s_waitcnt lgkmcnt(0)
  s_barrier
  s_mov_b32 s20, s50
  s_and_b32 s21, s51, 0xffff
  s_mov_b32 s22, 0x0
  s_mov_b32 s23, 0x20000
  s_mov_b32 s8, s48
  s_and_b32 s9, s49, 0xffff
  s_mov_b32 s10, 0x100
  s_mov_b32 s11, 0x20000
  v_and_b32 v2, 3, v0
  v_lshlrev_b32 v2, 6, v2
L_gate_452:
  buffer_load_dword v11, v2, s[8:11], 0 offen offset:8 sc1
  s_waitcnt vmcnt(0)
  v_cmp_gt_u32 vcc, 48, v11
  s_cbranch_vccz L_gateok_453
  s_add_u32 s72, s72, 1
  s_cmp_gt_u32 s72, 0x80000
  s_cbranch_scc1 L_exit
  s_sleep 2
  s_branch L_gate_452
L_gateok_453:
  s_mov_b32 s59, 0
  s_mov_b32 s88, 0
  s_mov_b32 s60, 0
  v_and_b32 v241, 0x3ff, v7
  v_add_u32 v242, 65536, v241
  s_lshl_b32 s91, s58, 11
  s_add_u32 s91, s91, 81920
  v_add_u32 v246, 81920, v241
  s_mov_b32 s89, 0
  v_mov_b32 v248, 0x0
  v_bfe_i32 v2, v0, 0, 1
  v_and_b32 v2, 0x4, v2
  v_add_u32 v248, v248, v2
  v_bfe_i32 v2, v0, 1, 1
  v_and_b32 v2, 0x8, v2
  v_add_u32 v248, v248, v2
  v_bfe_i32 v2, v0, 2, 1
  v_and_b32 v2, 0x40, v2
  v_add_u32 v248, v248, v2
  v_bfe_i32 v2, v0, 3, 1
  v_and_b32 v2, 0x80, v2
  v_add_u32 v248, v248, v2
  s_lshr_b32 s87, s54, 3
  s_lshl_b32 s87, s87, 4
  s_add_u32 s87, s87, s53
  s_add_u32 s87, s87, 0x18000
  s_sub_u32 s92, s53, 0x10000
  s_lshl_b32 s92, s92, 5
  s_add_u32 s92, s92, 0xd000000
  s_lshl_b32 s61, s54, 12
  s_add_u32 s92, s92, s61
L_s2_454:
  s_lshl_b32 s61, s55, 5
  s_add_u32 s61, s61, s54
  s_lshl_b32 s77, s61, 13
  s_add_u32 s77, s77, s52
  s_lshl_b32 s78, s61, 4
  s_add_u32 s78, s78, s53
  s_lshl_b32 s79, s55, 17
  s_add_u32 s79, s79, s92
  s_add_u32 s76, s55, s56
  s_min_u32 s76, s76, 63
  s_lshl_b32 s93, s76, 9
  s_lshl_b32 s61, s54, 4
  s_add_u32 s93, s93, s61
  s_add_u32 s93, s93, s53
  s_sub_u32 s73, s55, 8
  s_lshl_b32 s73, s73, 8
  s_add_u32 s73, s73, s87
  s_cmp_lt_u32 s55, 8
  s_cselect_b32 s73, 0x33000, s73
  s_add_u32 s74, s55, s56
  s_min_u32 s64, s74, 63
  s_lshl_b32 s96, s64, 6
  s_add_u32 s96, s96, 0x23000
  s_add_u32 s96, s96, s53
  s_lshl_b32 s94, s64, 15
  s_add_u32 s94, s94, 0x5a00000
  s_add_u32 s94, s94, s52
  s_lshl_b32 s95, s58, 12
  s_xor_b32 s64, s60, 0x8000
  s_add_u32 s95, s95, s64
  s_cmp_eq_u32 s59, 1
  s_cbranch_scc1 L_havepf_455
  s_lshl_b32 s63, s55, 6
  s_add_u32 s63, s63, 0x23000
  s_add_u32 s63, s63, s53
L_poll_457:
  buffer_load_dword v11, v8, s[4:7], s63 offen sc1
  s_waitcnt vmcnt(0)
  s_cmp_eq_u32 s88, 0
  s_cbranch_scc1 L_nofl_459
  s_mov_b64 exec, 1
  buffer_store_dword v10, v9, s[4:7], s88 offen sc1
  s_mov_b64 exec, -1
  s_mov_b32 s88, 0
L_nofl_459:
  v_cmp_eq_u32 vcc, 0, v11
  s_cbranch_vccz L_pollok_458
  s_add_u32 s72, s72, 1
  s_cmp_gt_u32 s72, 0x80000
  s_cbranch_scc1 L_exit
  s_sleep 1
  s_branch L_poll_457
L_pollok_458:
  s_lshl_b32 s61, s55, 15
  s_add_u32 s61, s61, 0x5a00000
  s_add_u32 s61, s61, s52
  s_lshl_b32 s62, s58, 12
  s_add_u32 m0, s62, s60
  s_nop 0
  buffer_load_dwordx4 v6, s[4:7], s61 offen offset:0 sc1 lds
  buffer_load_dwordx4 v6, s[4:7], s61 offen offset:1024 sc1 lds
  buffer_load_dwordx4 v6, s[4:7], s61 offen offset:2048 sc1 lds
  buffer_load_dwordx4 v6, s[4:7], s61 offen offset:3072 sc1 lds
  s_add_u32 m0, m0, 0x4000
  s_add_u32 s61, s61, 0x4000
  buffer_load_dwordx4 v6, s[4:7], s61 offen offset:0 sc1 lds
  buffer_load_dwordx4 v6, s[4:7], s61 offen offset:1024 sc1 lds
  buffer_load_dwordx4 v6, s[4:7], s61 offen offset:2048 sc1 lds
  buffer_load_dwordx4 v6, s[4:7], s61 offen offset:3072 sc1 lds
  s_waitcnt vmcnt(0)
  s_branch L_head_456
L_havepf_455:
  s_waitcnt vmcnt(2)
L_head_456:
  s_barrier
  s_mov_b32 s59, 0
  ds_read_b128 v[16:19], v7 offset:0
  ds_read_b128 v[20:23], v7 offset:1024
  ds_read_b128 v[24:27], v7 offset:2048
  ds_read_b128 v[28:31], v7 offset:3072
  s_waitcnt lgkmcnt(3)
  v_mfma_f32_32x32x16_bf16 v[32:47], a[0:3], v[16:19], 0
  s_bitcmp1_b32 s89, 0
  s_cselect_b32 s22, 0x10000000, 0
  s_mov_b32 m0, s91
  s_add_u32 s62, s77, 0x1000000
  buffer_load_dwordx4 v12, s[20:23], s77 offen sc1 lds
  ds_read_b128 v[16:19], v7 offset:4096
  s_waitcnt lgkmcnt(3)
  v_mfma_f32_32x32x16_bf16 v[32:47], a[4:7], v[20:23], v[32:47]
  ds_read_b128 v[20:23], v7 offset:5120
  s_waitcnt lgkmcnt(3)
  v_mfma_f32_32x32x16_bf16 v[32:47], a[8:11], v[24:27], v[32:47]
  buffer_load_dwordx4 v12, s[20:23], s77 offen offset:1024 sc1 lds
  ds_read_b128 v[24:27], v7 offset:6144
  s_waitcnt lgkmcnt(3)
  v_mfma_f32_32x32x16_bf16 v[32:47], a[12:15], v[28:31], v[32:47]
  ds_read_b128 v[28:31], v7 offset:7168
  s_waitcnt lgkmcnt(3)
  v_mfma_f32_32x32x16_bf16 v[32:47], a[16:19], v[16:19], v[32:47]
  buffer_load_dwordx4 v[176:179], v12, s[20:23], s62 offen sc1
  ds_read_b128 v[16:19], v7 offset:8192
  s_waitcnt lgkmcnt(3)
  v_mfma_f32_32x32x16_bf16 v[32:47], a[20:23], v[20:23], v[32:47]
  ds_read_b128 v[20:23], v7 offset:9216
  s_waitcnt lgkmcnt(3)
  v_mfma_f32_32x32x16_bf16 v[32:47], a[24:27], v[24:27], v[32:47]
  buffer_load_dwordx4 v[180:183], v12, s[20:23], s62 offen offset:1024 sc1
  ds_read_b128 v[24:27], v7 offset:10240
  s_waitcnt lgkmcnt(3)
  v_mfma_f32_32x32x16_bf16 v[32:47], a[28:31], v[28:31], v[32:47]
  ds_read_b128 v[28:31], v7 offset:11264
  s_waitcnt lgkmcnt(3)
  v_mfma_f32_32x32x16_bf16 v[32:47], a[32:35], v[16:19], v[32:47]
  buffer_load_dword v11, v8, s[4:7], s96 offen sc1
  ds_read_b128 v[16:19], v7 offset:12288
  s_waitcnt lgkmcnt(3)
  v_mfma_f32_32x32x16_bf16 v[32:47], a[36:39], v[20:23], v[32:47]
  ds_read_b128 v[20:23], v7 offset:13312
  s_waitcnt lgkmcnt(3)
  v_mfma_f32_32x32x16_bf16 v[32:47], a[40:43], v[24:27], v[32:47]
  buffer_load_dword v244, v239, s[4:7], s93 offen sc1
  ds_read_b128 v[24:27], v7 offset:14336
  s_waitcnt lgkmcnt(3)
  v_mfma_f32_32x32x16_bf16 v[32:47], a[44:47], v[28:31], v[32:47]
  ds_read_b128 v[28:31], v7 offset:15360
  s_waitcnt lgkmcnt(3)
  v_mfma_f32_32x32x16_bf16 v[32:47], a[48:51], v[16:19], v[32:47]
  buffer_load_dword v247, v248, s[4:7], s73 offen sc1
  ds_read_b128 v[16:19], v7 offset:16384
  s_waitcnt lgkmcnt(3)
  v_mfma_f32_32x32x16_bf16 v[32:47], a[52:55], v[20:23], v[32:47]
  ds_read_b128 v[20:23], v7 offset:17408
  s_waitcnt lgkmcnt(3)
  v_mfma_f32_32x32x16_bf16 v[32:47], a[56:59], v[24:27], v[32:47]
  s_mov_b32 m0, s80
  s_nop 0
  buffer_load_dwordx4 v241, s[4:7], s79 offen sc1 lds
  ds_read_b128 v[24:27], v7 offset:18432
  s_waitcnt lgkmcnt(3)
  v_mfma_f32_32x32x16_bf16 v[32:47], a[60:63], v[28:31], v[32:47]
  ds_read_b128 v[28:31], v7 offset:19456
  s_waitcnt lgkmcnt(3)
  v_mfma_f32_32x32x16_bf16 v[32:47], a[64:67], v[16:19], v[32:47]
  buffer_load_dwordx4 v241, s[4:7], s79 offen offset:1024 sc1 lds
  ds_read_b128 v[16:19], v7 offset:20480
  s_waitcnt lgkmcnt(3)
  v_mfma_f32_32x32x16_bf16 v[32:47], a[68:71], v[20:23], v[32:47]
  ds_read_b128 v[20:23], v7 offset:21504
  s_waitcnt lgkmcnt(3)
  v_mfma_f32_32x32x16_bf16 v[32:47], a[72:75], v[24:27], v[32:47]
  buffer_load_dwordx2 v[184:185], v238, s[4:7], s79 offen sc1
  ds_read_b128 v[24:27], v7 offset:22528
  s_waitcnt lgkmcnt(3)
  v_mfma_f32_32x32x16_bf16 v[32:47], a[76:79], v[28:31], v[32:47]
  s_cmp_eq_u32 s88, 0
  s_cbranch_scc1 L_s2f_460
  s_waitcnt vmcnt(10)
  s_mov_b64 exec, 1
  buffer_store_dword v10, v9, s[4:7], s88 offen sc1
  s_mov_b64 exec, -1
L_s2f_460:
  ds_read_b128 v[28:31], v7 offset:23552
  s_waitcnt lgkmcnt(3)
  v_mfma_f32_32x32x16_bf16 v[32:47], a[80:83], v[16:19], v[32:47]
  ds_read_b128 v[16:19], v7 offset:24576
  s_waitcnt lgkmcnt(3)
  v_mfma_f32_32x32x16_bf16 v[32:47], a[84:87], v[20:23], v[32:47]
  ds_read_b128 v[20:23], v7 offset:25600
  s_waitcnt lgkmcnt(3)
  v_mfma_f32_32x32x16_bf16 v[32:47], a[88:91], v[24:27], v[32:47]
  ds_read_b128 v[24:27], v7 offset:26624
  s_waitcnt lgkmcnt(3)
  v_mfma_f32_32x32x16_bf16 v[32:47], a[92:95], v[28:31], v[32:47]
  ds_read_b128 v[28:31], v7 offset:27648
  s_waitcnt lgkmcnt(3)
  v_mfma_f32_32x32x16_bf16 v[32:47], a[96:99], v[16:19], v[32:47]
  ds_read_b128 v[16:19], v7 offset:28672
  s_waitcnt lgkmcnt(3)
  v_mfma_f32_32x32x16_bf16 v[32:47], a[100:103], v[20:23], v[32:47]
  ds_read_b128 v[20:23], v7 offset:29696
  s_waitcnt lgkmcnt(3)
  v_mfma_f32_32x32x16_bf16 v[32:47], a[104:107], v[24:27], v[32:47]
  ds_read_b128 v[24:27], v7 offset:30720
  s_waitcnt lgkmcnt(3)
  v_mfma_f32_32x32x16_bf16 v[32:47], a[108:111], v[28:31], v[32:47]
  ds_read_b128 v[28:31], v7 offset:31744
  s_waitcnt lgkmcnt(3)
  v_mfma_f32_32x32x16_bf16 v[32:47], a[112:115], v[16:19], v[32:47]
  s_waitcnt lgkmcnt(2)
  v_mfma_f32_32x32x16_bf16 v[32:47], a[116:119], v[20:23], v[32:47]
  s_waitcnt lgkmcnt(1)
  v_mfma_f32_32x32x16_bf16 v[32:47], a[120:123], v[24:27], v[32:47]
  s_waitcnt lgkmcnt(0)
  v_mfma_f32_32x32x16_bf16 v[32:47], a[124:127], v[28:31], v[32:47]
  s_nop 9
  s_cmp_lg_u32 s88, 0
  s_mov_b32 s88, 0
  v_cvt_pk_bf16_f32 v64, v32, v33
  v_cvt_pk_bf16_f32 v65, v34, v35
  v_cvt_pk_bf16_f32 v66, v36, v37
  v_cvt_pk_bf16_f32 v67, v38, v39
  v_cvt_pk_bf16_f32 v68, v40, v41
  v_cvt_pk_bf16_f32 v69, v42, v43
  v_cvt_pk_bf16_f32 v70, v44, v45
  v_cvt_pk_bf16_f32 v71, v46, v47
  ds_write_b128 v236, v[64:67]
  ds_write_b128 v236, v[68:71] offset:1024
  s_cbranch_scc1 L_s2w_461
  s_waitcnt vmcnt(0)
L_s2w_461:
  s_waitcnt vmcnt(1)
  s_bitcmp1_b32 s89, 0
  s_cbranch_scc1 L_s2c_462
L_poll_463:
  buffer_load_dword v232, v239, s[4:7], s78 offen sc1
  s_waitcnt vmcnt(0)
  v_cmp_eq_u32 vcc, 0, v232
  s_cbranch_vccz L_pollok_464
  s_add_u32 s72, s72, 1
  s_cmp_gt_u32 s72, 0x80000
  s_cbranch_scc1 L_exit
  s_sleep 1
  s_branch L_poll_463
L_pollok_464:
  s_mov_b32 m0, s91
  s_add_u32 s62, s77, 0x1000000
  buffer_load_dwordx4 v12, s[4:7], s77 offen sc1 lds
  buffer_load_dwordx4 v12, s[4:7], s77 offen offset:1024 sc1 lds
  buffer_load_dwordx4 v[176:179], v12, s[4:7], s62 offen sc1
  buffer_load_dwordx4 v[180:183], v12, s[4:7], s62 offen offset:1024 sc1
  s_waitcnt vmcnt(0)
L_s2c_462:
  v_cmp_eq_u32 vcc, 0, v11
  s_cmp_lt_u32 s74, s57
  s_cselect_b64 s[70:71], vcc, -1
  s_cmp_eq_u64 s[70:71], 0
  s_cselect_b32 s22, 0x10000000, 0
  s_cselect_b32 s59, 1, 0
  s_waitcnt lgkmcnt(0)
  s_barrier
  ds_read_b128 v[80:83], v242 offset:0
  ds_read_b128 v[112:115], v246 offset:0
  ds_read_b128 v[84:87], v242 offset:1024
  ds_read_b128 v[116:119], v246 offset:1024
  ds_read_b128 v[88:91], v242 offset:2048
  ds_read_b128 v[120:123], v246 offset:2048
  ds_read_b128 v[92:95], v242 offset:3072
  ds_read_b128 v[124:127], v246 offset:3072
  ds_read_b128 v[96:99], v242 offset:4096
  ds_read_b128 v[128:131], v246 offset:4096
  s_waitcnt lgkmcnt(8)
  v_mfma_f32_32x32x16_bf16 v[48:63], v[112:115], v[80:83], v[188:203]
  ds_read_b128 v[100:103], v242 offset:5120
  ds_read_b128 v[132:135], v246 offset:5120
  s_waitcnt lgkmcnt(8)
  v_mfma_f32_32x32x16_bf16 v[48:63], v[116:119], v[84:87], v[48:63]
  s_mov_b32 m0, s95
  s_nop 0
  buffer_load_dwordx4 v6, s[20:23], s94 offen offset:0 sc1 lds
  ds_read_b128 v[104:107], v242 offset:6144
  ds_read_b128 v[136:139], v246 offset:6144
  s_waitcnt lgkmcnt(8)
  v_mfma_f32_32x32x16_bf16 v[48:63], v[120:123], v[88:91], v[48:63]
  ds_read_b128 v[108:111], v242 offset:7168
  ds_read_b128 v[140:143], v246 offset:7168
  s_waitcnt lgkmcnt(8)
  v_mfma_f32_32x32x16_bf16 v[48:63], v[124:127], v[92:95], v[48:63]
  buffer_load_dwordx4 v6, s[20:23], s94 offen offset:1024 sc1 lds
  s_waitcnt lgkmcnt(6)
  v_mfma_f32_32x32x16_bf16 v[48:63], v[128:131], v[96:99], v[48:63]
  s_waitcnt lgkmcnt(4)
  v_mfma_f32_32x32x16_bf16 v[48:63], v[132:135], v[100:103], v[48:63]
  buffer_load_dwordx4 v6, s[20:23], s94 offen offset:2048 sc1 lds
  s_waitcnt lgkmcnt(2)
  v_mfma_f32_32x32x16_bf16 v[48:63], v[136:139], v[104:107], v[48:63]
  s_waitcnt lgkmcnt(0)
  v_mfma_f32_32x32x16_bf16 v[48:63], v[140:143], v[108:111], v[48:63]
  buffer_load_dwordx4 v6, s[20:23], s94 offen offset:3072 sc1 lds
  s_add_u32 s94, s94, 0x4000
  s_add_u32 s95, s95, 0x4000
  s_mov_b32 m0, s95
  s_nop 0
  buffer_load_dwordx4 v6, s[20:23], s94 offen offset:0 sc1 lds
  s_nop 5
  v_max3_f32 v232, v48, v49, v50
  v_max3_f32 v233, v51, v52, v53
  v_max3_f32 v232, v232, v54, v55
  v_max3_f32 v233, v233, v56, v57
  v_max3_f32 v232, v232, v58, v59
  v_max3_f32 v233, v233, v60, v61
  v_max3_f32 v232, v232, v62, v63
  v_max_f32 v232, v232, v233
  v_mov_b32 v233, v232
  buffer_load_dwordx4 v6, s[20:23], s94 offen offset:1024 sc1 lds
  s_nop 0
  v_permlane32_swap_b32 v232, v233
  s_nop 0
  v_max_f32 v232, v232, v233
  v_mul_f32 v232, s81, v232
  v_fma_f32 v48, v48, s81, -v232
  v_fma_f32 v49, v49, s81, -v232
  v_exp_f32 v48, v48
  v_fma_f32 v50, v50, s81, -v232
  v_exp_f32 v49, v49
  v_fma_f32 v51, v51, s81, -v232
  v_exp_f32 v50, v50
  v_fma_f32 v52, v52, s81, -v232
  v_exp_f32 v51, v51
  v_fma_f32 v53, v53, s81, -v232
  v_exp_f32 v52, v52
  v_fma_f32 v54, v54, s81, -v232
  v_exp_f32 v53, v53
  buffer_load_dwordx4 v6, s[20:23], s94 offen offset:2048 sc1 lds
  v_fma_f32 v55, v55, s81, -v232
  v_exp_f32 v54, v54
  v_fma_f32 v56, v56, s81, -v232
  v_exp_f32 v55, v55
  v_fma_f32 v57, v57, s81, -v232
  v_exp_f32 v56, v56
  v_fma_f32 v58, v58, s81, -v232
  v_exp_f32 v57, v57
  v_fma_f32 v59, v59, s81, -v232
  v_exp_f32 v58, v58
  v_fma_f32 v60, v60, s81, -v232
  v_exp_f32 v59, v59
  buffer_load_dwordx4 v6, s[20:23], s94 offen offset:3072 sc1 lds
  v_fma_f32 v61, v61, s81, -v232
  v_exp_f32 v60, v60
  v_fma_f32 v62, v62, s81, -v232
  v_exp_f32 v61, v61
  v_fma_f32 v63, v63, s81, -v232
  v_exp_f32 v62, v62
  v_exp_f32_e64 v63, v63
  v_cvt_pk_bf16_f32 v220, v48, v49
  v_cvt_pk_bf16_f32 v221, v50, v51
  v_cvt_pk_bf16_f32 v222, v52, v53
  v_cvt_pk_bf16_f32 v223, v54, v55
  v_cvt_pk_bf16_f32 v224, v56, v57
  v_cvt_pk_bf16_f32 v225, v58, v59
  v_cvt_pk_bf16_f32 v226, v60, v61
  v_cvt_pk_bf16_f32 v227, v62, v63
  v_add_f32 v234, v48, v49
  v_add_f32 v235, v50, v51
  v_mfma_f32_32x32x16_bf16 v[32:47], v[176:179], v[220:223], 0
  v_add_f32 v234, v234, v52
  v_add_f32 v235, v235, v53
  v_add_f32 v234, v234, v54
  v_add_f32 v235, v235, v55
  v_add_f32 v234, v234, v56
  v_add_f32 v235, v235, v57
  v_mfma_f32_32x32x16_bf16 v[32:47], v[180:183], v[224:227], v[32:47]
  v_add_f32 v234, v234, v58
  v_add_f32 v235, v235, v59
  v_add_f32 v234, v234, v60
  v_add_f32 v235, v235, v61
  v_add_f32 v234, v234, v62
  v_add_f32 v235, v235, v63
  v_add_f32 v234, v234, v235
  v_max_u32 v235, v184, v185
  v_cmp_eq_u32 vcc, -1, v235
  s_cbranch_vccz L_s2d_465
L_s2p_466:
  s_mov_b32 m0, s80
  s_nop 0
  buffer_load_dwordx4 v241, s[4:7], s79 offen sc1 lds
  buffer_load_dwordx4 v241, s[4:7], s79 offen offset:1024 sc1 lds
  buffer_load_dwordx2 v[184:185], v238, s[4:7], s79 offen sc1
  buffer_load_dword v11, v8, s[4:7], s96 offen sc1
  buffer_load_dword v244, v239, s[4:7], s93 offen sc1
  s_waitcnt vmcnt(0)
  v_max_u32 v235, v184, v185
  v_cmp_eq_u32 vcc, -1, v235
  s_cbranch_vccz L_s2d_465
  s_cmp_ge_u32 s74, s57
  s_cbranch_scc1 L_nopf_469
  s_cmp_eq_u32 s59, 1
  s_cbranch_scc1 L_nopf_469
  v_cmp_eq_u32 vcc, 0, v11
  s_cbranch_vccnz L_nopf_469
  s_xor_b32 s64, s60, 0x8000
  s_lshl_b32 s61, s74, 15
  s_add_u32 s61, s61, 0x5a00000
  s_add_u32 s61, s61, s52
  s_lshl_b32 s62, s58, 12
  s_add_u32 m0, s62, s64
  s_nop 0
  buffer_load_dwordx4 v6, s[4:7], s61 offen offset:0 sc1 lds
  buffer_load_dwordx4 v6, s[4:7], s61 offen offset:1024 sc1 lds
  buffer_load_dwordx4 v6, s[4:7], s61 offen offset:2048 sc1 lds
  buffer_load_dwordx4 v6, s[4:7], s61 offen offset:3072 sc1 lds
  s_add_u32 m0, m0, 0x4000
  s_add_u32 s61, s61, 0x4000
  buffer_load_dwordx4 v6, s[4:7], s61 offen offset:0 sc1 lds
  buffer_load_dwordx4 v6, s[4:7], s61 offen offset:1024 sc1 lds
  buffer_load_dwordx4 v6, s[4:7], s61 offen offset:2048 sc1 lds
  buffer_load_dwordx4 v6, s[4:7], s61 offen offset:3072 sc1 lds
  s_mov_b32 s59, 1
L_nopf_469:
  s_add_u32 s72, s72, 1
  s_cmp_gt_u32 s72, 0x80000
  s_cbranch_scc1 L_exit
  s_branch L_s2p_466
L_s2d_465:
  ds_read_b64_tr_b16 v[144:145], v237 offset:0
  ds_read_b64_tr_b16 v[146:147], v237 offset:128
  ds_read_b64_tr_b16 v[148:149], v237 offset:256
  ds_read_b64_tr_b16 v[150:151], v237 offset:384
  ds_read_b64_tr_b16 v[152:153], v237 offset:512
  ds_read_b64_tr_b16 v[154:155], v237 offset:640
  ds_read_b64_tr_b16 v[156:157], v237 offset:768
  ds_read_b64_tr_b16 v[158:159], v237 offset:896
  ds_read_b64_tr_b16 v[160:161], v237 offset:1024
  ds_read_b64_tr_b16 v[162:163], v237 offset:1152
  ds_read_b64_tr_b16 v[164:165], v237 offset:1280
  ds_read_b64_tr_b16 v[166:167], v237 offset:1408
  ds_read_b64_tr_b16 v[168:169], v237 offset:1536
  ds_read_b64_tr_b16 v[170:171], v237 offset:1664
  s_waitcnt lgkmcnt(8)
  ds_read_b64_tr_b16 v[172:173], v237 offset:1792
  ds_read_b64_tr_b16 v[174:175], v237 offset:1920
  s_waitcnt lgkmcnt(8)
  v_mfma_f32_32x32x16_bf16 v[204:219], v[144:147], v[80:83], 0
  s_waitcnt lgkmcnt(8)
  v_mfma_f32_32x32x16_bf16 v[204:219], v[148:151], v[84:87], v[204:219]
  s_waitcnt lgkmcnt(8)
  v_mfma_f32_32x32x16_bf16 v[204:219], v[152:155], v[88:91], v[204:219]
  s_waitcnt lgkmcnt(8)
  v_mfma_f32_32x32x16_bf16 v[204:219], v[156:159], v[92:95], v[204:219]
  s_waitcnt lgkmcnt(6)
  v_mfma_f32_32x32x16_bf16 v[204:219], v[160:163], v[96:99], v[204:219]
  s_waitcnt lgkmcnt(4)
  v_mfma_f32_32x32x16_bf16 v[204:219], v[164:167], v[100:103], v[204:219]
  s_waitcnt lgkmcnt(2)
  v_mfma_f32_32x32x16_bf16 v[204:219], v[168:171], v[104:107], v[204:219]
  s_waitcnt lgkmcnt(0)
  v_mfma_f32_32x32x16_bf16 v[204:219], v[172:175], v[108:111], v[204:219]
L_s2e_468:
  v_cmp_eq_u32 vcc, 0, v244
  s_cmp_eq_u64 vcc, 0
  s_cselect_b32 s89, 1, 0
  s_and_b32 s62, s77, 0x1fffff
  s_add_u32 s62, s62, s52
  s_add_u32 s62, s62, 0x2000000
  s_add_u32 s88, s78, 0x10000
  s_nop 6
  v_max3_f32 v233, v204, v205, v206
  v_cmp_u_f32 vcc, v204, v205
  v_cmp_u_f32 s[70:71], v206, v207
  v_max_f32 v233, v233, v207
  v_mul_f32 v233, s81, v233
  s_or_b64 vcc, vcc, s[70:71]
  s_cbranch_vccnz L_s2bad_467
L_s2good_470:
  v_mov_b32 v235, v233
  s_nop 1
  v_permlane32_swap_b32 v233, v235
  s_nop 0
  v_max3_f32 v233, v233, v235, v232
  v_sub_f32_e64 v235, v232, v233
  v_fma_f32 v204, v204, s81, -v233
  v_fma_f32 v205, v205, s81, -v233
  v_fma_f32 v206, v206, s81, -v233
  v_fma_f32 v207, v207, s81, -v233
  v_exp_f32 v235, v235
  v_exp_f32 v204, v204
  v_exp_f32 v205, v205
  v_exp_f32 v206, v206
  v_exp_f32 v207, v207
  s_nop 0
  v_fma_f32 v232, v234, v235, v204
  v_add_f32 v233, v205, v206
  v_add_f32 v232, v232, v207
  v_add_f32 v232, v232, v233
  v_mov_b32 v233, v232
  s_nop 1
  v_permlane32_swap_b32 v232, v233
  s_nop 0
  v_add_f32 v232, v232, v233
  v_rcp_f32 v232, v232
  s_nop 0
  v_mul_f32 v235, v235, v232
  v_mul_f32 v204, v204, v232
  v_mul_f32 v205, v205, v232
  v_mul_f32 v206, v206, v232
  v_mul_f32 v207, v207, v232
  v_cvt_pk_bf16_f32 v228, v204, v205
  v_cvt_pk_bf16_f32 v229, v206, v207
  v_mul_f32 v32, v32, v235
  v_mul_f32 v33, v33, v235
  v_mul_f32 v34, v34, v235
  v_mul_f32 v35, v35, v235
  v_mul_f32 v36, v36, v235
  v_mul_f32 v37, v37, v235
  v_mul_f32 v38, v38, v235
  v_mul_f32 v39, v39, v235
  v_mul_f32 v40, v40, v235
  v_mul_f32 v41, v41, v235
  v_mul_f32 v42, v42, v235
  v_mul_f32 v43, v43, v235
  v_mul_f32 v44, v44, v235
  v_mul_f32 v45, v45, v235
  v_mul_f32 v46, v46, v235
  v_mul_f32 v47, v47, v235
  s_nop 1
  v_mfma_f32_32x32x16_bf16 v[32:47], v[184:187], v[228:231], v[32:47]
  s_nop 11
  v_cvt_pk_bf16_f32 v64, v32, v33
  v_cvt_pk_bf16_f32 v65, v34, v35
  v_cvt_pk_bf16_f32 v66, v36, v37
  v_cvt_pk_bf16_f32 v67, v38, v39
  v_cvt_pk_bf16_f32 v68, v40, v41
  v_cvt_pk_bf16_f32 v69, v42, v43
  v_cvt_pk_bf16_f32 v70, v44, v45
  v_cvt_pk_bf16_f32 v71, v46, v47
  v_cmp_eq_u32 vcc, 0, v247
  s_cbranch_vccz L_s2cr_471
L_poll_472:
  buffer_load_dword v247, v248, s[4:7], s73 offen sc1
  s_waitcnt vmcnt(0)
  v_cmp_eq_u32 vcc, 0, v247
  s_cbranch_vccz L_pollok_473
  s_add_u32 s72, s72, 1
  s_cmp_gt_u32 s72, 0x80000
  s_cbranch_scc1 L_exit
  s_sleep 1
  s_branch L_poll_472
L_pollok_473:
L_s2cr_471:
  buffer_store_dwordx4 v[64:67], v12, s[4:7], s62 offen sc1
  buffer_store_dwordx4 v[68:71], v12, s[4:7], s62 offen offset:1024 sc1
  s_xor_b32 s60, s60, 0x8000
  v_xor_b32 v7, 0x8000, v7
  s_mov_b32 s55, s74
  s_cmp_lt_u32 s55, s57
  s_cbranch_scc1 L_s2_454
  s_waitcnt vmcnt(0)
  s_cmp_eq_u32 s88, 0
  s_cbranch_scc1 L_nofl_474
  s_mov_b64 exec, 1
  buffer_store_dword v10, v9, s[4:7], s88 offen sc1
  s_mov_b64 exec, -1
  s_mov_b32 s88, 0
L_nofl_474:
  s_endpgm
L_s2bad_467:
  v_pk_max_u16 v235, v144, v145
  v_pk_max_u16 v235, v235, v146
  v_pk_max_u16 v235, v235, v147
  v_pk_max_u16 v235, v235, v148
  v_pk_max_u16 v235, v235, v149
  v_pk_max_u16 v235, v235, v150
  v_pk_max_u16 v235, v235, v151
  v_pk_max_u16 v235, v235, v152
  v_pk_max_u16 v235, v235, v153
  v_pk_max_u16 v235, v235, v154
  v_pk_max_u16 v235, v235, v155
  v_pk_max_u16 v235, v235, v156
  v_pk_max_u16 v235, v235, v157
  v_pk_max_u16 v235, v235, v158
  v_pk_max_u16 v235, v235, v159
  v_pk_max_u16 v235, v235, v160
  v_pk_max_u16 v235, v235, v161
  v_pk_max_u16 v235, v235, v162
  v_pk_max_u16 v235, v235, v163
  v_pk_max_u16 v235, v235, v164
  v_pk_max_u16 v235, v235, v165
  v_pk_max_u16 v235, v235, v166
  v_pk_max_u16 v235, v235, v167
  v_pk_max_u16 v235, v235, v168
  v_pk_max_u16 v235, v235, v169
  v_pk_max_u16 v235, v235, v170
  v_pk_max_u16 v235, v235, v171
  v_pk_max_u16 v235, v235, v172
  v_pk_max_u16 v235, v235, v173
  v_pk_max_u16 v235, v235, v174
  v_pk_max_u16 v235, v235, v175
  v_lshrrev_b32 v2, 16, v235
  v_and_b32 v235, 0xffff, v235
  v_max_u32 v235, v235, v2
  v_cmp_eq_u32 vcc, 0xffff, v235
  s_cbranch_vccz L_s2good_470
  s_mov_b32 s88, 0
  s_add_u32 s72, s72, 1
  s_cmp_gt_u32 s72, 0x80000
  s_cbranch_scc1 L_exit
  s_branch L_s2p_466
  s_endpgm
B_chain_f:
  v_mov_b32 v2, 0x44444444
  v_bfe_i32 v1, v0, 0, 1
  v_and_b32 v1, 0xaaaaaaaa, v1
  v_add_u32 v2, v2, v1
  v_mov_b32 v3, 0x0
  v_bfe_i32 v1, v0, 0, 1
  v_and_b32 v1, 0x10, v1
  v_add_u32 v3, v3, v1
  v_bfe_i32 v1, v0, 1, 1
  v_and_b32 v1, 0x20, v1
  v_add_u32 v3, v3, v1
  v_bfe_i32 v1, v0, 2, 1
  v_and_b32 v1, 0x40, v1
  v_add_u32 v3, v3, v1
  v_bfe_i32 v1, v0, 3, 1
  v_and_b32 v1, 0x80, v1
  v_add_u32 v3, v3, v1
  v_bfe_i32 v1, v0, 4, 1
  v_and_b32 v1, 0x100, v1
  v_add_u32 v3, v3, v1
  v_bfe_i32 v1, v0, 5, 1
  v_and_b32 v1, 0x200, v1
  v_add_u32 v3, v3, v1
  v_bfe_i32 v1, v0, 6, 1
  v_and_b32 v1, 0x800, v1
  v_add_u32 v3, v3, v1
  v_bfe_i32 v1, v0, 7, 1
  v_and_b32 v1, 0x1000, v1
  v_add_u32 v3, v3, v1
  v_mov_b32 v21, 0x0
  v_bfe_i32 v1, v0, 0, 1
  v_and_b32 v1, 0x10, v1
  v_add_u32 v21, v21, v1
  v_bfe_i32 v1, v0, 1, 1
  v_and_b32 v1, 0x20, v1
  v_add_u32 v21, v21, v1
  v_bfe_i32 v1, v0, 2, 1
  v_and_b32 v1, 0x40, v1
  v_add_u32 v21, v21, v1
  v_bfe_i32 v1, v0, 3, 1
  v_and_b32 v1, 0x80, v1
  v_add_u32 v21, v21, v1
  v_bfe_i32 v1, v0, 4, 1
  v_and_b32 v1, 0x100, v1
  v_add_u32 v21, v21, v1
  v_bfe_i32 v1, v0, 5, 1
  v_and_b32 v1, 0x200, v1
  v_add_u32 v21, v21, v1
  v_bfe_i32 v1, v0, 6, 1
  v_and_b32 v1, 0x400, v1
  v_add_u32 v21, v21, v1
  v_bfe_i32 v1, v0, 7, 1
  v_and_b32 v1, 0x800, v1
  v_add_u32 v21, v21, v1
  v_mov_b32 v4, 0x0
  v_bfe_i32 v1, v0, 0, 1
  v_and_b32 v1, 0x10, v1
  v_add_u32 v4, v4, v1
  v_bfe_i32 v1, v0, 1, 1
  v_and_b32 v1, 0x20, v1
  v_add_u32 v4, v4, v1
  v_bfe_i32 v1, v0, 2, 1
  v_and_b32 v1, 0x40, v1
  v_add_u32 v4, v4, v1
  v_bfe_i32 v1, v0, 3, 1
  v_and_b32 v1, 0x80, v1
  v_add_u32 v4, v4, v1
  v_bfe_i32 v1, v0, 4, 1
  v_and_b32 v1, 0x100, v1
  v_add_u32 v4, v4, v1
  v_bfe_i32 v1, v0, 5, 1
  v_and_b32 v1, 0x200, v1
  v_add_u32 v4, v4, v1
  v_mov_b32 v5, 0x0
  v_bfe_i32 v1, v0, 0, 1
  v_and_b32 v1, 0x10, v1
  v_add_u32 v5, v5, v1
  v_bfe_i32 v1, v0, 1, 1
  v_and_b32 v1, 0x20, v1
  v_add_u32 v5, v5, v1
  v_bfe_i32 v1, v0, 2, 1
  v_and_b32 v1, 0x40, v1
  v_add_u32 v5, v5, v1
  v_bfe_i32 v1, v0, 3, 1
  v_and_b32 v1, 0x80, v1
  v_add_u32 v5, v5, v1
  v_bfe_i32 v1, v0, 4, 1
  v_and_b32 v1, 0x100, v1
  v_add_u32 v5, v5, v1
  v_bfe_i32 v1, v0, 5, 1
  v_and_b32 v1, 0x200, v1
  v_add_u32 v5, v5, v1
  v_bfe_i32 v1, v0, 6, 1
  v_and_b32 v1, 0x4000, v1
  v_add_u32 v5, v5, v1
  v_bfe_i32 v1, v0, 7, 1
  v_and_b32 v1, 0x8000, v1
  v_add_u32 v5, v5, v1
  v_mov_b32 v6, 0x4000
  v_bfe_i32 v1, v0, 0, 1
  v_and_b32 v1, 0x10, v1
  v_add_u32 v6, v6, v1
  v_bfe_i32 v1, v0, 1, 1
  v_and_b32 v1, 0x20, v1
  v_add_u32 v6, v6, v1
  v_bfe_i32 v1, v0, 2, 1
  v_and_b32 v1, 0x40, v1
  v_add_u32 v6, v6, v1
  v_bfe_i32 v1, v0, 3, 1
  v_and_b32 v1, 0x100, v1
  v_add_u32 v6, v6, v1
  v_bfe_i32 v1, v0, 4, 1
  v_and_b32 v1, 0x200, v1
  v_add_u32 v6, v6, v1
  v_bfe_i32 v1, v0, 5, 1
  v_and_b32 v1, 0x400, v1
  v_add_u32 v6, v6, v1
  v_mov_b32 v7, 0x0
  v_bfe_i32 v1, v0, 0, 1
  v_and_b32 v1, 0x10, v1
  v_add_u32 v7, v7, v1
  v_bfe_i32 v1, v0, 1, 1
  v_and_b32 v1, 0x20, v1
  v_add_u32 v7, v7, v1
  v_bfe_i32 v1, v0, 2, 1
  v_and_b32 v1, 0x40, v1
  v_add_u32 v7, v7, v1
  v_bfe_i32 v1, v0, 3, 1
  v_and_b32 v1, 0x80, v1
  v_add_u32 v7, v7, v1
  v_bfe_i32 v1, v0, 4, 1
  v_and_b32 v1, 0x200, v1
  v_add_u32 v7, v7, v1
  v_bfe_i32 v1, v0, 5, 1
  v_and_b32 v1, 0x400, v1
  v_add_u32 v7, v7, v1
  v_bfe_i32 v1, v0, 6, 1
  v_and_b32 v1, 0x800, v1
  v_add_u32 v7, v7, v1
  v_bfe_i32 v1, v0, 7, 1
  v_and_b32 v1, 0x1000, v1
  v_add_u32 v7, v7, v1
  v_mov_b32 v8, 0x2000
  v_bfe_i32 v1, v0, 0, 1
  v_and_b32 v1, 0x20, v1
  v_add_u32 v8, v8, v1
  v_bfe_i32 v1, v0, 1, 1
  v_and_b32 v1, 0x40, v1
  v_add_u32 v8, v8, v1
  v_bfe_i32 v1, v0, 2, 1
  v_and_b32 v1, 0x80, v1
  v_add_u32 v8, v8, v1
  v_bfe_i32 v1, v0, 3, 1
  v_and_b32 v1, 0x100, v1
  v_add_u32 v8, v8, v1
  v_bfe_i32 v1, v0, 4, 1
  v_and_b32 v1, 0x8, v1
  v_add_u32 v8, v8, v1
  v_bfe_i32 v1, v0, 5, 1
  v_and_b32 v1, 0x10, v1
  v_add_u32 v8, v8, v1
  v_bfe_i32 v1, v0, 6, 1
  v_and_b32 v1, 0x400, v1
  v_add_u32 v8, v8, v1
  v_bfe_i32 v1, v0, 7, 1
  v_and_b32 v1, 0x800, v1
  v_add_u32 v8, v8, v1
  v_mov_b32 v9, 0x2000
  v_bfe_i32 v1, v0, 0, 1
  v_and_b32 v1, 0x8, v1
  v_add_u32 v9, v9, v1
  v_bfe_i32 v1, v0, 1, 1
  v_and_b32 v1, 0x10, v1
  v_add_u32 v9, v9, v1
  v_bfe_i32 v1, v0, 2, 1
  v_and_b32 v1, 0x20, v1
  v_add_u32 v9, v9, v1
  v_bfe_i32 v1, v0, 3, 1
  v_and_b32 v1, 0x40, v1
  v_add_u32 v9, v9, v1
  v_bfe_i32 v1, v0, 4, 1
  v_and_b32 v1, 0x80, v1
  v_add_u32 v9, v9, v1
  v_bfe_i32 v1, v0, 5, 1
  v_and_b32 v1, 0x200, v1
  v_add_u32 v9, v9, v1
  v_mov_b32 v10, 0x3800
  v_bfe_i32 v1, v0, 0, 1
  v_and_b32 v1, 0x20, v1
  v_add_u32 v10, v10, v1
  v_bfe_i32 v1, v0, 2, 1
  v_and_b32 v1, 0x40, v1
  v_add_u32 v10, v10, v1
  v_bfe_i32 v1, v0, 3, 1
  v_and_b32 v1, 0x80, v1
  v_add_u32 v10, v10, v1
  v_bfe_i32 v1, v0, 4, 1
  v_and_b32 v1, 0x10, v1
  v_add_u32 v10, v10, v1
  v_bfe_i32 v1, v0, 5, 1
  v_and_b32 v1, 0x100, v1
  v_add_u32 v10, v10, v1
  v_bfe_i32 v1, v0, 6, 1
  v_and_b32 v1, 0x200, v1
  v_add_u32 v10, v10, v1
  v_bfe_i32 v1, v0, 7, 1
  v_and_b32 v1, 0x400, v1
  v_add_u32 v10, v10, v1
  v_mov_b32 v11, 0x0
  v_bfe_i32 v1, v0, 0, 1
  v_and_b32 v1, 0x20, v1
  v_add_u32 v11, v11, v1
  v_bfe_i32 v1, v0, 1, 1
  v_and_b32 v1, 0x40, v1
  v_add_u32 v11, v11, v1
  v_bfe_i32 v1, v0, 2, 1
  v_and_b32 v1, 0x1000, v1
  v_add_u32 v11, v11, v1
  v_bfe_i32 v1, v0, 3, 1
  v_and_b32 v1, 0x2000, v1
  v_add_u32 v11, v11, v1
  v_bfe_i32 v1, v0, 4, 1
  v_and_b32 v1, 0x8, v1
  v_add_u32 v11, v11, v1
  v_bfe_i32 v1, v0, 5, 1
  v_and_b32 v1, 0x10, v1
  v_add_u32 v11, v11, v1
  v_bfe_i32 v1, v0, 6, 1
  v_and_b32 v1, 0x10000, v1
  v_add_u32 v11, v11, v1
  v_bfe_i32 v1, v0, 7, 1
  v_and_b32 v1, 0x20000, v1
  v_add_u32 v11, v11, v1
  v_mov_b32 v20, 0x0
  v_bfe_i32 v1, v0, 0, 1
  v_and_b32 v1, 0x80, v1
  v_add_u32 v20, v20, v1
  v_bfe_i32 v1, v0, 1, 1
  v_and_b32 v1, 0x20, v1
  v_add_u32 v20, v20, v1
  v_bfe_i32 v1, v0, 2, 1
  v_and_b32 v1, 0x40, v1
  v_add_u32 v20, v20, v1
  v_bfe_i32 v1, v0, 3, 1
  v_and_b32 v1, 0x10, v1
  v_add_u32 v20, v20, v1
  v_bfe_i32 v1, v0, 4, 1
  v_and_b32 v1, 0x100, v1
  v_add_u32 v20, v20, v1
  v_bfe_i32 v1, v0, 5, 1
  v_and_b32 v1, 0x200, v1
  v_add_u32 v20, v20, v1
  v_bfe_i32 v1, v0, 6, 1
  v_and_b32 v1, 0x1000, v1
  v_add_u32 v20, v20, v1
  v_mov_b32 v12, 0x0
  v_bfe_i32 v1, v0, 0, 1
  v_and_b32 v1, 0x20, v1
  v_add_u32 v12, v12, v1
  v_bfe_i32 v1, v0, 1, 1
  v_and_b32 v1, 0x100, v1
  v_add_u32 v12, v12, v1
  v_bfe_i32 v1, v0, 2, 1
  v_and_b32 v1, 0x40, v1
  v_add_u32 v12, v12, v1
  v_bfe_i32 v1, v0, 4, 1
  v_and_b32 v1, 0x4, v1
  v_add_u32 v12, v12, v1
  v_bfe_i32 v1, v0, 5, 1
  v_and_b32 v1, 0x80, v1
  v_add_u32 v12, v12, v1
  v_bfe_i32 v1, v0, 6, 1
  v_and_b32 v1, 0x8, v1
  v_add_u32 v12, v12, v1
  v_mov_b32 v14, 0x0
  v_bfe_i32 v1, v0, 0, 1
  v_and_b32 v1, 0x10, v1
  v_add_u32 v14, v14, v1
  v_bfe_i32 v1, v0, 1, 1
  v_and_b32 v1, 0x20, v1
  v_add_u32 v14, v14, v1
  v_bfe_i32 v1, v0, 2, 1
  v_and_b32 v1, 0x40, v1
  v_add_u32 v14, v14, v1
  v_bfe_i32 v1, v0, 3, 1
  v_and_b32 v1, 0x80, v1
  v_add_u32 v14, v14, v1
  v_bfe_i32 v1, v0, 4, 1
  v_and_b32 v1, 0x4, v1
  v_add_u32 v14, v14, v1
  v_bfe_i32 v1, v0, 5, 1
  v_and_b32 v1, 0x8, v1
  v_add_u32 v14, v14, v1
  v_bfe_i32 v1, v0, 6, 1
  v_and_b32 v1, 0x200, v1
  v_add_u32 v14, v14, v1
  v_bfe_i32 v1, v0, 7, 1
  v_and_b32 v1, 0x400, v1
  v_add_u32 v14, v14, v1
  v_mov_b32 v15, 0x0
  v_bfe_i32 v1, v0, 0, 1
  v_and_b32 v1, 0x4, v1
  v_add_u32 v15, v15, v1
  v_bfe_i32 v1, v0, 1, 1
  v_and_b32 v1, 0x8, v1
  v_add_u32 v15, v15, v1
  v_mov_b32 v16, 0x3f803f80
  v_mov_b32 v17, 0x3f803f80
  v_mov_b32 v18, 0x3f803f80
  v_mov_b32 v19, 0x3f803f80
  s_mov_b32 s81, 0x3e0293ee
  s_mov_b32 s82, 0x00ff00ff
  s_mov_b32 s83, 0x00ff00ff
  s_mov_b32 s84, 0xcccccccc
  s_mov_b32 s85, 0xcccccccc
  s_mov_b32 s8, s28
  s_and_b32 s9, s29, 0xffff
  s_mov_b32 s10, 0x400000
  s_mov_b32 s11, 0x20000
  s_mov_b32 s12, s30
  s_and_b32 s13, s31, 0xffff
  s_mov_b32 s14, 0x400000
  s_mov_b32 s15, 0x20000
  s_mov_b32 s16, s32
  s_and_b32 s17, s33, 0xffff
  s_mov_b32 s18, 0x400000
  s_mov_b32 s19, 0x20000
  s_mov_b32 s20, s34
  s_and_b32 s21, s35, 0xffff
  s_mov_b32 s22, 0x400000
  s_mov_b32 s23, 0x20000
  v_mov_b32 v112, 0x0
  v_bfe_i32 v1, v0, 0, 1
  v_and_b32 v1, 0x10, v1
  v_xor_b32 v112, v112, v1
  v_bfe_i32 v1, v0, 1, 1
  v_and_b32 v1, 0x20, v1
  v_xor_b32 v112, v112, v1
  v_bfe_i32 v1, v0, 2, 1
  v_and_b32 v1, 0x40, v1
  v_xor_b32 v112, v112, v1
  v_bfe_i32 v1, v0, 3, 1
  v_and_b32 v1, 0x80, v1
  v_xor_b32 v112, v112, v1
  v_bfe_i32 v1, v0, 4, 1
  v_and_b32 v1, 0x20, v1
  v_xor_b32 v112, v112, v1
  v_mov_b32 v113, 0x40
  v_bfe_i32 v1, v0, 0, 1
  v_and_b32 v1, 0x10, v1
  v_xor_b32 v113, v113, v1
  v_bfe_i32 v1, v0, 1, 1
  v_and_b32 v1, 0x20, v1
  v_xor_b32 v113, v113, v1
  v_bfe_i32 v1, v0, 2, 1
  v_and_b32 v1, 0x40, v1
  v_xor_b32 v113, v113, v1
  v_bfe_i32 v1, v0, 3, 1
  v_and_b32 v1, 0x80, v1
  v_xor_b32 v113, v113, v1
  v_bfe_i32 v1, v0, 4, 1
  v_and_b32 v1, 0x20, v1
  v_xor_b32 v113, v113, v1
  v_mov_b32 v114, 0x80
  v_bfe_i32 v1, v0, 0, 1
  v_and_b32 v1, 0x10, v1
  v_xor_b32 v114, v114, v1
  v_bfe_i32 v1, v0, 1, 1
  v_and_b32 v1, 0x20, v1
  v_xor_b32 v114, v114, v1
  v_bfe_i32 v1, v0, 2, 1
  v_and_b32 v1, 0x40, v1
  v_xor_b32 v114, v114, v1
  v_bfe_i32 v1, v0, 3, 1
  v_and_b32 v1, 0x80, v1
  v_xor_b32 v114, v114, v1
  v_bfe_i32 v1, v0, 4, 1
  v_and_b32 v1, 0x20, v1
  v_xor_b32 v114, v114, v1
  v_mov_b32 v115, 0xc0
  v_bfe_i32 v1, v0, 0, 1
  v_and_b32 v1, 0x10, v1
  v_xor_b32 v115, v115, v1
  v_bfe_i32 v1, v0, 1, 1
  v_and_b32 v1, 0x20, v1
  v_xor_b32 v115, v115, v1
  v_bfe_i32 v1, v0, 2, 1
  v_and_b32 v1, 0x40, v1
  v_xor_b32 v115, v115, v1
  v_bfe_i32 v1, v0, 3, 1
  v_and_b32 v1, 0x80, v1
  v_xor_b32 v115, v115, v1
  v_bfe_i32 v1, v0, 4, 1
  v_and_b32 v1, 0x20, v1
  v_xor_b32 v115, v115, v1
  v_mov_b32 v116, 0x0
  v_bfe_i32 v1, v0, 4, 1
  v_and_b32 v1, 0x2000, v1
  v_add_u32 v116, v116, v1
  v_bfe_i32 v1, v0, 5, 1
  v_and_b32 v1, 0x4000, v1
  v_add_u32 v116, v116, v1
  v_add_u32 v112, v112, v116
  v_add_u32 v113, v113, v116
  v_add_u32 v114, v114, v116
  v_add_u32 v115, v115, v116
  v_mov_b32 v116, 0x8000
  v_bfe_i32 v1, v0, 0, 1
  v_and_b32 v1, 0x8, v1
  v_xor_b32 v116, v116, v1
  v_bfe_i32 v1, v0, 1, 1
  v_and_b32 v1, 0x10, v1
  v_xor_b32 v116, v116, v1
  v_bfe_i32 v1, v0, 2, 1
  v_and_b32 v1, 0x120, v1
  v_xor_b32 v116, v116, v1
  v_bfe_i32 v1, v0, 3, 1
  v_and_b32 v1, 0x880, v1
  v_xor_b32 v116, v116, v1
  v_bfe_i32 v1, v0, 4, 1
  v_and_b32 v1, 0x440, v1
  v_xor_b32 v116, v116, v1
  v_bfe_i32 v1, v0, 5, 1
  v_and_b32 v1, 0x1000, v1
  v_xor_b32 v116, v116, v1
  v_bfe_i32 v1, v0, 6, 1
  v_and_b32 v1, 0x40, v1
  v_xor_b32 v116, v116, v1
  v_bfe_i32 v1, v0, 7, 1
  v_and_b32 v1, 0x80, v1
  v_xor_b32 v116, v116, v1
  v_add_u32 v117, 0x10000, v116
  v_xor_b32 v118, 32, v116
  v_xor_b32 v119, 32, v117
  s_barrier
  s_lshl_b32 s61, s58, 19
  s_lshl_b32 s62, s54, 8
  s_add_u32 s61, s61, s62
  s_add_u32 s61, s61, 0x0
  s_lshl_b32 s62, s58, 14
  s_add_u32 s62, s62, 32768
  s_mov_b32 s63, 0
L_cw_475:
  s_mov_b32 m0, s62
  s_add_u32 s62, s62, 1024
  buffer_load_dwordx4 v112, s[8:11], s61 offen lds
  s_add_u32 s61, s61, 32768
  s_mov_b32 m0, s62
  s_add_u32 s62, s62, 1024
  buffer_load_dwordx4 v113, s[8:11], s61 offen lds
  s_add_u32 s61, s61, 32768
  s_mov_b32 m0, s62
  s_add_u32 s62, s62, 1024
  buffer_load_dwordx4 v114, s[8:11], s61 offen lds
  s_add_u32 s61, s61, 32768
  s_mov_b32 m0, s62
  s_add_u32 s62, s62, 1024
  buffer_load_dwordx4 v115, s[8:11], s61 offen lds
  s_add_u32 s61, s61, 32768
  s_add_u32 s63, s63, 1
  s_cmp_lt_u32 s63, 4
  s_cbranch_scc1 L_cw_475
  s_lshl_b32 s61, s58, 19
  s_lshl_b32 s62, s54, 8
  s_add_u32 s61, s61, s62
  s_add_u32 s61, s61, 0x200000
  s_lshl_b32 s62, s58, 14
  s_add_u32 s62, s62, 98304
  s_mov_b32 s63, 0
L_cw_476:
  s_mov_b32 m0, s62
  s_add_u32 s62, s62, 1024
  buffer_load_dwordx4 v112, s[8:11], s61 offen lds
  s_add_u32 s61, s61, 32768
  s_mov_b32 m0, s62
  s_add_u32 s62, s62, 1024
  buffer_load_dwordx4 v113, s[8:11], s61 offen lds
  s_add_u32 s61, s61, 32768
  s_mov_b32 m0, s62
  s_add_u32 s62, s62, 1024
  buffer_load_dwordx4 v114, s[8:11], s61 offen lds
  s_add_u32 s61, s61, 32768
  s_mov_b32 m0, s62
  s_add_u32 s62, s62, 1024
  buffer_load_dwordx4 v115, s[8:11], s61 offen lds
  s_add_u32 s61, s61, 32768
  s_add_u32 s63, s63, 1
  s_cmp_lt_u32 s63, 4
  s_cbranch_scc1 L_cw_476
  s_waitcnt vmcnt(16)
  s_barrier
  ds_read_b64_tr_b16 a[0:1], v116 offset:0
  ds_read_b64_tr_b16 a[2:3], v116 offset:512
  ds_read_b64_tr_b16 a[4:5], v116 offset:8192
  ds_read_b64_tr_b16 a[6:7], v116 offset:8704
  ds_read_b64_tr_b16 a[8:9], v116 offset:16384
  ds_read_b64_tr_b16 a[10:11], v116 offset:16896
  ds_read_b64_tr_b16 a[12:13], v116 offset:24576
  ds_read_b64_tr_b16 a[14:15], v116 offset:25088
  s_waitcnt lgkmcnt(4)
  ds_read_b64_tr_b16 a[16:17], v116 offset:32768
  ds_read_b64_tr_b16 a[18:19], v116 offset:33280
  ds_read_b64_tr_b16 a[20:21], v116 offset:40960
  ds_read_b64_tr_b16 a[22:23], v116 offset:41472
  ds_read_b64_tr_b16 a[24:25], v116 offset:49152
  ds_read_b64_tr_b16 a[26:27], v116 offset:49664
  ds_read_b64_tr_b16 a[28:29], v116 offset:57344
  ds_read_b64_tr_b16 a[30:31], v116 offset:57856
  s_waitcnt lgkmcnt(4)
  ds_read_b64_tr_b16 a[64:65], v118 offset:0
  ds_read_b64_tr_b16 a[66:67], v118 offset:512
  ds_read_b64_tr_b16 a[68:69], v118 offset:8192
  ds_read_b64_tr_b16 a[70:71], v118 offset:8704
  ds_read_b64_tr_b16 a[72:73], v118 offset:16384
  ds_read_b64_tr_b16 a[74:75], v118 offset:16896
  ds_read_b64_tr_b16 a[76:77], v118 offset:24576
  ds_read_b64_tr_b16 a[78:79], v118 offset:25088
  s_waitcnt lgkmcnt(4)
  ds_read_b64_tr_b16 a[80:81], v118 offset:32768
  ds_read_b64_tr_b16 a[82:83], v118 offset:33280
  ds_read_b64_tr_b16 a[84:85], v118 offset:40960
  ds_read_b64_tr_b16 a[86:87], v118 offset:41472
  ds_read_b64_tr_b16 a[88:89], v118 offset:49152
  ds_read_b64_tr_b16 a[90:91], v118 offset:49664
  ds_read_b64_tr_b16 a[92:93], v118 offset:57344
  ds_read_b64_tr_b16 a[94:95], v118 offset:57856
  s_waitcnt lgkmcnt(4)
  s_waitcnt lgkmcnt(0)
  s_barrier
  s_lshl_b32 s61, s58, 19
  s_lshl_b32 s62, s54, 8
  s_add_u32 s61, s61, s62
  s_add_u32 s61, s61, 0x0
  s_lshl_b32 s62, s58, 14
  s_add_u32 s62, s62, 32768
  s_mov_b32 s63, 0
L_cw_477:
  s_mov_b32 m0, s62
  s_add_u32 s62, s62, 1024
  buffer_load_dwordx4 v112, s[12:15], s61 offen lds
  s_add_u32 s61, s61, 32768
  s_mov_b32 m0, s62
  s_add_u32 s62, s62, 1024
  buffer_load_dwordx4 v113, s[12:15], s61 offen lds
  s_add_u32 s61, s61, 32768
  s_mov_b32 m0, s62
  s_add_u32 s62, s62, 1024
  buffer_load_dwordx4 v114, s[12:15], s61 offen lds
  s_add_u32 s61, s61, 32768
  s_mov_b32 m0, s62
  s_add_u32 s62, s62, 1024
  buffer_load_dwordx4 v115, s[12:15], s61 offen lds
  s_add_u32 s61, s61, 32768
  s_add_u32 s63, s63, 1
  s_cmp_lt_u32 s63, 4
  s_cbranch_scc1 L_cw_477
  s_waitcnt vmcnt(16)
  s_barrier
  ds_read_b64_tr_b16 a[32:33], v117 offset:0
  ds_read_b64_tr_b16 a[34:35], v117 offset:512
  ds_read_b64_tr_b16 a[36:37], v117 offset:8192
  ds_read_b64_tr_b16 a[38:39], v117 offset:8704
  ds_read_b64_tr_b16 a[40:41], v117 offset:16384
  ds_read_b64_tr_b16 a[42:43], v117 offset:16896
  ds_read_b64_tr_b16 a[44:45], v117 offset:24576
  ds_read_b64_tr_b16 a[46:47], v117 offset:25088
  s_waitcnt lgkmcnt(4)
  ds_read_b64_tr_b16 a[48:49], v117 offset:32768
  ds_read_b64_tr_b16 a[50:51], v117 offset:33280
  ds_read_b64_tr_b16 a[52:53], v117 offset:40960
  ds_read_b64_tr_b16 a[54:55], v117 offset:41472
  ds_read_b64_tr_b16 a[56:57], v117 offset:49152
  ds_read_b64_tr_b16 a[58:59], v117 offset:49664
  ds_read_b64_tr_b16 a[60:61], v117 offset:57344
  ds_read_b64_tr_b16 a[62:63], v117 offset:57856
  s_waitcnt lgkmcnt(4)
  ds_read_b64_tr_b16 a[96:97], v119 offset:0
  ds_read_b64_tr_b16 a[98:99], v119 offset:512
  ds_read_b64_tr_b16 a[100:101], v119 offset:8192
  ds_read_b64_tr_b16 a[102:103], v119 offset:8704
  ds_read_b64_tr_b16 a[104:105], v119 offset:16384
  ds_read_b64_tr_b16 a[106:107], v119 offset:16896
  ds_read_b64_tr_b16 a[108:109], v119 offset:24576
  ds_read_b64_tr_b16 a[110:111], v119 offset:25088
  s_waitcnt lgkmcnt(4)
  ds_read_b64_tr_b16 a[112:113], v119 offset:32768
  ds_read_b64_tr_b16 a[114:115], v119 offset:33280
  ds_read_b64_tr_b16 a[116:117], v119 offset:40960
  ds_read_b64_tr_b16 a[118:119], v119 offset:41472
  ds_read_b64_tr_b16 a[120:121], v119 offset:49152
  ds_read_b64_tr_b16 a[122:123], v119 offset:49664
  ds_read_b64_tr_b16 a[124:125], v119 offset:57344
  ds_read_b64_tr_b16 a[126:127], v119 offset:57856
  s_waitcnt lgkmcnt(4)
  s_waitcnt lgkmcnt(0)
  s_barrier
  s_lshl_b32 s61, s58, 19
  s_lshl_b32 s62, s54, 8
  s_add_u32 s61, s61, s62
  s_add_u32 s61, s61, 0x200000
  s_lshl_b32 s62, s58, 14
  s_add_u32 s62, s62, 98304
  s_mov_b32 s63, 0
L_cw_478:
  s_mov_b32 m0, s62
  s_add_u32 s62, s62, 1024
  buffer_load_dwordx4 v112, s[12:15], s61 offen lds
  s_add_u32 s61, s61, 32768
  s_mov_b32 m0, s62
  s_add_u32 s62, s62, 1024
  buffer_load_dwordx4 v113, s[12:15], s61 offen lds
  s_add_u32 s61, s61, 32768
  s_mov_b32 m0, s62
  s_add_u32 s62, s62, 1024
  buffer_load_dwordx4 v114, s[12:15], s61 offen lds
  s_add_u32 s61, s61, 32768
  s_mov_b32 m0, s62
  s_add_u32 s62, s62, 1024
  buffer_load_dwordx4 v115, s[12:15], s61 offen lds
  s_add_u32 s61, s61, 32768
  s_add_u32 s63, s63, 1
  s_cmp_lt_u32 s63, 4
  s_cbranch_scc1 L_cw_478
  s_waitcnt vmcnt(16)
  s_barrier
  ds_read_b64_tr_b16 a[128:129], v116 offset:0
  ds_read_b64_tr_b16 a[130:131], v116 offset:512
  ds_read_b64_tr_b16 a[132:133], v116 offset:8192
  ds_read_b64_tr_b16 a[134:135], v116 offset:8704
  ds_read_b64_tr_b16 a[136:137], v116 offset:16384
  ds_read_b64_tr_b16 a[138:139], v116 offset:16896
  ds_read_b64_tr_b16 a[140:141], v116 offset:24576
  ds_read_b64_tr_b16 a[142:143], v116 offset:25088
  s_waitcnt lgkmcnt(4)
  ds_read_b64_tr_b16 a[144:145], v116 offset:32768
  ds_read_b64_tr_b16 a[146:147], v116 offset:33280
  ds_read_b64_tr_b16 a[148:149], v116 offset:40960
  ds_read_b64_tr_b16 a[150:151], v116 offset:41472
  ds_read_b64_tr_b16 a[152:153], v116 offset:49152
  ds_read_b64_tr_b16 a[154:155], v116 offset:49664
  ds_read_b64_tr_b16 a[156:157], v116 offset:57344
  ds_read_b64_tr_b16 a[158:159], v116 offset:57856
  s_waitcnt lgkmcnt(4)
  ds_read_b64_tr_b16 a[192:193], v118 offset:0
  ds_read_b64_tr_b16 a[194:195], v118 offset:512
  ds_read_b64_tr_b16 a[196:197], v118 offset:8192
  ds_read_b64_tr_b16 a[198:199], v118 offset:8704
  ds_read_b64_tr_b16 a[200:201], v118 offset:16384
  ds_read_b64_tr_b16 a[202:203], v118 offset:16896
  ds_read_b64_tr_b16 a[204:205], v118 offset:24576
  ds_read_b64_tr_b16 a[206:207], v118 offset:25088
  s_waitcnt lgkmcnt(4)
  ds_read_b64_tr_b16 a[208:209], v118 offset:32768
  ds_read_b64_tr_b16 a[210:211], v118 offset:33280
  ds_read_b64_tr_b16 a[212:213], v118 offset:40960
  ds_read_b64_tr_b16 a[214:215], v118 offset:41472
  ds_read_b64_tr_b16 a[216:217], v118 offset:49152
  ds_read_b64_tr_b16 a[218:219], v118 offset:49664
  ds_read_b64_tr_b16 a[220:221], v118 offset:57344
  ds_read_b64_tr_b16 a[222:223], v118 offset:57856
  s_waitcnt lgkmcnt(4)
  s_waitcnt lgkmcnt(0)
  s_barrier
  s_lshl_b32 s61, s58, 19
  s_lshl_b32 s62, s54, 8
  s_add_u32 s61, s61, s62
  s_add_u32 s61, s61, 0x0
  s_lshl_b32 s62, s58, 14
  s_add_u32 s62, s62, 32768
  s_mov_b32 s63, 0
L_cw_479:
  s_mov_b32 m0, s62
  s_add_u32 s62, s62, 1024
  buffer_load_dwordx4 v112, s[16:19], s61 offen lds
  s_add_u32 s61, s61, 32768
  s_mov_b32 m0, s62
  s_add_u32 s62, s62, 1024
  buffer_load_dwordx4 v113, s[16:19], s61 offen lds
  s_add_u32 s61, s61, 32768
  s_mov_b32 m0, s62
  s_add_u32 s62, s62, 1024
  buffer_load_dwordx4 v114, s[16:19], s61 offen lds
  s_add_u32 s61, s61, 32768
  s_mov_b32 m0, s62
  s_add_u32 s62, s62, 1024
  buffer_load_dwordx4 v115, s[16:19], s61 offen lds
  s_add_u32 s61, s61, 32768
  s_add_u32 s63, s63, 1
  s_cmp_lt_u32 s63, 4
  s_cbranch_scc1 L_cw_479
  s_waitcnt vmcnt(16)
  s_barrier
  ds_read_b64_tr_b16 a[160:161], v117 offset:0
  ds_read_b64_tr_b16 a[162:163], v117 offset:512
  ds_read_b64_tr_b16 a[164:165], v117 offset:8192
  ds_read_b64_tr_b16 a[166:167], v117 offset:8704
  ds_read_b64_tr_b16 a[168:169], v117 offset:16384
  ds_read_b64_tr_b16 a[170:171], v117 offset:16896
  ds_read_b64_tr_b16 a[172:173], v117 offset:24576
  ds_read_b64_tr_b16 a[174:175], v117 offset:25088
  s_waitcnt lgkmcnt(4)
  ds_read_b64_tr_b16 a[176:177], v117 offset:32768
  ds_read_b64_tr_b16 a[178:179], v117 offset:33280
  ds_read_b64_tr_b16 a[180:181], v117 offset:40960
  ds_read_b64_tr_b16 a[182:183], v117 offset:41472
  ds_read_b64_tr_b16 a[184:185], v117 offset:49152
  ds_read_b64_tr_b16 a[186:187], v117 offset:49664
  ds_read_b64_tr_b16 a[188:189], v117 offset:57344
  ds_read_b64_tr_b16 a[190:191], v117 offset:57856
  s_waitcnt lgkmcnt(4)
  ds_read_b64_tr_b16 a[224:225], v119 offset:0
  ds_read_b64_tr_b16 a[226:227], v119 offset:512
  ds_read_b64_tr_b16 a[228:229], v119 offset:8192
  ds_read_b64_tr_b16 a[230:231], v119 offset:8704
  ds_read_b64_tr_b16 a[232:233], v119 offset:16384
  ds_read_b64_tr_b16 a[234:235], v119 offset:16896
  ds_read_b64_tr_b16 a[236:237], v119 offset:24576
  ds_read_b64_tr_b16 a[238:239], v119 offset:25088
  s_waitcnt lgkmcnt(4)
  ds_read_b64_tr_b16 a[240:241], v119 offset:32768
  ds_read_b64_tr_b16 a[242:243], v119 offset:33280
  ds_read_b64_tr_b16 a[244:245], v119 offset:40960
  ds_read_b64_tr_b16 a[246:247], v119 offset:41472
  ds_read_b64_tr_b16 a[248:249], v119 offset:49152
  ds_read_b64_tr_b16 a[250:251], v119 offset:49664
  ds_read_b64_tr_b16 a[252:253], v119 offset:57344
  ds_read_b64_tr_b16 a[254:255], v119 offset:57856
  s_waitcnt lgkmcnt(4)
  s_waitcnt lgkmcnt(0)
  s_barrier
  s_lshl_b32 s61, s58, 19
  s_lshl_b32 s62, s54, 8
  s_add_u32 s61, s61, s62
  s_add_u32 s61, s61, 0x200000
  s_lshl_b32 s62, s58, 14
  s_add_u32 s62, s62, 98304
  s_mov_b32 s63, 0
L_cw_480:
  s_mov_b32 m0, s62
  s_add_u32 s62, s62, 1024
  buffer_load_dwordx4 v112, s[16:19], s61 offen lds
  s_add_u32 s61, s61, 32768
  s_mov_b32 m0, s62
  s_add_u32 s62, s62, 1024
  buffer_load_dwordx4 v113, s[16:19], s61 offen lds
  s_add_u32 s61, s61, 32768
  s_mov_b32 m0, s62
  s_add_u32 s62, s62, 1024
  buffer_load_dwordx4 v114, s[16:19], s61 offen lds
  s_add_u32 s61, s61, 32768
  s_mov_b32 m0, s62
  s_add_u32 s62, s62, 1024
  buffer_load_dwordx4 v115, s[16:19], s61 offen lds
  s_add_u32 s61, s61, 32768
  s_add_u32 s63, s63, 1
  s_cmp_lt_u32 s63, 4
  s_cbranch_scc1 L_cw_480
  s_waitcnt vmcnt(16)
  s_barrier
  ds_read_b64_tr_b16 v[128:129], v116 offset:0
  ds_read_b64_tr_b16 v[130:131], v116 offset:512
  ds_read_b64_tr_b16 v[132:133], v116 offset:8192
  ds_read_b64_tr_b16 v[134:135], v116 offset:8704
  ds_read_b64_tr_b16 v[136:137], v116 offset:16384
  ds_read_b64_tr_b16 v[138:139], v116 offset:16896
  ds_read_b64_tr_b16 v[140:141], v116 offset:24576
  ds_read_b64_tr_b16 v[142:143], v116 offset:25088
  s_waitcnt lgkmcnt(4)
  ds_read_b64_tr_b16 v[144:145], v116 offset:32768
  ds_read_b64_tr_b16 v[146:147], v116 offset:33280
  ds_read_b64_tr_b16 v[148:149], v116 offset:40960
  ds_read_b64_tr_b16 v[150:151], v116 offset:41472
  ds_read_b64_tr_b16 v[152:153], v116 offset:49152
  ds_read_b64_tr_b16 v[154:155], v116 offset:49664
  ds_read_b64_tr_b16 v[156:157], v116 offset:57344
  ds_read_b64_tr_b16 v[158:159], v116 offset:57856
  s_waitcnt lgkmcnt(4)
  ds_read_b64_tr_b16 v[44:45], v118 offset:0
  ds_read_b64_tr_b16 v[46:47], v118 offset:512
  ds_read_b64_tr_b16 v[48:49], v118 offset:8192
  ds_read_b64_tr_b16 v[50:51], v118 offset:8704
  ds_read_b64_tr_b16 v[52:53], v118 offset:16384
  ds_read_b64_tr_b16 v[54:55], v118 offset:16896
  ds_read_b64_tr_b16 v[56:57], v118 offset:24576
  ds_read_b64_tr_b16 v[58:59], v118 offset:25088
  s_waitcnt lgkmcnt(4)
  ds_read_b64_tr_b16 v[60:61], v118 offset:32768
  ds_read_b64_tr_b16 v[62:63], v118 offset:33280
  ds_read_b64_tr_b16 v[64:65], v118 offset:40960
  ds_read_b64_tr_b16 v[66:67], v118 offset:41472
  ds_read_b64_tr_b16 v[68:69], v118 offset:49152
  ds_read_b64_tr_b16 v[70:71], v118 offset:49664
  ds_read_b64_tr_b16 v[72:73], v118 offset:57344
  ds_read_b64_tr_b16 v[74:75], v118 offset:57856
  s_waitcnt lgkmcnt(4)
  s_waitcnt lgkmcnt(0)
  s_barrier
  s_waitcnt vmcnt(0)
  s_barrier
  ds_read_b64_tr_b16 v[160:161], v117 offset:0
  ds_read_b64_tr_b16 v[162:163], v117 offset:512
  ds_read_b64_tr_b16 v[164:165], v117 offset:8192
  ds_read_b64_tr_b16 v[166:167], v117 offset:8704
  ds_read_b64_tr_b16 v[168:169], v117 offset:16384
  ds_read_b64_tr_b16 v[170:171], v117 offset:16896
  ds_read_b64_tr_b16 v[172:173], v117 offset:24576
  ds_read_b64_tr_b16 v[174:175], v117 offset:25088
  s_waitcnt lgkmcnt(4)
  ds_read_b64_tr_b16 v[176:177], v117 offset:32768
  ds_read_b64_tr_b16 v[178:179], v117 offset:33280
  ds_read_b64_tr_b16 v[180:181], v117 offset:40960
  ds_read_b64_tr_b16 v[182:183], v117 offset:41472
  ds_read_b64_tr_b16 v[184:185], v117 offset:49152
  ds_read_b64_tr_b16 v[186:187], v117 offset:49664
  ds_read_b64_tr_b16 v[188:189], v117 offset:57344
  ds_read_b64_tr_b16 v[190:191], v117 offset:57856
  s_waitcnt lgkmcnt(4)
  ds_read_b64_tr_b16 v[76:77], v119 offset:0
  ds_read_b64_tr_b16 v[78:79], v119 offset:512
  ds_read_b64_tr_b16 v[80:81], v119 offset:8192
  ds_read_b64_tr_b16 v[82:83], v119 offset:8704
  ds_read_b64_tr_b16 v[84:85], v119 offset:16384
  ds_read_b64_tr_b16 v[86:87], v119 offset:16896
  ds_read_b64_tr_b16 v[88:89], v119 offset:24576
  ds_read_b64_tr_b16 v[90:91], v119 offset:25088
  s_waitcnt lgkmcnt(4)
  ds_read_b64_tr_b16 v[92:93], v119 offset:32768
  ds_read_b64_tr_b16 v[94:95], v119 offset:33280
  ds_read_b64_tr_b16 v[96:97], v119 offset:40960
  ds_read_b64_tr_b16 v[98:99], v119 offset:41472
  ds_read_b64_tr_b16 v[100:101], v119 offset:49152
  ds_read_b64_tr_b16 v[102:103], v119 offset:49664
  ds_read_b64_tr_b16 v[104:105], v119 offset:57344
  ds_read_b64_tr_b16 v[106:107], v119 offset:57856
  s_waitcnt lgkmcnt(4)
  s_waitcnt lgkmcnt(0)
  s_barrier
  v_mov_b32 v112, 0x0
  v_bfe_i32 v1, v0, 0, 1
  v_and_b32 v1, 0x10, v1
  v_add_u32 v112, v112, v1
  v_bfe_i32 v1, v0, 1, 1
  v_and_b32 v1, 0x20, v1
  v_add_u32 v112, v112, v1
  v_bfe_i32 v1, v0, 2, 1
  v_and_b32 v1, 0x40, v1
  v_add_u32 v112, v112, v1
  v_bfe_i32 v1, v0, 3, 1
  v_and_b32 v1, 0x80, v1
  v_add_u32 v112, v112, v1
  v_bfe_i32 v1, v0, 4, 1
  v_and_b32 v1, 0x100, v1
  v_add_u32 v112, v112, v1
  v_bfe_i32 v1, v0, 5, 1
  v_and_b32 v1, 0x200, v1
  v_add_u32 v112, v112, v1
  v_mov_b32 v116, 0x18000
  v_bfe_i32 v1, v0, 0, 1
  v_and_b32 v1, 0x8, v1
  v_add_u32 v116, v116, v1
  v_bfe_i32 v1, v0, 1, 1
  v_and_b32 v1, 0x10, v1
  v_add_u32 v116, v116, v1
  v_bfe_i32 v1, v0, 2, 1
  v_and_b32 v1, 0x420, v1
  v_add_u32 v116, v116, v1
  v_bfe_i32 v1, v0, 3, 1
  v_and_b32 v1, 0x1040, v1
  v_add_u32 v116, v116, v1
  v_bfe_i32 v1, v0, 4, 1
  v_and_b32 v1, 0x4080, v1
  v_add_u32 v116, v116, v1
  v_bfe_i32 v1, v0, 5, 1
  v_and_b32 v1, 0x2000, v1
  v_add_u32 v116, v116, v1
  v_bfe_i32 v1, v0, 6, 1
  v_and_b32 v1, 0x100, v1
  v_add_u32 v116, v116, v1
  v_bfe_i32 v1, v0, 7, 1
  v_and_b32 v1, 0x200, v1
  v_add_u32 v116, v116, v1
  s_barrier
  s_lshl_b32 s61, s54, 17
  s_lshl_b32 s62, s58, 14
  s_add_u32 s61, s61, s62
  s_add_u32 s61, s61, 0
  s_add_u32 s62, s62, 98304
  s_and_b32 s64, s58, 1
  s_lshl_b32 s64, s64, 7
  s_or_b32 s63, s64, 0
  v_xor_b32 v113, s63, v112
  s_mov_b32 m0, s62
  s_add_u32 s62, s62, 1024
  buffer_load_dwordx4 v113, s[20:23], s61 offen lds
  s_add_u32 s61, s61, 1024
  s_or_b32 s63, s64, 32
  v_xor_b32_e64 v114, s63, v112
  s_mov_b32 m0, s62
  s_add_u32 s62, s62, 1024
  buffer_load_dwordx4 v114, s[20:23], s61 offen lds
  s_add_u32 s61, s61, 1024
  s_or_b32 s63, s64, 0
  v_xor_b32_e64 v113, s63, v112
  s_mov_b32 m0, s62
  s_add_u32 s62, s62, 1024
  buffer_load_dwordx4 v113, s[20:23], s61 offen lds
  s_add_u32 s61, s61, 1024
  s_or_b32 s63, s64, 32
  v_xor_b32_e64 v114, s63, v112
  s_mov_b32 m0, s62
  s_add_u32 s62, s62, 1024
  buffer_load_dwordx4 v114, s[20:23], s61 offen lds
  s_add_u32 s61, s61, 1024
  s_or_b32 s63, s64, 64
  v_xor_b32_e64 v113, s63, v112
  s_mov_b32 m0, s62
  s_add_u32 s62, s62, 1024
  buffer_load_dwordx4 v113, s[20:23], s61 offen lds
  s_add_u32 s61, s61, 1024
  s_or_b32 s63, s64, 96
  v_xor_b32 v114, s63, v112
  s_mov_b32 m0, s62
  s_add_u32 s62, s62, 1024
  buffer_load_dwordx4 v114, s[20:23], s61 offen lds
  s_add_u32 s61, s61, 1024
  s_or_b32 s63, s64, 64
  v_xor_b32_e64 v113, s63, v112
  s_mov_b32 m0, s62
  s_add_u32 s62, s62, 1024
  buffer_load_dwordx4 v113, s[20:23], s61 offen lds
  s_add_u32 s61, s61, 1024
  s_or_b32 s63, s64, 96
  v_xor_b32 v114, s63, v112
  s_mov_b32 m0, s62
  s_add_u32 s62, s62, 1024
  buffer_load_dwordx4 v114, s[20:23], s61 offen lds
  s_add_u32 s61, s61, 1024
  s_or_b32 s63, s64, 0
  v_xor_b32_e64 v113, s63, v112
  s_mov_b32 m0, s62
  s_add_u32 s62, s62, 1024
  buffer_load_dwordx4 v113, s[20:23], s61 offen lds
  s_add_u32 s61, s61, 1024
  s_or_b32 s63, s64, 32
  v_xor_b32_e64 v114, s63, v112
  s_mov_b32 m0, s62
  s_add_u32 s62, s62, 1024
  buffer_load_dwordx4 v114, s[20:23], s61 offen lds
  s_add_u32 s61, s61, 1024
  s_or_b32 s63, s64, 0
  v_xor_b32_e64 v113, s63, v112
  s_mov_b32 m0, s62
  s_add_u32 s62, s62, 1024
  buffer_load_dwordx4 v113, s[20:23], s61 offen lds
  s_add_u32 s61, s61, 1024
  s_or_b32 s63, s64, 32
  v_xor_b32_e64 v114, s63, v112
  s_mov_b32 m0, s62
  s_add_u32 s62, s62, 1024
  buffer_load_dwordx4 v114, s[20:23], s61 offen lds
  s_add_u32 s61, s61, 1024
  s_or_b32 s63, s64, 64
  v_xor_b32_e64 v113, s63, v112
  s_mov_b32 m0, s62
  s_add_u32 s62, s62, 1024
  buffer_load_dwordx4 v113, s[20:23], s61 offen lds
  s_add_u32 s61, s61, 1024
  s_or_b32 s63, s64, 96
  v_xor_b32 v114, s63, v112
  s_mov_b32 m0, s62
  s_add_u32 s62, s62, 1024
  buffer_load_dwordx4 v114, s[20:23], s61 offen lds
  s_add_u32 s61, s61, 1024
  s_or_b32 s63, s64, 64
  v_xor_b32_e64 v113, s63, v112
  s_mov_b32 m0, s62
  s_add_u32 s62, s62, 1024
  buffer_load_dwordx4 v113, s[20:23], s61 offen lds
  s_add_u32 s61, s61, 1024
  s_or_b32 s63, s64, 96
  v_xor_b32 v114, s63, v112
  s_mov_b32 m0, s62
  s_add_u32 s62, s62, 1024
  buffer_load_dwordx4 v114, s[20:23], s61 offen lds
  s_add_u32 s61, s61, 1024
  ds_write_b128 v5, v[44:47] offset:32768
  ds_write_b128 v5, v[48:51] offset:33792
  ds_write_b128 v5, v[52:55] offset:34816
  ds_write_b128 v5, v[56:59] offset:35840
  ds_write_b128 v5, v[60:63] offset:36864
  ds_write_b128 v5, v[64:67] offset:37888
  ds_write_b128 v5, v[68:71] offset:38912
  ds_write_b128 v5, v[72:75] offset:39936
  ds_write_b128 v5, v[76:79] offset:40960
  ds_write_b128 v5, v[80:83] offset:41984
  ds_write_b128 v5, v[84:87] offset:43008
  ds_write_b128 v5, v[88:91] offset:44032
  ds_write_b128 v5, v[92:95] offset:45056
  ds_write_b128 v5, v[96:99] offset:46080
  ds_write_b128 v5, v[100:103] offset:47104
  ds_write_b128 v5, v[104:107] offset:48128
  s_waitcnt lgkmcnt(0)
  s_waitcnt vmcnt(0)
  s_barrier
  v_xor_b32 v117, 0, v116
  ds_read_b64_tr_b16 v[192:193], v117 offset:0
  ds_read_b64_tr_b16 v[194:195], v117 offset:2048
  ds_read_b64_tr_b16 v[196:197], v117 offset:32768
  ds_read_b64_tr_b16 v[198:199], v117 offset:34816
  s_waitcnt lgkmcnt(0)
  v_xor_b32 v117, 32, v116
  ds_read_b64_tr_b16 v[208:209], v117 offset:0
  ds_read_b64_tr_b16 v[210:211], v117 offset:2048
  ds_read_b64_tr_b16 v[212:213], v117 offset:32768
  ds_read_b64_tr_b16 v[214:215], v117 offset:34816
  s_waitcnt lgkmcnt(0)
  v_xor_b32 v117, 64, v116
  ds_read_b64_tr_b16 v[224:225], v117 offset:0
  ds_read_b64_tr_b16 v[226:227], v117 offset:2048
  ds_read_b64_tr_b16 v[228:229], v117 offset:32768
  ds_read_b64_tr_b16 v[230:231], v117 offset:34816
  s_waitcnt lgkmcnt(0)
  v_xor_b32 v117, 96, v116
  ds_read_b64_tr_b16 v[240:241], v117 offset:0
  ds_read_b64_tr_b16 v[242:243], v117 offset:2048
  ds_read_b64_tr_b16 v[244:245], v117 offset:32768
  ds_read_b64_tr_b16 v[246:247], v117 offset:34816
  s_waitcnt lgkmcnt(0)
  v_xor_b32 v117, 128, v116
  ds_read_b64_tr_b16 v[44:45], v117 offset:0
  ds_read_b64_tr_b16 v[46:47], v117 offset:2048
  ds_read_b64_tr_b16 v[48:49], v117 offset:32768
  ds_read_b64_tr_b16 v[50:51], v117 offset:34816
  s_waitcnt lgkmcnt(0)
  v_xor_b32 v117, 160, v116
  ds_read_b64_tr_b16 v[60:61], v117 offset:0
  ds_read_b64_tr_b16 v[62:63], v117 offset:2048
  ds_read_b64_tr_b16 v[64:65], v117 offset:32768
  ds_read_b64_tr_b16 v[66:67], v117 offset:34816
  s_waitcnt lgkmcnt(0)
  v_xor_b32 v117, 192, v116
  ds_read_b64_tr_b16 v[76:77], v117 offset:0
  ds_read_b64_tr_b16 v[78:79], v117 offset:2048
  ds_read_b64_tr_b16 v[80:81], v117 offset:32768
  ds_read_b64_tr_b16 v[82:83], v117 offset:34816
  s_waitcnt lgkmcnt(0)
  v_xor_b32 v117, 224, v116
  ds_read_b64_tr_b16 v[92:93], v117 offset:0
  ds_read_b64_tr_b16 v[94:95], v117 offset:2048
  ds_read_b64_tr_b16 v[96:97], v117 offset:32768
  ds_read_b64_tr_b16 v[98:99], v117 offset:34816
  s_waitcnt lgkmcnt(0)
  s_barrier
  s_lshl_b32 s61, s54, 17
  s_lshl_b32 s62, s58, 14
  s_add_u32 s61, s61, s62
  s_add_u32 s61, s61, 65536
  s_add_u32 s62, s62, 98304
  s_and_b32 s64, s58, 1
  s_lshl_b32 s64, s64, 7
  s_or_b32 s63, s64, 0
  v_xor_b32_e64 v113, s63, v112
  s_mov_b32 m0, s62
  s_add_u32 s62, s62, 1024
  buffer_load_dwordx4 v113, s[20:23], s61 offen lds
  s_add_u32 s61, s61, 1024
  s_or_b32 s63, s64, 32
  v_xor_b32_e64 v114, s63, v112
  s_mov_b32 m0, s62
  s_add_u32 s62, s62, 1024
  buffer_load_dwordx4 v114, s[20:23], s61 offen lds
  s_add_u32 s61, s61, 1024
  s_or_b32 s63, s64, 0
  v_xor_b32_e64 v113, s63, v112
  s_mov_b32 m0, s62
  s_add_u32 s62, s62, 1024
  buffer_load_dwordx4 v113, s[20:23], s61 offen lds
  s_add_u32 s61, s61, 1024
  s_or_b32 s63, s64, 32
  v_xor_b32_e64 v114, s63, v112
  s_mov_b32 m0, s62
  s_add_u32 s62, s62, 1024
  buffer_load_dwordx4 v114, s[20:23], s61 offen lds
  s_add_u32 s61, s61, 1024
  s_or_b32 s63, s64, 64
  v_xor_b32_e64 v113, s63, v112
  s_mov_b32 m0, s62
  s_add_u32 s62, s62, 1024
  buffer_load_dwordx4 v113, s[20:23], s61 offen lds
  s_add_u32 s61, s61, 1024
  s_or_b32 s63, s64, 96
  v_xor_b32 v114, s63, v112
  s_mov_b32 m0, s62
  s_add_u32 s62, s62, 1024
  buffer_load_dwordx4 v114, s[20:23], s61 offen lds
  s_add_u32 s61, s61, 1024
  s_or_b32 s63, s64, 64
  v_xor_b32_e64 v113, s63, v112
  s_mov_b32 m0, s62
  s_add_u32 s62, s62, 1024
  buffer_load_dwordx4 v113, s[20:23], s61 offen lds
  s_add_u32 s61, s61, 1024
  s_or_b32 s63, s64, 96
  v_xor_b32 v114, s63, v112
  s_mov_b32 m0, s62
  s_add_u32 s62, s62, 1024
  buffer_load_dwordx4 v114, s[20:23], s61 offen lds
  s_add_u32 s61, s61, 1024
  s_or_b32 s63, s64, 0
  v_xor_b32_e64 v113, s63, v112
  s_mov_b32 m0, s62
  s_add_u32 s62, s62, 1024
  buffer_load_dwordx4 v113, s[20:23], s61 offen lds
  s_add_u32 s61, s61, 1024
  s_or_b32 s63, s64, 32
  v_xor_b32_e64 v114, s63, v112
  s_mov_b32 m0, s62
  s_add_u32 s62, s62, 1024
  buffer_load_dwordx4 v114, s[20:23], s61 offen lds
  s_add_u32 s61, s61, 1024
  s_or_b32 s63, s64, 0
  v_xor_b32_e64 v113, s63, v112
  s_mov_b32 m0, s62
  s_add_u32 s62, s62, 1024
  buffer_load_dwordx4 v113, s[20:23], s61 offen lds
  s_add_u32 s61, s61, 1024
  s_or_b32 s63, s64, 32
  v_xor_b32_e64 v114, s63, v112
  s_mov_b32 m0, s62
  s_add_u32 s62, s62, 1024
  buffer_load_dwordx4 v114, s[20:23], s61 offen lds
  s_add_u32 s61, s61, 1024
  s_or_b32 s63, s64, 64
  v_xor_b32_e64 v113, s63, v112
  s_mov_b32 m0, s62
  s_add_u32 s62, s62, 1024
  buffer_load_dwordx4 v113, s[20:23], s61 offen lds
  s_add_u32 s61, s61, 1024
  s_or_b32 s63, s64, 96
  v_xor_b32 v114, s63, v112
  s_mov_b32 m0, s62
  s_add_u32 s62, s62, 1024
  buffer_load_dwordx4 v114, s[20:23], s61 offen lds
  s_add_u32 s61, s61, 1024
  s_or_b32 s63, s64, 64
  v_xor_b32_e64 v113, s63, v112
  s_mov_b32 m0, s62
  s_add_u32 s62, s62, 1024
  buffer_load_dwordx4 v113, s[20:23], s61 offen lds
  s_add_u32 s61, s61, 1024
  s_or_b32 s63, s64, 96
  v_xor_b32 v114, s63, v112
  s_mov_b32 m0, s62
  s_add_u32 s62, s62, 1024
  buffer_load_dwordx4 v114, s[20:23], s61 offen lds
  s_add_u32 s61, s61, 1024
  s_waitcnt vmcnt(0)
  s_barrier
  v_xor_b32_e64 v117, 0, v116
  ds_read_b64_tr_b16 v[200:201], v117 offset:0
  ds_read_b64_tr_b16 v[202:203], v117 offset:2048
  ds_read_b64_tr_b16 v[204:205], v117 offset:32768
  ds_read_b64_tr_b16 v[206:207], v117 offset:34816
  s_waitcnt lgkmcnt(0)
  v_xor_b32 v117, 32, v116
  ds_read_b64_tr_b16 v[216:217], v117 offset:0
  ds_read_b64_tr_b16 v[218:219], v117 offset:2048
  ds_read_b64_tr_b16 v[220:221], v117 offset:32768
  ds_read_b64_tr_b16 v[222:223], v117 offset:34816
  s_waitcnt lgkmcnt(0)
  v_xor_b32 v117, 64, v116
  ds_read_b64_tr_b16 v[232:233], v117 offset:0
  ds_read_b64_tr_b16 v[234:235], v117 offset:2048
  ds_read_b64_tr_b16 v[236:237], v117 offset:32768
  ds_read_b64_tr_b16 v[238:239], v117 offset:34816
  s_waitcnt lgkmcnt(0)
  v_xor_b32 v117, 96, v116
  ds_read_b64_tr_b16 v[248:249], v117 offset:0
  ds_read_b64_tr_b16 v[250:251], v117 offset:2048
  ds_read_b64_tr_b16 v[252:253], v117 offset:32768
  ds_read_b64_tr_b16 v[254:255], v117 offset:34816
  s_waitcnt lgkmcnt(0)
  v_xor_b32 v117, 128, v116
  ds_read_b64_tr_b16 v[52:53], v117 offset:0
  ds_read_b64_tr_b16 v[54:55], v117 offset:2048
  ds_read_b64_tr_b16 v[56:57], v117 offset:32768
  ds_read_b64_tr_b16 v[58:59], v117 offset:34816
  s_waitcnt lgkmcnt(0)
  v_xor_b32 v117, 160, v116
  ds_read_b64_tr_b16 v[68:69], v117 offset:0
  ds_read_b64_tr_b16 v[70:71], v117 offset:2048
  ds_read_b64_tr_b16 v[72:73], v117 offset:32768
  ds_read_b64_tr_b16 v[74:75], v117 offset:34816
  s_waitcnt lgkmcnt(0)
  v_xor_b32 v117, 192, v116
  ds_read_b64_tr_b16 v[84:85], v117 offset:0
  ds_read_b64_tr_b16 v[86:87], v117 offset:2048
  ds_read_b64_tr_b16 v[88:89], v117 offset:32768
  ds_read_b64_tr_b16 v[90:91], v117 offset:34816
  s_waitcnt lgkmcnt(0)
  v_xor_b32 v117, 224, v116
  ds_read_b64_tr_b16 v[100:101], v117 offset:0
  ds_read_b64_tr_b16 v[102:103], v117 offset:2048
  ds_read_b64_tr_b16 v[104:105], v117 offset:32768
  ds_read_b64_tr_b16 v[106:107], v117 offset:34816
  s_waitcnt lgkmcnt(0)
  s_barrier
  v_add_u32 v117, 98304, v5
  ds_write_b128 v117, v[44:47] offset:0
  ds_write_b128 v117, v[48:51] offset:1024
  ds_write_b128 v117, v[52:55] offset:2048
  ds_write_b128 v117, v[56:59] offset:3072
  ds_write_b128 v117, v[60:63] offset:4096
  ds_write_b128 v117, v[64:67] offset:5120
  ds_write_b128 v117, v[68:71] offset:6144
  ds_write_b128 v117, v[72:75] offset:7168
  ds_write_b128 v117, v[76:79] offset:8192
  ds_write_b128 v117, v[80:83] offset:9216
  ds_write_b128 v117, v[84:87] offset:10240
  ds_write_b128 v117, v[88:91] offset:11264
  ds_write_b128 v117, v[92:95] offset:12288
  ds_write_b128 v117, v[96:99] offset:13312
  ds_write_b128 v117, v[100:103] offset:14336
  ds_write_b128 v117, v[104:107] offset:15360
  s_waitcnt lgkmcnt(0)
  s_lshl_b32 s61, s54, 13
  s_add_u32 s78, s52, s61
  s_add_u32 s67, s75, s61
  s_add_u32 s67, s67, 0x82000
  s_lshl_b32 s61, s54, 7
  s_add_u32 s61, s75, s61
  s_add_u32 s92, s61, 0x82000
  s_add_u32 s93, s61, 0x86000
  s_add_u32 s94, s61, 0x8a000
  s_add_u32 s95, s61, 0x8e000
  s_lshl_b32 s61, s54, 4
  s_add_u32 s80, s53, s61
  s_sub_u32 s79, s53, 0x10000
  s_lshl_b32 s79, s79, 5
  s_add_u32 s79, s79, 0xd000000
  s_lshl_b32 s61, s54, 12
  s_add_u32 s79, s79, s61
  s_add_u32 s76, s75, 8192
  s_lshr_b32 s61, s54, 1
  s_lshl_b32 s61, s61, 9
  s_and_b32 s62, s54, 1
  s_lshl_b32 s62, s62, 4
  s_add_u32 s61, s61, s62
  s_add_u32 s77, s76, s61
  s_lshl_b32 s68, s58, 11
  s_add_u32 s68, s68, 16384
  s_cmp_ge_u32 s58, 2
  s_cselect_b32 s96, 3, 0
  v_add_u32 v13, 98304, v5
  v_and_b32 v1, 15, v0
  v_mov_b32 v24, 0
  v_mov_b32 v124, 0x3f80
  v_cmp_eq_u32 vcc, 0, v1
  s_nop 1
  v_cndmask_b32 v24, v24, v124, vcc
  v_mov_b32 v124, 0x3f800000
  v_cmp_eq_u32 vcc, 1, v1
  s_nop 1
  v_cndmask_b32 v24, v24, v124, vcc
  v_and_b32 v1, 15, v0
  v_mov_b32 v25, 0
  v_mov_b32 v124, 0x3f80
  v_cmp_eq_u32 vcc, 2, v1
  s_nop 1
  v_cndmask_b32 v25, v25, v124, vcc
  v_mov_b32 v124, 0x3f800000
  v_cmp_eq_u32 vcc, 3, v1
  s_nop 1
  v_cndmask_b32 v25, v25, v124, vcc
  v_and_b32 v1, 15, v0
  v_mov_b32 v26, 0
  v_mov_b32 v124, 0x3f80
  v_cmp_eq_u32 vcc, 4, v1
  s_nop 1
  v_cndmask_b32 v26, v26, v124, vcc
  v_mov_b32 v124, 0x3f800000
  v_cmp_eq_u32 vcc, 5, v1
  s_nop 1
  v_cndmask_b32 v26, v26, v124, vcc
  v_and_b32 v1, 15, v0
  v_mov_b32 v27, 0
  v_mov_b32 v124, 0x3f80
  v_cmp_eq_u32 vcc, 6, v1
  s_nop 1
  v_cndmask_b32 v27, v27, v124, vcc
  v_mov_b32 v124, 0x3f800000
  v_cmp_eq_u32 vcc, 7, v1
  s_nop 1
  v_cndmask_b32 v27, v27, v124, vcc
  s_mov_b32 s55, 0
  v_pk_mov_b32 v[76:77], 0, 0
  v_pk_mov_b32 v[78:79], 0, 0
  v_pk_mov_b32 v[80:81], 0, 0
  v_pk_mov_b32 v[82:83], 0, 0
  v_pk_mov_b32 v[84:85], 0, 0
  v_pk_mov_b32 v[86:87], 0, 0
  v_pk_mov_b32 v[88:89], 0, 0
  v_pk_mov_b32 v[90:91], 0, 0
  v_pk_mov_b32 v[92:93], 0, 0
  v_pk_mov_b32 v[94:95], 0, 0
  v_pk_mov_b32 v[96:97], 0, 0
  v_pk_mov_b32 v[98:99], 0, 0
  s_barrier
  ds_read_b128 v[100:103], v5 offset:32768
  ds_read_b128 v[104:107], v5 offset:33792
  ds_read_b128 v[108:111], v5 offset:34816
  ds_read_b128 v[112:115], v5 offset:35840
  ds_read_b128 v[116:119], v5 offset:36864
  ds_read_b128 v[120:123], v5 offset:37888
  s_mov_b32 s8, s48
  s_and_b32 s9, s49, 0xffff
  s_mov_b32 s10, 0x100
  s_mov_b32 s11, 0x20000
  v_and_b32 v1, 3, v0
  v_lshlrev_b32 v1, 6, v1
L_gate_483:
  buffer_load_dword v126, v1, s[8:11], 0 offen offset:8 sc1
  s_waitcnt vmcnt(0)
  v_cmp_gt_u32 vcc, 48, v126
  s_cbranch_vccz L_gateok_484
  s_add_u32 s72, s72, 1
  s_cmp_gt_u32 s72, 0x80000
  s_cbranch_scc1 L_exit
  s_sleep 2
  s_branch L_gate_483
L_gateok_484:
L_poll_485:
  buffer_load_dword v126, v15, s[4:7], s80 offen sc1
  s_waitcnt vmcnt(0)
  v_cmp_eq_u32 vcc, 0, v126
  s_cbranch_vccz L_pollok_486
  s_add_u32 s72, s72, 1
  s_cmp_gt_u32 s72, 0x80000
  s_cbranch_scc1 L_exit
  s_sleep 1
  s_branch L_poll_485
L_pollok_486:
  s_mov_b32 m0, s68
  s_add_u32 s61, s78, 0x1000000
  buffer_load_dwordx4 v3, s[4:7], s78 offen sc1 lds
  buffer_load_dwordx4 v3, s[4:7], s78 offen offset:1024 sc1 lds
  buffer_load_dwordx4 v[28:31], v7, s[4:7], s61 offen sc1
  buffer_load_dwordx4 v[32:35], v7, s[4:7], s61 offen offset:256 sc1
  s_mov_b32 s8, s26
  s_and_b32 s9, s27, 0xffff
  s_mov_b32 s10, 0x2000
  s_mov_b32 s11, 0x20000
  v_mov_b32 v23, 0x0
  v_bfe_i32 v1, v0, 0, 1
  v_and_b32 v1, 0x10, v1
  v_add_u32 v23, v23, v1
  v_bfe_i32 v1, v0, 1, 1
  v_and_b32 v1, 0x400, v1
  v_add_u32 v23, v23, v1
  v_bfe_i32 v1, v0, 2, 1
  v_and_b32 v1, 0x800, v1
  v_add_u32 v23, v23, v1
  v_bfe_i32 v1, v0, 3, 1
  v_and_b32 v1, 0x1000, v1
  v_add_u32 v23, v23, v1
  v_bfe_i32 v1, v0, 4, 1
  v_and_b32 v1, 0x20, v1
  v_add_u32 v23, v23, v1
  v_bfe_i32 v1, v0, 5, 1
  v_and_b32 v1, 0x40, v1
  v_add_u32 v23, v23, v1
  v_bfe_i32 v1, v0, 6, 1
  v_and_b32 v1, 0x100, v1
  v_add_u32 v23, v23, v1
  v_bfe_i32 v1, v0, 7, 1
  v_and_b32 v1, 0x200, v1
  v_add_u32 v23, v23, v1
  buffer_load_dwordx4 v[44:47], v23, s[8:11], 0 offen offset:0
  buffer_load_dwordx4 v[48:51], v23, s[8:11], 0 offen offset:128
  buffer_load_dword v126, v15, s[4:7], s80 offen offset:512 sc1
  s_waitcnt vmcnt(0)
  ds_write_b128 v3, v[44:47]
  ds_write_b128 v3, v[48:51] offset:1024
  s_branch L_ch_have_481
L_ch_top_487:
L_ch_pm_488:
  buffer_load_dwordx4 v[44:47], v3, s[4:7], s76 offen sc1
  buffer_load_dwordx4 v[48:51], v3, s[4:7], s76 offen offset:1024 sc1
  s_waitcnt vmcnt(1)
  v_max3_u32 v1, v44, v45, v46
  s_waitcnt vmcnt(0)
  v_max3_u32 v124, v48, v49, v50
  v_max3_u32 v1, v1, v47, v51
  v_max_u32_e64 v1, v1, v124
  v_cmp_eq_u32 vcc, -1, v1
  s_cbranch_vccnz L_ch_pmr_489
  ds_write_b128 v3, v[44:47]
  ds_write_b128 v3, v[48:51] offset:1024
  s_add_u32 s76, s76, 8192
L_ch_have_481:
  s_add_u32 s74, s55, 1
  s_cmp_lt_u32 s74, 64
  s_cselect_b32 s61, 0x40000, 0
  s_cselect_b32 s62, 512, 0
  s_waitcnt lgkmcnt(0)
  s_barrier
  ds_read_b128 v[44:47], v4 offset:0
  ds_read_b128 v[48:51], v4 offset:1024
  ds_read_b128 v[52:55], v4 offset:2048
  ds_read_b128 v[56:59], v4 offset:3072
  ds_read_b128 v[60:63], v4 offset:4096
  ds_read_b128 v[64:67], v4 offset:5120
  ds_read_b128 v[68:71], v4 offset:6144
  ds_read_b128 v[72:75], v4 offset:7168
  s_add_u32 s78, s78, s61
  s_add_u32 s80, s80, s62
  s_xor_b32 s68, s68, 0x2000
  v_cmp_eq_u32 vcc, 0, v126
  s_cbranch_vccnz L_ch_kvslow_490
L_ch_kvback_491:
  s_mov_b32 m0, s68
  s_add_u32 s61, s78, 0x1000000
  s_add_u32 s62, s79, 0x80000
  s_cmp_lt_u32 s55, 60
  s_cselect_b32 s62, s62, 0xeff0000
  s_waitcnt lgkmcnt(7)
  v_smfmac_f32_16x16x64_bf16 v[76:79], v[44:47], a[0:7], v2
  v_smfmac_f32_16x16x64_bf16 v[80:83], v[44:47], a[64:71], v2
  s_waitcnt lgkmcnt(6)
  v_smfmac_f32_16x16x64_bf16 v[76:79], v[48:51], a[8:15], v2
  v_mov_b32 v36, -1
  v_smfmac_f32_16x16x64_bf16 v[80:83], v[48:51], a[72:79], v2
  buffer_load_dwordx4 v3, s[4:7], s78 offen sc1 lds
  s_waitcnt lgkmcnt(5)
  v_smfmac_f32_16x16x64_bf16 v[76:79], v[52:55], a[16:23], v2
  v_mov_b32 v37, -1
  v_smfmac_f32_16x16x64_bf16 v[80:83], v[52:55], a[80:87], v2
  s_waitcnt lgkmcnt(4)
  v_smfmac_f32_16x16x64_bf16 v[76:79], v[56:59], a[24:31], v2
  v_mov_b32 v38, -1
  v_smfmac_f32_16x16x64_bf16 v[80:83], v[56:59], a[88:95], v2
  buffer_load_dwordx4 v3, s[4:7], s78 offen offset:1024 sc1 lds
  s_waitcnt lgkmcnt(3)
  v_smfmac_f32_16x16x64_bf16 v[76:79], v[60:63], a[32:39], v2
  v_mov_b32 v39, -1
  v_smfmac_f32_16x16x64_bf16 v[80:83], v[60:63], a[96:103], v2
  s_waitcnt lgkmcnt(2)
  v_smfmac_f32_16x16x64_bf16 v[76:79], v[64:67], a[40:47], v2
  v_smfmac_f32_16x16x64_bf16 v[80:83], v[64:67], a[104:111], v2
  buffer_store_dwordx4 v[36:39], v21, s[4:7], s62 offen sc1
  s_waitcnt lgkmcnt(1)
  v_smfmac_f32_16x16x64_bf16 v[76:79], v[68:71], a[48:55], v2
  v_smfmac_f32_16x16x64_bf16 v[80:83], v[68:71], a[112:119], v2
  s_waitcnt lgkmcnt(0)
  v_smfmac_f32_16x16x64_bf16 v[76:79], v[72:75], a[56:63], v2
  v_smfmac_f32_16x16x64_bf16 v[80:83], v[72:75], a[120:127], v2
  buffer_load_dwordx4 v[36:39], v7, s[4:7], s61 offen sc1
  v_smfmac_f32_16x16x64_bf16 v[84:87], v[44:47], a[128:135], v2
  v_smfmac_f32_16x16x64_bf16 v[88:91], v[44:47], a[192:199], v2
  buffer_load_dwordx4 v[40:43], v7, s[4:7], s61 offen offset:256 sc1
  s_nop 0
  v_smfmac_f32_16x16x64_bf16 v[84:87], v[48:51], a[136:143], v2
  v_smfmac_f32_16x16x64_bf16 v[88:91], v[48:51], a[200:207], v2
  buffer_load_dword v126, v15, s[4:7], s80 offen offset:512 sc1
  s_nop 0
  v_smfmac_f32_16x16x64_bf16 v[84:87], v[52:55], a[144:151], v2
  v_add_f32 v76, v76, v77
  v_smfmac_f32_16x16x64_bf16 v[88:91], v[52:55], a[208:215], v2
  v_add_f32 v78, v78, v79
  v_smfmac_f32_16x16x64_bf16 v[84:87], v[56:59], a[152:159], v2
  v_add_f32 v80, v80, v81
  v_smfmac_f32_16x16x64_bf16 v[88:91], v[56:59], a[216:223], v2
  v_add_f32 v82, v82, v83
  v_smfmac_f32_16x16x64_bf16 v[84:87], v[60:63], a[160:167], v2
  v_mul_f32 v76, s81, v76
  v_smfmac_f32_16x16x64_bf16 v[88:91], v[60:63], a[224:231], v2
  v_mul_f32 v78, s81, v78
  v_smfmac_f32_16x16x64_bf16 v[84:87], v[64:67], a[168:175], v2
  v_mul_f32 v80, s81, v80
  v_smfmac_f32_16x16x64_bf16 v[88:91], v[64:67], a[232:239], v2
  v_mul_f32 v82, s81, v82
  v_smfmac_f32_16x16x64_bf16 v[84:87], v[68:71], a[176:183], v2
  v_cvt_pk_bf16_f32 v76, v76, v78
  v_smfmac_f32_16x16x64_bf16 v[88:91], v[68:71], a[240:247], v2
  v_cvt_pk_bf16_f32 v77, v80, v82
  v_smfmac_f32_16x16x64_bf16 v[84:87], v[72:75], a[184:191], v2
  ds_write2_b32 v8, v76, v77 offset0:1 offset1:129
  v_smfmac_f32_16x16x64_bf16 v[88:91], v[72:75], a[248:255], v2
  buffer_load_dword v22, v12, s[4:7], s77 offen sc1
  v_smfmac_f32_16x16x64_bf16 v[92:95], v[44:47], v[128:135], v2
  v_smfmac_f32_16x16x64_bf16 v[96:99], v[44:47], v[100:107], v2
  ds_read_b128 v[100:103], v5 offset:38912
  v_smfmac_f32_16x16x64_bf16 v[92:95], v[48:51], v[136:143], v2
  ds_read_b128 v[104:107], v5 offset:39936
  v_smfmac_f32_16x16x64_bf16 v[96:99], v[48:51], v[108:115], v2
  ds_read_b128 v[108:111], v5 offset:40960
  s_nop 0
  v_add_f32 v84, v84, v85
  v_add_f32 v86, v86, v87
  v_add_f32 v88, v88, v89
  v_add_f32_e64 v90, v90, v91
  v_cvt_pk_bf16_f32 v84, v84, v86
  v_cvt_pk_bf16_f32 v85, v88, v90
  ds_write2_b32 v8, v84, v85 offset0:0 offset1:128
  v_smfmac_f32_16x16x64_bf16 v[92:95], v[52:55], v[144:151], v2
  ds_read_b128 v[112:115], v5 offset:41984
  v_smfmac_f32_16x16x64_bf16 v[96:99], v[52:55], v[116:123], v2
  ds_read_b128 v[44:47], v6 offset:0
  buffer_store_dword v84, v14, s[4:7], s79 offen sc1
  buffer_store_dword v85, v14, s[4:7], s79 offen offset:256 sc1
  s_waitcnt lgkmcnt(2)
  s_barrier
  ds_read_b64_tr_b16 v[76:77], v9 offset:0
  ds_read_b64_tr_b16 v[78:79], v9 offset:256
  ds_read_b64_tr_b16 v[80:81], v9 offset:1024
  ds_read_b64_tr_b16 v[82:83], v9 offset:1280
  ds_read_b64_tr_b16 v[84:85], v9 offset:2048
  ds_read_b64_tr_b16 v[86:87], v9 offset:2304
  ds_read_b64_tr_b16 v[88:89], v9 offset:3072
  ds_read_b64_tr_b16 v[90:91], v9 offset:3328
  v_smfmac_f32_16x16x64_bf16 v[92:95], v[56:59], v[152:159], v2
  ds_read_b128 v[116:119], v5 offset:43008
  v_smfmac_f32_16x16x64_bf16 v[96:99], v[56:59], v[100:107], v2
  ds_read_b128 v[120:123], v5 offset:44032
  v_smfmac_f32_16x16x64_bf16 v[92:95], v[60:63], v[160:167], v2
  ds_read_b128 v[48:51], v6 offset:128
  s_waitcnt lgkmcnt(12)
  v_smfmac_f32_16x16x64_bf16 v[96:99], v[60:63], v[108:115], v2
  ds_read_b128 v[100:103], v5 offset:45056
  v_smfmac_f32_16x16x64_bf16 v[92:95], v[64:67], v[168:175], v2
  ds_read_b128 v[104:107], v5 offset:46080
  s_waitcnt lgkmcnt(3)
  v_smfmac_f32_16x16x64_bf16 v[96:99], v[64:67], v[116:123], v2
  ds_read_b128 v[108:111], v5 offset:47104
  v_mfma_f32_16x16x32_bf16 v[116:119], v[44:47], v[76:79], 0
  ds_read_b128 v[112:115], v5 offset:48128
  s_waitcnt lgkmcnt(4)
  v_mfma_f32_16x16x32_bf16 v[120:123], v[48:51], v[76:79], 0
  ds_read_b128 v[52:55], v6 offset:2048
  v_smfmac_f32_16x16x64_bf16 v[92:95], v[68:71], v[176:183], v2
  ds_read_b128 v[56:59], v6 offset:2176
  s_waitcnt lgkmcnt(4)
  v_smfmac_f32_16x16x64_bf16 v[96:99], v[68:71], v[100:107], v2
  ds_read_b128 v[60:63], v6 offset:4096
  v_mfma_f32_16x16x32_bf16 v[100:103], v[76:79], v[76:79], 0
  ds_read_b128 v[64:67], v6 offset:4224
  v_smfmac_f32_16x16x64_bf16 v[92:95], v[72:75], v[184:191], v2
  ds_read_b128 v[68:71], v6 offset:6144
  s_waitcnt lgkmcnt(5)
  v_smfmac_f32_16x16x64_bf16 v[96:99], v[72:75], v[108:115], v2
  ds_read_b128 v[72:75], v6 offset:6272
  v_mfma_f32_16x16x32_bf16 v[100:103], v[80:83], v[80:83], v[100:103]
  ds_read_b128 v[44:47], v13 offset:0
  s_waitcnt lgkmcnt(6)
  v_mfma_f32_16x16x32_bf16 v[116:119], v[52:55], v[80:83], v[116:119]
  ds_read_b128 v[48:51], v13 offset:1024
  s_waitcnt lgkmcnt(6)
  v_mfma_f32_16x16x32_bf16 v[120:123], v[56:59], v[80:83], v[120:123]
  v_mov_b32 v109, 0
  v_mfma_f32_16x16x32_bf16 v[100:103], v[84:87], v[84:87], v[100:103]
  ds_read_b128 v[52:55], v13 offset:2048
  s_waitcnt lgkmcnt(6)
  v_mfma_f32_16x16x32_bf16 v[116:119], v[60:63], v[84:87], v[116:119]
  ds_read_b128 v[56:59], v13 offset:3072
  s_waitcnt lgkmcnt(6)
  v_mfma_f32_16x16x32_bf16 v[120:123], v[64:67], v[84:87], v[120:123]
  v_mov_b32 v111, 0
  v_mfma_f32_16x16x32_bf16 v[100:103], v[88:91], v[88:91], v[100:103]
  ds_read_b128 v[60:63], v13 offset:4096
  s_waitcnt lgkmcnt(6)
  v_mfma_f32_16x16x32_bf16 v[116:119], v[68:71], v[88:91], v[116:119]
  ds_read_b128 v[64:67], v13 offset:5120
  s_waitcnt lgkmcnt(6)
  v_mfma_f32_16x16x32_bf16 v[120:123], v[72:75], v[88:91], v[120:123]
  v_add_f32 v92, v92, v93
  v_add_f32 v94, v94, v95
  v_add_f32 v96, v96, v97
  v_add_f32 v98, v98, v99
  v_cvt_pk_bf16_f32 v108, v92, v94
  v_cvt_pk_bf16_f32 v110, v96, v98
  s_nop 0
  v_max3_f32 v124, v100, v101, v116
  v_max3_f32 v124, v124, v117, v118
  v_max3_f32 v125, v119, v120, v121
  v_max3_f32 v124, v124, v122, v123
  v_max_f32 v124, v124, v125
  v_mov_b32 v125, v124
  ds_read_b128 v[68:71], v13 offset:6144
  buffer_store_dword v108, v14, s[4:7], s79 offen offset:2048 sc1
  v_permlane16_swap_b32 v124, v125
  v_mov_b32 v113, 0
  v_max_f32 v124, v124, v125
  v_mov_b32 v125, v124
  ds_read_b128 v[72:75], v13 offset:7168
  buffer_store_dword v110, v14, s[4:7], s79 offen offset:2304 sc1
  v_permlane32_swap_b32 v124, v125
  s_add_u32 s79, s79, 0x20000
  v_max_f32 v124, v124, v125
  v_sub_f32 v116, v116, v124
  v_sub_f32 v117, v117, v124
  v_exp_f32 v116, v116
  v_sub_f32 v118, v118, v124
  v_exp_f32 v117, v117
  v_sub_f32 v119, v119, v124
  v_exp_f32 v118, v118
  v_cvt_pk_bf16_f32 v104, v116, v117
  v_sub_f32 v120, v120, v124
  v_exp_f32 v119, v119
  v_sub_f32 v121, v121, v124
  v_exp_f32 v120, v120
  v_cvt_pk_bf16_f32 v105, v118, v119
  v_sub_f32 v122, v122, v124
  v_exp_f32 v121, v121
  v_sub_f32 v123, v123, v124
  v_exp_f32 v122, v122
  v_cvt_pk_bf16_f32 v106, v120, v121
  v_sub_f32 v100, v100, v124
  v_exp_f32 v123, v123
  v_sub_f32 v101, v101, v124
  v_exp_f32 v100, v100
  v_cvt_pk_bf16_f32 v107, v122, v123
  v_exp_f32 v101, v101
  s_nop 0
  v_mfma_f32_16x16x32_bf16 v[84:87], v[16:19], v[104:107], 0
  v_cvt_pk_bf16_f32 v112, v100, v101
  v_mfma_f32_16x16x32_bf16 v[76:79], v[28:31], v[104:107], 0
  v_mov_b32 v96, 0
  v_mfma_f32_16x16x32_bf16 v[80:83], v[32:35], v[104:107], 0
  v_mov_b32 v97, 0
  s_nop 0
  v_mfma_f32_16x16x16_bf16 v[84:87], v[16:17], v[112:113], v[84:87]
  v_mov_b32 v98, 0
  v_mfma_f32_16x16x16_bf16 v[76:79], v[108:109], v[112:113], v[76:79]
  v_mov_b32 v99, 0
  v_mfma_f32_16x16x16_bf16 v[80:83], v[110:111], v[112:113], v[80:83]
  v_mov_b32 v100, 0
  v_mov_b32 v101, 0
  v_mov_b32 v102, 0
  v_mov_b32 v103, 0
  v_rcp_f32 v124, v84
  s_mov_b64 exec, s[84:85]
  v_mul_f32 v76, v76, v124
  v_mul_f32 v77, v77, v124
  v_mul_f32 v78, v78, v124
  v_mul_f32 v79, v79, v124
  v_cvt_pk_bf16_f32 v84, v76, v77
  v_cvt_pk_bf16_f32 v85, v78, v79
  v_mul_f32 v80, v80, v124
  v_mul_f32 v81, v81, v124
  v_mul_f32 v82, v82, v124
  v_mul_f32 v83, v83, v124
  v_cvt_pk_bf16_f32 v86, v80, v81
  v_cvt_pk_bf16_f32 v87, v82, v83
  ds_write_b128 v10, v[84:87]
  s_mov_b64 exec, -1
  v_pk_mov_b32 v[92:93], 0, 0
  v_pk_mov_b32 v[94:95], 0, 0
  v_pk_mov_b32 v[104:105], 0, 0
  v_pk_mov_b32 v[106:107], 0, 0
  v_pk_mov_b32 v[108:109], 0, 0
  v_pk_mov_b32 v[110:111], 0, 0
  s_waitcnt lgkmcnt(0)
  s_barrier
  ds_read_b128 v[76:79], v4 offset:14336
  ds_read_b128 v[80:83], v4 offset:15360
  v_pk_mov_b32 v[112:113], 0, 0
  v_pk_mov_b32 v[114:115], 0, 0
  v_pk_mov_b32 v[116:117], 0, 0
  v_pk_mov_b32 v[118:119], 0, 0
  v_pk_mov_b32 v[120:121], 0, 0
  v_pk_mov_b32 v[122:123], 0, 0
  v_xor_b32 v6, 0x2000, v6
  s_waitcnt lgkmcnt(0)
  v_smfmac_f32_16x16x64_bf16 v[108:111], v[76:79], v[44:51], v2
  ds_read_b128 v[44:47], v13 offset:8192
  v_smfmac_f32_16x16x64_bf16 v[108:111], v[80:83], v[52:59], v2
  ds_read_b128 v[48:51], v13 offset:9216
  v_smfmac_f32_16x16x64_bf16 v[112:115], v[76:79], v[60:67], v2
  ds_read_b128 v[52:55], v13 offset:10240
  v_smfmac_f32_16x16x64_bf16 v[112:115], v[80:83], v[68:75], v2
  ds_read_b128 v[56:59], v13 offset:11264
  v_smfmac_f32_16x16x64_bf16 v[92:95], v[76:79], v[192:199], v2
  ds_read_b128 v[60:63], v13 offset:12288
  v_smfmac_f32_16x16x64_bf16 v[92:95], v[80:83], v[200:207], v2
  ds_read_b128 v[64:67], v13 offset:13312
  v_smfmac_f32_16x16x64_bf16 v[96:99], v[76:79], v[208:215], v2
  ds_read_b128 v[68:71], v13 offset:14336
  v_smfmac_f32_16x16x64_bf16 v[96:99], v[80:83], v[216:223], v2
  ds_read_b128 v[72:75], v13 offset:15360
  v_smfmac_f32_16x16x64_bf16 v[100:103], v[76:79], v[224:231], v2
  v_add_f32 v108, v108, v109
  v_add_f32 v110, v110, v111
  v_smfmac_f32_16x16x64_bf16 v[100:103], v[80:83], v[232:239], v2
  v_add_f32 v112, v112, v113
  v_add_f32 v114, v114, v115
  v_smfmac_f32_16x16x64_bf16 v[104:107], v[76:79], v[240:247], v2
  v_cvt_pk_bf16_f32 v88, v108, v110
  v_and_b32 v88, -2, v88
  v_smfmac_f32_16x16x64_bf16 v[104:107], v[80:83], v[248:255], v2
  v_cvt_pk_bf16_f32 v89, v112, v114
  buffer_store_dwordx2 v[88:89], v11, s[4:7], s94 offen
  s_waitcnt lgkmcnt(6)
  v_smfmac_f32_16x16x64_bf16 v[116:119], v[76:79], v[44:51], v2
  v_add_f32 v92, v92, v93
  v_add_f32 v94, v94, v95
  s_waitcnt lgkmcnt(4)
  v_smfmac_f32_16x16x64_bf16 v[116:119], v[80:83], v[52:59], v2
  v_add_f32 v96, v96, v97
  v_add_f32 v98, v98, v99
  s_waitcnt lgkmcnt(2)
  v_smfmac_f32_16x16x64_bf16 v[120:123], v[76:79], v[60:67], v2
  v_cvt_pk_bf16_f32 v84, v92, v94
  v_and_b32 v84, -2, v84
  s_waitcnt lgkmcnt(0)
  v_smfmac_f32_16x16x64_bf16 v[120:123], v[80:83], v[68:75], v2
  v_cvt_pk_bf16_f32 v85, v96, v98
  buffer_store_dwordx2 v[84:85], v11, s[4:7], s92 offen
  v_add_f32 v100, v100, v101
  v_add_f32 v102, v102, v103
  v_add_f32 v104, v104, v105
  v_add_f32 v106, v106, v107
  v_cvt_pk_bf16_f32 v86, v100, v102
  v_and_b32 v86, -2, v86
  v_cvt_pk_bf16_f32 v87, v104, v106
  buffer_store_dwordx2 v[86:87], v11, s[4:7], s93 offen
  v_add_f32 v116, v116, v117
  v_add_f32 v118, v118, v119
  v_add_f32 v120, v120, v121
  v_add_f32 v122, v122, v123
  v_cvt_pk_bf16_f32 v90, v116, v118
  v_and_b32 v90, -2, v90
  v_cvt_pk_bf16_f32 v91, v120, v122
  buffer_store_dwordx2 v[90:91], v11, s[4:7], s95 offen
  ds_read_b128 v[100:103], v5 offset:32768
  ds_read_b128 v[104:107], v5 offset:33792
  ds_read_b128 v[108:111], v5 offset:34816
  ds_read_b128 v[112:115], v5 offset:35840
  ds_read_b128 v[116:119], v5 offset:36864
  ds_read_b128 v[120:123], v5 offset:37888
  v_pk_mov_b32 v[76:77], 0, 0
  v_pk_mov_b32 v[78:79], 0, 0
  v_pk_mov_b32 v[80:81], 0, 0
  v_pk_mov_b32 v[82:83], 0, 0
  v_pk_mov_b32 v[84:85], 0, 0
  v_pk_mov_b32 v[86:87], 0, 0
  v_pk_mov_b32 v[88:89], 0, 0
  v_pk_mov_b32 v[90:91], 0, 0
  v_pk_mov_b32 v[96:97], 0, 0
  v_pk_mov_b32 v[98:99], 0, 0
  s_cmp_ge_u32 s58, 2
  s_cbranch_scc1 L_ch_z_494
  s_sleep 2
L_ch_pr_492:
  buffer_load_dwordx4 v[44:47], v20, s[4:7], s67 offen offset:0 sc1
  buffer_load_dwordx4 v[48:51], v20, s[4:7], s67 offen offset:1024 sc1
  buffer_load_dwordx4 v[52:55], v20, s[4:7], s67 offen offset:2048 sc1
  buffer_load_dwordx4 v[56:59], v20, s[4:7], s67 offen offset:3072 sc1
  s_waitcnt vmcnt(3)
  v_mfma_f32_16x16x32_bf16 v[92:95], v[44:47], v[24:27], 0
  v_or_b32 v1, v44, v46
  s_waitcnt vmcnt(2)
  v_mfma_f32_16x16x32_bf16 v[92:95], v[48:51], v[24:27], v[92:95]
  v_bitop3_b32 v1, v1, v48, v50 bitop3:0xfe
  s_waitcnt vmcnt(1)
  v_mfma_f32_16x16x32_bf16 v[92:95], v[52:55], v[24:27], v[92:95]
  v_bitop3_b32 v1, v1, v52, v54 bitop3:0xfe
  s_waitcnt vmcnt(0)
  v_mfma_f32_16x16x32_bf16 v[92:95], v[56:59], v[24:27], v[92:95]
  v_bitop3_b32 v1, v1, v56, v58 bitop3:0xfe
  v_and_b32 v1, 1, v1
  v_cmp_ne_u32 vcc, 0, v1
  s_cbranch_vccnz L_ch_prs_493
  s_mov_b64 exec, s[82:83]
  s_nop 2
  v_add_f32 v92, v92, v93
  v_add_f32 v94, v94, v95
  v_cvt_pk_bf16_f32 v23, v92, v94
  buffer_store_dword v23, v12, s[4:7], s77 offen
  s_mov_b64 exec, -1
L_ch_z_494:
  s_barrier
  v_pk_mov_b32 v[92:93], 0, 0
  v_pk_mov_b32 v[94:95], 0, 0
  s_add_u32 s77, s77, 8192
  s_mov_b32 s55, s74
  s_sleep 2
L_ch_pm_495:
  buffer_load_dwordx4 v[44:47], v3, s[4:7], s76 offen sc1
  buffer_load_dwordx4 v[48:51], v3, s[4:7], s76 offen offset:1024 sc1
  s_waitcnt vmcnt(1)
  v_max3_u32 v1, v44, v45, v46
  s_waitcnt vmcnt(0)
  v_max3_u32 v124, v48, v49, v50
  v_max3_u32 v1, v1, v47, v51
  v_max_u32 v1, v1, v124
  v_cmp_eq_u32 vcc, -1, v1
  s_cbranch_vccnz L_ch_pmr_496
  ds_write_b128 v3, v[44:47]
  ds_write_b128 v3, v[48:51] offset:1024
  s_add_u32 s76, s76, 8192
  s_add_u32 s74, s55, 1
  s_cmp_lt_u32 s74, 64
  s_cselect_b32 s61, 0x40000, 0
  s_cselect_b32 s62, 512, 0
  s_waitcnt lgkmcnt(0)
  s_barrier
  ds_read_b128 v[44:47], v4 offset:0
  ds_read_b128 v[48:51], v4 offset:1024
  ds_read_b128 v[52:55], v4 offset:2048
  ds_read_b128 v[56:59], v4 offset:3072
  ds_read_b128 v[60:63], v4 offset:4096
  ds_read_b128 v[64:67], v4 offset:5120
  ds_read_b128 v[68:71], v4 offset:6144
  ds_read_b128 v[72:75], v4 offset:7168
  s_add_u32 s78, s78, s61
  s_add_u32 s80, s80, s62
  s_xor_b32 s68, s68, 0x2000
  v_cmp_eq_u32 vcc, 0, v126
  s_cbranch_vccnz L_ch_kvslow_497
L_ch_kvback_498:
  s_mov_b32 m0, s68
  s_add_u32 s61, s78, 0x1000000
  s_add_u32 s62, s79, 0x80000
  s_cmp_lt_u32 s55, 60
  s_cselect_b32 s62, s62, 0xeff0000
  s_waitcnt lgkmcnt(7)
  v_smfmac_f32_16x16x64_bf16 v[76:79], v[44:47], a[0:7], v2
  v_smfmac_f32_16x16x64_bf16 v[80:83], v[44:47], a[64:71], v2
  s_waitcnt lgkmcnt(6)
  v_smfmac_f32_16x16x64_bf16 v[76:79], v[48:51], a[8:15], v2
  v_mov_b32 v28, -1
  v_smfmac_f32_16x16x64_bf16 v[80:83], v[48:51], a[72:79], v2
  buffer_load_dwordx4 v3, s[4:7], s78 offen sc1 lds
  s_waitcnt lgkmcnt(5)
  v_smfmac_f32_16x16x64_bf16 v[76:79], v[52:55], a[16:23], v2
  v_mov_b32 v29, -1
  v_smfmac_f32_16x16x64_bf16 v[80:83], v[52:55], a[80:87], v2
  s_waitcnt lgkmcnt(4)
  v_smfmac_f32_16x16x64_bf16 v[76:79], v[56:59], a[24:31], v2
  v_mov_b32 v30, -1
  v_smfmac_f32_16x16x64_bf16 v[80:83], v[56:59], a[88:95], v2
  buffer_load_dwordx4 v3, s[4:7], s78 offen offset:1024 sc1 lds
  s_waitcnt lgkmcnt(3)
  v_smfmac_f32_16x16x64_bf16 v[76:79], v[60:63], a[32:39], v2
  v_mov_b32 v31, -1
  v_smfmac_f32_16x16x64_bf16 v[80:83], v[60:63], a[96:103], v2
  s_waitcnt lgkmcnt(2)
  v_smfmac_f32_16x16x64_bf16 v[76:79], v[64:67], a[40:47], v2
  v_smfmac_f32_16x16x64_bf16 v[80:83], v[64:67], a[104:111], v2
  buffer_store_dwordx4 v[28:31], v21, s[4:7], s62 offen sc1
  s_waitcnt lgkmcnt(1)
  v_smfmac_f32_16x16x64_bf16 v[76:79], v[68:71], a[48:55], v2
  v_smfmac_f32_16x16x64_bf16 v[80:83], v[68:71], a[112:119], v2
  s_waitcnt lgkmcnt(0)
  v_smfmac_f32_16x16x64_bf16 v[76:79], v[72:75], a[56:63], v2
  v_smfmac_f32_16x16x64_bf16 v[80:83], v[72:75], a[120:127], v2
  buffer_load_dwordx4 v[28:31], v7, s[4:7], s61 offen sc1
  v_smfmac_f32_16x16x64_bf16 v[84:87], v[44:47], a[128:135], v2
  v_smfmac_f32_16x16x64_bf16 v[88:91], v[44:47], a[192:199], v2
  buffer_load_dwordx4 v[32:35], v7, s[4:7], s61 offen offset:256 sc1
  s_nop 0
  v_smfmac_f32_16x16x64_bf16 v[84:87], v[48:51], a[136:143], v2
  v_smfmac_f32_16x16x64_bf16 v[88:91], v[48:51], a[200:207], v2
  buffer_load_dword v126, v15, s[4:7], s80 offen offset:512 sc1
  s_nop 0
  v_smfmac_f32_16x16x64_bf16 v[84:87], v[52:55], a[144:151], v2
  v_add_f32 v76, v76, v77
  v_smfmac_f32_16x16x64_bf16 v[88:91], v[52:55], a[208:215], v2
  v_add_f32 v78, v78, v79
  v_smfmac_f32_16x16x64_bf16 v[84:87], v[56:59], a[152:159], v2
  v_add_f32 v80, v80, v81
  v_smfmac_f32_16x16x64_bf16 v[88:91], v[56:59], a[216:223], v2
  v_add_f32 v82, v82, v83
  v_smfmac_f32_16x16x64_bf16 v[84:87], v[60:63], a[160:167], v2
  v_mul_f32 v76, s81, v76
  v_smfmac_f32_16x16x64_bf16 v[88:91], v[60:63], a[224:231], v2
  v_mul_f32 v78, s81, v78
  v_smfmac_f32_16x16x64_bf16 v[84:87], v[64:67], a[168:175], v2
  v_mul_f32 v80, s81, v80
  v_smfmac_f32_16x16x64_bf16 v[88:91], v[64:67], a[232:239], v2
  v_mul_f32 v82, s81, v82
  v_smfmac_f32_16x16x64_bf16 v[84:87], v[68:71], a[176:183], v2
  v_cvt_pk_bf16_f32 v76, v76, v78
  v_smfmac_f32_16x16x64_bf16 v[88:91], v[68:71], a[240:247], v2
  v_cvt_pk_bf16_f32 v77, v80, v82
  v_smfmac_f32_16x16x64_bf16 v[84:87], v[72:75], a[184:191], v2
  ds_write2_b32 v8, v76, v77 offset0:1 offset1:129
  v_smfmac_f32_16x16x64_bf16 v[88:91], v[72:75], a[248:255], v2
  buffer_load_dword v22, v12, s[4:7], s77 offen sc1
  v_smfmac_f32_16x16x64_bf16 v[92:95], v[44:47], v[128:135], v2
  v_smfmac_f32_16x16x64_bf16 v[96:99], v[44:47], v[100:107], v2
  ds_read_b128 v[100:103], v5 offset:38912
  v_smfmac_f32_16x16x64_bf16 v[92:95], v[48:51], v[136:143], v2
  ds_read_b128 v[104:107], v5 offset:39936
  v_smfmac_f32_16x16x64_bf16 v[96:99], v[48:51], v[108:115], v2
  ds_read_b128 v[108:111], v5 offset:40960
  s_nop 0
  v_add_f32 v84, v84, v85
  v_add_f32 v86, v86, v87
  v_add_f32 v88, v88, v89
  v_add_f32_e64 v90, v90, v91
  v_cvt_pk_bf16_f32 v84, v84, v86
  v_cvt_pk_bf16_f32 v85, v88, v90
  ds_write2_b32 v8, v84, v85 offset0:0 offset1:128
  v_smfmac_f32_16x16x64_bf16 v[92:95], v[52:55], v[144:151], v2
  ds_read_b128 v[112:115], v5 offset:41984
  v_smfmac_f32_16x16x64_bf16 v[96:99], v[52:55], v[116:123], v2
  ds_read_b128 v[44:47], v6 offset:0
  buffer_store_dword v84, v14, s[4:7], s79 offen sc1
  buffer_store_dword v85, v14, s[4:7], s79 offen offset:256 sc1
  s_waitcnt lgkmcnt(2)
  s_barrier
  ds_read_b64_tr_b16 v[76:77], v9 offset:0
  ds_read_b64_tr_b16 v[78:79], v9 offset:256
  ds_read_b64_tr_b16 v[80:81], v9 offset:1024
  ds_read_b64_tr_b16 v[82:83], v9 offset:1280
  ds_read_b64_tr_b16 v[84:85], v9 offset:2048
  ds_read_b64_tr_b16 v[86:87], v9 offset:2304
  ds_read_b64_tr_b16 v[88:89], v9 offset:3072
  ds_read_b64_tr_b16 v[90:91], v9 offset:3328
  v_smfmac_f32_16x16x64_bf16 v[92:95], v[56:59], v[152:159], v2
  ds_read_b128 v[116:119], v5 offset:43008
  v_smfmac_f32_16x16x64_bf16 v[96:99], v[56:59], v[100:107], v2
  ds_read_b128 v[120:123], v5 offset:44032
  v_smfmac_f32_16x16x64_bf16 v[92:95], v[60:63], v[160:167], v2
  ds_read_b128 v[48:51], v6 offset:128
  s_waitcnt lgkmcnt(12)
  v_smfmac_f32_16x16x64_bf16 v[96:99], v[60:63], v[108:115], v2
  ds_read_b128 v[100:103], v5 offset:45056
  v_smfmac_f32_16x16x64_bf16 v[92:95], v[64:67], v[168:175], v2
  ds_read_b128 v[104:107], v5 offset:46080
  s_waitcnt lgkmcnt(3)
  v_smfmac_f32_16x16x64_bf16 v[96:99], v[64:67], v[116:123], v2
  ds_read_b128 v[108:111], v5 offset:47104
  v_mfma_f32_16x16x32_bf16 v[116:119], v[44:47], v[76:79], 0
  ds_read_b128 v[112:115], v5 offset:48128
  s_waitcnt lgkmcnt(4)
  v_mfma_f32_16x16x32_bf16 v[120:123], v[48:51], v[76:79], 0
  ds_read_b128 v[52:55], v6 offset:2048
  v_smfmac_f32_16x16x64_bf16 v[92:95], v[68:71], v[176:183], v2
  ds_read_b128 v[56:59], v6 offset:2176
  s_waitcnt lgkmcnt(4)
  v_smfmac_f32_16x16x64_bf16 v[96:99], v[68:71], v[100:107], v2
  ds_read_b128 v[60:63], v6 offset:4096
  v_mfma_f32_16x16x32_bf16 v[100:103], v[76:79], v[76:79], 0
  ds_read_b128 v[64:67], v6 offset:4224
  v_smfmac_f32_16x16x64_bf16 v[92:95], v[72:75], v[184:191], v2
  ds_read_b128 v[68:71], v6 offset:6144
  s_waitcnt lgkmcnt(5)
  v_smfmac_f32_16x16x64_bf16 v[96:99], v[72:75], v[108:115], v2
  ds_read_b128 v[72:75], v6 offset:6272
  v_mfma_f32_16x16x32_bf16 v[100:103], v[80:83], v[80:83], v[100:103]
  ds_read_b128 v[44:47], v13 offset:0
  s_waitcnt lgkmcnt(6)
  v_mfma_f32_16x16x32_bf16 v[116:119], v[52:55], v[80:83], v[116:119]
  ds_read_b128 v[48:51], v13 offset:1024
  s_waitcnt lgkmcnt(6)
  v_mfma_f32_16x16x32_bf16 v[120:123], v[56:59], v[80:83], v[120:123]
  v_mov_b32 v109, 0
  v_mfma_f32_16x16x32_bf16 v[100:103], v[84:87], v[84:87], v[100:103]
  ds_read_b128 v[52:55], v13 offset:2048
  s_waitcnt lgkmcnt(6)
  v_mfma_f32_16x16x32_bf16 v[116:119], v[60:63], v[84:87], v[116:119]
  ds_read_b128 v[56:59], v13 offset:3072
  s_waitcnt lgkmcnt(6)
  v_mfma_f32_16x16x32_bf16 v[120:123], v[64:67], v[84:87], v[120:123]
  v_mov_b32 v111, 0
  v_mfma_f32_16x16x32_bf16 v[100:103], v[88:91], v[88:91], v[100:103]
  ds_read_b128 v[60:63], v13 offset:4096
  s_waitcnt lgkmcnt(6)
  v_mfma_f32_16x16x32_bf16 v[116:119], v[68:71], v[88:91], v[116:119]
  ds_read_b128 v[64:67], v13 offset:5120
  s_waitcnt lgkmcnt(6)
  v_mfma_f32_16x16x32_bf16 v[120:123], v[72:75], v[88:91], v[120:123]
  v_add_f32 v92, v92, v93
  v_add_f32 v94, v94, v95
  v_add_f32 v96, v96, v97
  v_add_f32 v98, v98, v99
  v_cvt_pk_bf16_f32 v108, v92, v94
  v_cvt_pk_bf16_f32 v110, v96, v98
  s_nop 0
  v_max3_f32 v124, v100, v101, v116
  v_max3_f32 v124, v124, v117, v118
  v_max3_f32 v125, v119, v120, v121
  v_max3_f32 v124, v124, v122, v123
  v_max_f32 v124, v124, v125
  v_mov_b32 v125, v124
  ds_read_b128 v[68:71], v13 offset:6144
  buffer_store_dword v108, v14, s[4:7], s79 offen offset:2048 sc1
  v_permlane16_swap_b32 v124, v125
  v_mov_b32 v113, 0
  v_max_f32 v124, v124, v125
  v_mov_b32 v125, v124
  ds_read_b128 v[72:75], v13 offset:7168
  buffer_store_dword v110, v14, s[4:7], s79 offen offset:2304 sc1
  v_permlane32_swap_b32 v124, v125
  s_add_u32 s79, s79, 0x20000
  v_max_f32 v124, v124, v125
  v_sub_f32 v116, v116, v124
  v_sub_f32 v117, v117, v124
  v_exp_f32 v116, v116
  v_sub_f32 v118, v118, v124
  v_exp_f32 v117, v117
  v_sub_f32 v119, v119, v124
  v_exp_f32 v118, v118
  v_cvt_pk_bf16_f32 v104, v116, v117
  v_sub_f32 v120, v120, v124
  v_exp_f32 v119, v119
  v_sub_f32 v121, v121, v124
  v_exp_f32 v120, v120
  v_cvt_pk_bf16_f32 v105, v118, v119
  v_sub_f32 v122, v122, v124
  v_exp_f32 v121, v121
  v_sub_f32 v123, v123, v124
  v_exp_f32 v122, v122
  v_cvt_pk_bf16_f32 v106, v120, v121
  v_sub_f32 v100, v100, v124
  v_exp_f32 v123, v123
  v_sub_f32 v101, v101, v124
  v_exp_f32 v100, v100
  v_cvt_pk_bf16_f32 v107, v122, v123
  v_exp_f32 v101, v101
  s_nop 0
  v_mfma_f32_16x16x32_bf16 v[84:87], v[16:19], v[104:107], 0
  v_cvt_pk_bf16_f32 v112, v100, v101
  v_mfma_f32_16x16x32_bf16 v[76:79], v[36:39], v[104:107], 0
  v_mov_b32 v96, 0
  v_mfma_f32_16x16x32_bf16 v[80:83], v[40:43], v[104:107], 0
  v_mov_b32 v97, 0
  s_nop 0
  v_mfma_f32_16x16x16_bf16 v[84:87], v[16:17], v[112:113], v[84:87]
  v_mov_b32 v98, 0
  v_mfma_f32_16x16x16_bf16 v[76:79], v[108:109], v[112:113], v[76:79]
  v_mov_b32 v99, 0
  v_mfma_f32_16x16x16_bf16 v[80:83], v[110:111], v[112:113], v[80:83]
  v_mov_b32 v100, 0
  v_mov_b32 v101, 0
  v_mov_b32 v102, 0
  v_mov_b32 v103, 0
  v_rcp_f32 v124, v84
  s_mov_b64 exec, s[84:85]
  v_mul_f32 v76, v76, v124
  v_mul_f32 v77, v77, v124
  v_mul_f32 v78, v78, v124
  v_mul_f32 v79, v79, v124
  v_cvt_pk_bf16_f32 v84, v76, v77
  v_cvt_pk_bf16_f32 v85, v78, v79
  v_mul_f32 v80, v80, v124
  v_mul_f32 v81, v81, v124
  v_mul_f32 v82, v82, v124
  v_mul_f32 v83, v83, v124
  v_cvt_pk_bf16_f32 v86, v80, v81
  v_cvt_pk_bf16_f32 v87, v82, v83
  ds_write_b128 v10, v[84:87]
  s_mov_b64 exec, -1
  v_pk_mov_b32 v[92:93], 0, 0
  v_pk_mov_b32 v[94:95], 0, 0
  v_pk_mov_b32 v[104:105], 0, 0
  v_pk_mov_b32 v[106:107], 0, 0
  v_pk_mov_b32 v[108:109], 0, 0
  v_pk_mov_b32 v[110:111], 0, 0
  s_waitcnt lgkmcnt(0)
  s_barrier
  ds_read_b128 v[76:79], v4 offset:14336
  ds_read_b128 v[80:83], v4 offset:15360
  v_pk_mov_b32 v[112:113], 0, 0
  v_pk_mov_b32 v[114:115], 0, 0
  v_pk_mov_b32 v[116:117], 0, 0
  v_pk_mov_b32 v[118:119], 0, 0
  v_pk_mov_b32 v[120:121], 0, 0
  v_pk_mov_b32 v[122:123], 0, 0
  v_xor_b32 v6, 0x2000, v6
  s_waitcnt lgkmcnt(0)
  v_smfmac_f32_16x16x64_bf16 v[108:111], v[76:79], v[44:51], v2
  ds_read_b128 v[44:47], v13 offset:8192
  v_smfmac_f32_16x16x64_bf16 v[108:111], v[80:83], v[52:59], v2
  ds_read_b128 v[48:51], v13 offset:9216
  v_smfmac_f32_16x16x64_bf16 v[112:115], v[76:79], v[60:67], v2
  ds_read_b128 v[52:55], v13 offset:10240
  v_smfmac_f32_16x16x64_bf16 v[112:115], v[80:83], v[68:75], v2
  ds_read_b128 v[56:59], v13 offset:11264
  v_smfmac_f32_16x16x64_bf16 v[92:95], v[76:79], v[192:199], v2
  ds_read_b128 v[60:63], v13 offset:12288
  v_smfmac_f32_16x16x64_bf16 v[92:95], v[80:83], v[200:207], v2
  ds_read_b128 v[64:67], v13 offset:13312
  v_smfmac_f32_16x16x64_bf16 v[96:99], v[76:79], v[208:215], v2
  ds_read_b128 v[68:71], v13 offset:14336
  v_smfmac_f32_16x16x64_bf16 v[96:99], v[80:83], v[216:223], v2
  ds_read_b128 v[72:75], v13 offset:15360
  v_smfmac_f32_16x16x64_bf16 v[100:103], v[76:79], v[224:231], v2
  v_add_f32 v108, v108, v109
  v_add_f32 v110, v110, v111
  v_smfmac_f32_16x16x64_bf16 v[100:103], v[80:83], v[232:239], v2
  v_add_f32 v112, v112, v113
  v_add_f32 v114, v114, v115
  v_smfmac_f32_16x16x64_bf16 v[104:107], v[76:79], v[240:247], v2
  v_cvt_pk_bf16_f32 v88, v108, v110
  v_or_b32 v88, 1, v88
  v_smfmac_f32_16x16x64_bf16 v[104:107], v[80:83], v[248:255], v2
  v_cvt_pk_bf16_f32 v89, v112, v114
  buffer_store_dwordx2 v[88:89], v11, s[4:7], s94 offen
  s_waitcnt lgkmcnt(6)
  v_smfmac_f32_16x16x64_bf16 v[116:119], v[76:79], v[44:51], v2
  v_add_f32 v92, v92, v93
  v_add_f32 v94, v94, v95
  s_waitcnt lgkmcnt(4)
  v_smfmac_f32_16x16x64_bf16 v[116:119], v[80:83], v[52:59], v2
  v_add_f32 v96, v96, v97
  v_add_f32 v98, v98, v99
  s_waitcnt lgkmcnt(2)
  v_smfmac_f32_16x16x64_bf16 v[120:123], v[76:79], v[60:67], v2
  v_cvt_pk_bf16_f32 v84, v92, v94
  v_or_b32 v84, 1, v84
  s_waitcnt lgkmcnt(0)
  v_smfmac_f32_16x16x64_bf16 v[120:123], v[80:83], v[68:75], v2
  v_cvt_pk_bf16_f32 v85, v96, v98
  buffer_store_dwordx2 v[84:85], v11, s[4:7], s92 offen
  v_add_f32 v100, v100, v101
  v_add_f32 v102, v102, v103
  v_add_f32 v104, v104, v105
  v_add_f32 v106, v106, v107
  v_cvt_pk_bf16_f32 v86, v100, v102
  v_or_b32 v86, 1, v86
  v_cvt_pk_bf16_f32 v87, v104, v106
  buffer_store_dwordx2 v[86:87], v11, s[4:7], s93 offen
  v_add_f32 v116, v116, v117
  v_add_f32 v118, v118, v119
  v_add_f32 v120, v120, v121
  v_add_f32 v122, v122, v123
  v_cvt_pk_bf16_f32 v90, v116, v118
  v_or_b32 v90, 1, v90
  v_cvt_pk_bf16_f32 v91, v120, v122
  buffer_store_dwordx2 v[90:91], v11, s[4:7], s95 offen
  s_cmp_ge_u32 s74, 64
  s_cbranch_scc1 L_ch_last_482
  ds_read_b128 v[100:103], v5 offset:32768
  ds_read_b128 v[104:107], v5 offset:33792
  ds_read_b128 v[108:111], v5 offset:34816
  ds_read_b128 v[112:115], v5 offset:35840
  ds_read_b128 v[116:119], v5 offset:36864
  ds_read_b128 v[120:123], v5 offset:37888
  v_pk_mov_b32 v[76:77], 0, 0
  v_pk_mov_b32 v[78:79], 0, 0
  v_pk_mov_b32 v[80:81], 0, 0
  v_pk_mov_b32 v[82:83], 0, 0
  v_pk_mov_b32 v[84:85], 0, 0
  v_pk_mov_b32 v[86:87], 0, 0
  v_pk_mov_b32 v[88:89], 0, 0
  v_pk_mov_b32 v[90:91], 0, 0
  v_pk_mov_b32 v[96:97], 0, 0
  v_pk_mov_b32 v[98:99], 0, 0
  s_cmp_ge_u32 s58, 2
  s_cbranch_scc1 L_ch_z_501
  s_sleep 2
L_ch_pr_499:
  buffer_load_dwordx4 v[44:47], v20, s[4:7], s67 offen offset:0 sc1
  buffer_load_dwordx4 v[48:51], v20, s[4:7], s67 offen offset:1024 sc1
  buffer_load_dwordx4 v[52:55], v20, s[4:7], s67 offen offset:2048 sc1
  buffer_load_dwordx4 v[56:59], v20, s[4:7], s67 offen offset:3072 sc1
  s_waitcnt vmcnt(3)
  v_mfma_f32_16x16x32_bf16 v[92:95], v[44:47], v[24:27], 0
  v_and_b32 v1, v44, v46
  s_waitcnt vmcnt(2)
  v_mfma_f32_16x16x32_bf16 v[92:95], v[48:51], v[24:27], v[92:95]
  v_bitop3_b32 v1, v1, v48, v50 bitop3:0x80
  s_waitcnt vmcnt(1)
  v_mfma_f32_16x16x32_bf16 v[92:95], v[52:55], v[24:27], v[92:95]
  v_bitop3_b32 v1, v1, v52, v54 bitop3:0x80
  s_waitcnt vmcnt(0)
  v_mfma_f32_16x16x32_bf16 v[92:95], v[56:59], v[24:27], v[92:95]
  v_bitop3_b32 v1, v1, v56, v58 bitop3:0x80
  v_and_b32 v1, 1, v1
  v_cmp_ne_u32 vcc, 1, v1
  s_cbranch_vccnz L_ch_prs_500
  s_mov_b64 exec, s[82:83]
  s_nop 2
  v_add_f32 v92, v92, v93
  v_add_f32 v94, v94, v95
  v_cvt_pk_bf16_f32 v23, v92, v94
  buffer_store_dword v23, v12, s[4:7], s77 offen
  s_mov_b64 exec, -1
L_ch_z_501:
  s_barrier
  v_pk_mov_b32 v[92:93], 0, 0
  v_pk_mov_b32 v[94:95], 0, 0
  s_add_u32 s77, s77, 8192
  s_mov_b32 s55, s74
  s_sleep 2
  s_branch L_ch_top_487
L_ch_last_482:
  s_endpgm
L_ch_pmr_489:
  s_add_u32 s72, s72, 1
  s_cmp_gt_u32 s72, 0x80000
  s_cbranch_scc1 L_exit
  s_branch L_ch_pm_488
L_ch_kvslow_490:
L_poll_502:
  buffer_load_dword v126, v15, s[4:7], s80 offen sc1
  s_waitcnt vmcnt(0)
  v_cmp_eq_u32 vcc, 0, v126
  s_cbranch_vccz L_pollok_503
  s_add_u32 s72, s72, 1
  s_cmp_gt_u32 s72, 0x80000
  s_cbranch_scc1 L_exit
  s_sleep 1
  s_branch L_poll_502
L_pollok_503:
  s_branch L_ch_kvback_491
L_ch_prs_493:
  s_add_u32 s72, s72, 1
  s_cmp_gt_u32 s72, 0x80000
  s_cbranch_scc1 L_exit
  s_branch L_ch_pr_492
L_ch_pmr_496:
  s_add_u32 s72, s72, 1
  s_cmp_gt_u32 s72, 0x80000
  s_cbranch_scc1 L_exit
  s_branch L_ch_pm_495
L_ch_kvslow_497:
L_poll_504:
  buffer_load_dword v126, v15, s[4:7], s80 offen sc1
  s_waitcnt vmcnt(0)
  v_cmp_eq_u32 vcc, 0, v126
  s_cbranch_vccz L_pollok_505
  s_add_u32 s72, s72, 1
  s_cmp_gt_u32 s72, 0x80000
  s_cbranch_scc1 L_exit
  s_sleep 1
  s_branch L_poll_504
L_pollok_505:
  s_branch L_ch_kvback_498
L_ch_prs_500:
  s_add_u32 s72, s72, 1
  s_cmp_gt_u32 s72, 0x80000
  s_cbranch_scc1 L_exit
  s_branch L_ch_pr_499
B_chain:
  v_mov_b32 v2, 0x44444444
  v_bfe_i32 v1, v0, 0, 1
  v_and_b32 v1, 0xaaaaaaaa, v1
  v_add_u32 v2, v2, v1
  v_mov_b32 v3, 0x0
  v_bfe_i32 v1, v0, 0, 1
  v_and_b32 v1, 0x10, v1
  v_add_u32 v3, v3, v1
  v_bfe_i32 v1, v0, 1, 1
  v_and_b32 v1, 0x20, v1
  v_add_u32 v3, v3, v1
  v_bfe_i32 v1, v0, 2, 1
  v_and_b32 v1, 0x40, v1
  v_add_u32 v3, v3, v1
  v_bfe_i32 v1, v0, 3, 1
  v_and_b32 v1, 0x80, v1
  v_add_u32 v3, v3, v1
  v_bfe_i32 v1, v0, 4, 1
  v_and_b32 v1, 0x100, v1
  v_add_u32 v3, v3, v1
  v_bfe_i32 v1, v0, 5, 1
  v_and_b32 v1, 0x200, v1
  v_add_u32 v3, v3, v1
  v_bfe_i32 v1, v0, 6, 1
  v_and_b32 v1, 0x800, v1
  v_add_u32 v3, v3, v1
  v_bfe_i32 v1, v0, 7, 1
  v_and_b32 v1, 0x1000, v1
  v_add_u32 v3, v3, v1
  v_mov_b32 v21, 0x0
  v_bfe_i32 v1, v0, 0, 1
  v_and_b32 v1, 0x10, v1
  v_add_u32 v21, v21, v1
  v_bfe_i32 v1, v0, 1, 1
  v_and_b32 v1, 0x20, v1
  v_add_u32 v21, v21, v1
  v_bfe_i32 v1, v0, 2, 1
  v_and_b32 v1, 0x40, v1
  v_add_u32 v21, v21, v1
  v_bfe_i32 v1, v0, 3, 1
  v_and_b32 v1, 0x80, v1
  v_add_u32 v21, v21, v1
  v_bfe_i32 v1, v0, 4, 1
  v_and_b32 v1, 0x100, v1
  v_add_u32 v21, v21, v1
  v_bfe_i32 v1, v0, 5, 1
  v_and_b32 v1, 0x200, v1
  v_add_u32 v21, v21, v1
  v_bfe_i32 v1, v0, 6, 1
  v_and_b32 v1, 0x400, v1
  v_add_u32 v21, v21, v1
  v_bfe_i32 v1, v0, 7, 1
  v_and_b32 v1, 0x800, v1
  v_add_u32 v21, v21, v1
  v_mov_b32 v4, 0x0
  v_bfe_i32 v1, v0, 0, 1
  v_and_b32 v1, 0x10, v1
  v_add_u32 v4, v4, v1
  v_bfe_i32 v1, v0, 1, 1
  v_and_b32 v1, 0x20, v1
  v_add_u32 v4, v4, v1
  v_bfe_i32 v1, v0, 2, 1
  v_and_b32 v1, 0x40, v1
  v_add_u32 v4, v4, v1
  v_bfe_i32 v1, v0, 3, 1
  v_and_b32 v1, 0x80, v1
  v_add_u32 v4, v4, v1
  v_bfe_i32 v1, v0, 4, 1
  v_and_b32 v1, 0x100, v1
  v_add_u32 v4, v4, v1
  v_bfe_i32 v1, v0, 5, 1
  v_and_b32 v1, 0x200, v1
  v_add_u32 v4, v4, v1
  v_mov_b32 v5, 0x0
  v_bfe_i32 v1, v0, 0, 1
  v_and_b32 v1, 0x10, v1
  v_add_u32 v5, v5, v1
  v_bfe_i32 v1, v0, 1, 1
  v_and_b32 v1, 0x20, v1
  v_add_u32 v5, v5, v1
  v_bfe_i32 v1, v0, 2, 1
  v_and_b32 v1, 0x40, v1
  v_add_u32 v5, v5, v1
  v_bfe_i32 v1, v0, 3, 1
  v_and_b32 v1, 0x80, v1
  v_add_u32 v5, v5, v1
  v_bfe_i32 v1, v0, 4, 1
  v_and_b32 v1, 0x100, v1
  v_add_u32 v5, v5, v1
  v_bfe_i32 v1, v0, 5, 1
  v_and_b32 v1, 0x200, v1
  v_add_u32 v5, v5, v1
  v_bfe_i32 v1, v0, 6, 1
  v_and_b32 v1, 0x4000, v1
  v_add_u32 v5, v5, v1
  v_bfe_i32 v1, v0, 7, 1
  v_and_b32 v1, 0x8000, v1
  v_add_u32 v5, v5, v1
  v_mov_b32 v6, 0x4000
  v_bfe_i32 v1, v0, 0, 1
  v_and_b32 v1, 0x10, v1
  v_add_u32 v6, v6, v1
  v_bfe_i32 v1, v0, 1, 1
  v_and_b32 v1, 0x20, v1
  v_add_u32 v6, v6, v1
  v_bfe_i32 v1, v0, 2, 1
  v_and_b32 v1, 0x40, v1
  v_add_u32 v6, v6, v1
  v_bfe_i32 v1, v0, 3, 1
  v_and_b32 v1, 0x100, v1
  v_add_u32 v6, v6, v1
  v_bfe_i32 v1, v0, 4, 1
  v_and_b32 v1, 0x200, v1
  v_add_u32 v6, v6, v1
  v_bfe_i32 v1, v0, 5, 1
  v_and_b32 v1, 0x400, v1
  v_add_u32 v6, v6, v1
  v_mov_b32 v7, 0x0
  v_bfe_i32 v1, v0, 0, 1
  v_and_b32 v1, 0x10, v1
  v_add_u32 v7, v7, v1
  v_bfe_i32 v1, v0, 1, 1
  v_and_b32 v1, 0x20, v1
  v_add_u32 v7, v7, v1
  v_bfe_i32 v1, v0, 2, 1
  v_and_b32 v1, 0x40, v1
  v_add_u32 v7, v7, v1
  v_bfe_i32 v1, v0, 3, 1
  v_and_b32 v1, 0x80, v1
  v_add_u32 v7, v7, v1
  v_bfe_i32 v1, v0, 4, 1
  v_and_b32 v1, 0x200, v1
  v_add_u32 v7, v7, v1
  v_bfe_i32 v1, v0, 5, 1
  v_and_b32 v1, 0x400, v1
  v_add_u32 v7, v7, v1
  v_bfe_i32 v1, v0, 6, 1
  v_and_b32 v1, 0x800, v1
  v_add_u32 v7, v7, v1
  v_bfe_i32 v1, v0, 7, 1
  v_and_b32 v1, 0x1000, v1
  v_add_u32 v7, v7, v1
  v_mov_b32 v8, 0x2000
  v_bfe_i32 v1, v0, 0, 1
  v_and_b32 v1, 0x20, v1
  v_add_u32 v8, v8, v1
  v_bfe_i32 v1, v0, 1, 1
  v_and_b32 v1, 0x40, v1
  v_add_u32 v8, v8, v1
  v_bfe_i32 v1, v0, 2, 1
  v_and_b32 v1, 0x80, v1
  v_add_u32 v8, v8, v1
  v_bfe_i32 v1, v0, 3, 1
  v_and_b32 v1, 0x100, v1
  v_add_u32 v8, v8, v1
  v_bfe_i32 v1, v0, 4, 1
  v_and_b32 v1, 0x8, v1
  v_add_u32 v8, v8, v1
  v_bfe_i32 v1, v0, 5, 1
  v_and_b32 v1, 0x10, v1
  v_add_u32 v8, v8, v1
  v_bfe_i32 v1, v0, 6, 1
  v_and_b32 v1, 0x400, v1
  v_add_u32 v8, v8, v1
  v_bfe_i32 v1, v0, 7, 1
  v_and_b32 v1, 0x800, v1
  v_add_u32 v8, v8, v1
  v_mov_b32 v9, 0x2000
  v_bfe_i32 v1, v0, 0, 1
  v_and_b32 v1, 0x8, v1
  v_add_u32 v9, v9, v1
  v_bfe_i32 v1, v0, 1, 1
  v_and_b32 v1, 0x10, v1
  v_add_u32 v9, v9, v1
  v_bfe_i32 v1, v0, 2, 1
  v_and_b32 v1, 0x20, v1
  v_add_u32 v9, v9, v1
  v_bfe_i32 v1, v0, 3, 1
  v_and_b32 v1, 0x40, v1
  v_add_u32 v9, v9, v1
  v_bfe_i32 v1, v0, 4, 1
  v_and_b32 v1, 0x80, v1
  v_add_u32 v9, v9, v1
  v_bfe_i32 v1, v0, 5, 1
  v_and_b32 v1, 0x200, v1
  v_add_u32 v9, v9, v1
  v_mov_b32 v10, 0x3800
  v_bfe_i32 v1, v0, 0, 1
  v_and_b32 v1, 0x20, v1
  v_add_u32 v10, v10, v1
  v_bfe_i32 v1, v0, 2, 1
  v_and_b32 v1, 0x40, v1
  v_add_u32 v10, v10, v1
  v_bfe_i32 v1, v0, 3, 1
  v_and_b32 v1, 0x80, v1
  v_add_u32 v10, v10, v1
  v_bfe_i32 v1, v0, 4, 1
  v_and_b32 v1, 0x10, v1
  v_add_u32 v10, v10, v1
  v_bfe_i32 v1, v0, 5, 1
  v_and_b32 v1, 0x100, v1
  v_add_u32 v10, v10, v1
  v_bfe_i32 v1, v0, 6, 1
  v_and_b32 v1, 0x200, v1
  v_add_u32 v10, v10, v1
  v_bfe_i32 v1, v0, 7, 1
  v_and_b32 v1, 0x400, v1
  v_add_u32 v10, v10, v1
  v_mov_b32 v11, 0x0
  v_bfe_i32 v1, v0, 0, 1
  v_and_b32 v1, 0x20, v1
  v_add_u32 v11, v11, v1
  v_bfe_i32 v1, v0, 1, 1
  v_and_b32 v1, 0x40, v1
  v_add_u32 v11, v11, v1
  v_bfe_i32 v1, v0, 2, 1
  v_and_b32 v1, 0x1000, v1
  v_add_u32 v11, v11, v1
  v_bfe_i32 v1, v0, 3, 1
  v_and_b32 v1, 0x2000, v1
  v_add_u32 v11, v11, v1
  v_bfe_i32 v1, v0, 4, 1
  v_and_b32 v1, 0x8, v1
  v_add_u32 v11, v11, v1
  v_bfe_i32 v1, v0, 5, 1
  v_and_b32 v1, 0x10, v1
  v_add_u32 v11, v11, v1
  v_bfe_i32 v1, v0, 6, 1
  v_and_b32 v1, 0x10000, v1
  v_add_u32 v11, v11, v1
  v_bfe_i32 v1, v0, 7, 1
  v_and_b32 v1, 0x20000, v1
  v_add_u32 v11, v11, v1
  v_mov_b32 v20, 0x0
  v_bfe_i32 v1, v0, 0, 1
  v_and_b32 v1, 0x80, v1
  v_add_u32 v20, v20, v1
  v_bfe_i32 v1, v0, 1, 1
  v_and_b32 v1, 0x20, v1
  v_add_u32 v20, v20, v1
  v_bfe_i32 v1, v0, 2, 1
  v_and_b32 v1, 0x40, v1
  v_add_u32 v20, v20, v1
  v_bfe_i32 v1, v0, 3, 1
  v_and_b32 v1, 0x10, v1
  v_add_u32 v20, v20, v1
  v_bfe_i32 v1, v0, 4, 1
  v_and_b32 v1, 0x100, v1
  v_add_u32 v20, v20, v1
  v_bfe_i32 v1, v0, 5, 1
  v_and_b32 v1, 0x200, v1
  v_add_u32 v20, v20, v1
  v_bfe_i32 v1, v0, 6, 1
  v_and_b32 v1, 0x1000, v1
  v_add_u32 v20, v20, v1
  v_mov_b32 v12, 0x0
  v_bfe_i32 v1, v0, 0, 1
  v_and_b32 v1, 0x20, v1
  v_add_u32 v12, v12, v1
  v_bfe_i32 v1, v0, 1, 1
  v_and_b32 v1, 0x100, v1
  v_add_u32 v12, v12, v1
  v_bfe_i32 v1, v0, 2, 1
  v_and_b32 v1, 0x40, v1
  v_add_u32 v12, v12, v1
  v_bfe_i32 v1, v0, 4, 1
  v_and_b32 v1, 0x4, v1
  v_add_u32 v12, v12, v1
  v_bfe_i32 v1, v0, 5, 1
  v_and_b32 v1, 0x80, v1
  v_add_u32 v12, v12, v1
  v_bfe_i32 v1, v0, 6, 1
  v_and_b32 v1, 0x8, v1
  v_add_u32 v12, v12, v1
  v_mov_b32 v14, 0x0
  v_bfe_i32 v1, v0, 0, 1
  v_and_b32 v1, 0x10, v1
  v_add_u32 v14, v14, v1
  v_bfe_i32 v1, v0, 1, 1
  v_and_b32 v1, 0x20, v1
  v_add_u32 v14, v14, v1
  v_bfe_i32 v1, v0, 2, 1
  v_and_b32 v1, 0x40, v1
  v_add_u32 v14, v14, v1
  v_bfe_i32 v1, v0, 3, 1
  v_and_b32 v1, 0x80, v1
  v_add_u32 v14, v14, v1
  v_bfe_i32 v1, v0, 4, 1
  v_and_b32 v1, 0x4, v1
  v_add_u32 v14, v14, v1
  v_bfe_i32 v1, v0, 5, 1
  v_and_b32 v1, 0x8, v1
  v_add_u32 v14, v14, v1
  v_bfe_i32 v1, v0, 6, 1
  v_and_b32 v1, 0x200, v1
  v_add_u32 v14, v14, v1
  v_bfe_i32 v1, v0, 7, 1
  v_and_b32 v1, 0x400, v1
  v_add_u32 v14, v14, v1
  v_mov_b32 v15, 0x0
  v_bfe_i32 v1, v0, 0, 1
  v_and_b32 v1, 0x4, v1
  v_add_u32 v15, v15, v1
  v_bfe_i32 v1, v0, 1, 1
  v_and_b32 v1, 0x8, v1
  v_add_u32_e64 v15, v15, v1
  v_mov_b32 v16, 0x3f803f80
  v_mov_b32 v17, 0x3f803f80
  v_mov_b32 v18, 0x3f803f80
  v_mov_b32 v19, 0x3f803f80
  s_mov_b32 s81, 0x3e0293ee
  s_mov_b32 s82, 0x00ff00ff
  s_mov_b32 s83, 0x00ff00ff
  s_mov_b32 s84, 0xcccccccc
  s_mov_b32 s85, 0xcccccccc
  s_mov_b32 s8, s28
  s_and_b32 s9, s29, 0xffff
  s_mov_b32 s10, 0x400000
  s_mov_b32 s11, 0x20000
  s_mov_b32 s12, s30
  s_and_b32 s13, s31, 0xffff
  s_mov_b32 s14, 0x400000
  s_mov_b32 s15, 0x20000
  s_mov_b32 s16, s32
  s_and_b32 s17, s33, 0xffff
  s_mov_b32 s18, 0x400000
  s_mov_b32 s19, 0x20000
  s_mov_b32 s20, s34
  s_and_b32 s21, s35, 0xffff
  s_mov_b32 s22, 0x400000
  s_mov_b32 s23, 0x20000
  v_mov_b32 v112, 0x0
  v_bfe_i32 v1, v0, 0, 1
  v_and_b32 v1, 0x10, v1
  v_xor_b32 v112, v112, v1
  v_bfe_i32 v1, v0, 1, 1
  v_and_b32 v1, 0x20, v1
  v_xor_b32 v112, v112, v1
  v_bfe_i32 v1, v0, 2, 1
  v_and_b32 v1, 0x40, v1
  v_xor_b32 v112, v112, v1
  v_bfe_i32 v1, v0, 3, 1
  v_and_b32 v1, 0x80, v1
  v_xor_b32 v112, v112, v1
  v_bfe_i32 v1, v0, 4, 1
  v_and_b32 v1, 0x20, v1
  v_xor_b32 v112, v112, v1
  v_mov_b32 v113, 0x40
  v_bfe_i32 v1, v0, 0, 1
  v_and_b32 v1, 0x10, v1
  v_xor_b32 v113, v113, v1
  v_bfe_i32 v1, v0, 1, 1
  v_and_b32 v1, 0x20, v1
  v_xor_b32 v113, v113, v1
  v_bfe_i32 v1, v0, 2, 1
  v_and_b32 v1, 0x40, v1
  v_xor_b32 v113, v113, v1
  v_bfe_i32 v1, v0, 3, 1
  v_and_b32 v1, 0x80, v1
  v_xor_b32 v113, v113, v1
  v_bfe_i32 v1, v0, 4, 1
  v_and_b32 v1, 0x20, v1
  v_xor_b32 v113, v113, v1
  v_mov_b32 v114, 0x80
  v_bfe_i32 v1, v0, 0, 1
  v_and_b32 v1, 0x10, v1
  v_xor_b32 v114, v114, v1
  v_bfe_i32 v1, v0, 1, 1
  v_and_b32 v1, 0x20, v1
  v_xor_b32 v114, v114, v1
  v_bfe_i32 v1, v0, 2, 1
  v_and_b32 v1, 0x40, v1
  v_xor_b32 v114, v114, v1
  v_bfe_i32 v1, v0, 3, 1
  v_and_b32 v1, 0x80, v1
  v_xor_b32 v114, v114, v1
  v_bfe_i32 v1, v0, 4, 1
  v_and_b32 v1, 0x20, v1
  v_xor_b32 v114, v114, v1
  v_mov_b32 v115, 0xc0
  v_bfe_i32 v1, v0, 0, 1
  v_and_b32 v1, 0x10, v1
  v_xor_b32 v115, v115, v1
  v_bfe_i32 v1, v0, 1, 1
  v_and_b32 v1, 0x20, v1
  v_xor_b32 v115, v115, v1
  v_bfe_i32 v1, v0, 2, 1
  v_and_b32 v1, 0x40, v1
  v_xor_b32 v115, v115, v1
  v_bfe_i32 v1, v0, 3, 1
  v_and_b32 v1, 0x80, v1
  v_xor_b32 v115, v115, v1
  v_bfe_i32 v1, v0, 4, 1
  v_and_b32 v1, 0x20, v1
  v_xor_b32 v115, v115, v1
  v_mov_b32 v116, 0x0
  v_bfe_i32 v1, v0, 4, 1
  v_and_b32 v1, 0x2000, v1
  v_add_u32 v116, v116, v1
  v_bfe_i32 v1, v0, 5, 1
  v_and_b32 v1, 0x4000, v1
  v_add_u32 v116, v116, v1
  v_add_u32 v112, v112, v116
  v_add_u32 v113, v113, v116
  v_add_u32 v114, v114, v116
  v_add_u32 v115, v115, v116
  v_mov_b32 v116, 0x8000
  v_bfe_i32 v1, v0, 0, 1
  v_and_b32 v1, 0x8, v1
  v_xor_b32 v116, v116, v1
  v_bfe_i32 v1, v0, 1, 1
  v_and_b32 v1, 0x10, v1
  v_xor_b32 v116, v116, v1
  v_bfe_i32 v1, v0, 2, 1
  v_and_b32 v1, 0x120, v1
  v_xor_b32 v116, v116, v1
  v_bfe_i32 v1, v0, 3, 1
  v_and_b32 v1, 0x880, v1
  v_xor_b32 v116, v116, v1
  v_bfe_i32 v1, v0, 4, 1
  v_and_b32 v1, 0x440, v1
  v_xor_b32 v116, v116, v1
  v_bfe_i32 v1, v0, 5, 1
  v_and_b32 v1, 0x1000, v1
  v_xor_b32 v116, v116, v1
  v_bfe_i32 v1, v0, 6, 1
  v_and_b32 v1, 0x40, v1
  v_xor_b32 v116, v116, v1
  v_bfe_i32 v1, v0, 7, 1
  v_and_b32 v1, 0x80, v1
  v_xor_b32 v116, v116, v1
  v_add_u32 v117, 0x10000, v116
  v_xor_b32 v118, 32, v116
  v_xor_b32 v119, 32, v117
  s_barrier
  s_lshl_b32 s61, s58, 19
  s_lshl_b32 s62, s54, 8
  s_add_u32 s61, s61, s62
  s_add_u32 s61, s61, 0x0
  s_lshl_b32 s62, s58, 14
  s_add_u32 s62, s62, 32768
  s_mov_b32 s63, 0
L_cw_506:
  s_mov_b32 m0, s62
  s_add_u32 s62, s62, 1024
  buffer_load_dwordx4 v112, s[8:11], s61 offen lds
  s_add_u32 s61, s61, 32768
  s_mov_b32 m0, s62
  s_add_u32 s62, s62, 1024
  buffer_load_dwordx4 v113, s[8:11], s61 offen lds
  s_add_u32 s61, s61, 32768
  s_mov_b32 m0, s62
  s_add_u32 s62, s62, 1024
  buffer_load_dwordx4 v114, s[8:11], s61 offen lds
  s_add_u32 s61, s61, 32768
  s_mov_b32 m0, s62
  s_add_u32 s62, s62, 1024
  buffer_load_dwordx4 v115, s[8:11], s61 offen lds
  s_add_u32 s61, s61, 32768
  s_add_u32 s63, s63, 1
  s_cmp_lt_u32 s63, 4
  s_cbranch_scc1 L_cw_506
  s_lshl_b32 s61, s58, 19
  s_lshl_b32 s62, s54, 8
  s_add_u32 s61, s61, s62
  s_add_u32 s61, s61, 0x200000
  s_lshl_b32 s62, s58, 14
  s_add_u32 s62, s62, 98304
  s_mov_b32 s63, 0
L_cw_507:
  s_mov_b32 m0, s62
  s_add_u32 s62, s62, 1024
  buffer_load_dwordx4 v112, s[8:11], s61 offen lds
  s_add_u32 s61, s61, 32768
  s_mov_b32 m0, s62
  s_add_u32 s62, s62, 1024
  buffer_load_dwordx4 v113, s[8:11], s61 offen lds
  s_add_u32 s61, s61, 32768
  s_mov_b32 m0, s62
  s_add_u32 s62, s62, 1024
  buffer_load_dwordx4 v114, s[8:11], s61 offen lds
  s_add_u32 s61, s61, 32768
  s_mov_b32 m0, s62
  s_add_u32 s62, s62, 1024
  buffer_load_dwordx4 v115, s[8:11], s61 offen lds
  s_add_u32 s61, s61, 32768
  s_add_u32 s63, s63, 1
  s_cmp_lt_u32 s63, 4
  s_cbranch_scc1 L_cw_507
  s_waitcnt vmcnt(16)
  s_barrier
  ds_read_b64_tr_b16 a[0:1], v116 offset:0
  ds_read_b64_tr_b16 a[2:3], v116 offset:512
  ds_read_b64_tr_b16 a[4:5], v116 offset:8192
  ds_read_b64_tr_b16 a[6:7], v116 offset:8704
  ds_read_b64_tr_b16 a[8:9], v116 offset:16384
  ds_read_b64_tr_b16 a[10:11], v116 offset:16896
  ds_read_b64_tr_b16 a[12:13], v116 offset:24576
  ds_read_b64_tr_b16 a[14:15], v116 offset:25088
  s_waitcnt lgkmcnt(4)
  ds_read_b64_tr_b16 a[16:17], v116 offset:32768
  ds_read_b64_tr_b16 a[18:19], v116 offset:33280
  ds_read_b64_tr_b16 a[20:21], v116 offset:40960
  ds_read_b64_tr_b16 a[22:23], v116 offset:41472
  ds_read_b64_tr_b16 a[24:25], v116 offset:49152
  ds_read_b64_tr_b16 a[26:27], v116 offset:49664
  ds_read_b64_tr_b16 a[28:29], v116 offset:57344
  ds_read_b64_tr_b16 a[30:31], v116 offset:57856
  s_waitcnt lgkmcnt(4)
  ds_read_b64_tr_b16 a[64:65], v118 offset:0
  ds_read_b64_tr_b16 a[66:67], v118 offset:512
  ds_read_b64_tr_b16 a[68:69], v118 offset:8192
  ds_read_b64_tr_b16 a[70:71], v118 offset:8704
  ds_read_b64_tr_b16 a[72:73], v118 offset:16384
  ds_read_b64_tr_b16 a[74:75], v118 offset:16896
  ds_read_b64_tr_b16 a[76:77], v118 offset:24576
  ds_read_b64_tr_b16 a[78:79], v118 offset:25088
  s_waitcnt lgkmcnt(4)
  ds_read_b64_tr_b16 a[80:81], v118 offset:32768
  ds_read_b64_tr_b16 a[82:83], v118 offset:33280
  ds_read_b64_tr_b16 a[84:85], v118 offset:40960
  ds_read_b64_tr_b16 a[86:87], v118 offset:41472
  ds_read_b64_tr_b16 a[88:89], v118 offset:49152
  ds_read_b64_tr_b16 a[90:91], v118 offset:49664
  ds_read_b64_tr_b16 a[92:93], v118 offset:57344
  ds_read_b64_tr_b16 a[94:95], v118 offset:57856
  s_waitcnt lgkmcnt(4)
  s_waitcnt lgkmcnt(0)
  s_barrier
  s_lshl_b32 s61, s58, 19
  s_lshl_b32 s62, s54, 8
  s_add_u32 s61, s61, s62
  s_add_u32 s61, s61, 0x0
  s_lshl_b32 s62, s58, 14
  s_add_u32 s62, s62, 32768
  s_mov_b32 s63, 0
L_cw_508:
  s_mov_b32 m0, s62
  s_add_u32 s62, s62, 1024
  buffer_load_dwordx4 v112, s[12:15], s61 offen lds
  s_add_u32 s61, s61, 32768
  s_mov_b32 m0, s62
  s_add_u32 s62, s62, 1024
  buffer_load_dwordx4 v113, s[12:15], s61 offen lds
  s_add_u32 s61, s61, 32768
  s_mov_b32 m0, s62
  s_add_u32 s62, s62, 1024
  buffer_load_dwordx4 v114, s[12:15], s61 offen lds
  s_add_u32 s61, s61, 32768
  s_mov_b32 m0, s62
  s_add_u32 s62, s62, 1024
  buffer_load_dwordx4 v115, s[12:15], s61 offen lds
  s_add_u32 s61, s61, 32768
  s_add_u32 s63, s63, 1
  s_cmp_lt_u32 s63, 4
  s_cbranch_scc1 L_cw_508
  s_waitcnt vmcnt(16)
  s_barrier
  ds_read_b64_tr_b16 a[32:33], v117 offset:0
  ds_read_b64_tr_b16 a[34:35], v117 offset:512
  ds_read_b64_tr_b16 a[36:37], v117 offset:8192
  ds_read_b64_tr_b16 a[38:39], v117 offset:8704
  ds_read_b64_tr_b16 a[40:41], v117 offset:16384
  ds_read_b64_tr_b16 a[42:43], v117 offset:16896
  ds_read_b64_tr_b16 a[44:45], v117 offset:24576
  ds_read_b64_tr_b16 a[46:47], v117 offset:25088
  s_waitcnt lgkmcnt(4)
  ds_read_b64_tr_b16 a[48:49], v117 offset:32768
  ds_read_b64_tr_b16 a[50:51], v117 offset:33280
  ds_read_b64_tr_b16 a[52:53], v117 offset:40960
  ds_read_b64_tr_b16 a[54:55], v117 offset:41472
  ds_read_b64_tr_b16 a[56:57], v117 offset:49152
  ds_read_b64_tr_b16 a[58:59], v117 offset:49664
  ds_read_b64_tr_b16 a[60:61], v117 offset:57344
  ds_read_b64_tr_b16 a[62:63], v117 offset:57856
  s_waitcnt lgkmcnt(4)
  ds_read_b64_tr_b16 a[96:97], v119 offset:0
  ds_read_b64_tr_b16 a[98:99], v119 offset:512
  ds_read_b64_tr_b16 a[100:101], v119 offset:8192
  ds_read_b64_tr_b16 a[102:103], v119 offset:8704
  ds_read_b64_tr_b16 a[104:105], v119 offset:16384
  ds_read_b64_tr_b16 a[106:107], v119 offset:16896
  ds_read_b64_tr_b16 a[108:109], v119 offset:24576
  ds_read_b64_tr_b16 a[110:111], v119 offset:25088
  s_waitcnt lgkmcnt(4)
  ds_read_b64_tr_b16 a[112:113], v119 offset:32768
  ds_read_b64_tr_b16 a[114:115], v119 offset:33280
  ds_read_b64_tr_b16 a[116:117], v119 offset:40960
  ds_read_b64_tr_b16 a[118:119], v119 offset:41472
  ds_read_b64_tr_b16 a[120:121], v119 offset:49152
  ds_read_b64_tr_b16 a[122:123], v119 offset:49664
  ds_read_b64_tr_b16 a[124:125], v119 offset:57344
  ds_read_b64_tr_b16 a[126:127], v119 offset:57856
  s_waitcnt lgkmcnt(4)
  s_waitcnt lgkmcnt(0)
  s_barrier
  s_lshl_b32 s61, s58, 19
  s_lshl_b32 s62, s54, 8
  s_add_u32 s61, s61, s62
  s_add_u32 s61, s61, 0x200000
  s_lshl_b32 s62, s58, 14
  s_add_u32 s62, s62, 98304
  s_mov_b32 s63, 0
L_cw_509:
  s_mov_b32 m0, s62
  s_add_u32 s62, s62, 1024
  buffer_load_dwordx4 v112, s[12:15], s61 offen lds
  s_add_u32 s61, s61, 32768
  s_mov_b32 m0, s62
  s_add_u32 s62, s62, 1024
  buffer_load_dwordx4 v113, s[12:15], s61 offen lds
  s_add_u32 s61, s61, 32768
  s_mov_b32 m0, s62
  s_add_u32 s62, s62, 1024
  buffer_load_dwordx4 v114, s[12:15], s61 offen lds
  s_add_u32 s61, s61, 32768
  s_mov_b32 m0, s62
  s_add_u32 s62, s62, 1024
  buffer_load_dwordx4 v115, s[12:15], s61 offen lds
  s_add_u32 s61, s61, 32768
  s_add_u32 s63, s63, 1
  s_cmp_lt_u32 s63, 4
  s_cbranch_scc1 L_cw_509
  s_waitcnt vmcnt(16)
  s_barrier
  ds_read_b64_tr_b16 a[128:129], v116 offset:0
  ds_read_b64_tr_b16 a[130:131], v116 offset:512
  ds_read_b64_tr_b16 a[132:133], v116 offset:8192
  ds_read_b64_tr_b16 a[134:135], v116 offset:8704
  ds_read_b64_tr_b16 a[136:137], v116 offset:16384
  ds_read_b64_tr_b16 a[138:139], v116 offset:16896
  ds_read_b64_tr_b16 a[140:141], v116 offset:24576
  ds_read_b64_tr_b16 a[142:143], v116 offset:25088
  s_waitcnt lgkmcnt(4)
  ds_read_b64_tr_b16 a[144:145], v116 offset:32768
  ds_read_b64_tr_b16 a[146:147], v116 offset:33280
  ds_read_b64_tr_b16 a[148:149], v116 offset:40960
  ds_read_b64_tr_b16 a[150:151], v116 offset:41472
  ds_read_b64_tr_b16 a[152:153], v116 offset:49152
  ds_read_b64_tr_b16 a[154:155], v116 offset:49664
  ds_read_b64_tr_b16 a[156:157], v116 offset:57344
  ds_read_b64_tr_b16 a[158:159], v116 offset:57856
  s_waitcnt lgkmcnt(4)
  ds_read_b64_tr_b16 a[192:193], v118 offset:0
  ds_read_b64_tr_b16 a[194:195], v118 offset:512
  ds_read_b64_tr_b16 a[196:197], v118 offset:8192
  ds_read_b64_tr_b16 a[198:199], v118 offset:8704
  ds_read_b64_tr_b16 a[200:201], v118 offset:16384
  ds_read_b64_tr_b16 a[202:203], v118 offset:16896
  ds_read_b64_tr_b16 a[204:205], v118 offset:24576
  ds_read_b64_tr_b16 a[206:207], v118 offset:25088
  s_waitcnt lgkmcnt(4)
  ds_read_b64_tr_b16 a[208:209], v118 offset:32768
  ds_read_b64_tr_b16 a[210:211], v118 offset:33280
  ds_read_b64_tr_b16 a[212:213], v118 offset:40960
  ds_read_b64_tr_b16 a[214:215], v118 offset:41472
  ds_read_b64_tr_b16 a[216:217], v118 offset:49152
  ds_read_b64_tr_b16 a[218:219], v118 offset:49664
  ds_read_b64_tr_b16 a[220:221], v118 offset:57344
  ds_read_b64_tr_b16 a[222:223], v118 offset:57856
  s_waitcnt lgkmcnt(4)
  s_waitcnt lgkmcnt(0)
  s_barrier
  s_lshl_b32 s61, s58, 19
  s_lshl_b32 s62, s54, 8
  s_add_u32 s61, s61, s62
  s_add_u32 s61, s61, 0x0
  s_lshl_b32 s62, s58, 14
  s_add_u32 s62, s62, 32768
  s_mov_b32 s63, 0
L_cw_510:
  s_mov_b32 m0, s62
  s_add_u32 s62, s62, 1024
  buffer_load_dwordx4 v112, s[16:19], s61 offen lds
  s_add_u32 s61, s61, 32768
  s_mov_b32 m0, s62
  s_add_u32 s62, s62, 1024
  buffer_load_dwordx4 v113, s[16:19], s61 offen lds
  s_add_u32 s61, s61, 32768
  s_mov_b32 m0, s62
  s_add_u32 s62, s62, 1024
  buffer_load_dwordx4 v114, s[16:19], s61 offen lds
  s_add_u32 s61, s61, 32768
  s_mov_b32 m0, s62
  s_add_u32 s62, s62, 1024
  buffer_load_dwordx4 v115, s[16:19], s61 offen lds
  s_add_u32 s61, s61, 32768
  s_add_u32 s63, s63, 1
  s_cmp_lt_u32 s63, 4
  s_cbranch_scc1 L_cw_510
  s_waitcnt vmcnt(16)
  s_barrier
  ds_read_b64_tr_b16 a[160:161], v117 offset:0
  ds_read_b64_tr_b16 a[162:163], v117 offset:512
  ds_read_b64_tr_b16 a[164:165], v117 offset:8192
  ds_read_b64_tr_b16 a[166:167], v117 offset:8704
  ds_read_b64_tr_b16 a[168:169], v117 offset:16384
  ds_read_b64_tr_b16 a[170:171], v117 offset:16896
  ds_read_b64_tr_b16 a[172:173], v117 offset:24576
  ds_read_b64_tr_b16 a[174:175], v117 offset:25088
  s_waitcnt lgkmcnt(4)
  ds_read_b64_tr_b16 a[176:177], v117 offset:32768
  ds_read_b64_tr_b16 a[178:179], v117 offset:33280
  ds_read_b64_tr_b16 a[180:181], v117 offset:40960
  ds_read_b64_tr_b16 a[182:183], v117 offset:41472
  ds_read_b64_tr_b16 a[184:185], v117 offset:49152
  ds_read_b64_tr_b16 a[186:187], v117 offset:49664
  ds_read_b64_tr_b16 a[188:189], v117 offset:57344
  ds_read_b64_tr_b16 a[190:191], v117 offset:57856
  s_waitcnt lgkmcnt(4)
  ds_read_b64_tr_b16 a[224:225], v119 offset:0
  ds_read_b64_tr_b16 a[226:227], v119 offset:512
  ds_read_b64_tr_b16 a[228:229], v119 offset:8192
  ds_read_b64_tr_b16 a[230:231], v119 offset:8704
  ds_read_b64_tr_b16 a[232:233], v119 offset:16384
  ds_read_b64_tr_b16 a[234:235], v119 offset:16896
  ds_read_b64_tr_b16 a[236:237], v119 offset:24576
  ds_read_b64_tr_b16 a[238:239], v119 offset:25088
  s_waitcnt lgkmcnt(4)
  ds_read_b64_tr_b16 a[240:241], v119 offset:32768
  ds_read_b64_tr_b16 a[242:243], v119 offset:33280
  ds_read_b64_tr_b16 a[244:245], v119 offset:40960
  ds_read_b64_tr_b16 a[246:247], v119 offset:41472
  ds_read_b64_tr_b16 a[248:249], v119 offset:49152
  ds_read_b64_tr_b16 a[250:251], v119 offset:49664
  ds_read_b64_tr_b16 a[252:253], v119 offset:57344
  ds_read_b64_tr_b16 a[254:255], v119 offset:57856
  s_waitcnt lgkmcnt(4)
  s_waitcnt lgkmcnt(0)
  s_barrier
  s_lshl_b32 s61, s58, 19
  s_lshl_b32 s62, s54, 8
  s_add_u32 s61, s61, s62
  s_add_u32 s61, s61, 0x200000
  s_lshl_b32 s62, s58, 14
  s_add_u32 s62, s62, 98304
  s_mov_b32 s63, 0
L_cw_511:
  s_mov_b32 m0, s62
  s_add_u32 s62, s62, 1024
  buffer_load_dwordx4 v112, s[16:19], s61 offen lds
  s_add_u32 s61, s61, 32768
  s_mov_b32 m0, s62
  s_add_u32 s62, s62, 1024
  buffer_load_dwordx4 v113, s[16:19], s61 offen lds
  s_add_u32 s61, s61, 32768
  s_mov_b32 m0, s62
  s_add_u32 s62, s62, 1024
  buffer_load_dwordx4 v114, s[16:19], s61 offen lds
  s_add_u32 s61, s61, 32768
  s_mov_b32 m0, s62
  s_add_u32 s62, s62, 1024
  buffer_load_dwordx4 v115, s[16:19], s61 offen lds
  s_add_u32 s61, s61, 32768
  s_add_u32 s63, s63, 1
  s_cmp_lt_u32 s63, 4
  s_cbranch_scc1 L_cw_511
  s_waitcnt vmcnt(16)
  s_barrier
  ds_read_b64_tr_b16 v[128:129], v116 offset:0
  ds_read_b64_tr_b16 v[130:131], v116 offset:512
  ds_read_b64_tr_b16 v[132:133], v116 offset:8192
  ds_read_b64_tr_b16 v[134:135], v116 offset:8704
  ds_read_b64_tr_b16 v[136:137], v116 offset:16384
  ds_read_b64_tr_b16 v[138:139], v116 offset:16896
  ds_read_b64_tr_b16 v[140:141], v116 offset:24576
  ds_read_b64_tr_b16 v[142:143], v116 offset:25088
  s_waitcnt lgkmcnt(4)
  ds_read_b64_tr_b16 v[144:145], v116 offset:32768
  ds_read_b64_tr_b16 v[146:147], v116 offset:33280
  ds_read_b64_tr_b16 v[148:149], v116 offset:40960
  ds_read_b64_tr_b16 v[150:151], v116 offset:41472
  ds_read_b64_tr_b16 v[152:153], v116 offset:49152
  ds_read_b64_tr_b16 v[154:155], v116 offset:49664
  ds_read_b64_tr_b16 v[156:157], v116 offset:57344
  ds_read_b64_tr_b16 v[158:159], v116 offset:57856
  s_waitcnt lgkmcnt(4)
  ds_read_b64_tr_b16 v[44:45], v118 offset:0
  ds_read_b64_tr_b16 v[46:47], v118 offset:512
  ds_read_b64_tr_b16 v[48:49], v118 offset:8192
  ds_read_b64_tr_b16 v[50:51], v118 offset:8704
  ds_read_b64_tr_b16 v[52:53], v118 offset:16384
  ds_read_b64_tr_b16 v[54:55], v118 offset:16896
  ds_read_b64_tr_b16 v[56:57], v118 offset:24576
  ds_read_b64_tr_b16 v[58:59], v118 offset:25088
  s_waitcnt lgkmcnt(4)
  ds_read_b64_tr_b16 v[60:61], v118 offset:32768
  ds_read_b64_tr_b16 v[62:63], v118 offset:33280
  ds_read_b64_tr_b16 v[64:65], v118 offset:40960
  ds_read_b64_tr_b16 v[66:67], v118 offset:41472
  ds_read_b64_tr_b16 v[68:69], v118 offset:49152
  ds_read_b64_tr_b16 v[70:71], v118 offset:49664
  ds_read_b64_tr_b16 v[72:73], v118 offset:57344
  ds_read_b64_tr_b16 v[74:75], v118 offset:57856
  s_waitcnt lgkmcnt(4)
  s_waitcnt lgkmcnt(0)
  s_barrier
  s_waitcnt vmcnt(0)
  s_barrier
  ds_read_b64_tr_b16 v[160:161], v117 offset:0
  ds_read_b64_tr_b16 v[162:163], v117 offset:512
  ds_read_b64_tr_b16 v[164:165], v117 offset:8192
  ds_read_b64_tr_b16 v[166:167], v117 offset:8704
  ds_read_b64_tr_b16 v[168:169], v117 offset:16384
  ds_read_b64_tr_b16 v[170:171], v117 offset:16896
  ds_read_b64_tr_b16 v[172:173], v117 offset:24576
  ds_read_b64_tr_b16 v[174:175], v117 offset:25088
  s_waitcnt lgkmcnt(4)
  ds_read_b64_tr_b16 v[176:177], v117 offset:32768
  ds_read_b64_tr_b16 v[178:179], v117 offset:33280
  ds_read_b64_tr_b16 v[180:181], v117 offset:40960
  ds_read_b64_tr_b16 v[182:183], v117 offset:41472
  ds_read_b64_tr_b16 v[184:185], v117 offset:49152
  ds_read_b64_tr_b16 v[186:187], v117 offset:49664
  ds_read_b64_tr_b16 v[188:189], v117 offset:57344
  ds_read_b64_tr_b16 v[190:191], v117 offset:57856
  s_waitcnt lgkmcnt(4)
  ds_read_b64_tr_b16 v[76:77], v119 offset:0
  ds_read_b64_tr_b16 v[78:79], v119 offset:512
  ds_read_b64_tr_b16 v[80:81], v119 offset:8192
  ds_read_b64_tr_b16 v[82:83], v119 offset:8704
  ds_read_b64_tr_b16 v[84:85], v119 offset:16384
  ds_read_b64_tr_b16 v[86:87], v119 offset:16896
  ds_read_b64_tr_b16 v[88:89], v119 offset:24576
  ds_read_b64_tr_b16 v[90:91], v119 offset:25088
  s_waitcnt lgkmcnt(4)
  ds_read_b64_tr_b16 v[92:93], v119 offset:32768
  ds_read_b64_tr_b16 v[94:95], v119 offset:33280
  ds_read_b64_tr_b16 v[96:97], v119 offset:40960
  ds_read_b64_tr_b16 v[98:99], v119 offset:41472
  ds_read_b64_tr_b16 v[100:101], v119 offset:49152
  ds_read_b64_tr_b16 v[102:103], v119 offset:49664
  ds_read_b64_tr_b16 v[104:105], v119 offset:57344
  ds_read_b64_tr_b16 v[106:107], v119 offset:57856
  s_waitcnt lgkmcnt(4)
  s_waitcnt lgkmcnt(0)
  s_barrier
  v_mov_b32 v112, 0x0
  v_bfe_i32 v1, v0, 0, 1
  v_and_b32 v1, 0x10, v1
  v_add_u32 v112, v112, v1
  v_bfe_i32 v1, v0, 1, 1
  v_and_b32 v1, 0x20, v1
  v_add_u32 v112, v112, v1
  v_bfe_i32 v1, v0, 2, 1
  v_and_b32 v1, 0x40, v1
  v_add_u32 v112, v112, v1
  v_bfe_i32 v1, v0, 3, 1
  v_and_b32 v1, 0x80, v1
  v_add_u32 v112, v112, v1
  v_bfe_i32 v1, v0, 4, 1
  v_and_b32 v1, 0x100, v1
  v_add_u32 v112, v112, v1
  v_bfe_i32 v1, v0, 5, 1
  v_and_b32 v1, 0x200, v1
  v_add_u32 v112, v112, v1
  v_mov_b32 v116, 0x18000
  v_bfe_i32 v1, v0, 0, 1
  v_and_b32 v1, 0x8, v1
  v_add_u32 v116, v116, v1
  v_bfe_i32 v1, v0, 1, 1
  v_and_b32 v1, 0x10, v1
  v_add_u32 v116, v116, v1
  v_bfe_i32 v1, v0, 2, 1
  v_and_b32 v1, 0x420, v1
  v_add_u32 v116, v116, v1
  v_bfe_i32 v1, v0, 3, 1
  v_and_b32 v1, 0x1040, v1
  v_add_u32 v116, v116, v1
  v_bfe_i32 v1, v0, 4, 1
  v_and_b32 v1, 0x4080, v1
  v_add_u32 v116, v116, v1
  v_bfe_i32 v1, v0, 5, 1
  v_and_b32 v1, 0x2000, v1
  v_add_u32 v116, v116, v1
  v_bfe_i32 v1, v0, 6, 1
  v_and_b32 v1, 0x100, v1
  v_add_u32 v116, v116, v1
  v_bfe_i32 v1, v0, 7, 1
  v_and_b32 v1, 0x200, v1
  v_add_u32 v116, v116, v1
  s_barrier
  s_lshl_b32 s61, s54, 17
  s_lshl_b32 s62, s58, 14
  s_add_u32 s61, s61, s62
  s_add_u32 s61, s61, 0
  s_add_u32 s62, s62, 98304
  s_and_b32 s64, s58, 1
  s_lshl_b32 s64, s64, 7
  s_or_b32 s63, s64, 0
  v_xor_b32 v113, s63, v112
  s_mov_b32 m0, s62
  s_add_u32 s62, s62, 1024
  buffer_load_dwordx4 v113, s[20:23], s61 offen lds
  s_add_u32 s61, s61, 1024
  s_or_b32 s63, s64, 32
  v_xor_b32_e64 v114, s63, v112
  s_mov_b32 m0, s62
  s_add_u32 s62, s62, 1024
  buffer_load_dwordx4 v114, s[20:23], s61 offen lds
  s_add_u32 s61, s61, 1024
  s_or_b32 s63, s64, 0
  v_xor_b32_e64 v113, s63, v112
  s_mov_b32 m0, s62
  s_add_u32 s62, s62, 1024
  buffer_load_dwordx4 v113, s[20:23], s61 offen lds
  s_add_u32 s61, s61, 1024
  s_or_b32 s63, s64, 32
  v_xor_b32_e64 v114, s63, v112
  s_mov_b32 m0, s62
  s_add_u32 s62, s62, 1024
  buffer_load_dwordx4 v114, s[20:23], s61 offen lds
  s_add_u32 s61, s61, 1024
  s_or_b32 s63, s64, 64
  v_xor_b32_e64 v113, s63, v112
  s_mov_b32 m0, s62
  s_add_u32 s62, s62, 1024
  buffer_load_dwordx4 v113, s[20:23], s61 offen lds
  s_add_u32 s61, s61, 1024
  s_or_b32 s63, s64, 96
  v_xor_b32 v114, s63, v112
  s_mov_b32 m0, s62
  s_add_u32 s62, s62, 1024
  buffer_load_dwordx4 v114, s[20:23], s61 offen lds
  s_add_u32 s61, s61, 1024
  s_or_b32 s63, s64, 64
  v_xor_b32_e64 v113, s63, v112
  s_mov_b32 m0, s62
  s_add_u32 s62, s62, 1024
  buffer_load_dwordx4 v113, s[20:23], s61 offen lds
  s_add_u32 s61, s61, 1024
  s_or_b32 s63, s64, 96
  v_xor_b32 v114, s63, v112
  s_mov_b32 m0, s62
  s_add_u32 s62, s62, 1024
  buffer_load_dwordx4 v114, s[20:23], s61 offen lds
  s_add_u32 s61, s61, 1024
  s_or_b32 s63, s64, 0
  v_xor_b32_e64 v113, s63, v112
  s_mov_b32 m0, s62
  s_add_u32 s62, s62, 1024
  buffer_load_dwordx4 v113, s[20:23], s61 offen lds
  s_add_u32 s61, s61, 1024
  s_or_b32 s63, s64, 32
  v_xor_b32_e64 v114, s63, v112
  s_mov_b32 m0, s62
  s_add_u32 s62, s62, 1024
  buffer_load_dwordx4 v114, s[20:23], s61 offen lds
  s_add_u32 s61, s61, 1024
  s_or_b32 s63, s64, 0
  v_xor_b32_e64 v113, s63, v112
  s_mov_b32 m0, s62
  s_add_u32 s62, s62, 1024
  buffer_load_dwordx4 v113, s[20:23], s61 offen lds
  s_add_u32 s61, s61, 1024
  s_or_b32 s63, s64, 32
  v_xor_b32_e64 v114, s63, v112
  s_mov_b32 m0, s62
  s_add_u32 s62, s62, 1024
  buffer_load_dwordx4 v114, s[20:23], s61 offen lds
  s_add_u32 s61, s61, 1024
  s_or_b32 s63, s64, 64
  v_xor_b32_e64 v113, s63, v112
  s_mov_b32 m0, s62
  s_add_u32 s62, s62, 1024
  buffer_load_dwordx4 v113, s[20:23], s61 offen lds
  s_add_u32 s61, s61, 1024
  s_or_b32 s63, s64, 96
  v_xor_b32 v114, s63, v112
  s_mov_b32 m0, s62
  s_add_u32 s62, s62, 1024
  buffer_load_dwordx4 v114, s[20:23], s61 offen lds
  s_add_u32 s61, s61, 1024
  s_or_b32 s63, s64, 64
  v_xor_b32_e64 v113, s63, v112
  s_mov_b32 m0, s62
  s_add_u32 s62, s62, 1024
  buffer_load_dwordx4 v113, s[20:23], s61 offen lds
  s_add_u32 s61, s61, 1024
  s_or_b32 s63, s64, 96
  v_xor_b32 v114, s63, v112
  s_mov_b32 m0, s62
  s_add_u32 s62, s62, 1024
  buffer_load_dwordx4 v114, s[20:23], s61 offen lds
  s_add_u32 s61, s61, 1024
  ds_write_b128 v5, v[44:47] offset:32768
  ds_write_b128 v5, v[48:51] offset:33792
  ds_write_b128 v5, v[52:55] offset:34816
  ds_write_b128 v5, v[56:59] offset:35840
  ds_write_b128 v5, v[60:63] offset:36864
  ds_write_b128 v5, v[64:67] offset:37888
  ds_write_b128 v5, v[68:71] offset:38912
  ds_write_b128 v5, v[72:75] offset:39936
  ds_write_b128 v5, v[76:79] offset:40960
  ds_write_b128 v5, v[80:83] offset:41984
  ds_write_b128 v5, v[84:87] offset:43008
  ds_write_b128 v5, v[88:91] offset:44032
  ds_write_b128 v5, v[92:95] offset:45056
  ds_write_b128 v5, v[96:99] offset:46080
  ds_write_b128 v5, v[100:103] offset:47104
  ds_write_b128 v5, v[104:107] offset:48128
  s_waitcnt lgkmcnt(0)
  s_waitcnt vmcnt(0)
  s_barrier
  v_xor_b32 v117, 0, v116
  ds_read_b64_tr_b16 v[192:193], v117 offset:0
  ds_read_b64_tr_b16 v[194:195], v117 offset:2048
  ds_read_b64_tr_b16 v[196:197], v117 offset:32768
  ds_read_b64_tr_b16 v[198:199], v117 offset:34816
  s_waitcnt lgkmcnt(0)
  v_xor_b32 v117, 32, v116
  ds_read_b64_tr_b16 v[208:209], v117 offset:0
  ds_read_b64_tr_b16 v[210:211], v117 offset:2048
  ds_read_b64_tr_b16 v[212:213], v117 offset:32768
  ds_read_b64_tr_b16 v[214:215], v117 offset:34816
  s_waitcnt lgkmcnt(0)
  v_xor_b32 v117, 64, v116
  ds_read_b64_tr_b16 v[224:225], v117 offset:0
  ds_read_b64_tr_b16 v[226:227], v117 offset:2048
  ds_read_b64_tr_b16 v[228:229], v117 offset:32768
  ds_read_b64_tr_b16 v[230:231], v117 offset:34816
  s_waitcnt lgkmcnt(0)
  v_xor_b32 v117, 96, v116
  ds_read_b64_tr_b16 v[240:241], v117 offset:0
  ds_read_b64_tr_b16 v[242:243], v117 offset:2048
  ds_read_b64_tr_b16 v[244:245], v117 offset:32768
  ds_read_b64_tr_b16 v[246:247], v117 offset:34816
  s_waitcnt lgkmcnt(0)
  v_xor_b32 v117, 128, v116
  ds_read_b64_tr_b16 v[44:45], v117 offset:0
  ds_read_b64_tr_b16 v[46:47], v117 offset:2048
  ds_read_b64_tr_b16 v[48:49], v117 offset:32768
  ds_read_b64_tr_b16 v[50:51], v117 offset:34816
  s_waitcnt lgkmcnt(0)
  v_xor_b32 v117, 160, v116
  ds_read_b64_tr_b16 v[60:61], v117 offset:0
  ds_read_b64_tr_b16 v[62:63], v117 offset:2048
  ds_read_b64_tr_b16 v[64:65], v117 offset:32768
  ds_read_b64_tr_b16 v[66:67], v117 offset:34816
  s_waitcnt lgkmcnt(0)
  v_xor_b32 v117, 192, v116
  ds_read_b64_tr_b16 v[76:77], v117 offset:0
  ds_read_b64_tr_b16 v[78:79], v117 offset:2048
  ds_read_b64_tr_b16 v[80:81], v117 offset:32768
  ds_read_b64_tr_b16 v[82:83], v117 offset:34816
  s_waitcnt lgkmcnt(0)
  v_xor_b32 v117, 224, v116
  ds_read_b64_tr_b16 v[92:93], v117 offset:0
  ds_read_b64_tr_b16 v[94:95], v117 offset:2048
  ds_read_b64_tr_b16 v[96:97], v117 offset:32768
  ds_read_b64_tr_b16 v[98:99], v117 offset:34816
  s_waitcnt lgkmcnt(0)
  s_barrier
  s_lshl_b32 s61, s54, 17
  s_lshl_b32 s62, s58, 14
  s_add_u32 s61, s61, s62
  s_add_u32 s61, s61, 65536
  s_add_u32 s62, s62, 98304
  s_and_b32 s64, s58, 1
  s_lshl_b32 s64, s64, 7
  s_or_b32 s63, s64, 0
  v_xor_b32_e64 v113, s63, v112
  s_mov_b32 m0, s62
  s_add_u32 s62, s62, 1024
  buffer_load_dwordx4 v113, s[20:23], s61 offen lds
  s_add_u32 s61, s61, 1024
  s_or_b32 s63, s64, 32
  v_xor_b32_e64 v114, s63, v112
  s_mov_b32 m0, s62
  s_add_u32 s62, s62, 1024
  buffer_load_dwordx4 v114, s[20:23], s61 offen lds
  s_add_u32 s61, s61, 1024
  s_or_b32 s63, s64, 0
  v_xor_b32_e64 v113, s63, v112
  s_mov_b32 m0, s62
  s_add_u32 s62, s62, 1024
  buffer_load_dwordx4 v113, s[20:23], s61 offen lds
  s_add_u32 s61, s61, 1024
  s_or_b32 s63, s64, 32
  v_xor_b32_e64 v114, s63, v112
  s_mov_b32 m0, s62
  s_add_u32 s62, s62, 1024
  buffer_load_dwordx4 v114, s[20:23], s61 offen lds
  s_add_u32 s61, s61, 1024
  s_or_b32 s63, s64, 64
  v_xor_b32_e64 v113, s63, v112
  s_mov_b32 m0, s62
  s_add_u32 s62, s62, 1024
  buffer_load_dwordx4 v113, s[20:23], s61 offen lds
  s_add_u32 s61, s61, 1024
  s_or_b32 s63, s64, 96
  v_xor_b32 v114, s63, v112
  s_mov_b32 m0, s62
  s_add_u32 s62, s62, 1024
  buffer_load_dwordx4 v114, s[20:23], s61 offen lds
  s_add_u32 s61, s61, 1024
  s_or_b32 s63, s64, 64
  v_xor_b32_e64 v113, s63, v112
  s_mov_b32 m0, s62
  s_add_u32 s62, s62, 1024
  buffer_load_dwordx4 v113, s[20:23], s61 offen lds
  s_add_u32 s61, s61, 1024
  s_or_b32 s63, s64, 96
  v_xor_b32 v114, s63, v112
  s_mov_b32 m0, s62
  s_add_u32 s62, s62, 1024
  buffer_load_dwordx4 v114, s[20:23], s61 offen lds
  s_add_u32 s61, s61, 1024
  s_or_b32 s63, s64, 0
  v_xor_b32_e64 v113, s63, v112
  s_mov_b32 m0, s62
  s_add_u32 s62, s62, 1024
  buffer_load_dwordx4 v113, s[20:23], s61 offen lds
  s_add_u32 s61, s61, 1024
  s_or_b32 s63, s64, 32
  v_xor_b32_e64 v114, s63, v112
  s_mov_b32 m0, s62
  s_add_u32 s62, s62, 1024
  buffer_load_dwordx4 v114, s[20:23], s61 offen lds
  s_add_u32 s61, s61, 1024
  s_or_b32 s63, s64, 0
  v_xor_b32_e64 v113, s63, v112
  s_mov_b32 m0, s62
  s_add_u32 s62, s62, 1024
  buffer_load_dwordx4 v113, s[20:23], s61 offen lds
  s_add_u32 s61, s61, 1024
  s_or_b32 s63, s64, 32
  v_xor_b32_e64 v114, s63, v112
  s_mov_b32 m0, s62
  s_add_u32 s62, s62, 1024
  buffer_load_dwordx4 v114, s[20:23], s61 offen lds
  s_add_u32 s61, s61, 1024
  s_or_b32 s63, s64, 64
  v_xor_b32_e64 v113, s63, v112
  s_mov_b32 m0, s62
  s_add_u32 s62, s62, 1024
  buffer_load_dwordx4 v113, s[20:23], s61 offen lds
  s_add_u32 s61, s61, 1024
  s_or_b32 s63, s64, 96
  v_xor_b32 v114, s63, v112
  s_mov_b32 m0, s62
  s_add_u32 s62, s62, 1024
  buffer_load_dwordx4 v114, s[20:23], s61 offen lds
  s_add_u32 s61, s61, 1024
  s_or_b32 s63, s64, 64
  v_xor_b32_e64 v113, s63, v112
  s_mov_b32 m0, s62
  s_add_u32 s62, s62, 1024
  buffer_load_dwordx4 v113, s[20:23], s61 offen lds
  s_add_u32 s61, s61, 1024
  s_or_b32 s63, s64, 96
  v_xor_b32 v114, s63, v112
  s_mov_b32 m0, s62
  s_add_u32 s62, s62, 1024
  buffer_load_dwordx4 v114, s[20:23], s61 offen lds
  s_add_u32 s61, s61, 1024
  s_waitcnt vmcnt(0)
  s_barrier
  v_xor_b32_e64 v117, 0, v116
  ds_read_b64_tr_b16 v[200:201], v117 offset:0
  ds_read_b64_tr_b16 v[202:203], v117 offset:2048
  ds_read_b64_tr_b16 v[204:205], v117 offset:32768
  ds_read_b64_tr_b16 v[206:207], v117 offset:34816
  s_waitcnt lgkmcnt(0)
  v_xor_b32 v117, 32, v116
  ds_read_b64_tr_b16 v[216:217], v117 offset:0
  ds_read_b64_tr_b16 v[218:219], v117 offset:2048
  ds_read_b64_tr_b16 v[220:221], v117 offset:32768
  ds_read_b64_tr_b16 v[222:223], v117 offset:34816
  s_waitcnt lgkmcnt(0)
  v_xor_b32 v117, 64, v116
  ds_read_b64_tr_b16 v[232:233], v117 offset:0
  ds_read_b64_tr_b16 v[234:235], v117 offset:2048
  ds_read_b64_tr_b16 v[236:237], v117 offset:32768
  ds_read_b64_tr_b16 v[238:239], v117 offset:34816
  s_waitcnt lgkmcnt(0)
  v_xor_b32 v117, 96, v116
  ds_read_b64_tr_b16 v[248:249], v117 offset:0
  ds_read_b64_tr_b16 v[250:251], v117 offset:2048
  ds_read_b64_tr_b16 v[252:253], v117 offset:32768
  ds_read_b64_tr_b16 v[254:255], v117 offset:34816
  s_waitcnt lgkmcnt(0)
  v_xor_b32 v117, 128, v116
  ds_read_b64_tr_b16 v[52:53], v117 offset:0
  ds_read_b64_tr_b16 v[54:55], v117 offset:2048
  ds_read_b64_tr_b16 v[56:57], v117 offset:32768
  ds_read_b64_tr_b16 v[58:59], v117 offset:34816
  s_waitcnt lgkmcnt(0)
  v_xor_b32 v117, 160, v116
  ds_read_b64_tr_b16 v[68:69], v117 offset:0
  ds_read_b64_tr_b16 v[70:71], v117 offset:2048
  ds_read_b64_tr_b16 v[72:73], v117 offset:32768
  ds_read_b64_tr_b16 v[74:75], v117 offset:34816
  s_waitcnt lgkmcnt(0)
  v_xor_b32 v117, 192, v116
  ds_read_b64_tr_b16 v[84:85], v117 offset:0
  ds_read_b64_tr_b16 v[86:87], v117 offset:2048
  ds_read_b64_tr_b16 v[88:89], v117 offset:32768
  ds_read_b64_tr_b16 v[90:91], v117 offset:34816
  s_waitcnt lgkmcnt(0)
  v_xor_b32 v117, 224, v116
  ds_read_b64_tr_b16 v[100:101], v117 offset:0
  ds_read_b64_tr_b16 v[102:103], v117 offset:2048
  ds_read_b64_tr_b16 v[104:105], v117 offset:32768
  ds_read_b64_tr_b16 v[106:107], v117 offset:34816
  s_waitcnt lgkmcnt(0)
  s_barrier
  v_add_u32 v117, 98304, v5
  ds_write_b128 v117, v[44:47] offset:0
  ds_write_b128 v117, v[48:51] offset:1024
  ds_write_b128 v117, v[52:55] offset:2048
  ds_write_b128 v117, v[56:59] offset:3072
  ds_write_b128 v117, v[60:63] offset:4096
  ds_write_b128 v117, v[64:67] offset:5120
  ds_write_b128 v117, v[68:71] offset:6144
  ds_write_b128 v117, v[72:75] offset:7168
  ds_write_b128 v117, v[76:79] offset:8192
  ds_write_b128 v117, v[80:83] offset:9216
  ds_write_b128 v117, v[84:87] offset:10240
  ds_write_b128 v117, v[88:91] offset:11264
  ds_write_b128 v117, v[92:95] offset:12288
  ds_write_b128 v117, v[96:99] offset:13312
  ds_write_b128 v117, v[100:103] offset:14336
  ds_write_b128 v117, v[104:107] offset:15360
  s_waitcnt lgkmcnt(0)
  s_lshl_b32 s61, s54, 13
  s_add_u32 s78, s52, s61
  s_add_u32 s67, s75, s61
  s_add_u32 s67, s67, 0x82000
  s_lshl_b32 s61, s54, 7
  s_add_u32 s61, s75, s61
  s_add_u32 s92, s61, 0x82000
  s_add_u32 s93, s61, 0x86000
  s_add_u32 s94, s61, 0x8a000
  s_add_u32 s95, s61, 0x8e000
  s_lshl_b32 s61, s54, 4
  s_add_u32 s80, s53, s61
  s_sub_u32 s79, s53, 0x10000
  s_lshl_b32 s79, s79, 5
  s_add_u32 s79, s79, 0xd000000
  s_lshl_b32 s61, s54, 12
  s_add_u32 s79, s79, s61
  s_add_u32 s76, s75, 8192
  s_lshr_b32 s61, s54, 1
  s_lshl_b32 s61, s61, 9
  s_and_b32 s62, s54, 1
  s_lshl_b32 s62, s62, 4
  s_add_u32 s61, s61, s62
  s_add_u32 s77, s76, s61
  s_lshl_b32 s68, s58, 11
  s_add_u32 s68, s68, 16384
  s_cmp_ge_u32 s58, 2
  s_cselect_b32 s96, 3, 0
  v_add_u32 v13, 98304, v5
  v_and_b32 v1, 15, v0
  v_mov_b32 v24, 0
  v_mov_b32 v124, 0x3f80
  v_cmp_eq_u32 vcc, 0, v1
  s_nop 1
  v_cndmask_b32 v24, v24, v124, vcc
  v_mov_b32 v124, 0x3f800000
  v_cmp_eq_u32 vcc, 1, v1
  s_nop 1
  v_cndmask_b32 v24, v24, v124, vcc
  v_and_b32 v1, 15, v0
  v_mov_b32 v25, 0
  v_mov_b32 v124, 0x3f80
  v_cmp_eq_u32 vcc, 2, v1
  s_nop 1
  v_cndmask_b32 v25, v25, v124, vcc
  v_mov_b32 v124, 0x3f800000
  v_cmp_eq_u32 vcc, 3, v1
  s_nop 1
  v_cndmask_b32 v25, v25, v124, vcc
  v_and_b32 v1, 15, v0
  v_mov_b32 v26, 0
  v_mov_b32 v124, 0x3f80
  v_cmp_eq_u32 vcc, 4, v1
  s_nop 1
  v_cndmask_b32 v26, v26, v124, vcc
  v_mov_b32 v124, 0x3f800000
  v_cmp_eq_u32 vcc, 5, v1
  s_nop 1
  v_cndmask_b32 v26, v26, v124, vcc
  v_and_b32 v1, 15, v0
  v_mov_b32 v27, 0
  v_mov_b32 v124, 0x3f80
  v_cmp_eq_u32 vcc, 6, v1
  s_nop 1
  v_cndmask_b32 v27, v27, v124, vcc
  v_mov_b32 v124, 0x3f800000
  v_cmp_eq_u32 vcc, 7, v1
  s_nop 1
  v_cndmask_b32 v27, v27, v124, vcc
  s_mov_b32 s55, 0
  v_pk_mov_b32 v[76:77], 0, 0
  v_pk_mov_b32 v[78:79], 0, 0
  v_pk_mov_b32 v[80:81], 0, 0
  v_pk_mov_b32 v[82:83], 0, 0
  v_pk_mov_b32 v[84:85], 0, 0
  v_pk_mov_b32 v[86:87], 0, 0
  v_pk_mov_b32 v[88:89], 0, 0
  v_pk_mov_b32 v[90:91], 0, 0
  v_pk_mov_b32 v[92:93], 0, 0
  v_pk_mov_b32 v[94:95], 0, 0
  v_pk_mov_b32 v[96:97], 0, 0
  v_pk_mov_b32 v[98:99], 0, 0
  s_barrier
  ds_read_b128 v[100:103], v5 offset:32768
  ds_read_b128 v[104:107], v5 offset:33792
  ds_read_b128 v[108:111], v5 offset:34816
  ds_read_b128 v[112:115], v5 offset:35840
  ds_read_b128 v[116:119], v5 offset:36864
  ds_read_b128 v[120:123], v5 offset:37888
  s_mov_b32 s8, s48
  s_and_b32 s9, s49, 0xffff
  s_mov_b32 s10, 0x100
  s_mov_b32 s11, 0x20000
  v_and_b32 v1, 3, v0
  v_lshlrev_b32 v1, 6, v1
L_gate_514:
  buffer_load_dword v126, v1, s[8:11], 0 offen offset:8 sc1
  s_waitcnt vmcnt(0)
  v_cmp_gt_u32 vcc, 48, v126
  s_cbranch_vccz L_gateok_515
  s_add_u32 s72, s72, 1
  s_cmp_gt_u32 s72, 0x80000
  s_cbranch_scc1 L_exit
  s_sleep 2
  s_branch L_gate_514
L_gateok_515:
L_poll_516:
  buffer_load_dword v126, v15, s[4:7], s80 offen sc1
  s_waitcnt vmcnt(0)
  v_cmp_eq_u32 vcc, 0, v126
  s_cbranch_vccz L_pollok_517
  s_add_u32 s72, s72, 1
  s_cmp_gt_u32 s72, 0x80000
  s_cbranch_scc1 L_exit
  s_sleep 1
  s_branch L_poll_516
L_pollok_517:
  s_mov_b32 m0, s68
  s_add_u32 s61, s78, 0x1000000
  buffer_load_dwordx4 v3, s[4:7], s78 offen sc1 lds
  buffer_load_dwordx4 v3, s[4:7], s78 offen offset:1024 sc1 lds
  buffer_load_dwordx4 v[28:31], v7, s[4:7], s61 offen sc1
  buffer_load_dwordx4 v[32:35], v7, s[4:7], s61 offen offset:256 sc1
  s_mov_b32 s8, s26
  s_and_b32 s9, s27, 0xffff
  s_mov_b32 s10, 0x2000
  s_mov_b32 s11, 0x20000
  v_mov_b32 v23, 0x0
  v_bfe_i32 v1, v0, 0, 1
  v_and_b32 v1, 0x10, v1
  v_add_u32 v23, v23, v1
  v_bfe_i32 v1, v0, 1, 1
  v_and_b32 v1, 0x400, v1
  v_add_u32 v23, v23, v1
  v_bfe_i32 v1, v0, 2, 1
  v_and_b32 v1, 0x800, v1
  v_add_u32 v23, v23, v1
  v_bfe_i32 v1, v0, 3, 1
  v_and_b32 v1, 0x1000, v1
  v_add_u32 v23, v23, v1
  v_bfe_i32 v1, v0, 4, 1
  v_and_b32 v1, 0x20, v1
  v_add_u32 v23, v23, v1
  v_bfe_i32 v1, v0, 5, 1
  v_and_b32 v1, 0x40, v1
  v_add_u32 v23, v23, v1
  v_bfe_i32 v1, v0, 6, 1
  v_and_b32 v1, 0x100, v1
  v_add_u32 v23, v23, v1
  v_bfe_i32 v1, v0, 7, 1
  v_and_b32 v1, 0x200, v1
  v_add_u32 v23, v23, v1
  buffer_load_dwordx4 v[44:47], v23, s[8:11], 0 offen offset:0
  buffer_load_dwordx4 v[48:51], v23, s[8:11], 0 offen offset:128
  buffer_load_dword v126, v15, s[4:7], s80 offen offset:512 sc1
  s_waitcnt vmcnt(0)
  ds_write_b128 v3, v[44:47]
  ds_write_b128 v3, v[48:51] offset:1024
  s_branch L_ch_have_512
L_ch_top_518:
L_ch_pm_519:
  buffer_load_dwordx4 v[44:47], v3, s[4:7], s76 offen sc1
  buffer_load_dwordx4 v[48:51], v3, s[4:7], s76 offen offset:1024 sc1
  s_waitcnt vmcnt(1)
  v_max3_u32 v1, v44, v45, v46
  s_waitcnt vmcnt(0)
  v_max3_u32 v124, v48, v49, v50
  v_max3_u32 v1, v1, v47, v51
  v_max_u32_e64 v1, v1, v124
  v_cmp_eq_u32 vcc, -1, v1
  s_cbranch_vccnz L_ch_pmr_520
  ds_write_b128 v3, v[44:47]
  ds_write_b128 v3, v[48:51] offset:1024
  s_add_u32 s76, s76, 8192
L_ch_have_512:
  s_add_u32 s74, s55, 1
  s_cmp_lt_u32 s74, 64
  s_cselect_b32 s61, 0x40000, 0
  s_cselect_b32 s62, 512, 0
  s_waitcnt lgkmcnt(0)
  s_barrier
  ds_read_b128 v[44:47], v4 offset:0
  ds_read_b128 v[48:51], v4 offset:1024
  ds_read_b128 v[52:55], v4 offset:2048
  ds_read_b128 v[56:59], v4 offset:3072
  ds_read_b128 v[60:63], v4 offset:4096
  ds_read_b128 v[64:67], v4 offset:5120
  ds_read_b128 v[68:71], v4 offset:6144
  ds_read_b128 v[72:75], v4 offset:7168
  s_add_u32 s78, s78, s61
  s_add_u32 s80, s80, s62
  s_xor_b32 s68, s68, 0x2000
  v_cmp_eq_u32 vcc, 0, v126
  s_cbranch_vccnz L_ch_kvslow_521
L_ch_kvback_522:
  s_mov_b32 m0, s68
  s_add_u32 s61, s78, 0x1000000
  s_add_u32 s62, s79, 0x80000
  s_cmp_lt_u32 s55, 60
  s_cselect_b32 s62, s62, 0xeff0000
  s_waitcnt lgkmcnt(7)
  v_smfmac_f32_16x16x64_bf16 v[76:79], v[44:47], a[0:7], v2
  v_smfmac_f32_16x16x64_bf16 v[80:83], v[44:47], a[64:71], v2
  s_waitcnt lgkmcnt(6)
  v_smfmac_f32_16x16x64_bf16 v[76:79], v[48:51], a[8:15], v2
  v_mov_b32 v36, -1
  v_smfmac_f32_16x16x64_bf16 v[80:83], v[48:51], a[72:79], v2
  buffer_load_dwordx4 v3, s[4:7], s78 offen sc1 lds
  s_waitcnt lgkmcnt(5)
  v_smfmac_f32_16x16x64_bf16 v[76:79], v[52:55], a[16:23], v2
  v_mov_b32 v37, -1
  v_smfmac_f32_16x16x64_bf16 v[80:83], v[52:55], a[80:87], v2
  s_waitcnt lgkmcnt(4)
  v_smfmac_f32_16x16x64_bf16 v[76:79], v[56:59], a[24:31], v2
  v_mov_b32 v38, -1
  v_smfmac_f32_16x16x64_bf16 v[80:83], v[56:59], a[88:95], v2
  buffer_load_dwordx4 v3, s[4:7], s78 offen offset:1024 sc1 lds
  s_waitcnt lgkmcnt(3)
  v_smfmac_f32_16x16x64_bf16 v[76:79], v[60:63], a[32:39], v2
  v_mov_b32 v39, -1
  v_smfmac_f32_16x16x64_bf16 v[80:83], v[60:63], a[96:103], v2
  s_waitcnt lgkmcnt(2)
  v_smfmac_f32_16x16x64_bf16 v[76:79], v[64:67], a[40:47], v2
  v_smfmac_f32_16x16x64_bf16 v[80:83], v[64:67], a[104:111], v2
  buffer_store_dwordx4 v[36:39], v21, s[4:7], s62 offen sc1
  s_waitcnt lgkmcnt(1)
  v_smfmac_f32_16x16x64_bf16 v[76:79], v[68:71], a[48:55], v2
  v_smfmac_f32_16x16x64_bf16 v[80:83], v[68:71], a[112:119], v2
  s_waitcnt lgkmcnt(0)
  v_smfmac_f32_16x16x64_bf16 v[76:79], v[72:75], a[56:63], v2
  v_smfmac_f32_16x16x64_bf16 v[80:83], v[72:75], a[120:127], v2
  buffer_load_dwordx4 v[36:39], v7, s[4:7], s61 offen sc1
  v_smfmac_f32_16x16x64_bf16 v[84:87], v[44:47], a[128:135], v2
  v_smfmac_f32_16x16x64_bf16 v[88:91], v[44:47], a[192:199], v2
  buffer_load_dwordx4 v[40:43], v7, s[4:7], s61 offen offset:256 sc1
  s_nop 0
  v_smfmac_f32_16x16x64_bf16 v[84:87], v[48:51], a[136:143], v2
  v_smfmac_f32_16x16x64_bf16 v[88:91], v[48:51], a[200:207], v2
  buffer_load_dword v126, v15, s[4:7], s80 offen offset:512 sc1
  s_nop 0
  v_smfmac_f32_16x16x64_bf16 v[84:87], v[52:55], a[144:151], v2
  v_add_f32 v76, v76, v77
  v_smfmac_f32_16x16x64_bf16 v[88:91], v[52:55], a[208:215], v2
  v_add_f32 v78, v78, v79
  v_smfmac_f32_16x16x64_bf16 v[84:87], v[56:59], a[152:159], v2
  v_add_f32 v80, v80, v81
  v_smfmac_f32_16x16x64_bf16 v[88:91], v[56:59], a[216:223], v2
  v_add_f32 v82, v82, v83
  v_smfmac_f32_16x16x64_bf16 v[84:87], v[60:63], a[160:167], v2
  v_mul_f32 v76, s81, v76
  v_smfmac_f32_16x16x64_bf16 v[88:91], v[60:63], a[224:231], v2
  v_mul_f32 v78, s81, v78
  v_smfmac_f32_16x16x64_bf16 v[84:87], v[64:67], a[168:175], v2
  v_mul_f32 v80, s81, v80
  v_smfmac_f32_16x16x64_bf16 v[88:91], v[64:67], a[232:239], v2
  v_mul_f32 v82, s81, v82
  v_smfmac_f32_16x16x64_bf16 v[84:87], v[68:71], a[176:183], v2
  v_cvt_pk_bf16_f32 v76, v76, v78
  v_smfmac_f32_16x16x64_bf16 v[88:91], v[68:71], a[240:247], v2
  v_cvt_pk_bf16_f32 v77, v80, v82
  v_smfmac_f32_16x16x64_bf16 v[84:87], v[72:75], a[184:191], v2
  ds_write2_b32 v8, v76, v77 offset0:1 offset1:129
  v_smfmac_f32_16x16x64_bf16 v[88:91], v[72:75], a[248:255], v2
  buffer_load_dword v22, v12, s[4:7], s77 offen sc1
  v_smfmac_f32_16x16x64_bf16 v[92:95], v[44:47], v[128:135], v2
  v_smfmac_f32_16x16x64_bf16 v[96:99], v[44:47], v[100:107], v2
  ds_read_b128 v[100:103], v5 offset:38912
  v_smfmac_f32_16x16x64_bf16 v[92:95], v[48:51], v[136:143], v2
  ds_read_b128 v[104:107], v5 offset:39936
  v_smfmac_f32_16x16x64_bf16 v[96:99], v[48:51], v[108:115], v2
  ds_read_b128 v[108:111], v5 offset:40960
  s_nop 0
  v_add_f32 v84, v84, v85
  v_add_f32 v86, v86, v87
  v_add_f32 v88, v88, v89
  v_add_f32_e64 v90, v90, v91
  v_cvt_pk_bf16_f32 v84, v84, v86
  v_cvt_pk_bf16_f32 v85, v88, v90
  ds_write2_b32 v8, v84, v85 offset0:0 offset1:128
  v_smfmac_f32_16x16x64_bf16 v[92:95], v[52:55], v[144:151], v2
  ds_read_b128 v[112:115], v5 offset:41984
  v_smfmac_f32_16x16x64_bf16 v[96:99], v[52:55], v[116:123], v2
  ds_read_b128 v[44:47], v6 offset:0
  buffer_store_dword v84, v14, s[4:7], s79 offen sc1
  buffer_store_dword v85, v14, s[4:7], s79 offen offset:256 sc1
  s_waitcnt lgkmcnt(2)
  s_barrier
  ds_read_b64_tr_b16 v[76:77], v9 offset:0
  ds_read_b64_tr_b16 v[78:79], v9 offset:256
  ds_read_b64_tr_b16 v[80:81], v9 offset:1024
  ds_read_b64_tr_b16 v[82:83], v9 offset:1280
  ds_read_b64_tr_b16 v[84:85], v9 offset:2048
  ds_read_b64_tr_b16 v[86:87], v9 offset:2304
  ds_read_b64_tr_b16 v[88:89], v9 offset:3072
  ds_read_b64_tr_b16 v[90:91], v9 offset:3328
  v_smfmac_f32_16x16x64_bf16 v[92:95], v[56:59], v[152:159], v2
  ds_read_b128 v[116:119], v5 offset:43008
  v_smfmac_f32_16x16x64_bf16 v[96:99], v[56:59], v[100:107], v2
  ds_read_b128 v[120:123], v5 offset:44032
  v_smfmac_f32_16x16x64_bf16 v[92:95], v[60:63], v[160:167], v2
  ds_read_b128 v[48:51], v6 offset:128
  s_waitcnt lgkmcnt(12)
  v_smfmac_f32_16x16x64_bf16 v[96:99], v[60:63], v[108:115], v2
  ds_read_b128 v[100:103], v5 offset:45056
  v_smfmac_f32_16x16x64_bf16 v[92:95], v[64:67], v[168:175], v2
  ds_read_b128 v[104:107], v5 offset:46080
  s_waitcnt lgkmcnt(3)
  v_smfmac_f32_16x16x64_bf16 v[96:99], v[64:67], v[116:123], v2
  ds_read_b128 v[108:111], v5 offset:47104
  v_mfma_f32_16x16x32_bf16 v[116:119], v[44:47], v[76:79], 0
  ds_read_b128 v[112:115], v5 offset:48128
  s_waitcnt lgkmcnt(4)
  v_mfma_f32_16x16x32_bf16 v[120:123], v[48:51], v[76:79], 0
  ds_read_b128 v[52:55], v6 offset:2048
  v_smfmac_f32_16x16x64_bf16 v[92:95], v[68:71], v[176:183], v2
  ds_read_b128 v[56:59], v6 offset:2176
  s_waitcnt lgkmcnt(4)
  v_smfmac_f32_16x16x64_bf16 v[96:99], v[68:71], v[100:107], v2
  ds_read_b128 v[60:63], v6 offset:4096
  v_mfma_f32_16x16x32_bf16 v[100:103], v[76:79], v[76:79], 0
  ds_read_b128 v[64:67], v6 offset:4224
  v_smfmac_f32_16x16x64_bf16 v[92:95], v[72:75], v[184:191], v2
  ds_read_b128 v[68:71], v6 offset:6144
  s_waitcnt lgkmcnt(5)
  v_smfmac_f32_16x16x64_bf16 v[96:99], v[72:75], v[108:115], v2
  ds_read_b128 v[72:75], v6 offset:6272
  v_mfma_f32_16x16x32_bf16 v[100:103], v[80:83], v[80:83], v[100:103]
  ds_read_b128 v[44:47], v13 offset:0
  s_waitcnt lgkmcnt(6)
  v_mfma_f32_16x16x32_bf16 v[116:119], v[52:55], v[80:83], v[116:119]
  ds_read_b128 v[48:51], v13 offset:1024
  s_waitcnt lgkmcnt(6)
  v_mfma_f32_16x16x32_bf16 v[120:123], v[56:59], v[80:83], v[120:123]
  v_mov_b32 v109, 0
  v_mfma_f32_16x16x32_bf16 v[100:103], v[84:87], v[84:87], v[100:103]
  ds_read_b128 v[52:55], v13 offset:2048
  s_waitcnt lgkmcnt(6)
  v_mfma_f32_16x16x32_bf16 v[116:119], v[60:63], v[84:87], v[116:119]
  ds_read_b128 v[56:59], v13 offset:3072
  s_waitcnt lgkmcnt(6)
  v_mfma_f32_16x16x32_bf16 v[120:123], v[64:67], v[84:87], v[120:123]
  v_mov_b32 v111, 0
  v_mfma_f32_16x16x32_bf16 v[100:103], v[88:91], v[88:91], v[100:103]
  ds_read_b128 v[60:63], v13 offset:4096
  s_waitcnt lgkmcnt(6)
  v_mfma_f32_16x16x32_bf16 v[116:119], v[68:71], v[88:91], v[116:119]
  ds_read_b128 v[64:67], v13 offset:5120
  s_waitcnt lgkmcnt(6)
  v_mfma_f32_16x16x32_bf16 v[120:123], v[72:75], v[88:91], v[120:123]
  v_add_f32 v92, v92, v93
  v_add_f32 v94, v94, v95
  v_add_f32 v96, v96, v97
  v_add_f32 v98, v98, v99
  v_cvt_pk_bf16_f32 v108, v92, v94
  v_cvt_pk_bf16_f32 v110, v96, v98
  s_nop 0
  v_max3_f32 v124, v100, v101, v116
  v_max3_f32 v124, v124, v117, v118
  v_max3_f32 v125, v119, v120, v121
  v_max3_f32 v124, v124, v122, v123
  v_max_f32 v124, v124, v125
  v_mov_b32 v125, v124
  ds_read_b128 v[68:71], v13 offset:6144
  buffer_store_dword v108, v14, s[4:7], s79 offen offset:2048 sc1
  v_permlane16_swap_b32 v124, v125
  v_mov_b32 v113, 0
  v_max_f32 v124, v124, v125
  v_mov_b32 v125, v124
  ds_read_b128 v[72:75], v13 offset:7168
  buffer_store_dword v110, v14, s[4:7], s79 offen offset:2304 sc1
  v_permlane32_swap_b32 v124, v125
  s_add_u32 s79, s79, 0x20000
  v_max_f32 v124, v124, v125
  v_sub_f32 v116, v116, v124
  v_sub_f32 v117, v117, v124
  v_exp_f32 v116, v116
  v_sub_f32 v118, v118, v124
  v_exp_f32 v117, v117
  v_sub_f32 v119, v119, v124
  v_exp_f32 v118, v118
  v_cvt_pk_bf16_f32 v104, v116, v117
  v_sub_f32 v120, v120, v124
  v_exp_f32 v119, v119
  v_sub_f32 v121, v121, v124
  v_exp_f32 v120, v120
  v_cvt_pk_bf16_f32 v105, v118, v119
  v_sub_f32 v122, v122, v124
  v_exp_f32 v121, v121
  v_sub_f32 v123, v123, v124
  v_exp_f32 v122, v122
  v_cvt_pk_bf16_f32 v106, v120, v121
  v_sub_f32 v100, v100, v124
  v_exp_f32 v123, v123
  v_sub_f32 v101, v101, v124
  v_exp_f32 v100, v100
  v_cvt_pk_bf16_f32 v107, v122, v123
  v_exp_f32 v101, v101
  s_nop 0
  v_mfma_f32_16x16x32_bf16 v[84:87], v[16:19], v[104:107], 0
  v_cvt_pk_bf16_f32 v112, v100, v101
  v_mfma_f32_16x16x32_bf16 v[76:79], v[28:31], v[104:107], 0
  v_mov_b32 v96, 0
  v_mfma_f32_16x16x32_bf16 v[80:83], v[32:35], v[104:107], 0
  v_mov_b32 v97, 0
  s_nop 0
  v_mfma_f32_16x16x16_bf16 v[84:87], v[16:17], v[112:113], v[84:87]
  v_mov_b32 v98, 0
  v_mfma_f32_16x16x16_bf16 v[76:79], v[108:109], v[112:113], v[76:79]
  v_mov_b32 v99, 0
  v_mfma_f32_16x16x16_bf16 v[80:83], v[110:111], v[112:113], v[80:83]
  v_mov_b32 v100, 0
  v_mov_b32 v101, 0
  v_mov_b32 v102, 0
  v_mov_b32 v103, 0
  v_rcp_f32 v124, v84
  s_mov_b64 exec, s[84:85]
  v_mul_f32 v76, v76, v124
  v_mul_f32 v77, v77, v124
  v_mul_f32 v78, v78, v124
  v_mul_f32 v79, v79, v124
  v_cvt_pk_bf16_f32 v84, v76, v77
  v_cvt_pk_bf16_f32 v85, v78, v79
  v_mul_f32 v80, v80, v124
  v_mul_f32 v81, v81, v124
  v_mul_f32 v82, v82, v124
  v_mul_f32 v83, v83, v124
  v_cvt_pk_bf16_f32 v86, v80, v81
  v_cvt_pk_bf16_f32 v87, v82, v83
  ds_write_b128 v10, v[84:87]
  s_mov_b64 exec, -1
  v_pk_mov_b32 v[92:93], 0, 0
  v_pk_mov_b32 v[94:95], 0, 0
  v_pk_mov_b32 v[104:105], 0, 0
  v_pk_mov_b32 v[106:107], 0, 0
  v_pk_mov_b32 v[108:109], 0, 0
  v_pk_mov_b32 v[110:111], 0, 0
  s_waitcnt lgkmcnt(0)
  s_barrier
  ds_read_b128 v[76:79], v4 offset:14336
  ds_read_b128 v[80:83], v4 offset:15360
  v_pk_mov_b32 v[112:113], 0, 0
  v_pk_mov_b32 v[114:115], 0, 0
  v_pk_mov_b32 v[116:117], 0, 0
  v_pk_mov_b32 v[118:119], 0, 0
  v_pk_mov_b32 v[120:121], 0, 0
  v_pk_mov_b32 v[122:123], 0, 0
  v_xor_b32 v6, 0x2000, v6
  s_waitcnt lgkmcnt(0)
  v_smfmac_f32_16x16x64_bf16 v[108:111], v[76:79], v[44:51], v2
  ds_read_b128 v[44:47], v13 offset:8192
  v_smfmac_f32_16x16x64_bf16 v[108:111], v[80:83], v[52:59], v2
  ds_read_b128 v[48:51], v13 offset:9216
  v_smfmac_f32_16x16x64_bf16 v[112:115], v[76:79], v[60:67], v2
  ds_read_b128 v[52:55], v13 offset:10240
  v_smfmac_f32_16x16x64_bf16 v[112:115], v[80:83], v[68:75], v2
  ds_read_b128 v[56:59], v13 offset:11264
  v_smfmac_f32_16x16x64_bf16 v[92:95], v[76:79], v[192:199], v2
  ds_read_b128 v[60:63], v13 offset:12288
  v_smfmac_f32_16x16x64_bf16 v[92:95], v[80:83], v[200:207], v2
  ds_read_b128 v[64:67], v13 offset:13312
  v_smfmac_f32_16x16x64_bf16 v[96:99], v[76:79], v[208:215], v2
  ds_read_b128 v[68:71], v13 offset:14336
  v_smfmac_f32_16x16x64_bf16 v[96:99], v[80:83], v[216:223], v2
  ds_read_b128 v[72:75], v13 offset:15360
  v_smfmac_f32_16x16x64_bf16 v[100:103], v[76:79], v[224:231], v2
  v_add_f32 v108, v108, v109
  v_add_f32 v110, v110, v111
  v_smfmac_f32_16x16x64_bf16 v[100:103], v[80:83], v[232:239], v2
  v_add_f32 v112, v112, v113
  v_add_f32 v114, v114, v115
  v_smfmac_f32_16x16x64_bf16 v[104:107], v[76:79], v[240:247], v2
  v_cvt_pk_bf16_f32 v88, v108, v110
  v_and_b32 v88, -2, v88
  v_smfmac_f32_16x16x64_bf16 v[104:107], v[80:83], v[248:255], v2
  v_cvt_pk_bf16_f32 v89, v112, v114
  buffer_store_dwordx2 v[88:89], v11, s[4:7], s94 offen sc1
  s_waitcnt lgkmcnt(6)
  v_smfmac_f32_16x16x64_bf16 v[116:119], v[76:79], v[44:51], v2
  v_add_f32 v92, v92, v93
  v_add_f32 v94, v94, v95
  s_waitcnt lgkmcnt(4)
  v_smfmac_f32_16x16x64_bf16 v[116:119], v[80:83], v[52:59], v2
  v_add_f32 v96, v96, v97
  v_add_f32 v98, v98, v99
  s_waitcnt lgkmcnt(2)
  v_smfmac_f32_16x16x64_bf16 v[120:123], v[76:79], v[60:67], v2
  v_cvt_pk_bf16_f32 v84, v92, v94
  v_and_b32 v84, -2, v84
  s_waitcnt lgkmcnt(0)
  v_smfmac_f32_16x16x64_bf16 v[120:123], v[80:83], v[68:75], v2
  v_cvt_pk_bf16_f32 v85, v96, v98
  buffer_store_dwordx2 v[84:85], v11, s[4:7], s92 offen sc1
  v_add_f32 v100, v100, v101
  v_add_f32 v102, v102, v103
  v_add_f32 v104, v104, v105
  v_add_f32 v106, v106, v107
  v_cvt_pk_bf16_f32 v86, v100, v102
  v_and_b32 v86, -2, v86
  v_cvt_pk_bf16_f32 v87, v104, v106
  buffer_store_dwordx2 v[86:87], v11, s[4:7], s93 offen sc1
  v_add_f32 v116, v116, v117
  v_add_f32 v118, v118, v119
  v_add_f32 v120, v120, v121
  v_add_f32 v122, v122, v123
  v_cvt_pk_bf16_f32 v90, v116, v118
  v_and_b32 v90, -2, v90
  v_cvt_pk_bf16_f32 v91, v120, v122
  buffer_store_dwordx2 v[90:91], v11, s[4:7], s95 offen sc1
  ds_read_b128 v[100:103], v5 offset:32768
  ds_read_b128 v[104:107], v5 offset:33792
  ds_read_b128 v[108:111], v5 offset:34816
  ds_read_b128 v[112:115], v5 offset:35840
  ds_read_b128 v[116:119], v5 offset:36864
  ds_read_b128 v[120:123], v5 offset:37888
  v_pk_mov_b32 v[76:77], 0, 0
  v_pk_mov_b32 v[78:79], 0, 0
  v_pk_mov_b32 v[80:81], 0, 0
  v_pk_mov_b32 v[82:83], 0, 0
  v_pk_mov_b32 v[84:85], 0, 0
  v_pk_mov_b32 v[86:87], 0, 0
  v_pk_mov_b32 v[88:89], 0, 0
  v_pk_mov_b32 v[90:91], 0, 0
  v_pk_mov_b32 v[96:97], 0, 0
  v_pk_mov_b32 v[98:99], 0, 0
  s_cmp_ge_u32 s58, 2
  s_cbranch_scc1 L_ch_z_525
  s_sleep 2
L_ch_pr_523:
  buffer_load_dwordx4 v[44:47], v20, s[4:7], s67 offen offset:0 sc1
  buffer_load_dwordx4 v[48:51], v20, s[4:7], s67 offen offset:1024 sc1
  buffer_load_dwordx4 v[52:55], v20, s[4:7], s67 offen offset:2048 sc1
  buffer_load_dwordx4 v[56:59], v20, s[4:7], s67 offen offset:3072 sc1
  s_waitcnt vmcnt(3)
  v_mfma_f32_16x16x32_bf16 v[92:95], v[44:47], v[24:27], 0
  v_or_b32 v1, v44, v46
  s_waitcnt vmcnt(2)
  v_mfma_f32_16x16x32_bf16 v[92:95], v[48:51], v[24:27], v[92:95]
  v_bitop3_b32 v1, v1, v48, v50 bitop3:0xfe
  s_waitcnt vmcnt(1)
  v_mfma_f32_16x16x32_bf16 v[92:95], v[52:55], v[24:27], v[92:95]
  v_bitop3_b32 v1, v1, v52, v54 bitop3:0xfe
  s_waitcnt vmcnt(0)
  v_mfma_f32_16x16x32_bf16 v[92:95], v[56:59], v[24:27], v[92:95]
  v_bitop3_b32 v1, v1, v56, v58 bitop3:0xfe
  v_and_b32 v1, 1, v1
  v_cmp_ne_u32 vcc, 0, v1
  s_cbranch_vccnz L_ch_prs_524
  s_mov_b64 exec, s[82:83]
  s_nop 2
  v_add_f32 v92, v92, v93
  v_add_f32 v94, v94, v95
  v_cvt_pk_bf16_f32 v23, v92, v94
  buffer_store_dword v23, v12, s[4:7], s77 offen sc1
  s_mov_b64 exec, -1
L_ch_z_525:
  s_barrier
  v_pk_mov_b32 v[92:93], 0, 0
  v_pk_mov_b32 v[94:95], 0, 0
  s_add_u32 s77, s77, 8192
  s_mov_b32 s55, s74
  s_sleep 2
L_ch_pm_526:
  buffer_load_dwordx4 v[44:47], v3, s[4:7], s76 offen sc1
  buffer_load_dwordx4 v[48:51], v3, s[4:7], s76 offen offset:1024 sc1
  s_waitcnt vmcnt(1)
  v_max3_u32 v1, v44, v45, v46
  s_waitcnt vmcnt(0)
  v_max3_u32 v124, v48, v49, v50
  v_max3_u32 v1, v1, v47, v51
  v_max_u32 v1, v1, v124
  v_cmp_eq_u32 vcc, -1, v1
  s_cbranch_vccnz L_ch_pmr_527
  ds_write_b128 v3, v[44:47]
  ds_write_b128 v3, v[48:51] offset:1024
  s_add_u32 s76, s76, 8192
  s_add_u32 s74, s55, 1
  s_cmp_lt_u32 s74, 64
  s_cselect_b32 s61, 0x40000, 0
  s_cselect_b32 s62, 512, 0
  s_waitcnt lgkmcnt(0)
  s_barrier
  ds_read_b128 v[44:47], v4 offset:0
  ds_read_b128 v[48:51], v4 offset:1024
  ds_read_b128 v[52:55], v4 offset:2048
  ds_read_b128 v[56:59], v4 offset:3072
  ds_read_b128 v[60:63], v4 offset:4096
  ds_read_b128 v[64:67], v4 offset:5120
  ds_read_b128 v[68:71], v4 offset:6144
  ds_read_b128 v[72:75], v4 offset:7168
  s_add_u32 s78, s78, s61
  s_add_u32 s80, s80, s62
  s_xor_b32 s68, s68, 0x2000
  v_cmp_eq_u32 vcc, 0, v126
  s_cbranch_vccnz L_ch_kvslow_528
L_ch_kvback_529:
  s_mov_b32 m0, s68
  s_add_u32 s61, s78, 0x1000000
  s_add_u32 s62, s79, 0x80000
  s_cmp_lt_u32 s55, 60
  s_cselect_b32 s62, s62, 0xeff0000
  s_waitcnt lgkmcnt(7)
  v_smfmac_f32_16x16x64_bf16 v[76:79], v[44:47], a[0:7], v2
  v_smfmac_f32_16x16x64_bf16 v[80:83], v[44:47], a[64:71], v2
  s_waitcnt lgkmcnt(6)
  v_smfmac_f32_16x16x64_bf16 v[76:79], v[48:51], a[8:15], v2
  v_mov_b32 v28, -1
  v_smfmac_f32_16x16x64_bf16 v[80:83], v[48:51], a[72:79], v2
  buffer_load_dwordx4 v3, s[4:7], s78 offen sc1 lds
  s_waitcnt lgkmcnt(5)
  v_smfmac_f32_16x16x64_bf16 v[76:79], v[52:55], a[16:23], v2
  v_mov_b32 v29, -1
  v_smfmac_f32_16x16x64_bf16 v[80:83], v[52:55], a[80:87], v2
  s_waitcnt lgkmcnt(4)
  v_smfmac_f32_16x16x64_bf16 v[76:79], v[56:59], a[24:31], v2
  v_mov_b32 v30, -1
  v_smfmac_f32_16x16x64_bf16 v[80:83], v[56:59], a[88:95], v2
  buffer_load_dwordx4 v3, s[4:7], s78 offen offset:1024 sc1 lds
  s_waitcnt lgkmcnt(3)
  v_smfmac_f32_16x16x64_bf16 v[76:79], v[60:63], a[32:39], v2
  v_mov_b32 v31, -1
  v_smfmac_f32_16x16x64_bf16 v[80:83], v[60:63], a[96:103], v2
  s_waitcnt lgkmcnt(2)
  v_smfmac_f32_16x16x64_bf16 v[76:79], v[64:67], a[40:47], v2
  v_smfmac_f32_16x16x64_bf16 v[80:83], v[64:67], a[104:111], v2
  buffer_store_dwordx4 v[28:31], v21, s[4:7], s62 offen sc1
  s_waitcnt lgkmcnt(1)
  v_smfmac_f32_16x16x64_bf16 v[76:79], v[68:71], a[48:55], v2
  v_smfmac_f32_16x16x64_bf16 v[80:83], v[68:71], a[112:119], v2
  s_waitcnt lgkmcnt(0)
  v_smfmac_f32_16x16x64_bf16 v[76:79], v[72:75], a[56:63], v2
  v_smfmac_f32_16x16x64_bf16 v[80:83], v[72:75], a[120:127], v2
  buffer_load_dwordx4 v[28:31], v7, s[4:7], s61 offen sc1
  v_smfmac_f32_16x16x64_bf16 v[84:87], v[44:47], a[128:135], v2
  v_smfmac_f32_16x16x64_bf16 v[88:91], v[44:47], a[192:199], v2
  buffer_load_dwordx4 v[32:35], v7, s[4:7], s61 offen offset:256 sc1
  s_nop 0
  v_smfmac_f32_16x16x64_bf16 v[84:87], v[48:51], a[136:143], v2
  v_smfmac_f32_16x16x64_bf16 v[88:91], v[48:51], a[200:207], v2
  buffer_load_dword v126, v15, s[4:7], s80 offen offset:512 sc1
  s_nop 0
  v_smfmac_f32_16x16x64_bf16 v[84:87], v[52:55], a[144:151], v2
  v_add_f32 v76, v76, v77
  v_smfmac_f32_16x16x64_bf16 v[88:91], v[52:55], a[208:215], v2
  v_add_f32 v78, v78, v79
  v_smfmac_f32_16x16x64_bf16 v[84:87], v[56:59], a[152:159], v2
  v_add_f32 v80, v80, v81
  v_smfmac_f32_16x16x64_bf16 v[88:91], v[56:59], a[216:223], v2
  v_add_f32 v82, v82, v83
  v_smfmac_f32_16x16x64_bf16 v[84:87], v[60:63], a[160:167], v2
  v_mul_f32 v76, s81, v76
  v_smfmac_f32_16x16x64_bf16 v[88:91], v[60:63], a[224:231], v2
  v_mul_f32 v78, s81, v78
  v_smfmac_f32_16x16x64_bf16 v[84:87], v[64:67], a[168:175], v2
  v_mul_f32 v80, s81, v80
  v_smfmac_f32_16x16x64_bf16 v[88:91], v[64:67], a[232:239], v2
  v_mul_f32 v82, s81, v82
  v_smfmac_f32_16x16x64_bf16 v[84:87], v[68:71], a[176:183], v2
  v_cvt_pk_bf16_f32 v76, v76, v78
  v_smfmac_f32_16x16x64_bf16 v[88:91], v[68:71], a[240:247], v2
  v_cvt_pk_bf16_f32 v77, v80, v82
  v_smfmac_f32_16x16x64_bf16 v[84:87], v[72:75], a[184:191], v2
  ds_write2_b32 v8, v76, v77 offset0:1 offset1:129
  v_smfmac_f32_16x16x64_bf16 v[88:91], v[72:75], a[248:255], v2
  buffer_load_dword v22, v12, s[4:7], s77 offen sc1
  v_smfmac_f32_16x16x64_bf16 v[92:95], v[44:47], v[128:135], v2
  v_smfmac_f32_16x16x64_bf16 v[96:99], v[44:47], v[100:107], v2
  ds_read_b128 v[100:103], v5 offset:38912
  v_smfmac_f32_16x16x64_bf16 v[92:95], v[48:51], v[136:143], v2
  ds_read_b128 v[104:107], v5 offset:39936
  v_smfmac_f32_16x16x64_bf16 v[96:99], v[48:51], v[108:115], v2
  ds_read_b128 v[108:111], v5 offset:40960
  s_nop 0
  v_add_f32 v84, v84, v85
  v_add_f32 v86, v86, v87
  v_add_f32 v88, v88, v89
  v_add_f32_e64 v90, v90, v91
  v_cvt_pk_bf16_f32 v84, v84, v86
  v_cvt_pk_bf16_f32 v85, v88, v90
  ds_write2_b32 v8, v84, v85 offset0:0 offset1:128
  v_smfmac_f32_16x16x64_bf16 v[92:95], v[52:55], v[144:151], v2
  ds_read_b128 v[112:115], v5 offset:41984
  v_smfmac_f32_16x16x64_bf16 v[96:99], v[52:55], v[116:123], v2
  ds_read_b128 v[44:47], v6 offset:0
  buffer_store_dword v84, v14, s[4:7], s79 offen sc1
  buffer_store_dword v85, v14, s[4:7], s79 offen offset:256 sc1
  s_waitcnt lgkmcnt(2)
  s_barrier
  ds_read_b64_tr_b16 v[76:77], v9 offset:0
  ds_read_b64_tr_b16 v[78:79], v9 offset:256
  ds_read_b64_tr_b16 v[80:81], v9 offset:1024
  ds_read_b64_tr_b16 v[82:83], v9 offset:1280
  ds_read_b64_tr_b16 v[84:85], v9 offset:2048
  ds_read_b64_tr_b16 v[86:87], v9 offset:2304
  ds_read_b64_tr_b16 v[88:89], v9 offset:3072
  ds_read_b64_tr_b16 v[90:91], v9 offset:3328
  v_smfmac_f32_16x16x64_bf16 v[92:95], v[56:59], v[152:159], v2
  ds_read_b128 v[116:119], v5 offset:43008
  v_smfmac_f32_16x16x64_bf16 v[96:99], v[56:59], v[100:107], v2
  ds_read_b128 v[120:123], v5 offset:44032
  v_smfmac_f32_16x16x64_bf16 v[92:95], v[60:63], v[160:167], v2
  ds_read_b128 v[48:51], v6 offset:128
  s_waitcnt lgkmcnt(12)
  v_smfmac_f32_16x16x64_bf16 v[96:99], v[60:63], v[108:115], v2
  ds_read_b128 v[100:103], v5 offset:45056
  v_smfmac_f32_16x16x64_bf16 v[92:95], v[64:67], v[168:175], v2
  ds_read_b128 v[104:107], v5 offset:46080
  s_waitcnt lgkmcnt(3)
  v_smfmac_f32_16x16x64_bf16 v[96:99], v[64:67], v[116:123], v2
  ds_read_b128 v[108:111], v5 offset:47104
  v_mfma_f32_16x16x32_bf16 v[116:119], v[44:47], v[76:79], 0
  ds_read_b128 v[112:115], v5 offset:48128
  s_waitcnt lgkmcnt(4)
  v_mfma_f32_16x16x32_bf16 v[120:123], v[48:51], v[76:79], 0
  ds_read_b128 v[52:55], v6 offset:2048
  v_smfmac_f32_16x16x64_bf16 v[92:95], v[68:71], v[176:183], v2
  ds_read_b128 v[56:59], v6 offset:2176
  s_waitcnt lgkmcnt(4)
  v_smfmac_f32_16x16x64_bf16 v[96:99], v[68:71], v[100:107], v2
  ds_read_b128 v[60:63], v6 offset:4096
  v_mfma_f32_16x16x32_bf16 v[100:103], v[76:79], v[76:79], 0
  ds_read_b128 v[64:67], v6 offset:4224
  v_smfmac_f32_16x16x64_bf16 v[92:95], v[72:75], v[184:191], v2
  ds_read_b128 v[68:71], v6 offset:6144
  s_waitcnt lgkmcnt(5)
  v_smfmac_f32_16x16x64_bf16 v[96:99], v[72:75], v[108:115], v2
  ds_read_b128 v[72:75], v6 offset:6272
  v_mfma_f32_16x16x32_bf16 v[100:103], v[80:83], v[80:83], v[100:103]
  ds_read_b128 v[44:47], v13 offset:0
  s_waitcnt lgkmcnt(6)
  v_mfma_f32_16x16x32_bf16 v[116:119], v[52:55], v[80:83], v[116:119]
  ds_read_b128 v[48:51], v13 offset:1024
  s_waitcnt lgkmcnt(6)
  v_mfma_f32_16x16x32_bf16 v[120:123], v[56:59], v[80:83], v[120:123]
  v_mov_b32 v109, 0
  v_mfma_f32_16x16x32_bf16 v[100:103], v[84:87], v[84:87], v[100:103]
  ds_read_b128 v[52:55], v13 offset:2048
  s_waitcnt lgkmcnt(6)
  v_mfma_f32_16x16x32_bf16 v[116:119], v[60:63], v[84:87], v[116:119]
  ds_read_b128 v[56:59], v13 offset:3072
  s_waitcnt lgkmcnt(6)
  v_mfma_f32_16x16x32_bf16 v[120:123], v[64:67], v[84:87], v[120:123]
  v_mov_b32 v111, 0
  v_mfma_f32_16x16x32_bf16 v[100:103], v[88:91], v[88:91], v[100:103]
  ds_read_b128 v[60:63], v13 offset:4096
  s_waitcnt lgkmcnt(6)
  v_mfma_f32_16x16x32_bf16 v[116:119], v[68:71], v[88:91], v[116:119]
  ds_read_b128 v[64:67], v13 offset:5120
  s_waitcnt lgkmcnt(6)
  v_mfma_f32_16x16x32_bf16 v[120:123], v[72:75], v[88:91], v[120:123]
  v_add_f32 v92, v92, v93
  v_add_f32 v94, v94, v95
  v_add_f32 v96, v96, v97
  v_add_f32 v98, v98, v99
  v_cvt_pk_bf16_f32 v108, v92, v94
  v_cvt_pk_bf16_f32 v110, v96, v98
  s_nop 0
  v_max3_f32 v124, v100, v101, v116
  v_max3_f32 v124, v124, v117, v118
  v_max3_f32 v125, v119, v120, v121
  v_max3_f32 v124, v124, v122, v123
  v_max_f32 v124, v124, v125
  v_mov_b32 v125, v124
  ds_read_b128 v[68:71], v13 offset:6144
  buffer_store_dword v108, v14, s[4:7], s79 offen offset:2048 sc1
  v_permlane16_swap_b32 v124, v125
  v_mov_b32 v113, 0
  v_max_f32 v124, v124, v125
  v_mov_b32 v125, v124
  ds_read_b128 v[72:75], v13 offset:7168
  buffer_store_dword v110, v14, s[4:7], s79 offen offset:2304 sc1
  v_permlane32_swap_b32 v124, v125
  s_add_u32 s79, s79, 0x20000
  v_max_f32 v124, v124, v125
  v_sub_f32 v116, v116, v124
  v_sub_f32 v117, v117, v124
  v_exp_f32 v116, v116
  v_sub_f32 v118, v118, v124
  v_exp_f32 v117, v117
  v_sub_f32 v119, v119, v124
  v_exp_f32 v118, v118
  v_cvt_pk_bf16_f32 v104, v116, v117
  v_sub_f32 v120, v120, v124
  v_exp_f32 v119, v119
  v_sub_f32 v121, v121, v124
  v_exp_f32 v120, v120
  v_cvt_pk_bf16_f32 v105, v118, v119
  v_sub_f32 v122, v122, v124
  v_exp_f32 v121, v121
  v_sub_f32 v123, v123, v124
  v_exp_f32 v122, v122
  v_cvt_pk_bf16_f32 v106, v120, v121
  v_sub_f32 v100, v100, v124
  v_exp_f32 v123, v123
  v_sub_f32 v101, v101, v124
  v_exp_f32 v100, v100
  v_cvt_pk_bf16_f32 v107, v122, v123
  v_exp_f32 v101, v101
  s_nop 0
  v_mfma_f32_16x16x32_bf16 v[84:87], v[16:19], v[104:107], 0
  v_cvt_pk_bf16_f32 v112, v100, v101
  v_mfma_f32_16x16x32_bf16 v[76:79], v[36:39], v[104:107], 0
  v_mov_b32 v96, 0
  v_mfma_f32_16x16x32_bf16 v[80:83], v[40:43], v[104:107], 0
  v_mov_b32 v97, 0
  s_nop 0
  v_mfma_f32_16x16x16_bf16 v[84:87], v[16:17], v[112:113], v[84:87]
  v_mov_b32 v98, 0
  v_mfma_f32_16x16x16_bf16 v[76:79], v[108:109], v[112:113], v[76:79]
  v_mov_b32 v99, 0
  v_mfma_f32_16x16x16_bf16 v[80:83], v[110:111], v[112:113], v[80:83]
  v_mov_b32 v100, 0
  v_mov_b32 v101, 0
  v_mov_b32 v102, 0
  v_mov_b32 v103, 0
  v_rcp_f32 v124, v84
  s_mov_b64 exec, s[84:85]
  v_mul_f32 v76, v76, v124
  v_mul_f32 v77, v77, v124
  v_mul_f32 v78, v78, v124
  v_mul_f32 v79, v79, v124
  v_cvt_pk_bf16_f32 v84, v76, v77
  v_cvt_pk_bf16_f32 v85, v78, v79
  v_mul_f32 v80, v80, v124
  v_mul_f32 v81, v81, v124
  v_mul_f32 v82, v82, v124
  v_mul_f32 v83, v83, v124
  v_cvt_pk_bf16_f32 v86, v80, v81
  v_cvt_pk_bf16_f32 v87, v82, v83
  ds_write_b128 v10, v[84:87]
  s_mov_b64 exec, -1
  v_pk_mov_b32 v[92:93], 0, 0
  v_pk_mov_b32 v[94:95], 0, 0
  v_pk_mov_b32 v[104:105], 0, 0
  v_pk_mov_b32 v[106:107], 0, 0
  v_pk_mov_b32 v[108:109], 0, 0
  v_pk_mov_b32 v[110:111], 0, 0
  s_waitcnt lgkmcnt(0)
  s_barrier
  ds_read_b128 v[76:79], v4 offset:14336
  ds_read_b128 v[80:83], v4 offset:15360
  v_pk_mov_b32 v[112:113], 0, 0
  v_pk_mov_b32 v[114:115], 0, 0
  v_pk_mov_b32 v[116:117], 0, 0
  v_pk_mov_b32 v[118:119], 0, 0
  v_pk_mov_b32 v[120:121], 0, 0
  v_pk_mov_b32 v[122:123], 0, 0
  v_xor_b32 v6, 0x2000, v6
  s_waitcnt lgkmcnt(0)
  v_smfmac_f32_16x16x64_bf16 v[108:111], v[76:79], v[44:51], v2
  ds_read_b128 v[44:47], v13 offset:8192
  v_smfmac_f32_16x16x64_bf16 v[108:111], v[80:83], v[52:59], v2
  ds_read_b128 v[48:51], v13 offset:9216
  v_smfmac_f32_16x16x64_bf16 v[112:115], v[76:79], v[60:67], v2
  ds_read_b128 v[52:55], v13 offset:10240
  v_smfmac_f32_16x16x64_bf16 v[112:115], v[80:83], v[68:75], v2
  ds_read_b128 v[56:59], v13 offset:11264
  v_smfmac_f32_16x16x64_bf16 v[92:95], v[76:79], v[192:199], v2
  ds_read_b128 v[60:63], v13 offset:12288
  v_smfmac_f32_16x16x64_bf16 v[92:95], v[80:83], v[200:207], v2
  ds_read_b128 v[64:67], v13 offset:13312
  v_smfmac_f32_16x16x64_bf16 v[96:99], v[76:79], v[208:215], v2
  ds_read_b128 v[68:71], v13 offset:14336
  v_smfmac_f32_16x16x64_bf16 v[96:99], v[80:83], v[216:223], v2
  ds_read_b128 v[72:75], v13 offset:15360
  v_smfmac_f32_16x16x64_bf16 v[100:103], v[76:79], v[224:231], v2
  v_add_f32 v108, v108, v109
  v_add_f32 v110, v110, v111
  v_smfmac_f32_16x16x64_bf16 v[100:103], v[80:83], v[232:239], v2
  v_add_f32 v112, v112, v113
  v_add_f32 v114, v114, v115
  v_smfmac_f32_16x16x64_bf16 v[104:107], v[76:79], v[240:247], v2
  v_cvt_pk_bf16_f32 v88, v108, v110
  v_or_b32 v88, 1, v88
  v_smfmac_f32_16x16x64_bf16 v[104:107], v[80:83], v[248:255], v2
  v_cvt_pk_bf16_f32 v89, v112, v114
  buffer_store_dwordx2 v[88:89], v11, s[4:7], s94 offen sc1
  s_waitcnt lgkmcnt(6)
  v_smfmac_f32_16x16x64_bf16 v[116:119], v[76:79], v[44:51], v2
  v_add_f32 v92, v92, v93
  v_add_f32 v94, v94, v95
  s_waitcnt lgkmcnt(4)
  v_smfmac_f32_16x16x64_bf16 v[116:119], v[80:83], v[52:59], v2
  v_add_f32 v96, v96, v97
  v_add_f32 v98, v98, v99
  s_waitcnt lgkmcnt(2)
  v_smfmac_f32_16x16x64_bf16 v[120:123], v[76:79], v[60:67], v2
  v_cvt_pk_bf16_f32 v84, v92, v94
  v_or_b32 v84, 1, v84
  s_waitcnt lgkmcnt(0)
  v_smfmac_f32_16x16x64_bf16 v[120:123], v[80:83], v[68:75], v2
  v_cvt_pk_bf16_f32 v85, v96, v98
  buffer_store_dwordx2 v[84:85], v11, s[4:7], s92 offen sc1
  v_add_f32 v100, v100, v101
  v_add_f32 v102, v102, v103
  v_add_f32 v104, v104, v105
  v_add_f32 v106, v106, v107
  v_cvt_pk_bf16_f32 v86, v100, v102
  v_or_b32 v86, 1, v86
  v_cvt_pk_bf16_f32 v87, v104, v106
  buffer_store_dwordx2 v[86:87], v11, s[4:7], s93 offen sc1
  v_add_f32 v116, v116, v117
  v_add_f32 v118, v118, v119
  v_add_f32 v120, v120, v121
  v_add_f32 v122, v122, v123
  v_cvt_pk_bf16_f32 v90, v116, v118
  v_or_b32 v90, 1, v90
  v_cvt_pk_bf16_f32 v91, v120, v122
  buffer_store_dwordx2 v[90:91], v11, s[4:7], s95 offen sc1
  s_cmp_ge_u32 s74, 64
  s_cbranch_scc1 L_ch_last_513
  ds_read_b128 v[100:103], v5 offset:32768
  ds_read_b128 v[104:107], v5 offset:33792
  ds_read_b128 v[108:111], v5 offset:34816
  ds_read_b128 v[112:115], v5 offset:35840
  ds_read_b128 v[116:119], v5 offset:36864
  ds_read_b128 v[120:123], v5 offset:37888
  v_pk_mov_b32 v[76:77], 0, 0
  v_pk_mov_b32 v[78:79], 0, 0
  v_pk_mov_b32 v[80:81], 0, 0
  v_pk_mov_b32 v[82:83], 0, 0
  v_pk_mov_b32 v[84:85], 0, 0
  v_pk_mov_b32 v[86:87], 0, 0
  v_pk_mov_b32 v[88:89], 0, 0
  v_pk_mov_b32 v[90:91], 0, 0
  v_pk_mov_b32 v[96:97], 0, 0
  v_pk_mov_b32 v[98:99], 0, 0
  s_cmp_ge_u32 s58, 2
  s_cbranch_scc1 L_ch_z_532
  s_sleep 2
L_ch_pr_530:
  buffer_load_dwordx4 v[44:47], v20, s[4:7], s67 offen offset:0 sc1
  buffer_load_dwordx4 v[48:51], v20, s[4:7], s67 offen offset:1024 sc1
  buffer_load_dwordx4 v[52:55], v20, s[4:7], s67 offen offset:2048 sc1
  buffer_load_dwordx4 v[56:59], v20, s[4:7], s67 offen offset:3072 sc1
  s_waitcnt vmcnt(3)
  v_mfma_f32_16x16x32_bf16 v[92:95], v[44:47], v[24:27], 0
  v_and_b32 v1, v44, v46
  s_waitcnt vmcnt(2)
  v_mfma_f32_16x16x32_bf16 v[92:95], v[48:51], v[24:27], v[92:95]
  v_bitop3_b32 v1, v1, v48, v50 bitop3:0x80
  s_waitcnt vmcnt(1)
  v_mfma_f32_16x16x32_bf16 v[92:95], v[52:55], v[24:27], v[92:95]
  v_bitop3_b32 v1, v1, v52, v54 bitop3:0x80
  s_waitcnt vmcnt(0)
  v_mfma_f32_16x16x32_bf16 v[92:95], v[56:59], v[24:27], v[92:95]
  v_bitop3_b32 v1, v1, v56, v58 bitop3:0x80
  v_and_b32 v1, 1, v1
  v_cmp_ne_u32 vcc, 1, v1
  s_cbranch_vccnz L_ch_prs_531
  s_mov_b64 exec, s[82:83]
  s_nop 2
  v_add_f32 v92, v92, v93
  v_add_f32 v94, v94, v95
  v_cvt_pk_bf16_f32 v23, v92, v94
  buffer_store_dword v23, v12, s[4:7], s77 offen sc1
  s_mov_b64 exec, -1
L_ch_z_532:
  s_barrier
  v_pk_mov_b32 v[92:93], 0, 0
  v_pk_mov_b32 v[94:95], 0, 0
  s_add_u32 s77, s77, 8192
  s_mov_b32 s55, s74
  s_sleep 2
  s_branch L_ch_top_518
L_ch_last_513:
  s_endpgm
L_ch_pmr_520:
  s_add_u32 s72, s72, 1
  s_cmp_gt_u32 s72, 0x80000
  s_cbranch_scc1 L_exit
  s_branch L_ch_pm_519
L_ch_kvslow_521:
L_poll_533:
  buffer_load_dword v126, v15, s[4:7], s80 offen sc1
  s_waitcnt vmcnt(0)
  v_cmp_eq_u32 vcc, 0, v126
  s_cbranch_vccz L_pollok_534
  s_add_u32 s72, s72, 1
  s_cmp_gt_u32 s72, 0x80000
  s_cbranch_scc1 L_exit
  s_sleep 1
  s_branch L_poll_533
L_pollok_534:
  s_branch L_ch_kvback_522
L_ch_prs_524:
  s_add_u32 s72, s72, 1
  s_cmp_gt_u32 s72, 0x80000
  s_cbranch_scc1 L_exit
  s_branch L_ch_pr_523
L_ch_pmr_527:
  s_add_u32 s72, s72, 1
  s_cmp_gt_u32 s72, 0x80000
  s_cbranch_scc1 L_exit
  s_branch L_ch_pm_526
L_ch_kvslow_528:
L_poll_535:
  buffer_load_dword v126, v15, s[4:7], s80 offen sc1
  s_waitcnt vmcnt(0)
  v_cmp_eq_u32 vcc, 0, v126
  s_cbranch_vccz L_pollok_536
  s_add_u32 s72, s72, 1
  s_cmp_gt_u32 s72, 0x80000
  s_cbranch_scc1 L_exit
  s_sleep 1
  s_branch L_poll_535
L_pollok_536:
  s_branch L_ch_kvback_529
L_ch_prs_531:
  s_add_u32 s72, s72, 1
  s_cmp_gt_u32 s72, 0x80000
  s_cbranch_scc1 L_exit
  s_branch L_ch_pr_530
L_exit:
  s_endpgm
.section .rodata,"a"
.p2align 6
.amdhsa_kernel interleave_layers__memory_aug_recurrent_mem_tr__glu_gated_reglu__prompt_kernel
  .amdhsa_next_free_vgpr 512
  .amdhsa_next_free_sgpr 102
  .amdhsa_accum_offset 256
  .amdhsa_group_segment_fixed_size 0
  .amdhsa_kernarg_size 112
  .amdhsa_user_sgpr_count 2
  .amdhsa_user_sgpr_kernarg_segment_ptr 1
  .amdhsa_system_sgpr_workgroup_id_x 1
.end_amdhsa_kernel
```
